```python
import torch

def _softmax(x, axis=-1):
    return torch.softmax(x, dim=axis)

def _gelu(x):
    return torch.nn.functional.gelu(x, approximate='tanh')

def _silu(x):
    return torch.nn.functional.silu(x)

def _sigmoid(x):
    return torch.sigmoid(x)

def _layernorm(x, axis=-1, eps=1e-05):
    m = x.mean(dim=axis, keepdim=True)
    v = x.var(dim=axis, keepdim=True, unbiased=False)
    return (x - m) / torch.sqrt(v + eps)

def _scatter_add(tgt, idx, src, axis=0):
    return tgt.clone().index_add_(axis, idx, src)

def _segment_sum(src, seg, n):
    out = torch.zeros((n,) + src.shape[1:], dtype=src.dtype)
    return out.index_add_(0, seg, src)

def _pad(x, pw):
    flat = tuple((v for pair in reversed(pw) for v in pair))
    return torch.nn.functional.pad(x, flat)
kernel_name = 'interleave_layers__memory_aug_recurrent_mem_tr__mixer_token_mlp__prompt'

def setup_inputs():

    _w = lambda a: (lambda t: t.to(torch.bfloat16) if t.is_floating_point() else t)(torch.as_tensor(a))

    def _A_setup():
        B, S, Dm = (1, 2048, 640)
        H, Dh = (32, 192)
        M, seg = (8, 32)
        seg = min(seg, S)
        S = S // seg * seg
        return {'x': _w((lambda *s: torch.randn(*s, dtype=torch.bfloat16) * 0.05)(B, S, Dm)), 'mem0': _w((lambda *s: torch.randn(*s, dtype=torch.bfloat16) * 0.2)(B, M, Dm)), 'Wq': _w((lambda *s: torch.randn(*s, dtype=torch.bfloat16) * 0.8)(Dm, H, Dh) * Dm ** (-0.5)), 'Wk': _w((lambda *s: torch.randn(*s, dtype=torch.bfloat16) * 0.8)(Dm, H, Dh) * Dm ** (-0.5)), 'Wv': _w((lambda *s: torch.randn(*s, dtype=torch.bfloat16) * 0.2)(Dm, H, Dh) * Dm ** (-0.5)), 'Wo': _w((lambda *s: torch.randn(*s, dtype=torch.bfloat16) * 0.2)(H, Dh, Dm) * (H * Dh) ** (-0.5)), 'seg_len': seg}
    _A_in = _A_setup()

    def _B_setup():
        B, S, D, F = (1, 2048, 640, 1536)
        return {'x': _w((lambda *s: torch.randn(*s, dtype=torch.bfloat16) * 0.05)(B, S, D)), 'w1': _w((lambda *s: torch.randn(*s, dtype=torch.bfloat16) * 0.2)(S, F) * S ** (-0.5)), 'b1': _w((lambda *s: torch.randn(*s, dtype=torch.bfloat16) * 3.2)(F) * 0.02), 'w2': _w((lambda *s: torch.randn(*s, dtype=torch.bfloat16) * 0.1)(F, S) * F ** (-0.5)), 'b2': _w((lambda *s: torch.randn(*s, dtype=torch.bfloat16) * 0.2)(S) * 0.02)}
    _B_in = _B_setup()
    return {'A_x': _A_in['x'], 'A_mem0': _A_in['mem0'], 'A_Wq': _A_in['Wq'], 'A_Wk': _A_in['Wk'], 'A_Wv': _A_in['Wv'], 'A_Wo': _A_in['Wo'], 'A_seg_len': _A_in['seg_len'], 'B_x': _B_in['x'], 'B_w1': _B_in['w1'], 'B_b1': _B_in['b1'], 'B_w2': _B_in['w2'], 'B_b2': _B_in['b2']}

def reference(A_x, A_mem0, A_Wq, A_Wk, A_Wv, A_Wo, A_seg_len, B_x, B_w1, B_b1, B_w2, B_b2):

    def _A_ref(x, mem0, Wq, Wk, Wv, Wo, seg_len):
        B, S, Dm = x.shape
        H, Dh = (Wq.shape[1], Wq.shape[2])
        M = mem0.shape[1]
        scale = Dh ** (-0.5)
        n_seg = S // seg_len
        L = M + seg_len
        idx = torch.arange(L)
        mask = (idx[:, None] < M) | (idx[:, None] >= idx[None, :])
        mem = mem0
        outs = []
        for s in range(n_seg):
            xs = x[:, s * seg_len:(s + 1) * seg_len, :].clone()
            h = torch.concatenate([mem, xs], axis=1)
            q = torch.einsum('btd,dhe->bhte', h, Wq)
            k = torch.einsum('btd,dhe->bhte', h, Wk)
            v = torch.einsum('btd,dhe->bhte', h, Wv)
            scores = torch.einsum('bhqe,bhke->bhqk', q, k) * scale
            scores = torch.where(mask[None, None], scores, -1000000000.0)
            p = _softmax(scores, axis=-1)
            o = torch.einsum('bhqk,bhke->bhqe', p, v)
            o = torch.einsum('bhte,hed->btd', o, Wo)
            mem = o[:, :M, :].clone()
            outs.append(o[:, M:, :])
        return torch.concatenate(outs, axis=1)

    def _B_ref(x, w1, b1, w2, b2):
        B, S, D = x.shape
        h = _layernorm(x, axis=-1)
        u = torch.einsum('bsd,sf->bdf', h, w1) + b1
        u = _gelu(u)
        y = torch.einsum('bdf,fs->bds', u, w2) + b2
        return (lambda x, *d: x.permute(*d))(y, 0, 2, 1)
    x = A_x
    x = x + _A_ref(_layernorm(x, axis=-1), A_mem0, A_Wq, A_Wk, A_Wv, A_Wo, A_seg_len)
    x = x + _B_ref(_layernorm(x, axis=-1), B_w1, B_b1, B_w2, B_b2)
    x = x + _A_ref(_layernorm(x, axis=-1), A_mem0, A_Wq, A_Wk, A_Wv, A_Wo, A_seg_len)
    x = x + _B_ref(_layernorm(x, axis=-1), B_w1, B_b1, B_w2, B_b2)
    return x
```

```asm
; @launch kernel=init_kernel grid=(81,1,1) block=(64,1,1) lds=0
; @launch kernel=main_kernel grid=(256,1,1) block=(256,1,1) lds=163840
.amdgcn_target "amdgcn-amd-amdhsa--gfx950"
.text
.globl init_kernel
.p2align 8
.type init_kernel,@function
init_kernel:
 s_cmp_ge_u32 s2, 81
 s_cbranch_scc0 go_1001
 s_endpgm
go_1001:
 s_load_dwordx2 s[4:5], s[0:1], 112
 s_mov_b32 s6, 268435456
 s_mov_b32 s7, 0x20000
 v_lshrrev_b32 v1, 6, v0
 s_nop 0
 v_readfirstlane_b32 s21, v1
 s_load_dwordx2 s[16:17], s[0:1], 8
 s_mov_b32 s18, 10240
 s_mov_b32 s19, 0x20000
 v_bfe_u32 v4, v0, 0, 6
 v_lshlrev_b32 v3, 4, v4
 s_lshl_b32 s91, s2, 14
 s_cmp_eq_u32 s2, 80
 s_cselect_b32 s91, 1572864, s91
 s_sub_u32 s20, s2, 40
 s_min_u32 s20, s20, s2
 s_cmp_eq_u32 s2, 80
 s_cselect_b32 s20, 8, s20
 s_waitcnt lgkmcnt(0)
 s_cmp_ge_u32 s20, 32
 s_cbranch_scc1 mbf_1002
 v_mov_b32 v16, -1
 v_mov_b32 v17, -1
 v_mov_b32 v18, -1
 v_mov_b32 v19, -1
 v_mov_b32 v20, -1
 v_mov_b32 v21, -1
 v_mov_b32 v22, -1
 v_mov_b32 v23, -1
 v_mov_b32 v24, -1
 v_mov_b32 v25, -1
 v_mov_b32 v26, -1
 v_mov_b32 v27, -1
 v_mov_b32 v28, -1
 v_mov_b32 v29, -1
 v_mov_b32 v30, -1
 v_mov_b32 v31, -1
 v_mov_b32 v32, -1
 v_mov_b32 v33, -1
 v_mov_b32 v34, -1
 v_mov_b32 v35, -1
 v_mov_b32 v36, -1
 v_mov_b32 v37, -1
 v_mov_b32 v38, -1
 v_mov_b32 v39, -1
 v_mov_b32 v40, -1
 v_mov_b32 v41, -1
 v_mov_b32 v42, -1
 v_mov_b32 v43, -1
 v_mov_b32 v44, -1
 v_mov_b32 v45, -1
 v_mov_b32 v46, -1
 v_mov_b32 v47, -1
 s_sub_u32 s92, s20, 6
 s_min_u32 s92, s92, s20
 s_cmp_ge_u32 s92, 2
 s_cbranch_scc1 mbend_1003
 v_bfe_u32 v4, v0, 0, 3
 v_mul_u32_u24 v2, 1280, v4
 v_bfe_u32 v4, v0, 3, 3
 v_lshl_add_u32 v2, v4, 4, v2
 s_lshl_b32 s90, s92, 10
 buffer_load_dwordx4 v[16:19], v2, s[16:19], s90 offen offset:0
 buffer_load_dwordx4 v[20:23], v2, s[16:19], s90 offen offset:128
 buffer_load_dwordx4 v[24:27], v2, s[16:19], s90 offen offset:256
 buffer_load_dwordx4 v[28:31], v2, s[16:19], s90 offen offset:384
 buffer_load_dwordx4 v[32:35], v2, s[16:19], s90 offen offset:512
 buffer_load_dwordx4 v[36:39], v2, s[16:19], s90 offen offset:640
 buffer_load_dwordx4 v[40:43], v2, s[16:19], s90 offen offset:768
 buffer_load_dwordx4 v[44:47], v2, s[16:19], s90 offen offset:896
 s_waitcnt vmcnt(0)
 v_min_u32 v16, -2, v16
 v_min_u32 v17, -2, v17
 v_min_u32 v18, -2, v18
 v_min_u32 v19, -2, v19
 v_min_u32 v20, -2, v20
 v_min_u32 v21, -2, v21
 v_min_u32 v22, -2, v22
 v_min_u32 v23, -2, v23
 v_min_u32 v24, -2, v24
 v_min_u32 v25, -2, v25
 v_min_u32 v26, -2, v26
 v_min_u32 v27, -2, v27
 v_min_u32 v28, -2, v28
 v_min_u32 v29, -2, v29
 v_min_u32 v30, -2, v30
 v_min_u32 v31, -2, v31
 v_min_u32 v32, -2, v32
 v_min_u32 v33, -2, v33
 v_min_u32 v34, -2, v34
 v_min_u32 v35, -2, v35
 v_min_u32 v36, -2, v36
 v_min_u32 v37, -2, v37
 v_min_u32 v38, -2, v38
 v_min_u32 v39, -2, v39
 v_min_u32 v40, -2, v40
 v_min_u32 v41, -2, v41
 v_min_u32 v42, -2, v42
 v_min_u32 v43, -2, v43
 v_min_u32 v44, -2, v44
 v_min_u32 v45, -2, v45
 v_min_u32 v46, -2, v46
 v_min_u32 v47, -2, v47
 s_branch mbend_1003
mbf_1002:
 v_mov_b32 v16, 0
 v_mov_b32 v17, 0
 v_mov_b32 v18, 0
 v_mov_b32 v19, 0
 v_mov_b32 v20, 0
 v_mov_b32 v21, 0
 v_mov_b32 v22, 0
 v_mov_b32 v23, 0
 v_mov_b32 v24, 0
 v_mov_b32 v25, 0
 v_mov_b32 v26, 0
 v_mov_b32 v27, 0
 v_mov_b32 v28, 0
 v_mov_b32 v29, 0
 v_mov_b32 v30, 0
 v_mov_b32 v31, 0
 v_mov_b32 v32, 0
 v_mov_b32 v33, 0
 v_mov_b32 v34, 0
 v_mov_b32 v35, 0
 v_mov_b32 v36, 0
 v_mov_b32 v37, 0
 v_mov_b32 v38, 0
 v_mov_b32 v39, 0
 v_mov_b32 v40, 0
 v_mov_b32 v41, 0
 v_mov_b32 v42, 0
 v_mov_b32 v43, 0
 v_mov_b32 v44, 0
 v_mov_b32 v45, 0
 v_mov_b32 v46, 0
 v_mov_b32 v47, 0
mbend_1003:
 s_add_u32 s90, s91, 0
 buffer_store_dwordx4 v[16:19], v3, s[4:7], s90 offen offset:0
 buffer_store_dwordx4 v[20:23], v3, s[4:7], s90 offen offset:1024
 buffer_store_dwordx4 v[24:27], v3, s[4:7], s90 offen offset:2048
 buffer_store_dwordx4 v[28:31], v3, s[4:7], s90 offen offset:3072
 s_add_u32 s90, s90, 4096
 buffer_store_dwordx4 v[32:35], v3, s[4:7], s90 offen offset:0
 buffer_store_dwordx4 v[36:39], v3, s[4:7], s90 offen offset:1024
 buffer_store_dwordx4 v[40:43], v3, s[4:7], s90 offen offset:2048
 buffer_store_dwordx4 v[44:47], v3, s[4:7], s90 offen offset:3072
 s_add_u32 s90, s90, 4096
 buffer_store_dwordx4 v[16:19], v3, s[4:7], s90 offen offset:0
 buffer_store_dwordx4 v[20:23], v3, s[4:7], s90 offen offset:1024
 buffer_store_dwordx4 v[24:27], v3, s[4:7], s90 offen offset:2048
 buffer_store_dwordx4 v[28:31], v3, s[4:7], s90 offen offset:3072
 s_add_u32 s90, s90, 4096
 buffer_store_dwordx4 v[32:35], v3, s[4:7], s90 offen offset:0
 buffer_store_dwordx4 v[36:39], v3, s[4:7], s90 offen offset:1024
 buffer_store_dwordx4 v[40:43], v3, s[4:7], s90 offen offset:2048
 buffer_store_dwordx4 v[44:47], v3, s[4:7], s90 offen offset:3072
 s_add_u32 s90, s90, 4096
 s_endpgm
.globl main_kernel
.p2align 8
.type main_kernel,@function
main_kernel:
 s_cmp_ge_u32 s2, 256
 s_cbranch_scc0 go_2001
 s_endpgm
go_2001:
 s_load_dwordx2 s[4:5], s[0:1], 112
 s_mov_b32 s6, 268435456
 s_mov_b32 s7, 0x20000
 v_lshrrev_b32 v1, 6, v0
 s_nop 0
 v_readfirstlane_b32 s21, v1
 s_mov_b32 s98, 0
 s_mov_b32 s3, 557056
 s_mov_b32 s18, 0
 s_mov_b32 s31, 0
 s_and_b32 s16, s2, 7
 s_lshr_b32 s17, s2, 3
 s_mov_b32 s85, 0
 s_cmp_eq_u32 s16, 0
 s_cbranch_scc1 first_s
 s_cmp_ge_u32 s16, 4
 s_cbranch_scc1 far_slots
 s_sub_u32 s20, s16, 1
 s_mul_i32 s20, s20, 27
 s_add_u32 s20, s20, s17
 s_mov_b32 s85, 1
 s_mov_b32 s22, s20
 s_cmp_lt_u32 s17, 27
 s_cselect_b32 s23, s20, 99
 s_cmp_lt_u32 s23, 80
 s_cbranch_scc1 bm_task
 s_mul_i32 s22, s16, 5
 s_add_u32 s22, s22, s17
 s_sub_u32 s22, s22, 32
 s_cmp_eq_u32 s16, 3
 s_cselect_b32 s23, 1, 0
 s_add_u32 s22, s22, s23
 s_and_b32 s17, s22, 3
 s_lshr_b32 s16, s22, 2
 s_add_u32 s16, s16, 4
 s_branch first_kv
far_slots:
 s_sub_u32 s22, s16, 4
 s_mul_i32 s22, s22, 12
 s_add_u32 s22, s22, s17
 s_add_u32 s22, s22, 80
 s_mov_b32 s85, 5
 s_cmp_lt_u32 s17, 4
 s_cbranch_scc1 bm_task
 s_sub_u32 s22, s22, 20
 s_mov_b32 s85, 4
 s_cmp_ge_u32 s17, 24
 s_cbranch_scc1 bm_task
 s_mov_b32 s85, 3
 s_cmp_ge_u32 s17, 16
 s_cbranch_scc1 first_ln
 s_mov_b32 s85, 2
 s_cmp_ge_u32 s17, 8
 s_cbranch_scc1 load_kv
first_kv:
 s_mov_b32 s85, 2
first_ln:
 s_sub_u32 s20, s16, 4
 s_lshl_b32 s20, s20, 3
 s_and_b32 s23, s17, 7
 s_add_u32 s20, s20, s23
 s_load_dwordx2 s[8:9], s[0:1], 0
 s_mov_b32 s10, 2621440
 s_mov_b32 s11, 0x20000
 s_lshr_b32 s22, s17, 4
 s_lshl_b32 s23, s20, 1
 s_add_u32 s22, s22, s23
 s_lshl_b32 s22, s22, 2
 s_add_u32 s22, s22, s21
 s_waitcnt lgkmcnt(0)
 s_lshr_b32 s90, s22, 2
 s_mul_i32 s90, s90, 40960
 s_and_b32 s91, s22, 3
 s_lshl_b32 s91, s91, 7
 s_add_u32 s90, s90, s91
 v_bfe_u32 v255, v0, 3, 3
 v_lshlrev_b32 v2, 9, v255
 v_bfe_u32 v255, v0, 0, 3
 v_lshl_add_u32 v2, v255, 4, v2
 v_bfe_u32 v255, v0, 0, 3
 v_mul_u32_u24 v3, 1280, v255
 v_bfe_u32 v255, v0, 3, 3
 v_lshl_add_u32 v3, v255, 4, v3
 s_mul_i32 s92, s22, 10240
 buffer_load_dwordx4 v[16:19], v3, s[8:11], s92 offen offset:0
 buffer_load_dwordx4 v[20:23], v3, s[8:11], s92 offen offset:128
 buffer_load_dwordx4 v[24:27], v3, s[8:11], s92 offen offset:256
 buffer_load_dwordx4 v[28:31], v3, s[8:11], s92 offen offset:384
 buffer_load_dwordx4 v[32:35], v3, s[8:11], s92 offen offset:512
 buffer_load_dwordx4 v[36:39], v3, s[8:11], s92 offen offset:640
 buffer_load_dwordx4 v[40:43], v3, s[8:11], s92 offen offset:768
 buffer_load_dwordx4 v[44:47], v3, s[8:11], s92 offen offset:896
 buffer_load_dwordx4 v[48:51], v3, s[8:11], s92 offen offset:1024
 buffer_load_dwordx4 v[52:55], v3, s[8:11], s92 offen offset:1152
 s_mov_b32 s94, 0xffff0000
 s_waitcnt vmcnt(9)
 v_lshlrev_b32 v64, 16, v16
 v_and_b32 v65, s94, v16
 v_lshlrev_b32 v66, 16, v17
 v_and_b32 v67, s94, v17
 v_lshlrev_b32 v68, 16, v18
 v_and_b32 v69, s94, v18
 v_lshlrev_b32 v70, 16, v19
 v_and_b32 v71, s94, v19
 s_waitcnt vmcnt(8)
 v_lshlrev_b32 v72, 16, v20
 v_and_b32 v73, s94, v20
 v_lshlrev_b32 v74, 16, v21
 v_and_b32 v75, s94, v21
 v_lshlrev_b32 v76, 16, v22
 v_and_b32 v77, s94, v22
 v_lshlrev_b32 v78, 16, v23
 v_and_b32 v79, s94, v23
 s_waitcnt vmcnt(7)
 v_lshlrev_b32 v80, 16, v24
 v_and_b32 v81, s94, v24
 v_lshlrev_b32 v82, 16, v25
 v_and_b32 v83, s94, v25
 v_lshlrev_b32 v84, 16, v26
 v_and_b32 v85, s94, v26
 v_lshlrev_b32 v86, 16, v27
 v_and_b32 v87, s94, v27
 s_waitcnt vmcnt(6)
 v_lshlrev_b32 v88, 16, v28
 v_and_b32 v89, s94, v28
 v_lshlrev_b32 v90, 16, v29
 v_and_b32 v91, s94, v29
 v_lshlrev_b32 v92, 16, v30
 v_and_b32 v93, s94, v30
 v_lshlrev_b32 v94, 16, v31
 v_and_b32 v95, s94, v31
 s_waitcnt vmcnt(5)
 v_lshlrev_b32 v96, 16, v32
 v_and_b32 v97, s94, v32
 v_lshlrev_b32 v98, 16, v33
 v_and_b32 v99, s94, v33
 v_lshlrev_b32 v100, 16, v34
 v_and_b32 v101, s94, v34
 v_lshlrev_b32 v102, 16, v35
 v_and_b32 v103, s94, v35
 s_waitcnt vmcnt(4)
 v_lshlrev_b32 v104, 16, v36
 v_and_b32 v105, s94, v36
 v_lshlrev_b32 v106, 16, v37
 v_and_b32 v107, s94, v37
 v_lshlrev_b32 v108, 16, v38
 v_and_b32 v109, s94, v38
 v_lshlrev_b32 v110, 16, v39
 v_and_b32 v111, s94, v39
 s_waitcnt vmcnt(3)
 v_lshlrev_b32 v112, 16, v40
 v_and_b32 v113, s94, v40
 v_lshlrev_b32 v114, 16, v41
 v_and_b32 v115, s94, v41
 v_lshlrev_b32 v116, 16, v42
 v_and_b32 v117, s94, v42
 v_lshlrev_b32 v118, 16, v43
 v_and_b32 v119, s94, v43
 s_waitcnt vmcnt(2)
 v_lshlrev_b32 v120, 16, v44
 v_and_b32 v121, s94, v44
 v_lshlrev_b32 v122, 16, v45
 v_and_b32 v123, s94, v45
 v_lshlrev_b32 v124, 16, v46
 v_and_b32 v125, s94, v46
 v_lshlrev_b32 v126, 16, v47
 v_and_b32 v127, s94, v47
 s_waitcnt vmcnt(1)
 v_lshlrev_b32 v128, 16, v48
 v_and_b32 v129, s94, v48
 v_lshlrev_b32 v130, 16, v49
 v_and_b32 v131, s94, v49
 v_lshlrev_b32 v132, 16, v50
 v_and_b32 v133, s94, v50
 v_lshlrev_b32 v134, 16, v51
 v_and_b32 v135, s94, v51
 s_waitcnt vmcnt(0)
 v_lshlrev_b32 v136, 16, v52
 v_and_b32 v137, s94, v52
 v_lshlrev_b32 v138, 16, v53
 v_and_b32 v139, s94, v53
 v_lshlrev_b32 v140, 16, v54
 v_and_b32 v141, s94, v54
 v_lshlrev_b32 v142, 16, v55
 v_and_b32 v143, s94, v55
 v_pk_add_f32 v[4:5], v[64:65], v[66:67]
 v_pk_add_f32 v[6:7], v[68:69], v[70:71]
 v_pk_add_f32 v[4:5], v[4:5], v[72:73]
 v_pk_add_f32 v[6:7], v[6:7], v[74:75]
 v_pk_add_f32 v[4:5], v[4:5], v[76:77]
 v_pk_add_f32 v[6:7], v[6:7], v[78:79]
 v_pk_add_f32 v[4:5], v[4:5], v[80:81]
 v_pk_add_f32 v[6:7], v[6:7], v[82:83]
 v_pk_add_f32 v[4:5], v[4:5], v[84:85]
 v_pk_add_f32 v[6:7], v[6:7], v[86:87]
 v_pk_add_f32 v[4:5], v[4:5], v[88:89]
 v_pk_add_f32 v[6:7], v[6:7], v[90:91]
 v_pk_add_f32 v[4:5], v[4:5], v[92:93]
 v_pk_add_f32 v[6:7], v[6:7], v[94:95]
 v_pk_add_f32 v[4:5], v[4:5], v[96:97]
 v_pk_add_f32 v[6:7], v[6:7], v[98:99]
 v_pk_add_f32 v[4:5], v[4:5], v[100:101]
 v_pk_add_f32 v[6:7], v[6:7], v[102:103]
 v_pk_add_f32 v[4:5], v[4:5], v[104:105]
 v_pk_add_f32 v[6:7], v[6:7], v[106:107]
 v_pk_add_f32 v[4:5], v[4:5], v[108:109]
 v_pk_add_f32 v[6:7], v[6:7], v[110:111]
 v_pk_add_f32 v[4:5], v[4:5], v[112:113]
 v_pk_add_f32 v[6:7], v[6:7], v[114:115]
 v_pk_add_f32 v[4:5], v[4:5], v[116:117]
 v_pk_add_f32 v[6:7], v[6:7], v[118:119]
 v_pk_add_f32 v[4:5], v[4:5], v[120:121]
 v_pk_add_f32 v[6:7], v[6:7], v[122:123]
 v_pk_add_f32 v[4:5], v[4:5], v[124:125]
 v_pk_add_f32 v[6:7], v[6:7], v[126:127]
 v_pk_add_f32 v[4:5], v[4:5], v[128:129]
 v_pk_add_f32 v[6:7], v[6:7], v[130:131]
 v_pk_add_f32 v[4:5], v[4:5], v[132:133]
 v_pk_add_f32 v[6:7], v[6:7], v[134:135]
 v_pk_add_f32 v[4:5], v[4:5], v[136:137]
 v_pk_add_f32 v[6:7], v[6:7], v[138:139]
 v_pk_add_f32 v[4:5], v[4:5], v[140:141]
 v_pk_add_f32 v[6:7], v[6:7], v[142:143]
 v_pk_add_f32 v[4:5], v[4:5], v[6:7]
 v_add_f32 v4, v4, v5
 s_nop 1
 v_add_f32_dpp v4, v4, v4 row_ror:8 row_mask:0xf bank_mask:0xf
 v_mov_b32 v8, v4
 s_nop 1
 v_permlane16_swap_b32 v8, v4
 v_add_f32 v4, v4, v8
 v_mov_b32 v8, v4
 s_nop 1
 v_permlane32_swap_b32 v8, v4
 v_add_f32 v4, v4, v8
 v_mul_f32 v4, 0xbacccccd, v4
 v_mov_b32 v5, v4
 v_pk_add_f32 v[64:65], v[64:65], v[4:5]
 v_pk_add_f32 v[66:67], v[66:67], v[4:5]
 v_pk_add_f32 v[68:69], v[68:69], v[4:5]
 v_pk_add_f32 v[70:71], v[70:71], v[4:5]
 v_pk_add_f32 v[72:73], v[72:73], v[4:5]
 v_pk_add_f32 v[74:75], v[74:75], v[4:5]
 v_pk_add_f32 v[76:77], v[76:77], v[4:5]
 v_pk_add_f32 v[78:79], v[78:79], v[4:5]
 v_pk_add_f32 v[80:81], v[80:81], v[4:5]
 v_pk_add_f32 v[82:83], v[82:83], v[4:5]
 v_pk_add_f32 v[84:85], v[84:85], v[4:5]
 v_pk_add_f32 v[86:87], v[86:87], v[4:5]
 v_pk_add_f32 v[88:89], v[88:89], v[4:5]
 v_pk_add_f32 v[90:91], v[90:91], v[4:5]
 v_pk_add_f32 v[92:93], v[92:93], v[4:5]
 v_pk_add_f32 v[94:95], v[94:95], v[4:5]
 v_pk_add_f32 v[96:97], v[96:97], v[4:5]
 v_pk_add_f32 v[98:99], v[98:99], v[4:5]
 v_pk_add_f32 v[100:101], v[100:101], v[4:5]
 v_pk_add_f32 v[102:103], v[102:103], v[4:5]
 v_pk_add_f32 v[104:105], v[104:105], v[4:5]
 v_pk_add_f32 v[106:107], v[106:107], v[4:5]
 v_pk_add_f32 v[108:109], v[108:109], v[4:5]
 v_pk_add_f32 v[110:111], v[110:111], v[4:5]
 v_pk_add_f32 v[112:113], v[112:113], v[4:5]
 v_pk_add_f32 v[114:115], v[114:115], v[4:5]
 v_pk_add_f32 v[116:117], v[116:117], v[4:5]
 v_pk_add_f32 v[118:119], v[118:119], v[4:5]
 v_pk_add_f32 v[120:121], v[120:121], v[4:5]
 v_pk_add_f32 v[122:123], v[122:123], v[4:5]
 v_pk_add_f32 v[124:125], v[124:125], v[4:5]
 v_pk_add_f32 v[126:127], v[126:127], v[4:5]
 v_pk_add_f32 v[128:129], v[128:129], v[4:5]
 v_pk_add_f32 v[130:131], v[130:131], v[4:5]
 v_pk_add_f32 v[132:133], v[132:133], v[4:5]
 v_pk_add_f32 v[134:135], v[134:135], v[4:5]
 v_pk_add_f32 v[136:137], v[136:137], v[4:5]
 v_pk_add_f32 v[138:139], v[138:139], v[4:5]
 v_pk_add_f32 v[140:141], v[140:141], v[4:5]
 v_pk_add_f32 v[142:143], v[142:143], v[4:5]
 v_pk_mul_f32 v[6:7], v[64:65], v[64:65]
 v_pk_mul_f32 v[10:11], v[66:67], v[66:67]
 v_pk_fma_f32 v[6:7], v[68:69], v[68:69], v[6:7]
 v_pk_fma_f32 v[10:11], v[70:71], v[70:71], v[10:11]
 v_pk_fma_f32 v[6:7], v[72:73], v[72:73], v[6:7]
 v_pk_fma_f32 v[10:11], v[74:75], v[74:75], v[10:11]
 v_pk_fma_f32 v[6:7], v[76:77], v[76:77], v[6:7]
 v_pk_fma_f32 v[10:11], v[78:79], v[78:79], v[10:11]
 v_pk_fma_f32 v[6:7], v[80:81], v[80:81], v[6:7]
 v_pk_fma_f32 v[10:11], v[82:83], v[82:83], v[10:11]
 v_pk_fma_f32 v[6:7], v[84:85], v[84:85], v[6:7]
 v_pk_fma_f32 v[10:11], v[86:87], v[86:87], v[10:11]
 v_pk_fma_f32 v[6:7], v[88:89], v[88:89], v[6:7]
 v_pk_fma_f32 v[10:11], v[90:91], v[90:91], v[10:11]
 v_pk_fma_f32 v[6:7], v[92:93], v[92:93], v[6:7]
 v_pk_fma_f32 v[10:11], v[94:95], v[94:95], v[10:11]
 v_pk_fma_f32 v[6:7], v[96:97], v[96:97], v[6:7]
 v_pk_fma_f32 v[10:11], v[98:99], v[98:99], v[10:11]
 v_pk_fma_f32 v[6:7], v[100:101], v[100:101], v[6:7]
 v_pk_fma_f32 v[10:11], v[102:103], v[102:103], v[10:11]
 v_pk_fma_f32 v[6:7], v[104:105], v[104:105], v[6:7]
 v_pk_fma_f32 v[10:11], v[106:107], v[106:107], v[10:11]
 v_pk_fma_f32 v[6:7], v[108:109], v[108:109], v[6:7]
 v_pk_fma_f32 v[10:11], v[110:111], v[110:111], v[10:11]
 v_pk_fma_f32 v[6:7], v[112:113], v[112:113], v[6:7]
 v_pk_fma_f32 v[10:11], v[114:115], v[114:115], v[10:11]
 v_pk_fma_f32 v[6:7], v[116:117], v[116:117], v[6:7]
 v_pk_fma_f32 v[10:11], v[118:119], v[118:119], v[10:11]
 v_pk_fma_f32 v[6:7], v[120:121], v[120:121], v[6:7]
 v_pk_fma_f32 v[10:11], v[122:123], v[122:123], v[10:11]
 v_pk_fma_f32 v[6:7], v[124:125], v[124:125], v[6:7]
 v_pk_fma_f32 v[10:11], v[126:127], v[126:127], v[10:11]
 v_pk_fma_f32 v[6:7], v[128:129], v[128:129], v[6:7]
 v_pk_fma_f32 v[10:11], v[130:131], v[130:131], v[10:11]
 v_pk_fma_f32 v[6:7], v[132:133], v[132:133], v[6:7]
 v_pk_fma_f32 v[10:11], v[134:135], v[134:135], v[10:11]
 v_pk_fma_f32 v[6:7], v[136:137], v[136:137], v[6:7]
 v_pk_fma_f32 v[10:11], v[138:139], v[138:139], v[10:11]
 v_pk_fma_f32 v[6:7], v[140:141], v[140:141], v[6:7]
 v_pk_fma_f32 v[10:11], v[142:143], v[142:143], v[10:11]
 v_pk_add_f32 v[6:7], v[6:7], v[10:11]
 v_add_f32 v6, v6, v7
 s_nop 1
 v_add_f32_dpp v6, v6, v6 row_ror:8 row_mask:0xf bank_mask:0xf
 v_mov_b32 v8, v6
 s_nop 1
 v_permlane16_swap_b32 v8, v6
 v_add_f32 v6, v6, v8
 v_mov_b32 v8, v6
 s_nop 1
 v_permlane32_swap_b32 v8, v6
 v_add_f32 v6, v6, v8
 v_mul_f32 v6, 0x3acccccd, v6
 v_add_f32 v7, 0x3727c5ac, v6
 v_rsq_f32 v4, v7
 s_nop 0
 v_mov_b32 v5, v4
 v_pk_mul_f32 v[64:65], v[64:65], v[4:5]
 v_cvt_pk_bf16_f32 v144, v64, v65
 v_pk_mul_f32 v[66:67], v[66:67], v[4:5]
 v_cvt_pk_bf16_f32 v145, v66, v67
 v_pk_mul_f32 v[68:69], v[68:69], v[4:5]
 v_cvt_pk_bf16_f32 v146, v68, v69
 v_pk_mul_f32 v[70:71], v[70:71], v[4:5]
 v_cvt_pk_bf16_f32 v147, v70, v71
 v_pk_mul_f32 v[72:73], v[72:73], v[4:5]
 v_cvt_pk_bf16_f32 v148, v72, v73
 v_pk_mul_f32 v[74:75], v[74:75], v[4:5]
 v_cvt_pk_bf16_f32 v149, v74, v75
 v_pk_mul_f32 v[76:77], v[76:77], v[4:5]
 v_cvt_pk_bf16_f32 v150, v76, v77
 v_pk_mul_f32 v[78:79], v[78:79], v[4:5]
 v_cvt_pk_bf16_f32 v151, v78, v79
 v_pk_mul_f32 v[80:81], v[80:81], v[4:5]
 v_cvt_pk_bf16_f32 v152, v80, v81
 v_pk_mul_f32 v[82:83], v[82:83], v[4:5]
 v_cvt_pk_bf16_f32 v153, v82, v83
 v_pk_mul_f32 v[84:85], v[84:85], v[4:5]
 v_cvt_pk_bf16_f32 v154, v84, v85
 v_pk_mul_f32 v[86:87], v[86:87], v[4:5]
 v_cvt_pk_bf16_f32 v155, v86, v87
 v_pk_mul_f32 v[88:89], v[88:89], v[4:5]
 v_cvt_pk_bf16_f32 v156, v88, v89
 v_pk_mul_f32 v[90:91], v[90:91], v[4:5]
 v_cvt_pk_bf16_f32 v157, v90, v91
 v_pk_mul_f32 v[92:93], v[92:93], v[4:5]
 v_cvt_pk_bf16_f32 v158, v92, v93
 v_pk_mul_f32 v[94:95], v[94:95], v[4:5]
 v_cvt_pk_bf16_f32 v159, v94, v95
 v_pk_mul_f32 v[96:97], v[96:97], v[4:5]
 v_cvt_pk_bf16_f32 v160, v96, v97
 v_pk_mul_f32 v[98:99], v[98:99], v[4:5]
 v_cvt_pk_bf16_f32 v161, v98, v99
 v_pk_mul_f32 v[100:101], v[100:101], v[4:5]
 v_cvt_pk_bf16_f32 v162, v100, v101
 v_pk_mul_f32 v[102:103], v[102:103], v[4:5]
 v_cvt_pk_bf16_f32 v163, v102, v103
 v_pk_mul_f32 v[104:105], v[104:105], v[4:5]
 v_cvt_pk_bf16_f32 v164, v104, v105
 v_pk_mul_f32 v[106:107], v[106:107], v[4:5]
 v_cvt_pk_bf16_f32 v165, v106, v107
 v_pk_mul_f32 v[108:109], v[108:109], v[4:5]
 v_cvt_pk_bf16_f32 v166, v108, v109
 v_pk_mul_f32 v[110:111], v[110:111], v[4:5]
 v_cvt_pk_bf16_f32 v167, v110, v111
 v_pk_mul_f32 v[112:113], v[112:113], v[4:5]
 v_cvt_pk_bf16_f32 v168, v112, v113
 v_pk_mul_f32 v[114:115], v[114:115], v[4:5]
 v_cvt_pk_bf16_f32 v169, v114, v115
 v_pk_mul_f32 v[116:117], v[116:117], v[4:5]
 v_cvt_pk_bf16_f32 v170, v116, v117
 v_pk_mul_f32 v[118:119], v[118:119], v[4:5]
 v_cvt_pk_bf16_f32 v171, v118, v119
 v_pk_mul_f32 v[120:121], v[120:121], v[4:5]
 v_cvt_pk_bf16_f32 v172, v120, v121
 v_pk_mul_f32 v[122:123], v[122:123], v[4:5]
 v_cvt_pk_bf16_f32 v173, v122, v123
 v_pk_mul_f32 v[124:125], v[124:125], v[4:5]
 v_cvt_pk_bf16_f32 v174, v124, v125
 v_pk_mul_f32 v[126:127], v[126:127], v[4:5]
 v_cvt_pk_bf16_f32 v175, v126, v127
 v_pk_mul_f32 v[128:129], v[128:129], v[4:5]
 v_cvt_pk_bf16_f32 v176, v128, v129
 v_pk_mul_f32 v[130:131], v[130:131], v[4:5]
 v_cvt_pk_bf16_f32 v177, v130, v131
 v_pk_mul_f32 v[132:133], v[132:133], v[4:5]
 v_cvt_pk_bf16_f32 v178, v132, v133
 v_pk_mul_f32 v[134:135], v[134:135], v[4:5]
 v_cvt_pk_bf16_f32 v179, v134, v135
 v_pk_mul_f32 v[136:137], v[136:137], v[4:5]
 v_cvt_pk_bf16_f32 v180, v136, v137
 v_pk_mul_f32 v[138:139], v[138:139], v[4:5]
 v_cvt_pk_bf16_f32 v181, v138, v139
 v_pk_mul_f32 v[140:141], v[140:141], v[4:5]
 v_cvt_pk_bf16_f32 v182, v140, v141
 v_pk_mul_f32 v[142:143], v[142:143], v[4:5]
 v_cvt_pk_bf16_f32 v183, v142, v143
 s_add_u32 s92, s90, 2097152
 s_add_u32 s93, s90, 7340032
 buffer_store_dwordx4 v[144:147], v2, s[4:7], s92 offen sc1
 buffer_store_dwordx4 v[16:19], v2, s[4:7], s93 offen sc1
 s_add_u32 s92, s92, 4096
 s_add_u32 s93, s93, 4096
 buffer_store_dwordx4 v[148:151], v2, s[4:7], s92 offen sc1
 buffer_store_dwordx4 v[20:23], v2, s[4:7], s93 offen sc1
 s_add_u32 s92, s92, 4096
 s_add_u32 s93, s93, 4096
 buffer_store_dwordx4 v[152:155], v2, s[4:7], s92 offen sc1
 buffer_store_dwordx4 v[24:27], v2, s[4:7], s93 offen sc1
 s_add_u32 s92, s92, 4096
 s_add_u32 s93, s93, 4096
 buffer_store_dwordx4 v[156:159], v2, s[4:7], s92 offen sc1
 buffer_store_dwordx4 v[28:31], v2, s[4:7], s93 offen sc1
 s_add_u32 s92, s92, 4096
 s_add_u32 s93, s93, 4096
 buffer_store_dwordx4 v[160:163], v2, s[4:7], s92 offen sc1
 buffer_store_dwordx4 v[32:35], v2, s[4:7], s93 offen sc1
 s_add_u32 s92, s92, 4096
 s_add_u32 s93, s93, 4096
 buffer_store_dwordx4 v[164:167], v2, s[4:7], s92 offen sc1
 buffer_store_dwordx4 v[36:39], v2, s[4:7], s93 offen sc1
 s_add_u32 s92, s92, 4096
 s_add_u32 s93, s93, 4096
 buffer_store_dwordx4 v[168:171], v2, s[4:7], s92 offen sc1
 buffer_store_dwordx4 v[40:43], v2, s[4:7], s93 offen sc1
 s_add_u32 s92, s92, 4096
 s_add_u32 s93, s93, 4096
 buffer_store_dwordx4 v[172:175], v2, s[4:7], s92 offen sc1
 buffer_store_dwordx4 v[44:47], v2, s[4:7], s93 offen sc1
 s_add_u32 s92, s92, 4096
 s_add_u32 s93, s93, 4096
 buffer_store_dwordx4 v[176:179], v2, s[4:7], s92 offen sc1
 buffer_store_dwordx4 v[48:51], v2, s[4:7], s93 offen sc1
 s_add_u32 s92, s92, 4096
 s_add_u32 s93, s93, 4096
 buffer_store_dwordx4 v[180:183], v2, s[4:7], s92 offen sc1
 buffer_store_dwordx4 v[52:55], v2, s[4:7], s93 offen sc1
 s_add_u32 s92, s92, 4096
 s_add_u32 s93, s93, 4096
 s_lshl_b32 s95, s22, 7
 s_add_u32 s95, s95, s3
 s_add_u32 s95, s95, 65536
 v_mov_b32 v2, 0x80000000
 v_writelane_b32 v2, s95, 0
 v_mov_b32 v3, 1
 s_waitcnt vmcnt(0) lgkmcnt(0)
 buffer_store_dword v3, v2, s[4:7], 0 offen sc1
 s_lshl_b32 s23, s2, 2
 s_add_u32 s23, s23, s21
 s_cmp_lg_u32 s23, 996
 s_cbranch_scc1 np_2002
 s_mov_b32 s40, -1
 s_mov_b32 s41, -1
 s_mov_b32 s42, 0
pr_2003:
 s_and_b32 s43, s42, 1
 s_lshl_b32 s43, s43, 12
 s_add_u32 s43, s43, 1835008
 s_memtime s[44:45]
 s_waitcnt lgkmcnt(0)
 s_load_dword s48, s[4:5], s43 glc
 s_waitcnt lgkmcnt(0)
 s_memtime s[46:47]
 s_waitcnt lgkmcnt(0)
 s_sub_u32 s44, s46, s44
 s_min_u32 s40, s40, s44
 s_and_b32 s43, s42, 1
 s_lshl_b32 s43, s43, 12
 s_add_u32 s43, s43, 1843200
 s_memtime s[44:45]
 s_waitcnt lgkmcnt(0)
 s_load_dword s48, s[4:5], s43 glc
 s_waitcnt lgkmcnt(0)
 s_memtime s[46:47]
 s_waitcnt lgkmcnt(0)
 s_sub_u32 s44, s46, s44
 s_min_u32 s41, s41, s44
 s_add_u32 s42, s42, 1
 s_cmp_lt_u32 s42, 6
 s_cbranch_scc1 pr_2003
 s_cmp_lt_u32 s41, s40
 s_cselect_b32 s40, 0x2000, 0
 v_mov_b32 v2, s40
 v_mov_b32 v3, 1572864
 buffer_store_dword v2, v3, s[4:7], 0 offen sc1
np_2002:
 s_cmp_eq_u32 s85, 3
 s_cbranch_scc1 first_o
load_kv:
 s_sub_u32 s20, s16, 4
 s_lshl_b32 s20, s20, 3
 s_and_b32 s23, s17, 7
 s_add_u32 s20, s20, s23
 s_lshr_b32 s23, s17, 3
 s_lshl_b32 s22, s23, 3
 s_add_u32 s22, s22, 24
 s_load_dwordx2 s[8:9], s[0:1], s22
 s_mov_b32 s10, 7864320
 s_mov_b32 s11, 0x20000
 s_waitcnt vmcnt(0) lgkmcnt(0)
 v_and_b32 v254, 63, v0
 v_add_u32 v254, 0, v254
 v_mul_u32_u24 v253, 2731, v254
 v_lshrrev_b32 v253, 16, v253
 v_mul_u32_u24 v252, 24, v253
 v_sub_u32 v254, v254, v252
 v_mul_u32_u24 v253, 12288, v253
 v_lshl_add_u32 v2, v254, 4, v253
 v_and_b32 v254, 63, v0
 v_add_u32 v254, 64, v254
 v_mul_u32_u24 v253, 2731, v254
 v_lshrrev_b32 v253, 16, v253
 v_mul_u32_u24 v252, 24, v253
 v_sub_u32 v254, v254, v252
 v_mul_u32_u24 v253, 12288, v253
 v_lshl_add_u32 v3, v254, 4, v253
 v_and_b32 v254, 63, v0
 v_add_u32 v254, 128, v254
 v_mul_u32_u24 v253, 2731, v254
 v_lshrrev_b32 v253, 16, v253
 v_mul_u32_u24 v252, 24, v253
 v_sub_u32 v254, v254, v252
 v_mul_u32_u24 v253, 12288, v253
 v_lshl_add_u32 v4, v254, 4, v253
 s_mul_i32 s88, s21, 6144
 s_mul_i32 s87, s20, 384
 s_mul_i32 s86, s21, 196608
 s_add_u32 s87, s87, s86
 s_mul_i32 s86, s21, 96
 v_mov_b32 v5, s86
 v_bfe_u32 v255, v0, 4, 2
 s_mov_b32 s101, 3072
 v_mad_u32_u24 v5, v255, s101, v5
 v_bfe_u32 v255, v0, 2, 2
 s_mov_b32 s101, 384
 v_mad_u32_u24 v5, v255, s101, v5
 v_bfe_u32 v255, v0, 0, 2
 v_lshl_add_u32 v5, v255, 4, v5
 v_mov_b32 v6, s86
 v_bfe_u32 v255, v0, 4, 2
 s_mov_b32 s101, 3072
 v_mad_u32_u24 v6, v255, s101, v6
 v_bfe_u32 v255, v0, 2, 2
 s_mov_b32 s101, 384
 v_mad_u32_u24 v6, v255, s101, v6
 v_bfe_u32 v255, v0, 0, 2
 v_lshl_add_u32 v6, v255, 3, v6
 s_add_u32 s89, s87, 0
 s_add_u32 m0, s88, 0
 s_nop 0
 buffer_load_dwordx4 v2, s[8:11], s89 offen lds
 s_add_u32 m0, s88, 1024
 s_nop 0
 buffer_load_dwordx4 v3, s[8:11], s89 offen lds
 s_add_u32 m0, s88, 2048
 s_nop 0
 buffer_load_dwordx4 v4, s[8:11], s89 offen lds
 s_add_u32 s89, s87, 98304
 s_add_u32 m0, s88, 3072
 s_nop 0
 buffer_load_dwordx4 v2, s[8:11], s89 offen lds
 s_add_u32 m0, s88, 4096
 s_nop 0
 buffer_load_dwordx4 v3, s[8:11], s89 offen lds
 s_add_u32 m0, s88, 5120
 s_nop 0
 buffer_load_dwordx4 v4, s[8:11], s89 offen lds
 s_add_u32 s89, s87, 786432
 s_add_u32 m0, s88, 24576
 s_nop 0
 buffer_load_dwordx4 v2, s[8:11], s89 offen lds
 s_add_u32 m0, s88, 25600
 s_nop 0
 buffer_load_dwordx4 v3, s[8:11], s89 offen lds
 s_add_u32 m0, s88, 26624
 s_nop 0
 buffer_load_dwordx4 v4, s[8:11], s89 offen lds
 s_add_u32 s89, s87, 884736
 s_add_u32 m0, s88, 27648
 s_nop 0
 buffer_load_dwordx4 v2, s[8:11], s89 offen lds
 s_add_u32 m0, s88, 28672
 s_nop 0
 buffer_load_dwordx4 v3, s[8:11], s89 offen lds
 s_add_u32 m0, s88, 29696
 s_nop 0
 buffer_load_dwordx4 v4, s[8:11], s89 offen lds
 s_add_u32 s89, s87, 1572864
 s_add_u32 m0, s88, 49152
 s_nop 0
 buffer_load_dwordx4 v2, s[8:11], s89 offen lds
 s_add_u32 m0, s88, 50176
 s_nop 0
 buffer_load_dwordx4 v3, s[8:11], s89 offen lds
 s_add_u32 m0, s88, 51200
 s_nop 0
 buffer_load_dwordx4 v4, s[8:11], s89 offen lds
 s_add_u32 s89, s87, 1671168
 s_add_u32 m0, s88, 52224
 s_nop 0
 buffer_load_dwordx4 v2, s[8:11], s89 offen lds
 s_add_u32 m0, s88, 53248
 s_nop 0
 buffer_load_dwordx4 v3, s[8:11], s89 offen lds
 s_add_u32 m0, s88, 54272
 s_nop 0
 buffer_load_dwordx4 v4, s[8:11], s89 offen lds
 s_add_u32 s89, s87, 2359296
 s_add_u32 m0, s88, 73728
 s_nop 0
 buffer_load_dwordx4 v2, s[8:11], s89 offen lds
 s_add_u32 m0, s88, 74752
 s_nop 0
 buffer_load_dwordx4 v3, s[8:11], s89 offen lds
 s_add_u32 m0, s88, 75776
 s_nop 0
 buffer_load_dwordx4 v4, s[8:11], s89 offen lds
 s_add_u32 s89, s87, 2457600
 s_add_u32 m0, s88, 76800
 s_nop 0
 buffer_load_dwordx4 v2, s[8:11], s89 offen lds
 s_add_u32 m0, s88, 77824
 s_nop 0
 buffer_load_dwordx4 v3, s[8:11], s89 offen lds
 s_add_u32 m0, s88, 78848
 s_nop 0
 buffer_load_dwordx4 v4, s[8:11], s89 offen lds
 s_add_u32 s89, s87, 3145728
 s_add_u32 m0, s88, 98304
 s_nop 0
 buffer_load_dwordx4 v2, s[8:11], s89 offen lds
 s_add_u32 m0, s88, 99328
 s_nop 0
 buffer_load_dwordx4 v3, s[8:11], s89 offen lds
 s_add_u32 m0, s88, 100352
 s_nop 0
 buffer_load_dwordx4 v4, s[8:11], s89 offen lds
 s_add_u32 s89, s87, 3244032
 s_add_u32 m0, s88, 101376
 s_nop 0
 buffer_load_dwordx4 v2, s[8:11], s89 offen lds
 s_add_u32 m0, s88, 102400
 s_nop 0
 buffer_load_dwordx4 v3, s[8:11], s89 offen lds
 s_add_u32 m0, s88, 103424
 s_nop 0
 buffer_load_dwordx4 v4, s[8:11], s89 offen lds
 s_waitcnt vmcnt(24)
 s_barrier
 s_add_u32 s89, s87, 3932160
 s_add_u32 m0, s88, 122880
 s_nop 0
 buffer_load_dwordx4 v2, s[8:11], s89 offen lds
 s_add_u32 m0, s88, 123904
 s_nop 0
 buffer_load_dwordx4 v3, s[8:11], s89 offen lds
 s_add_u32 m0, s88, 124928
 s_nop 0
 buffer_load_dwordx4 v4, s[8:11], s89 offen lds
 s_add_u32 s89, s87, 4030464
 s_add_u32 m0, s88, 125952
 s_nop 0
 buffer_load_dwordx4 v2, s[8:11], s89 offen lds
 s_add_u32 m0, s88, 126976
 s_nop 0
 buffer_load_dwordx4 v3, s[8:11], s89 offen lds
 s_add_u32 m0, s88, 128000
 s_nop 0
 buffer_load_dwordx4 v4, s[8:11], s89 offen lds
 v_add_u32 v7, 0, v5
 v_add_u32 v8, 0, v6
 ds_read_b64_tr_b16 a[0:1], v7 offset:0
 ds_read_b64_tr_b16 a[2:3], v7 offset:1536
 ds_read_b64_tr_b16 a[80:81], v7 offset:8
 ds_read_b64_tr_b16 a[82:83], v7 offset:1544
 ds_read_b64_tr_b16 a[160:161], v8 offset:64
 ds_read_b64_tr_b16 a[162:163], v8 offset:1600
 ds_read_b64_tr_b16 a[4:5], v7 offset:12288
 ds_read_b64_tr_b16 a[6:7], v7 offset:13824
 ds_read_b64_tr_b16 a[84:85], v7 offset:12296
 ds_read_b64_tr_b16 a[86:87], v7 offset:13832
 ds_read_b64_tr_b16 a[164:165], v8 offset:12352
 ds_read_b64_tr_b16 a[166:167], v8 offset:13888
 s_waitcnt lgkmcnt(0)
 s_waitcnt vmcnt(24)
 s_barrier
 s_add_u32 s89, s87, 4718592
 s_add_u32 m0, s88, 0
 s_nop 0
 buffer_load_dwordx4 v2, s[8:11], s89 offen lds
 s_add_u32 m0, s88, 1024
 s_nop 0
 buffer_load_dwordx4 v3, s[8:11], s89 offen lds
 s_add_u32 m0, s88, 2048
 s_nop 0
 buffer_load_dwordx4 v4, s[8:11], s89 offen lds
 s_add_u32 s89, s87, 4816896
 s_add_u32 m0, s88, 3072
 s_nop 0
 buffer_load_dwordx4 v2, s[8:11], s89 offen lds
 s_add_u32 m0, s88, 4096
 s_nop 0
 buffer_load_dwordx4 v3, s[8:11], s89 offen lds
 s_add_u32 m0, s88, 5120
 s_nop 0
 buffer_load_dwordx4 v4, s[8:11], s89 offen lds
 v_add_u32 v7, 24576, v5
 v_add_u32 v8, 24576, v6
 ds_read_b64_tr_b16 a[8:9], v7 offset:0
 ds_read_b64_tr_b16 a[10:11], v7 offset:1536
 ds_read_b64_tr_b16 a[88:89], v7 offset:8
 ds_read_b64_tr_b16 a[90:91], v7 offset:1544
 ds_read_b64_tr_b16 a[168:169], v8 offset:64
 ds_read_b64_tr_b16 a[170:171], v8 offset:1600
 ds_read_b64_tr_b16 a[12:13], v7 offset:12288
 ds_read_b64_tr_b16 a[14:15], v7 offset:13824
 ds_read_b64_tr_b16 a[92:93], v7 offset:12296
 ds_read_b64_tr_b16 a[94:95], v7 offset:13832
 ds_read_b64_tr_b16 a[172:173], v8 offset:12352
 ds_read_b64_tr_b16 a[174:175], v8 offset:13888
 s_waitcnt lgkmcnt(0)
 s_waitcnt vmcnt(24)
 s_barrier
 s_add_u32 s89, s87, 5505024
 s_add_u32 m0, s88, 24576
 s_nop 0
 buffer_load_dwordx4 v2, s[8:11], s89 offen lds
 s_add_u32 m0, s88, 25600
 s_nop 0
 buffer_load_dwordx4 v3, s[8:11], s89 offen lds
 s_add_u32 m0, s88, 26624
 s_nop 0
 buffer_load_dwordx4 v4, s[8:11], s89 offen lds
 s_add_u32 s89, s87, 5603328
 s_add_u32 m0, s88, 27648
 s_nop 0
 buffer_load_dwordx4 v2, s[8:11], s89 offen lds
 s_add_u32 m0, s88, 28672
 s_nop 0
 buffer_load_dwordx4 v3, s[8:11], s89 offen lds
 s_add_u32 m0, s88, 29696
 s_nop 0
 buffer_load_dwordx4 v4, s[8:11], s89 offen lds
 v_add_u32 v7, 49152, v5
 v_add_u32 v8, 49152, v6
 ds_read_b64_tr_b16 a[16:17], v7 offset:0
 ds_read_b64_tr_b16 a[18:19], v7 offset:1536
 ds_read_b64_tr_b16 a[96:97], v7 offset:8
 ds_read_b64_tr_b16 a[98:99], v7 offset:1544
 ds_read_b64_tr_b16 a[176:177], v8 offset:64
 ds_read_b64_tr_b16 a[178:179], v8 offset:1600
 ds_read_b64_tr_b16 a[20:21], v7 offset:12288
 ds_read_b64_tr_b16 a[22:23], v7 offset:13824
 ds_read_b64_tr_b16 a[100:101], v7 offset:12296
 ds_read_b64_tr_b16 a[102:103], v7 offset:13832
 ds_read_b64_tr_b16 a[180:181], v8 offset:12352
 ds_read_b64_tr_b16 a[182:183], v8 offset:13888
 s_waitcnt lgkmcnt(0)
 s_waitcnt vmcnt(24)
 s_barrier
 s_add_u32 s89, s87, 6291456
 s_add_u32 m0, s88, 49152
 s_nop 0
 buffer_load_dwordx4 v2, s[8:11], s89 offen lds
 s_add_u32 m0, s88, 50176
 s_nop 0
 buffer_load_dwordx4 v3, s[8:11], s89 offen lds
 s_add_u32 m0, s88, 51200
 s_nop 0
 buffer_load_dwordx4 v4, s[8:11], s89 offen lds
 s_add_u32 s89, s87, 6389760
 s_add_u32 m0, s88, 52224
 s_nop 0
 buffer_load_dwordx4 v2, s[8:11], s89 offen lds
 s_add_u32 m0, s88, 53248
 s_nop 0
 buffer_load_dwordx4 v3, s[8:11], s89 offen lds
 s_add_u32 m0, s88, 54272
 s_nop 0
 buffer_load_dwordx4 v4, s[8:11], s89 offen lds
 v_add_u32 v7, 73728, v5
 v_add_u32 v8, 73728, v6
 ds_read_b64_tr_b16 a[24:25], v7 offset:0
 ds_read_b64_tr_b16 a[26:27], v7 offset:1536
 ds_read_b64_tr_b16 a[104:105], v7 offset:8
 ds_read_b64_tr_b16 a[106:107], v7 offset:1544
 ds_read_b64_tr_b16 a[184:185], v8 offset:64
 ds_read_b64_tr_b16 a[186:187], v8 offset:1600
 ds_read_b64_tr_b16 a[28:29], v7 offset:12288
 ds_read_b64_tr_b16 a[30:31], v7 offset:13824
 ds_read_b64_tr_b16 a[108:109], v7 offset:12296
 ds_read_b64_tr_b16 a[110:111], v7 offset:13832
 ds_read_b64_tr_b16 a[188:189], v8 offset:12352
 ds_read_b64_tr_b16 a[190:191], v8 offset:13888
 s_waitcnt lgkmcnt(0)
 s_waitcnt vmcnt(24)
 s_barrier
 s_add_u32 s89, s87, 7077888
 s_add_u32 m0, s88, 73728
 s_nop 0
 buffer_load_dwordx4 v2, s[8:11], s89 offen lds
 s_add_u32 m0, s88, 74752
 s_nop 0
 buffer_load_dwordx4 v3, s[8:11], s89 offen lds
 s_add_u32 m0, s88, 75776
 s_nop 0
 buffer_load_dwordx4 v4, s[8:11], s89 offen lds
 s_add_u32 s89, s87, 7176192
 s_add_u32 m0, s88, 76800
 s_nop 0
 buffer_load_dwordx4 v2, s[8:11], s89 offen lds
 s_add_u32 m0, s88, 77824
 s_nop 0
 buffer_load_dwordx4 v3, s[8:11], s89 offen lds
 s_add_u32 m0, s88, 78848
 s_nop 0
 buffer_load_dwordx4 v4, s[8:11], s89 offen lds
 v_add_u32 v7, 98304, v5
 v_add_u32 v8, 98304, v6
 ds_read_b64_tr_b16 a[32:33], v7 offset:0
 ds_read_b64_tr_b16 a[34:35], v7 offset:1536
 ds_read_b64_tr_b16 a[112:113], v7 offset:8
 ds_read_b64_tr_b16 a[114:115], v7 offset:1544
 ds_read_b64_tr_b16 a[192:193], v8 offset:64
 ds_read_b64_tr_b16 a[194:195], v8 offset:1600
 ds_read_b64_tr_b16 a[36:37], v7 offset:12288
 ds_read_b64_tr_b16 a[38:39], v7 offset:13824
 ds_read_b64_tr_b16 a[116:117], v7 offset:12296
 ds_read_b64_tr_b16 a[118:119], v7 offset:13832
 ds_read_b64_tr_b16 a[196:197], v8 offset:12352
 ds_read_b64_tr_b16 a[198:199], v8 offset:13888
 s_waitcnt lgkmcnt(0)
 s_waitcnt vmcnt(24)
 s_barrier
 v_add_u32 v7, 122880, v5
 v_add_u32 v8, 122880, v6
 ds_read_b64_tr_b16 a[40:41], v7 offset:0
 ds_read_b64_tr_b16 a[42:43], v7 offset:1536
 ds_read_b64_tr_b16 a[120:121], v7 offset:8
 ds_read_b64_tr_b16 a[122:123], v7 offset:1544
 ds_read_b64_tr_b16 a[200:201], v8 offset:64
 ds_read_b64_tr_b16 a[202:203], v8 offset:1600
 ds_read_b64_tr_b16 a[44:45], v7 offset:12288
 ds_read_b64_tr_b16 a[46:47], v7 offset:13824
 ds_read_b64_tr_b16 a[124:125], v7 offset:12296
 ds_read_b64_tr_b16 a[126:127], v7 offset:13832
 ds_read_b64_tr_b16 a[204:205], v8 offset:12352
 ds_read_b64_tr_b16 a[206:207], v8 offset:13888
 s_waitcnt lgkmcnt(0)
 s_waitcnt vmcnt(18)
 s_barrier
 v_add_u32 v7, 0, v5
 v_add_u32 v8, 0, v6
 ds_read_b64_tr_b16 a[48:49], v7 offset:0
 ds_read_b64_tr_b16 a[50:51], v7 offset:1536
 ds_read_b64_tr_b16 a[128:129], v7 offset:8
 ds_read_b64_tr_b16 a[130:131], v7 offset:1544
 ds_read_b64_tr_b16 a[208:209], v8 offset:64
 ds_read_b64_tr_b16 a[210:211], v8 offset:1600
 ds_read_b64_tr_b16 a[52:53], v7 offset:12288
 ds_read_b64_tr_b16 a[54:55], v7 offset:13824
 ds_read_b64_tr_b16 a[132:133], v7 offset:12296
 ds_read_b64_tr_b16 a[134:135], v7 offset:13832
 ds_read_b64_tr_b16 a[212:213], v8 offset:12352
 ds_read_b64_tr_b16 a[214:215], v8 offset:13888
 s_waitcnt lgkmcnt(0)
 s_waitcnt vmcnt(12)
 s_barrier
 v_add_u32 v7, 24576, v5
 v_add_u32 v8, 24576, v6
 ds_read_b64_tr_b16 a[56:57], v7 offset:0
 ds_read_b64_tr_b16 a[58:59], v7 offset:1536
 ds_read_b64_tr_b16 a[136:137], v7 offset:8
 ds_read_b64_tr_b16 a[138:139], v7 offset:1544
 ds_read_b64_tr_b16 a[216:217], v8 offset:64
 ds_read_b64_tr_b16 a[218:219], v8 offset:1600
 ds_read_b64_tr_b16 a[60:61], v7 offset:12288
 ds_read_b64_tr_b16 a[62:63], v7 offset:13824
 ds_read_b64_tr_b16 a[140:141], v7 offset:12296
 ds_read_b64_tr_b16 a[142:143], v7 offset:13832
 ds_read_b64_tr_b16 a[220:221], v8 offset:12352
 ds_read_b64_tr_b16 a[222:223], v8 offset:13888
 s_waitcnt lgkmcnt(0)
 s_waitcnt vmcnt(6)
 s_barrier
 v_add_u32 v7, 49152, v5
 v_add_u32 v8, 49152, v6
 ds_read_b64_tr_b16 a[64:65], v7 offset:0
 ds_read_b64_tr_b16 a[66:67], v7 offset:1536
 ds_read_b64_tr_b16 a[144:145], v7 offset:8
 ds_read_b64_tr_b16 a[146:147], v7 offset:1544
 ds_read_b64_tr_b16 a[224:225], v8 offset:64
 ds_read_b64_tr_b16 a[226:227], v8 offset:1600
 ds_read_b64_tr_b16 a[68:69], v7 offset:12288
 ds_read_b64_tr_b16 a[70:71], v7 offset:13824
 ds_read_b64_tr_b16 a[148:149], v7 offset:12296
 ds_read_b64_tr_b16 a[150:151], v7 offset:13832
 ds_read_b64_tr_b16 a[228:229], v8 offset:12352
 ds_read_b64_tr_b16 a[230:231], v8 offset:13888
 s_waitcnt lgkmcnt(0)
 s_waitcnt vmcnt(0)
 s_barrier
 v_add_u32 v7, 73728, v5
 v_add_u32 v8, 73728, v6
 ds_read_b64_tr_b16 a[72:73], v7 offset:0
 ds_read_b64_tr_b16 a[74:75], v7 offset:1536
 ds_read_b64_tr_b16 a[152:153], v7 offset:8
 ds_read_b64_tr_b16 a[154:155], v7 offset:1544
 ds_read_b64_tr_b16 a[232:233], v8 offset:64
 ds_read_b64_tr_b16 a[234:235], v8 offset:1600
 ds_read_b64_tr_b16 a[76:77], v7 offset:12288
 ds_read_b64_tr_b16 a[78:79], v7 offset:13824
 ds_read_b64_tr_b16 a[156:157], v7 offset:12296
 ds_read_b64_tr_b16 a[158:159], v7 offset:13832
 ds_read_b64_tr_b16 a[236:237], v8 offset:12352
 ds_read_b64_tr_b16 a[238:239], v8 offset:13888
 s_waitcnt lgkmcnt(0)
 s_barrier
again_kv:
 s_sub_u32 s20, s16, 4
 s_lshl_b32 s20, s20, 3
 s_and_b32 s23, s17, 7
 s_add_u32 s20, s20, s23
 s_lshr_b32 s23, s17, 3
 s_mul_i32 s22, s23, 25165824
 s_add_u32 s22, s22, 53346304
 s_mul_i32 s23, s23, 32
 s_add_u32 s23, s23, s20
 s_lshl_b32 s23, s23, 7
 s_add_u32 s23, s23, s3
 s_add_u32 s15, s3, 65536
 v_mov_b32 v13, s15
 v_bfe_u32 v255, v0, 0, 6
 v_lshl_add_u32 v13, v255, 7, v13
 s_mov_b32 s92, 0
 s_mul_i32 s24, s21, 10240
 v_mov_b32 v9, s24
 v_bfe_u32 v255, v0, 0, 6
 v_lshl_add_u32 v9, v255, 4, v9
 v_bfe_u32 v255, v0, 4, 2
 v_lshlrev_b32 v10, 9, v255
 v_bfe_u32 v255, v0, 0, 4
 v_lshl_add_u32 v10, v255, 4, v10
 s_mul_i32 s86, s21, 3072
 v_mov_b32 v14, s86
 v_bfe_u32 v255, v0, 4, 2
 v_lshl_add_u32 v14, v255, 9, v14
 v_bfe_u32 v255, v0, 0, 4
 v_lshl_add_u32 v14, v255, 4, v14
 s_add_u32 s86, s86, 2048
 v_mov_b32 v15, s86
 v_bfe_u32 v255, v0, 5, 1
 v_lshl_add_u32 v15, v255, 9, v15
 v_bfe_u32 v255, v0, 4, 1
 v_lshl_add_u32 v15, v255, 8, v15
 v_bfe_u32 v255, v0, 0, 4
 v_lshl_add_u32 v15, v255, 4, v15
 s_mul_i32 s25, s20, 12288
 s_add_u32 s25, s25, s22
 s_mov_b32 s34, 0x20000000
 v_mov_b32 v16, 0x80000000
 v_mov_b32 v255, s23
 v_cmp_eq_u32 vcc, 0, v0
 s_nop 1
 v_cndmask_b32 v16, v16, v255, vcc
 s_mov_b32 s40, 0
 s_mov_b32 s41, 40960
 s_mov_b32 s42, 81920
 s_mov_b32 s43, 122880
 s_mov_b32 s29, 2097152
 s_cmp_gt_u32 s92, 0
 s_cbranch_scc1 hf_2004
 s_mov_b32 s100, 0
hs_2005:
 s_min_u32 s92, s92, 48
 s_lshl_b32 s93, s92, 9
 buffer_load_dword v4, v13, s[4:7], s93 offen sc1
 s_add_u32 s100, s100, 1
 s_cmp_gt_u32 s100, 200000
 s_cbranch_scc1 main_fail
 s_waitcnt vmcnt(0)
 v_cmp_eq_u32 vcc, 0, v4
 s_nop 1
 s_ff1_i32_b64 s93, vcc
 s_min_u32 s93, s93, 64
 s_lshr_b32 s93, s93, 2
 s_add_u32 s92, s92, s93
 s_cmp_gt_u32 s92, 0
 s_cbranch_scc0 hs_2005
hf_2004:
 s_add_u32 s30, s24, 0
 s_add_u32 m0, s30, 0
 s_add_u32 s89, s29, 0
 buffer_load_dwordx4 v9, s[4:7], s89 offen offset:0 sc1 lds
 buffer_load_dwordx4 v9, s[4:7], s89 offen offset:1024 sc1 lds
 buffer_load_dwordx4 v9, s[4:7], s89 offen offset:2048 sc1 lds
 buffer_load_dwordx4 v9, s[4:7], s89 offen offset:3072 sc1 lds
 s_add_u32 m0, s30, 4096
 s_add_u32 s89, s29, 4096
 buffer_load_dwordx4 v9, s[4:7], s89 offen offset:0 sc1 lds
 buffer_load_dwordx4 v9, s[4:7], s89 offen offset:1024 sc1 lds
 buffer_load_dwordx4 v9, s[4:7], s89 offen offset:2048 sc1 lds
 buffer_load_dwordx4 v9, s[4:7], s89 offen offset:3072 sc1 lds
 s_add_u32 m0, s30, 8192
 s_add_u32 s89, s29, 8192
 buffer_load_dwordx4 v9, s[4:7], s89 offen offset:0 sc1 lds
 buffer_load_dwordx4 v9, s[4:7], s89 offen offset:1024 sc1 lds
 s_add_u32 s29, s29, 40960
 s_cmp_gt_u32 s92, 1
 s_cbranch_scc1 hf_2006
 s_mov_b32 s100, 0
hs_2007:
 s_min_u32 s92, s92, 48
 s_lshl_b32 s93, s92, 9
 buffer_load_dword v4, v13, s[4:7], s93 offen sc1
 s_add_u32 s100, s100, 1
 s_cmp_gt_u32 s100, 200000
 s_cbranch_scc1 main_fail
 s_waitcnt vmcnt(0)
 v_cmp_eq_u32 vcc, 0, v4
 s_nop 1
 s_ff1_i32_b64 s93, vcc
 s_min_u32 s93, s93, 64
 s_lshr_b32 s93, s93, 2
 s_add_u32 s92, s92, s93
 s_cmp_gt_u32 s92, 1
 s_cbranch_scc0 hs_2007
hf_2006:
 s_add_u32 s30, s24, 40960
 s_add_u32 m0, s30, 0
 s_add_u32 s89, s29, 0
 buffer_load_dwordx4 v9, s[4:7], s89 offen offset:0 sc1 lds
 buffer_load_dwordx4 v9, s[4:7], s89 offen offset:1024 sc1 lds
 buffer_load_dwordx4 v9, s[4:7], s89 offen offset:2048 sc1 lds
 buffer_load_dwordx4 v9, s[4:7], s89 offen offset:3072 sc1 lds
 s_add_u32 m0, s30, 4096
 s_add_u32 s89, s29, 4096
 buffer_load_dwordx4 v9, s[4:7], s89 offen offset:0 sc1 lds
 buffer_load_dwordx4 v9, s[4:7], s89 offen offset:1024 sc1 lds
 buffer_load_dwordx4 v9, s[4:7], s89 offen offset:2048 sc1 lds
 buffer_load_dwordx4 v9, s[4:7], s89 offen offset:3072 sc1 lds
 s_add_u32 m0, s30, 8192
 s_add_u32 s89, s29, 8192
 buffer_load_dwordx4 v9, s[4:7], s89 offen offset:0 sc1 lds
 buffer_load_dwordx4 v9, s[4:7], s89 offen offset:1024 sc1 lds
 s_add_u32 s29, s29, 40960
 s_waitcnt vmcnt(10)
 s_barrier
 ds_read_b128 v[112:115], v10 offset:0
 ds_read_b128 v[116:119], v10 offset:256
 ds_read_b128 v[120:123], v10 offset:2048
 ds_read_b128 v[124:127], v10 offset:2304
 v_mov_b32 v11, v10
 s_mov_b32 s31, 0
proj_2008:
 s_waitcnt lgkmcnt(2)
 v_mfma_f32_16x16x32_bf16 v[64:67], a[0:3], v[112:115], 0
 ds_read_b128 v[128:131], v11 offset:4096
 v_mfma_f32_16x16x32_bf16 v[68:71], a[80:83], v[112:115], 0
 ds_read_b128 v[132:135], v11 offset:4352
 v_mfma_f32_16x16x32_bf16 v[72:75], a[160:163], v[112:115], 0
 s_add_u32 s90, s31, 2
 s_min_u32 s90, s90, 63
 v_mfma_f32_16x16x32_bf16 v[76:79], a[0:3], v[116:119], 0
 s_cmp_gt_u32 s92, s90
 s_cbranch_scc0 hsp_2009
hbk_2010:
 v_mfma_f32_16x16x32_bf16 v[80:83], a[80:83], v[116:119], 0
 v_mfma_f32_16x16x32_bf16 v[84:87], a[160:163], v[116:119], 0
 s_waitcnt lgkmcnt(2)
 v_mfma_f32_16x16x32_bf16 v[64:67], a[4:7], v[120:123], v[64:67]
 ds_read_b128 v[136:139], v11 offset:6144
 v_mfma_f32_16x16x32_bf16 v[68:71], a[84:87], v[120:123], v[68:71]
 ds_read_b128 v[140:143], v11 offset:6400
 v_mfma_f32_16x16x32_bf16 v[72:75], a[164:167], v[120:123], v[72:75]
 v_cvt_pk_bf16_f32 v144, v88, v89
 v_mfma_f32_16x16x32_bf16 v[76:79], a[4:7], v[124:127], v[76:79]
 v_cvt_pk_bf16_f32 v145, v90, v91
 v_mfma_f32_16x16x32_bf16 v[80:83], a[84:87], v[124:127], v[80:83]
 v_cvt_pk_bf16_f32 v146, v92, v93
 v_mfma_f32_16x16x32_bf16 v[84:87], a[164:167], v[124:127], v[84:87]
 s_waitcnt lgkmcnt(2)
 v_cvt_pk_bf16_f32 v147, v94, v95
 v_mfma_f32_16x16x32_bf16 v[64:67], a[8:11], v[128:131], v[64:67]
 ds_read_b128 v[112:115], v11 offset:8192
 v_cvt_pk_bf16_f32 v148, v100, v101
 v_mfma_f32_16x16x32_bf16 v[68:71], a[88:91], v[128:131], v[68:71]
 ds_read_b128 v[116:119], v11 offset:8448
 v_cvt_pk_bf16_f32 v149, v102, v103
 v_mfma_f32_16x16x32_bf16 v[72:75], a[168:171], v[128:131], v[72:75]
 v_cvt_pk_bf16_f32 v150, v104, v105
 v_mfma_f32_16x16x32_bf16 v[76:79], a[8:11], v[132:135], v[76:79]
 v_cvt_pk_bf16_f32 v151, v106, v107
 v_mfma_f32_16x16x32_bf16 v[80:83], a[88:91], v[132:135], v[80:83]
 v_cvt_pk_bf16_f32 v152, v96, v97
 v_mfma_f32_16x16x32_bf16 v[84:87], a[168:171], v[132:135], v[84:87]
 s_waitcnt lgkmcnt(2)
 v_cvt_pk_bf16_f32 v153, v98, v99
 v_mfma_f32_16x16x32_bf16 v[64:67], a[12:15], v[136:139], v[64:67]
 ds_read_b128 v[120:123], v11 offset:10240
 v_cvt_pk_bf16_f32 v154, v108, v109
 v_mfma_f32_16x16x32_bf16 v[68:71], a[92:95], v[136:139], v[68:71]
 ds_read_b128 v[124:127], v11 offset:10496
 v_cvt_pk_bf16_f32 v155, v110, v111
 v_mfma_f32_16x16x32_bf16 v[72:75], a[172:175], v[136:139], v[72:75]
 v_mfma_f32_16x16x32_bf16 v[76:79], a[12:15], v[140:143], v[76:79]
 v_permlane16_swap_b32 v152, v154
 v_mfma_f32_16x16x32_bf16 v[80:83], a[92:95], v[140:143], v[80:83]
 v_permlane16_swap_b32 v153, v155
 v_mfma_f32_16x16x32_bf16 v[84:87], a[172:175], v[140:143], v[84:87]
 s_waitcnt lgkmcnt(2)
 v_mfma_f32_16x16x32_bf16 v[64:67], a[16:19], v[112:115], v[64:67]
 ds_read_b128 v[128:131], v11 offset:12288
 v_mfma_f32_16x16x32_bf16 v[68:71], a[96:99], v[112:115], v[68:71]
 ds_read_b128 v[132:135], v11 offset:12544
 v_mfma_f32_16x16x32_bf16 v[72:75], a[176:179], v[112:115], v[72:75]
 buffer_store_dwordx4 v[144:147], v14, s[4:7], s34 offen sc1
 v_mfma_f32_16x16x32_bf16 v[76:79], a[16:19], v[116:119], v[76:79]
 v_mfma_f32_16x16x32_bf16 v[80:83], a[96:99], v[116:119], v[80:83]
 buffer_store_dwordx4 v[148:151], v14, s[4:7], s34 offen offset:256 sc1
 v_mfma_f32_16x16x32_bf16 v[84:87], a[176:179], v[116:119], v[84:87]
 s_waitcnt lgkmcnt(2)
 v_mfma_f32_16x16x32_bf16 v[64:67], a[20:23], v[120:123], v[64:67]
 ds_read_b128 v[136:139], v11 offset:14336
 v_mfma_f32_16x16x32_bf16 v[68:71], a[100:103], v[120:123], v[68:71]
 ds_read_b128 v[140:143], v11 offset:14592
 v_mfma_f32_16x16x32_bf16 v[72:75], a[180:183], v[120:123], v[72:75]
 buffer_store_dwordx4 v[152:155], v15, s[4:7], s34 offen sc1
 v_mfma_f32_16x16x32_bf16 v[76:79], a[20:23], v[124:127], v[76:79]
 s_mov_b32 s34, s25
 s_add_u32 s25, s25, 393216
 v_mfma_f32_16x16x32_bf16 v[80:83], a[100:103], v[124:127], v[80:83]
 s_cmp_ge_u32 s31, 62
 s_cselect_b32 s29, 0x20000000, s29
 s_add_u32 s30, s24, s42
 v_mfma_f32_16x16x32_bf16 v[84:87], a[180:183], v[124:127], v[84:87]
 s_waitcnt lgkmcnt(2)
 v_mfma_f32_16x16x32_bf16 v[64:67], a[24:27], v[128:131], v[64:67]
 ds_read_b128 v[112:115], v11 offset:16384
 v_mfma_f32_16x16x32_bf16 v[68:71], a[104:107], v[128:131], v[68:71]
 ds_read_b128 v[116:119], v11 offset:16640
 v_mfma_f32_16x16x32_bf16 v[72:75], a[184:187], v[128:131], v[72:75]
 s_add_u32 m0, s30, 0
 s_add_u32 s89, s29, 0
 v_mfma_f32_16x16x32_bf16 v[76:79], a[24:27], v[132:135], v[76:79]
 buffer_load_dwordx4 v9, s[4:7], s89 offen offset:0 sc1 lds
 v_mfma_f32_16x16x32_bf16 v[80:83], a[104:107], v[132:135], v[80:83]
 v_mfma_f32_16x16x32_bf16 v[84:87], a[184:187], v[132:135], v[84:87]
 s_waitcnt lgkmcnt(2)
 v_mfma_f32_16x16x32_bf16 v[64:67], a[28:31], v[136:139], v[64:67]
 ds_read_b128 v[120:123], v11 offset:18432
 v_mfma_f32_16x16x32_bf16 v[68:71], a[108:111], v[136:139], v[68:71]
 ds_read_b128 v[124:127], v11 offset:18688
 v_mfma_f32_16x16x32_bf16 v[72:75], a[188:191], v[136:139], v[72:75]
 v_mfma_f32_16x16x32_bf16 v[76:79], a[28:31], v[140:143], v[76:79]
 buffer_load_dwordx4 v9, s[4:7], s89 offen offset:1024 sc1 lds
 v_mfma_f32_16x16x32_bf16 v[80:83], a[108:111], v[140:143], v[80:83]
 v_mfma_f32_16x16x32_bf16 v[84:87], a[188:191], v[140:143], v[84:87]
 s_waitcnt lgkmcnt(2)
 v_mfma_f32_16x16x32_bf16 v[64:67], a[32:35], v[112:115], v[64:67]
 ds_read_b128 v[128:131], v11 offset:20480
 v_mfma_f32_16x16x32_bf16 v[68:71], a[112:115], v[112:115], v[68:71]
 ds_read_b128 v[132:135], v11 offset:20736
 v_mfma_f32_16x16x32_bf16 v[72:75], a[192:195], v[112:115], v[72:75]
 v_mfma_f32_16x16x32_bf16 v[76:79], a[32:35], v[116:119], v[76:79]
 buffer_load_dwordx4 v9, s[4:7], s89 offen offset:2048 sc1 lds
 v_add_u32 v12, s41, v10
 v_mfma_f32_16x16x32_bf16 v[80:83], a[112:115], v[116:119], v[80:83]
 v_mov_b32 v17, s31
 v_mfma_f32_16x16x32_bf16 v[84:87], a[192:195], v[116:119], v[84:87]
 s_waitcnt lgkmcnt(2)
 v_mfma_f32_16x16x32_bf16 v[64:67], a[36:39], v[120:123], v[64:67]
 ds_read_b128 v[136:139], v11 offset:22528
 v_mfma_f32_16x16x32_bf16 v[68:71], a[116:119], v[120:123], v[68:71]
 ds_read_b128 v[140:143], v11 offset:22784
 v_mfma_f32_16x16x32_bf16 v[72:75], a[196:199], v[120:123], v[72:75]
 v_mfma_f32_16x16x32_bf16 v[76:79], a[36:39], v[124:127], v[76:79]
 buffer_load_dwordx4 v9, s[4:7], s89 offen offset:3072 sc1 lds
 v_mfma_f32_16x16x32_bf16 v[80:83], a[116:119], v[124:127], v[80:83]
 v_mfma_f32_16x16x32_bf16 v[84:87], a[196:199], v[124:127], v[84:87]
 s_waitcnt lgkmcnt(2)
 v_mfma_f32_16x16x32_bf16 v[64:67], a[40:43], v[128:131], v[64:67]
 ds_read_b128 v[112:115], v11 offset:24576
 v_mfma_f32_16x16x32_bf16 v[68:71], a[120:123], v[128:131], v[68:71]
 ds_read_b128 v[116:119], v11 offset:24832
 v_mfma_f32_16x16x32_bf16 v[72:75], a[200:203], v[128:131], v[72:75]
 s_add_u32 m0, s30, 4096
 s_add_u32 s89, s29, 4096
 v_mfma_f32_16x16x32_bf16 v[76:79], a[40:43], v[132:135], v[76:79]
 buffer_load_dwordx4 v9, s[4:7], s89 offen offset:0 sc1 lds
 v_mfma_f32_16x16x32_bf16 v[80:83], a[120:123], v[132:135], v[80:83]
 v_mfma_f32_16x16x32_bf16 v[84:87], a[200:203], v[132:135], v[84:87]
 s_waitcnt lgkmcnt(2)
 v_mfma_f32_16x16x32_bf16 v[64:67], a[44:47], v[136:139], v[64:67]
 ds_read_b128 v[120:123], v11 offset:26624
 v_mfma_f32_16x16x32_bf16 v[68:71], a[124:127], v[136:139], v[68:71]
 ds_read_b128 v[124:127], v11 offset:26880
 v_mfma_f32_16x16x32_bf16 v[72:75], a[204:207], v[136:139], v[72:75]
 v_mfma_f32_16x16x32_bf16 v[76:79], a[44:47], v[140:143], v[76:79]
 buffer_load_dwordx4 v9, s[4:7], s89 offen offset:1024 sc1 lds
 v_mfma_f32_16x16x32_bf16 v[80:83], a[124:127], v[140:143], v[80:83]
 v_mfma_f32_16x16x32_bf16 v[84:87], a[204:207], v[140:143], v[84:87]
 s_waitcnt lgkmcnt(2)
 v_mfma_f32_16x16x32_bf16 v[64:67], a[48:51], v[112:115], v[64:67]
 ds_read_b128 v[128:131], v11 offset:28672
 v_mfma_f32_16x16x32_bf16 v[68:71], a[128:131], v[112:115], v[68:71]
 ds_read_b128 v[132:135], v11 offset:28928
 v_mfma_f32_16x16x32_bf16 v[72:75], a[208:211], v[112:115], v[72:75]
 v_mfma_f32_16x16x32_bf16 v[76:79], a[48:51], v[116:119], v[76:79]
 buffer_load_dwordx4 v9, s[4:7], s89 offen offset:2048 sc1 lds
 v_mfma_f32_16x16x32_bf16 v[80:83], a[128:131], v[116:119], v[80:83]
 v_mfma_f32_16x16x32_bf16 v[84:87], a[208:211], v[116:119], v[84:87]
 s_waitcnt lgkmcnt(2)
 v_mfma_f32_16x16x32_bf16 v[64:67], a[52:55], v[120:123], v[64:67]
 ds_read_b128 v[136:139], v11 offset:30720
 v_mfma_f32_16x16x32_bf16 v[68:71], a[132:135], v[120:123], v[68:71]
 ds_read_b128 v[140:143], v11 offset:30976
 v_mfma_f32_16x16x32_bf16 v[72:75], a[212:215], v[120:123], v[72:75]
 v_mfma_f32_16x16x32_bf16 v[76:79], a[52:55], v[124:127], v[76:79]
 buffer_load_dwordx4 v9, s[4:7], s89 offen offset:3072 sc1 lds
 v_mfma_f32_16x16x32_bf16 v[80:83], a[132:135], v[124:127], v[80:83]
 v_mfma_f32_16x16x32_bf16 v[84:87], a[212:215], v[124:127], v[84:87]
 s_waitcnt lgkmcnt(2)
 v_mfma_f32_16x16x32_bf16 v[64:67], a[56:59], v[128:131], v[64:67]
 ds_read_b128 v[112:115], v11 offset:32768
 v_mfma_f32_16x16x32_bf16 v[68:71], a[136:139], v[128:131], v[68:71]
 ds_read_b128 v[116:119], v11 offset:33024
 v_mfma_f32_16x16x32_bf16 v[72:75], a[216:219], v[128:131], v[72:75]
 s_add_u32 m0, s30, 8192
 s_add_u32 s89, s29, 8192
 v_mfma_f32_16x16x32_bf16 v[76:79], a[56:59], v[132:135], v[76:79]
 buffer_load_dwordx4 v9, s[4:7], s89 offen offset:0 sc1 lds
 v_mfma_f32_16x16x32_bf16 v[80:83], a[136:139], v[132:135], v[80:83]
 v_mfma_f32_16x16x32_bf16 v[84:87], a[216:219], v[132:135], v[84:87]
 s_waitcnt lgkmcnt(2)
 v_mfma_f32_16x16x32_bf16 v[64:67], a[60:63], v[136:139], v[64:67]
 ds_read_b128 v[120:123], v11 offset:34816
 v_mfma_f32_16x16x32_bf16 v[68:71], a[140:143], v[136:139], v[68:71]
 ds_read_b128 v[124:127], v11 offset:35072
 v_mfma_f32_16x16x32_bf16 v[72:75], a[220:223], v[136:139], v[72:75]
 v_mfma_f32_16x16x32_bf16 v[76:79], a[60:63], v[140:143], v[76:79]
 buffer_load_dwordx4 v9, s[4:7], s89 offen offset:1024 sc1 lds
 v_mfma_f32_16x16x32_bf16 v[80:83], a[140:143], v[140:143], v[80:83]
 v_mfma_f32_16x16x32_bf16 v[84:87], a[220:223], v[140:143], v[84:87]
 s_waitcnt lgkmcnt(2)
 v_mfma_f32_16x16x32_bf16 v[64:67], a[64:67], v[112:115], v[64:67]
 ds_read_b128 v[128:131], v11 offset:36864
 v_mfma_f32_16x16x32_bf16 v[68:71], a[144:147], v[112:115], v[68:71]
 ds_read_b128 v[132:135], v11 offset:37120
 v_mfma_f32_16x16x32_bf16 v[72:75], a[224:227], v[112:115], v[72:75]
 v_mfma_f32_16x16x32_bf16 v[76:79], a[64:67], v[116:119], v[76:79]
 v_mfma_f32_16x16x32_bf16 v[80:83], a[144:147], v[116:119], v[80:83]
 v_mfma_f32_16x16x32_bf16 v[84:87], a[224:227], v[116:119], v[84:87]
 s_waitcnt lgkmcnt(2)
 v_mfma_f32_16x16x32_bf16 v[64:67], a[68:71], v[120:123], v[64:67]
 ds_read_b128 v[136:139], v11 offset:38912
 v_mfma_f32_16x16x32_bf16 v[68:71], a[148:151], v[120:123], v[68:71]
 ds_read_b128 v[140:143], v11 offset:39168
 v_mfma_f32_16x16x32_bf16 v[72:75], a[228:231], v[120:123], v[72:75]
 s_waitcnt vmcnt(10)
 s_barrier
 v_mfma_f32_16x16x32_bf16 v[76:79], a[68:71], v[124:127], v[76:79]
 buffer_store_dword v17, v16, s[4:7], 0 offen sc1
 v_mfma_f32_16x16x32_bf16 v[80:83], a[148:151], v[124:127], v[80:83]
 v_mfma_f32_16x16x32_bf16 v[84:87], a[228:231], v[124:127], v[84:87]
 s_waitcnt lgkmcnt(2)
 v_mfma_f32_16x16x32_bf16 v[64:67], a[72:75], v[128:131], v[64:67]
 ds_read_b128 v[112:115], v12 offset:0
 v_mfma_f32_16x16x32_bf16 v[68:71], a[152:155], v[128:131], v[68:71]
 ds_read_b128 v[116:119], v12 offset:256
 v_mfma_f32_16x16x32_bf16 v[72:75], a[232:235], v[128:131], v[72:75]
 s_add_u32 s29, s29, 40960
 s_mov_b32 s30, s40
 s_mov_b32 s40, s41
 v_mfma_f32_16x16x32_bf16 v[76:79], a[72:75], v[132:135], v[76:79]
 s_mov_b32 s41, s42
 s_mov_b32 s42, s43
 s_mov_b32 s43, s30
 v_mfma_f32_16x16x32_bf16 v[80:83], a[152:155], v[132:135], v[80:83]
 v_mfma_f32_16x16x32_bf16 v[84:87], a[232:235], v[132:135], v[84:87]
 s_waitcnt lgkmcnt(2)
 v_mfma_f32_16x16x32_bf16 v[64:67], a[76:79], v[136:139], v[64:67]
 ds_read_b128 v[120:123], v12 offset:2048
 v_mfma_f32_16x16x32_bf16 v[68:71], a[156:159], v[136:139], v[68:71]
 ds_read_b128 v[124:127], v12 offset:2304
 v_mfma_f32_16x16x32_bf16 v[72:75], a[236:239], v[136:139], v[72:75]
 s_add_u32 s31, s31, 1
 s_cmp_lt_u32 s31, 64
 v_mfma_f32_16x16x32_bf16 v[76:79], a[76:79], v[140:143], v[76:79]
 v_mfma_f32_16x16x32_bf16 v[80:83], a[156:159], v[140:143], v[80:83]
 v_mfma_f32_16x16x32_bf16 v[84:87], a[236:239], v[140:143], v[84:87]
 s_waitcnt lgkmcnt(2)
 v_mfma_f32_16x16x32_bf16 v[88:91], a[0:3], v[112:115], 0
 ds_read_b128 v[128:131], v12 offset:4096
 v_mfma_f32_16x16x32_bf16 v[92:95], a[80:83], v[112:115], 0
 ds_read_b128 v[132:135], v12 offset:4352
 v_mfma_f32_16x16x32_bf16 v[96:99], a[160:163], v[112:115], 0
 s_add_u32 s90, s31, 2
 s_min_u32 s90, s90, 63
 v_mfma_f32_16x16x32_bf16 v[100:103], a[0:3], v[116:119], 0
 s_cmp_gt_u32 s92, s90
 s_cbranch_scc0 hsp_2011
hbk_2012:
 v_mfma_f32_16x16x32_bf16 v[104:107], a[80:83], v[116:119], 0
 v_mfma_f32_16x16x32_bf16 v[108:111], a[160:163], v[116:119], 0
 s_waitcnt lgkmcnt(2)
 v_mfma_f32_16x16x32_bf16 v[88:91], a[4:7], v[120:123], v[88:91]
 ds_read_b128 v[136:139], v12 offset:6144
 v_mfma_f32_16x16x32_bf16 v[92:95], a[84:87], v[120:123], v[92:95]
 ds_read_b128 v[140:143], v12 offset:6400
 v_mfma_f32_16x16x32_bf16 v[96:99], a[164:167], v[120:123], v[96:99]
 v_cvt_pk_bf16_f32 v144, v64, v65
 v_mfma_f32_16x16x32_bf16 v[100:103], a[4:7], v[124:127], v[100:103]
 v_cvt_pk_bf16_f32 v145, v66, v67
 v_mfma_f32_16x16x32_bf16 v[104:107], a[84:87], v[124:127], v[104:107]
 v_cvt_pk_bf16_f32 v146, v68, v69
 v_mfma_f32_16x16x32_bf16 v[108:111], a[164:167], v[124:127], v[108:111]
 s_waitcnt lgkmcnt(2)
 v_cvt_pk_bf16_f32 v147, v70, v71
 v_mfma_f32_16x16x32_bf16 v[88:91], a[8:11], v[128:131], v[88:91]
 ds_read_b128 v[112:115], v12 offset:8192
 v_cvt_pk_bf16_f32 v148, v76, v77
 v_mfma_f32_16x16x32_bf16 v[92:95], a[88:91], v[128:131], v[92:95]
 ds_read_b128 v[116:119], v12 offset:8448
 v_cvt_pk_bf16_f32 v149, v78, v79
 v_mfma_f32_16x16x32_bf16 v[96:99], a[168:171], v[128:131], v[96:99]
 v_cvt_pk_bf16_f32 v150, v80, v81
 v_mfma_f32_16x16x32_bf16 v[100:103], a[8:11], v[132:135], v[100:103]
 v_cvt_pk_bf16_f32 v151, v82, v83
 v_mfma_f32_16x16x32_bf16 v[104:107], a[88:91], v[132:135], v[104:107]
 v_cvt_pk_bf16_f32 v152, v72, v73
 v_mfma_f32_16x16x32_bf16 v[108:111], a[168:171], v[132:135], v[108:111]
 s_waitcnt lgkmcnt(2)
 v_cvt_pk_bf16_f32 v153, v74, v75
 v_mfma_f32_16x16x32_bf16 v[88:91], a[12:15], v[136:139], v[88:91]
 ds_read_b128 v[120:123], v12 offset:10240
 v_cvt_pk_bf16_f32 v154, v84, v85
 v_mfma_f32_16x16x32_bf16 v[92:95], a[92:95], v[136:139], v[92:95]
 ds_read_b128 v[124:127], v12 offset:10496
 v_cvt_pk_bf16_f32 v155, v86, v87
 v_mfma_f32_16x16x32_bf16 v[96:99], a[172:175], v[136:139], v[96:99]
 v_mfma_f32_16x16x32_bf16 v[100:103], a[12:15], v[140:143], v[100:103]
 v_permlane16_swap_b32 v152, v154
 v_mfma_f32_16x16x32_bf16 v[104:107], a[92:95], v[140:143], v[104:107]
 v_permlane16_swap_b32 v153, v155
 v_mfma_f32_16x16x32_bf16 v[108:111], a[172:175], v[140:143], v[108:111]
 s_waitcnt lgkmcnt(2)
 v_mfma_f32_16x16x32_bf16 v[88:91], a[16:19], v[112:115], v[88:91]
 ds_read_b128 v[128:131], v12 offset:12288
 v_mfma_f32_16x16x32_bf16 v[92:95], a[96:99], v[112:115], v[92:95]
 ds_read_b128 v[132:135], v12 offset:12544
 v_mfma_f32_16x16x32_bf16 v[96:99], a[176:179], v[112:115], v[96:99]
 buffer_store_dwordx4 v[144:147], v14, s[4:7], s34 offen sc1
 v_mfma_f32_16x16x32_bf16 v[100:103], a[16:19], v[116:119], v[100:103]
 v_mfma_f32_16x16x32_bf16 v[104:107], a[96:99], v[116:119], v[104:107]
 buffer_store_dwordx4 v[148:151], v14, s[4:7], s34 offen offset:256 sc1
 v_mfma_f32_16x16x32_bf16 v[108:111], a[176:179], v[116:119], v[108:111]
 s_waitcnt lgkmcnt(2)
 v_mfma_f32_16x16x32_bf16 v[88:91], a[20:23], v[120:123], v[88:91]
 ds_read_b128 v[136:139], v12 offset:14336
 v_mfma_f32_16x16x32_bf16 v[92:95], a[100:103], v[120:123], v[92:95]
 ds_read_b128 v[140:143], v12 offset:14592
 v_mfma_f32_16x16x32_bf16 v[96:99], a[180:183], v[120:123], v[96:99]
 buffer_store_dwordx4 v[152:155], v15, s[4:7], s34 offen sc1
 v_mfma_f32_16x16x32_bf16 v[100:103], a[20:23], v[124:127], v[100:103]
 s_mov_b32 s34, s25
 s_add_u32 s25, s25, 393216
 v_mfma_f32_16x16x32_bf16 v[104:107], a[100:103], v[124:127], v[104:107]
 s_cmp_ge_u32 s31, 62
 s_cselect_b32 s29, 0x20000000, s29
 s_add_u32 s30, s24, s42
 v_mfma_f32_16x16x32_bf16 v[108:111], a[180:183], v[124:127], v[108:111]
 s_waitcnt lgkmcnt(2)
 v_mfma_f32_16x16x32_bf16 v[88:91], a[24:27], v[128:131], v[88:91]
 ds_read_b128 v[112:115], v12 offset:16384
 v_mfma_f32_16x16x32_bf16 v[92:95], a[104:107], v[128:131], v[92:95]
 ds_read_b128 v[116:119], v12 offset:16640
 v_mfma_f32_16x16x32_bf16 v[96:99], a[184:187], v[128:131], v[96:99]
 s_add_u32 m0, s30, 0
 s_add_u32 s89, s29, 0
 v_mfma_f32_16x16x32_bf16 v[100:103], a[24:27], v[132:135], v[100:103]
 buffer_load_dwordx4 v9, s[4:7], s89 offen offset:0 sc1 lds
 v_mfma_f32_16x16x32_bf16 v[104:107], a[104:107], v[132:135], v[104:107]
 v_mfma_f32_16x16x32_bf16 v[108:111], a[184:187], v[132:135], v[108:111]
 s_waitcnt lgkmcnt(2)
 v_mfma_f32_16x16x32_bf16 v[88:91], a[28:31], v[136:139], v[88:91]
 ds_read_b128 v[120:123], v12 offset:18432
 v_mfma_f32_16x16x32_bf16 v[92:95], a[108:111], v[136:139], v[92:95]
 ds_read_b128 v[124:127], v12 offset:18688
 v_mfma_f32_16x16x32_bf16 v[96:99], a[188:191], v[136:139], v[96:99]
 v_mfma_f32_16x16x32_bf16 v[100:103], a[28:31], v[140:143], v[100:103]
 buffer_load_dwordx4 v9, s[4:7], s89 offen offset:1024 sc1 lds
 v_mfma_f32_16x16x32_bf16 v[104:107], a[108:111], v[140:143], v[104:107]
 v_mfma_f32_16x16x32_bf16 v[108:111], a[188:191], v[140:143], v[108:111]
 s_waitcnt lgkmcnt(2)
 v_mfma_f32_16x16x32_bf16 v[88:91], a[32:35], v[112:115], v[88:91]
 ds_read_b128 v[128:131], v12 offset:20480
 v_mfma_f32_16x16x32_bf16 v[92:95], a[112:115], v[112:115], v[92:95]
 ds_read_b128 v[132:135], v12 offset:20736
 v_mfma_f32_16x16x32_bf16 v[96:99], a[192:195], v[112:115], v[96:99]
 v_mfma_f32_16x16x32_bf16 v[100:103], a[32:35], v[116:119], v[100:103]
 buffer_load_dwordx4 v9, s[4:7], s89 offen offset:2048 sc1 lds
 v_add_u32 v11, s41, v10
 v_mfma_f32_16x16x32_bf16 v[104:107], a[112:115], v[116:119], v[104:107]
 v_mov_b32 v17, s31
 v_mfma_f32_16x16x32_bf16 v[108:111], a[192:195], v[116:119], v[108:111]
 s_waitcnt lgkmcnt(2)
 v_mfma_f32_16x16x32_bf16 v[88:91], a[36:39], v[120:123], v[88:91]
 ds_read_b128 v[136:139], v12 offset:22528
 v_mfma_f32_16x16x32_bf16 v[92:95], a[116:119], v[120:123], v[92:95]
 ds_read_b128 v[140:143], v12 offset:22784
 v_mfma_f32_16x16x32_bf16 v[96:99], a[196:199], v[120:123], v[96:99]
 v_mfma_f32_16x16x32_bf16 v[100:103], a[36:39], v[124:127], v[100:103]
 buffer_load_dwordx4 v9, s[4:7], s89 offen offset:3072 sc1 lds
 v_mfma_f32_16x16x32_bf16 v[104:107], a[116:119], v[124:127], v[104:107]
 v_mfma_f32_16x16x32_bf16 v[108:111], a[196:199], v[124:127], v[108:111]
 s_waitcnt lgkmcnt(2)
 v_mfma_f32_16x16x32_bf16 v[88:91], a[40:43], v[128:131], v[88:91]
 ds_read_b128 v[112:115], v12 offset:24576
 v_mfma_f32_16x16x32_bf16 v[92:95], a[120:123], v[128:131], v[92:95]
 ds_read_b128 v[116:119], v12 offset:24832
 v_mfma_f32_16x16x32_bf16 v[96:99], a[200:203], v[128:131], v[96:99]
 s_add_u32 m0, s30, 4096
 s_add_u32 s89, s29, 4096
 v_mfma_f32_16x16x32_bf16 v[100:103], a[40:43], v[132:135], v[100:103]
 buffer_load_dwordx4 v9, s[4:7], s89 offen offset:0 sc1 lds
 v_mfma_f32_16x16x32_bf16 v[104:107], a[120:123], v[132:135], v[104:107]
 v_mfma_f32_16x16x32_bf16 v[108:111], a[200:203], v[132:135], v[108:111]
 s_waitcnt lgkmcnt(2)
 v_mfma_f32_16x16x32_bf16 v[88:91], a[44:47], v[136:139], v[88:91]
 ds_read_b128 v[120:123], v12 offset:26624
 v_mfma_f32_16x16x32_bf16 v[92:95], a[124:127], v[136:139], v[92:95]
 ds_read_b128 v[124:127], v12 offset:26880
 v_mfma_f32_16x16x32_bf16 v[96:99], a[204:207], v[136:139], v[96:99]
 v_mfma_f32_16x16x32_bf16 v[100:103], a[44:47], v[140:143], v[100:103]
 buffer_load_dwordx4 v9, s[4:7], s89 offen offset:1024 sc1 lds
 v_mfma_f32_16x16x32_bf16 v[104:107], a[124:127], v[140:143], v[104:107]
 v_mfma_f32_16x16x32_bf16 v[108:111], a[204:207], v[140:143], v[108:111]
 s_waitcnt lgkmcnt(2)
 v_mfma_f32_16x16x32_bf16 v[88:91], a[48:51], v[112:115], v[88:91]
 ds_read_b128 v[128:131], v12 offset:28672
 v_mfma_f32_16x16x32_bf16 v[92:95], a[128:131], v[112:115], v[92:95]
 ds_read_b128 v[132:135], v12 offset:28928
 v_mfma_f32_16x16x32_bf16 v[96:99], a[208:211], v[112:115], v[96:99]
 v_mfma_f32_16x16x32_bf16 v[100:103], a[48:51], v[116:119], v[100:103]
 buffer_load_dwordx4 v9, s[4:7], s89 offen offset:2048 sc1 lds
 v_mfma_f32_16x16x32_bf16 v[104:107], a[128:131], v[116:119], v[104:107]
 v_mfma_f32_16x16x32_bf16 v[108:111], a[208:211], v[116:119], v[108:111]
 s_waitcnt lgkmcnt(2)
 v_mfma_f32_16x16x32_bf16 v[88:91], a[52:55], v[120:123], v[88:91]
 ds_read_b128 v[136:139], v12 offset:30720
 v_mfma_f32_16x16x32_bf16 v[92:95], a[132:135], v[120:123], v[92:95]
 ds_read_b128 v[140:143], v12 offset:30976
 v_mfma_f32_16x16x32_bf16 v[96:99], a[212:215], v[120:123], v[96:99]
 v_mfma_f32_16x16x32_bf16 v[100:103], a[52:55], v[124:127], v[100:103]
 buffer_load_dwordx4 v9, s[4:7], s89 offen offset:3072 sc1 lds
 v_mfma_f32_16x16x32_bf16 v[104:107], a[132:135], v[124:127], v[104:107]
 v_mfma_f32_16x16x32_bf16 v[108:111], a[212:215], v[124:127], v[108:111]
 s_waitcnt lgkmcnt(2)
 v_mfma_f32_16x16x32_bf16 v[88:91], a[56:59], v[128:131], v[88:91]
 ds_read_b128 v[112:115], v12 offset:32768
 v_mfma_f32_16x16x32_bf16 v[92:95], a[136:139], v[128:131], v[92:95]
 ds_read_b128 v[116:119], v12 offset:33024
 v_mfma_f32_16x16x32_bf16 v[96:99], a[216:219], v[128:131], v[96:99]
 s_add_u32 m0, s30, 8192
 s_add_u32 s89, s29, 8192
 v_mfma_f32_16x16x32_bf16 v[100:103], a[56:59], v[132:135], v[100:103]
 buffer_load_dwordx4 v9, s[4:7], s89 offen offset:0 sc1 lds
 v_mfma_f32_16x16x32_bf16 v[104:107], a[136:139], v[132:135], v[104:107]
 v_mfma_f32_16x16x32_bf16 v[108:111], a[216:219], v[132:135], v[108:111]
 s_waitcnt lgkmcnt(2)
 v_mfma_f32_16x16x32_bf16 v[88:91], a[60:63], v[136:139], v[88:91]
 ds_read_b128 v[120:123], v12 offset:34816
 v_mfma_f32_16x16x32_bf16 v[92:95], a[140:143], v[136:139], v[92:95]
 ds_read_b128 v[124:127], v12 offset:35072
 v_mfma_f32_16x16x32_bf16 v[96:99], a[220:223], v[136:139], v[96:99]
 v_mfma_f32_16x16x32_bf16 v[100:103], a[60:63], v[140:143], v[100:103]
 buffer_load_dwordx4 v9, s[4:7], s89 offen offset:1024 sc1 lds
 v_mfma_f32_16x16x32_bf16 v[104:107], a[140:143], v[140:143], v[104:107]
 v_mfma_f32_16x16x32_bf16 v[108:111], a[220:223], v[140:143], v[108:111]
 s_waitcnt lgkmcnt(2)
 v_mfma_f32_16x16x32_bf16 v[88:91], a[64:67], v[112:115], v[88:91]
 ds_read_b128 v[128:131], v12 offset:36864
 v_mfma_f32_16x16x32_bf16 v[92:95], a[144:147], v[112:115], v[92:95]
 ds_read_b128 v[132:135], v12 offset:37120
 v_mfma_f32_16x16x32_bf16 v[96:99], a[224:227], v[112:115], v[96:99]
 v_mfma_f32_16x16x32_bf16 v[100:103], a[64:67], v[116:119], v[100:103]
 v_mfma_f32_16x16x32_bf16 v[104:107], a[144:147], v[116:119], v[104:107]
 v_mfma_f32_16x16x32_bf16 v[108:111], a[224:227], v[116:119], v[108:111]
 s_waitcnt lgkmcnt(2)
 v_mfma_f32_16x16x32_bf16 v[88:91], a[68:71], v[120:123], v[88:91]
 ds_read_b128 v[136:139], v12 offset:38912
 v_mfma_f32_16x16x32_bf16 v[92:95], a[148:151], v[120:123], v[92:95]
 ds_read_b128 v[140:143], v12 offset:39168
 v_mfma_f32_16x16x32_bf16 v[96:99], a[228:231], v[120:123], v[96:99]
 s_waitcnt vmcnt(10)
 s_barrier
 v_mfma_f32_16x16x32_bf16 v[100:103], a[68:71], v[124:127], v[100:103]
 buffer_store_dword v17, v16, s[4:7], 0 offen sc1
 v_mfma_f32_16x16x32_bf16 v[104:107], a[148:151], v[124:127], v[104:107]
 v_mfma_f32_16x16x32_bf16 v[108:111], a[228:231], v[124:127], v[108:111]
 s_waitcnt lgkmcnt(2)
 v_mfma_f32_16x16x32_bf16 v[88:91], a[72:75], v[128:131], v[88:91]
 ds_read_b128 v[112:115], v11 offset:0
 v_mfma_f32_16x16x32_bf16 v[92:95], a[152:155], v[128:131], v[92:95]
 ds_read_b128 v[116:119], v11 offset:256
 v_mfma_f32_16x16x32_bf16 v[96:99], a[232:235], v[128:131], v[96:99]
 s_add_u32 s29, s29, 40960
 s_mov_b32 s30, s40
 s_mov_b32 s40, s41
 v_mfma_f32_16x16x32_bf16 v[100:103], a[72:75], v[132:135], v[100:103]
 s_mov_b32 s41, s42
 s_mov_b32 s42, s43
 s_mov_b32 s43, s30
 v_mfma_f32_16x16x32_bf16 v[104:107], a[152:155], v[132:135], v[104:107]
 v_mfma_f32_16x16x32_bf16 v[108:111], a[232:235], v[132:135], v[108:111]
 s_waitcnt lgkmcnt(2)
 v_mfma_f32_16x16x32_bf16 v[88:91], a[76:79], v[136:139], v[88:91]
 ds_read_b128 v[120:123], v11 offset:2048
 v_mfma_f32_16x16x32_bf16 v[92:95], a[156:159], v[136:139], v[92:95]
 ds_read_b128 v[124:127], v11 offset:2304
 v_mfma_f32_16x16x32_bf16 v[96:99], a[236:239], v[136:139], v[96:99]
 s_add_u32 s31, s31, 1
 s_cmp_lt_u32 s31, 64
 v_mfma_f32_16x16x32_bf16 v[100:103], a[76:79], v[140:143], v[100:103]
 v_mfma_f32_16x16x32_bf16 v[104:107], a[156:159], v[140:143], v[104:107]
 v_mfma_f32_16x16x32_bf16 v[108:111], a[236:239], v[140:143], v[108:111]
 s_cbranch_scc1 proj_2008
 v_cvt_pk_bf16_f32 v144, v88, v89
 v_cvt_pk_bf16_f32 v145, v90, v91
 v_cvt_pk_bf16_f32 v146, v92, v93
 v_cvt_pk_bf16_f32 v147, v94, v95
 s_nop 0
 v_cvt_pk_bf16_f32 v148, v100, v101
 v_cvt_pk_bf16_f32 v149, v102, v103
 v_cvt_pk_bf16_f32 v150, v104, v105
 v_cvt_pk_bf16_f32 v151, v106, v107
 v_cvt_pk_bf16_f32 v152, v96, v97
 v_cvt_pk_bf16_f32 v153, v98, v99
 v_cvt_pk_bf16_f32 v154, v108, v109
 v_cvt_pk_bf16_f32 v155, v110, v111
 s_nop 0
 v_permlane16_swap_b32 v152, v154
 v_permlane16_swap_b32 v153, v155
 buffer_store_dwordx4 v[144:147], v14, s[4:7], s34 offen sc1
 buffer_store_dwordx4 v[148:151], v14, s[4:7], s34 offen offset:256 sc1
 buffer_store_dwordx4 v[152:155], v15, s[4:7], s34 offen sc1
 s_waitcnt vmcnt(0) lgkmcnt(0)
 s_barrier
 v_mov_b32 v17, 64
 buffer_store_dword v17, v16, s[4:7], 0 offen sc1
 s_branch second
hsp_2009:
 s_mov_b32 s100, 0
hs_2013:
 s_min_u32 s92, s92, 48
 s_lshl_b32 s93, s92, 9
 buffer_load_dword v4, v13, s[4:7], s93 offen sc1
 s_add_u32 s100, s100, 1
 s_cmp_gt_u32 s100, 200000
 s_cbranch_scc1 main_fail
 s_waitcnt vmcnt(0)
 v_cmp_eq_u32 vcc, 0, v4
 s_nop 1
 s_ff1_i32_b64 s93, vcc
 s_min_u32 s93, s93, 64
 s_lshr_b32 s93, s93, 2
 s_add_u32 s92, s92, s93
 s_cmp_gt_u32 s92, s90
 s_cbranch_scc0 hs_2013
 s_branch hbk_2010
hsp_2011:
 s_mov_b32 s100, 0
hs_2014:
 s_min_u32 s92, s92, 48
 s_lshl_b32 s93, s92, 9
 buffer_load_dword v4, v13, s[4:7], s93 offen sc1
 s_add_u32 s100, s100, 1
 s_cmp_gt_u32 s100, 200000
 s_cbranch_scc1 main_fail
 s_waitcnt vmcnt(0)
 v_cmp_eq_u32 vcc, 0, v4
 s_nop 1
 s_ff1_i32_b64 s93, vcc
 s_min_u32 s93, s93, 64
 s_lshr_b32 s93, s93, 2
 s_add_u32 s92, s92, s93
 s_cmp_gt_u32 s92, s90
 s_cbranch_scc0 hs_2014
 s_branch hbk_2012
first_o:
 s_sub_u32 s20, s16, 4
 s_lshl_b32 s20, s20, 3
 s_and_b32 s23, s17, 7
 s_add_u32 s20, s20, s23
 s_load_dwordx2 s[8:9], s[0:1], 40
 s_mov_b32 s10, 7864320
 s_mov_b32 s11, 0x20000
 s_waitcnt vmcnt(0) lgkmcnt(0)
 s_mul_i32 s88, s21, 10240
 v_mov_b32 v2, s88
 v_bfe_u32 v255, v0, 0, 6
 v_lshl_add_u32 v2, v255, 4, v2
 s_mul_i32 s87, s20, 245760
 s_mul_i32 s86, s21, 320
 v_mov_b32 v5, s86
 v_bfe_u32 v255, v0, 5, 1
 s_mov_b32 s101, 10240
 v_mad_u32_u24 v5, v255, s101, v5
 v_bfe_u32 v255, v0, 2, 2
 s_mov_b32 s101, 1280
 v_mad_u32_u24 v5, v255, s101, v5
 v_bfe_u32 v255, v0, 4, 1
 v_lshl_add_u32 v5, v255, 5, v5
 v_bfe_u32 v255, v0, 0, 2
 v_lshl_add_u32 v5, v255, 3, v5
 s_add_u32 m0, s88, 0
 s_add_u32 s89, s87, 0
 buffer_load_dwordx4 v2, s[8:11], s89 offen offset:0 lds
 buffer_load_dwordx4 v2, s[8:11], s89 offen offset:1024 lds
 buffer_load_dwordx4 v2, s[8:11], s89 offen offset:2048 lds
 buffer_load_dwordx4 v2, s[8:11], s89 offen offset:3072 lds
 s_add_u32 m0, s88, 4096
 s_add_u32 s89, s87, 4096
 buffer_load_dwordx4 v2, s[8:11], s89 offen offset:0 lds
 buffer_load_dwordx4 v2, s[8:11], s89 offen offset:1024 lds
 buffer_load_dwordx4 v2, s[8:11], s89 offen offset:2048 lds
 buffer_load_dwordx4 v2, s[8:11], s89 offen offset:3072 lds
 s_add_u32 m0, s88, 8192
 s_add_u32 s89, s87, 8192
 buffer_load_dwordx4 v2, s[8:11], s89 offen offset:0 lds
 buffer_load_dwordx4 v2, s[8:11], s89 offen offset:1024 lds
 s_add_u32 m0, s88, 40960
 s_add_u32 s89, s87, 40960
 buffer_load_dwordx4 v2, s[8:11], s89 offen offset:0 lds
 buffer_load_dwordx4 v2, s[8:11], s89 offen offset:1024 lds
 buffer_load_dwordx4 v2, s[8:11], s89 offen offset:2048 lds
 buffer_load_dwordx4 v2, s[8:11], s89 offen offset:3072 lds
 s_add_u32 m0, s88, 45056
 s_add_u32 s89, s87, 45056
 buffer_load_dwordx4 v2, s[8:11], s89 offen offset:0 lds
 buffer_load_dwordx4 v2, s[8:11], s89 offen offset:1024 lds
 buffer_load_dwordx4 v2, s[8:11], s89 offen offset:2048 lds
 buffer_load_dwordx4 v2, s[8:11], s89 offen offset:3072 lds
 s_add_u32 m0, s88, 49152
 s_add_u32 s89, s87, 49152
 buffer_load_dwordx4 v2, s[8:11], s89 offen offset:0 lds
 buffer_load_dwordx4 v2, s[8:11], s89 offen offset:1024 lds
 s_add_u32 m0, s88, 81920
 s_add_u32 s89, s87, 81920
 buffer_load_dwordx4 v2, s[8:11], s89 offen offset:0 lds
 buffer_load_dwordx4 v2, s[8:11], s89 offen offset:1024 lds
 buffer_load_dwordx4 v2, s[8:11], s89 offen offset:2048 lds
 buffer_load_dwordx4 v2, s[8:11], s89 offen offset:3072 lds
 s_add_u32 m0, s88, 86016
 s_add_u32 s89, s87, 86016
 buffer_load_dwordx4 v2, s[8:11], s89 offen offset:0 lds
 buffer_load_dwordx4 v2, s[8:11], s89 offen offset:1024 lds
 buffer_load_dwordx4 v2, s[8:11], s89 offen offset:2048 lds
 buffer_load_dwordx4 v2, s[8:11], s89 offen offset:3072 lds
 s_add_u32 m0, s88, 90112
 s_add_u32 s89, s87, 90112
 buffer_load_dwordx4 v2, s[8:11], s89 offen offset:0 lds
 buffer_load_dwordx4 v2, s[8:11], s89 offen offset:1024 lds
 s_waitcnt vmcnt(20)
 s_barrier
 s_add_u32 m0, s88, 122880
 s_add_u32 s89, s87, 122880
 buffer_load_dwordx4 v2, s[8:11], s89 offen offset:0 lds
 buffer_load_dwordx4 v2, s[8:11], s89 offen offset:1024 lds
 buffer_load_dwordx4 v2, s[8:11], s89 offen offset:2048 lds
 buffer_load_dwordx4 v2, s[8:11], s89 offen offset:3072 lds
 s_add_u32 m0, s88, 126976
 s_add_u32 s89, s87, 126976
 buffer_load_dwordx4 v2, s[8:11], s89 offen offset:0 lds
 buffer_load_dwordx4 v2, s[8:11], s89 offen offset:1024 lds
 buffer_load_dwordx4 v2, s[8:11], s89 offen offset:2048 lds
 buffer_load_dwordx4 v2, s[8:11], s89 offen offset:3072 lds
 s_add_u32 m0, s88, 131072
 s_add_u32 s89, s87, 131072
 buffer_load_dwordx4 v2, s[8:11], s89 offen offset:0 lds
 buffer_load_dwordx4 v2, s[8:11], s89 offen offset:1024 lds
 v_add_u32 v7, 0, v5
 ds_read_b64_tr_b16 a[0:1], v7 offset:0
 ds_read_b64_tr_b16 a[2:3], v7 offset:5120
 ds_read_b64_tr_b16 a[48:49], v7 offset:64
 ds_read_b64_tr_b16 a[50:51], v7 offset:5184
 ds_read_b64_tr_b16 a[96:97], v7 offset:128
 ds_read_b64_tr_b16 a[98:99], v7 offset:5248
 ds_read_b64_tr_b16 a[144:145], v7 offset:192
 ds_read_b64_tr_b16 a[146:147], v7 offset:5312
 ds_read_b64_tr_b16 a[192:193], v7 offset:256
 ds_read_b64_tr_b16 a[194:195], v7 offset:5376
 s_waitcnt lgkmcnt(4)
 ds_read_b64_tr_b16 a[4:5], v7 offset:20480
 ds_read_b64_tr_b16 a[6:7], v7 offset:25600
 ds_read_b64_tr_b16 a[52:53], v7 offset:20544
 ds_read_b64_tr_b16 a[54:55], v7 offset:25664
 ds_read_b64_tr_b16 a[100:101], v7 offset:20608
 ds_read_b64_tr_b16 a[102:103], v7 offset:25728
 ds_read_b64_tr_b16 a[148:149], v7 offset:20672
 ds_read_b64_tr_b16 a[150:151], v7 offset:25792
 ds_read_b64_tr_b16 a[196:197], v7 offset:20736
 ds_read_b64_tr_b16 a[198:199], v7 offset:25856
 s_waitcnt lgkmcnt(0)
 s_waitcnt vmcnt(20)
 s_barrier
 s_add_u32 m0, s88, 0
 s_add_u32 s89, s87, 163840
 buffer_load_dwordx4 v2, s[8:11], s89 offen offset:0 lds
 buffer_load_dwordx4 v2, s[8:11], s89 offen offset:1024 lds
 buffer_load_dwordx4 v2, s[8:11], s89 offen offset:2048 lds
 buffer_load_dwordx4 v2, s[8:11], s89 offen offset:3072 lds
 s_add_u32 m0, s88, 4096
 s_add_u32 s89, s87, 167936
 buffer_load_dwordx4 v2, s[8:11], s89 offen offset:0 lds
 buffer_load_dwordx4 v2, s[8:11], s89 offen offset:1024 lds
 buffer_load_dwordx4 v2, s[8:11], s89 offen offset:2048 lds
 buffer_load_dwordx4 v2, s[8:11], s89 offen offset:3072 lds
 s_add_u32 m0, s88, 8192
 s_add_u32 s89, s87, 172032
 buffer_load_dwordx4 v2, s[8:11], s89 offen offset:0 lds
 buffer_load_dwordx4 v2, s[8:11], s89 offen offset:1024 lds
 v_add_u32 v7, 40960, v5
 ds_read_b64_tr_b16 a[8:9], v7 offset:0
 ds_read_b64_tr_b16 a[10:11], v7 offset:5120
 ds_read_b64_tr_b16 a[56:57], v7 offset:64
 ds_read_b64_tr_b16 a[58:59], v7 offset:5184
 ds_read_b64_tr_b16 a[104:105], v7 offset:128
 ds_read_b64_tr_b16 a[106:107], v7 offset:5248
 ds_read_b64_tr_b16 a[152:153], v7 offset:192
 ds_read_b64_tr_b16 a[154:155], v7 offset:5312
 ds_read_b64_tr_b16 a[200:201], v7 offset:256
 ds_read_b64_tr_b16 a[202:203], v7 offset:5376
 s_waitcnt lgkmcnt(4)
 ds_read_b64_tr_b16 a[12:13], v7 offset:20480
 ds_read_b64_tr_b16 a[14:15], v7 offset:25600
 ds_read_b64_tr_b16 a[60:61], v7 offset:20544
 ds_read_b64_tr_b16 a[62:63], v7 offset:25664
 ds_read_b64_tr_b16 a[108:109], v7 offset:20608
 ds_read_b64_tr_b16 a[110:111], v7 offset:25728
 ds_read_b64_tr_b16 a[156:157], v7 offset:20672
 ds_read_b64_tr_b16 a[158:159], v7 offset:25792
 ds_read_b64_tr_b16 a[204:205], v7 offset:20736
 ds_read_b64_tr_b16 a[206:207], v7 offset:25856
 s_waitcnt lgkmcnt(0)
 s_waitcnt vmcnt(20)
 s_barrier
 s_add_u32 m0, s88, 40960
 s_add_u32 s89, s87, 204800
 buffer_load_dwordx4 v2, s[8:11], s89 offen offset:0 lds
 buffer_load_dwordx4 v2, s[8:11], s89 offen offset:1024 lds
 buffer_load_dwordx4 v2, s[8:11], s89 offen offset:2048 lds
 buffer_load_dwordx4 v2, s[8:11], s89 offen offset:3072 lds
 s_add_u32 m0, s88, 45056
 s_add_u32 s89, s87, 208896
 buffer_load_dwordx4 v2, s[8:11], s89 offen offset:0 lds
 buffer_load_dwordx4 v2, s[8:11], s89 offen offset:1024 lds
 buffer_load_dwordx4 v2, s[8:11], s89 offen offset:2048 lds
 buffer_load_dwordx4 v2, s[8:11], s89 offen offset:3072 lds
 s_add_u32 m0, s88, 49152
 s_add_u32 s89, s87, 212992
 buffer_load_dwordx4 v2, s[8:11], s89 offen offset:0 lds
 buffer_load_dwordx4 v2, s[8:11], s89 offen offset:1024 lds
 v_add_u32 v7, 81920, v5
 ds_read_b64_tr_b16 a[16:17], v7 offset:0
 ds_read_b64_tr_b16 a[18:19], v7 offset:5120
 ds_read_b64_tr_b16 a[64:65], v7 offset:64
 ds_read_b64_tr_b16 a[66:67], v7 offset:5184
 ds_read_b64_tr_b16 a[112:113], v7 offset:128
 ds_read_b64_tr_b16 a[114:115], v7 offset:5248
 ds_read_b64_tr_b16 a[160:161], v7 offset:192
 ds_read_b64_tr_b16 a[162:163], v7 offset:5312
 ds_read_b64_tr_b16 a[208:209], v7 offset:256
 ds_read_b64_tr_b16 a[210:211], v7 offset:5376
 s_waitcnt lgkmcnt(4)
 ds_read_b64_tr_b16 a[20:21], v7 offset:20480
 ds_read_b64_tr_b16 a[22:23], v7 offset:25600
 ds_read_b64_tr_b16 a[68:69], v7 offset:20544
 ds_read_b64_tr_b16 a[70:71], v7 offset:25664
 ds_read_b64_tr_b16 a[116:117], v7 offset:20608
 ds_read_b64_tr_b16 a[118:119], v7 offset:25728
 ds_read_b64_tr_b16 a[164:165], v7 offset:20672
 ds_read_b64_tr_b16 a[166:167], v7 offset:25792
 ds_read_b64_tr_b16 a[212:213], v7 offset:20736
 ds_read_b64_tr_b16 a[214:215], v7 offset:25856
 s_waitcnt lgkmcnt(0)
 s_waitcnt vmcnt(20)
 s_barrier
 v_add_u32 v7, 122880, v5
 ds_read_b64_tr_b16 a[24:25], v7 offset:0
 ds_read_b64_tr_b16 a[26:27], v7 offset:5120
 ds_read_b64_tr_b16 a[72:73], v7 offset:64
 ds_read_b64_tr_b16 a[74:75], v7 offset:5184
 ds_read_b64_tr_b16 a[120:121], v7 offset:128
 ds_read_b64_tr_b16 a[122:123], v7 offset:5248
 ds_read_b64_tr_b16 a[168:169], v7 offset:192
 ds_read_b64_tr_b16 a[170:171], v7 offset:5312
 ds_read_b64_tr_b16 a[216:217], v7 offset:256
 ds_read_b64_tr_b16 a[218:219], v7 offset:5376
 s_waitcnt lgkmcnt(4)
 ds_read_b64_tr_b16 a[28:29], v7 offset:20480
 ds_read_b64_tr_b16 a[30:31], v7 offset:25600
 ds_read_b64_tr_b16 a[76:77], v7 offset:20544
 ds_read_b64_tr_b16 a[78:79], v7 offset:25664
 ds_read_b64_tr_b16 a[124:125], v7 offset:20608
 ds_read_b64_tr_b16 a[126:127], v7 offset:25728
 ds_read_b64_tr_b16 a[172:173], v7 offset:20672
 ds_read_b64_tr_b16 a[174:175], v7 offset:25792
 ds_read_b64_tr_b16 a[220:221], v7 offset:20736
 ds_read_b64_tr_b16 a[222:223], v7 offset:25856
 s_waitcnt lgkmcnt(0)
 s_waitcnt vmcnt(10)
 s_barrier
 v_add_u32 v7, 0, v5
 ds_read_b64_tr_b16 a[32:33], v7 offset:0
 ds_read_b64_tr_b16 a[34:35], v7 offset:5120
 ds_read_b64_tr_b16 a[80:81], v7 offset:64
 ds_read_b64_tr_b16 a[82:83], v7 offset:5184
 ds_read_b64_tr_b16 a[128:129], v7 offset:128
 ds_read_b64_tr_b16 a[130:131], v7 offset:5248
 ds_read_b64_tr_b16 a[176:177], v7 offset:192
 ds_read_b64_tr_b16 a[178:179], v7 offset:5312
 ds_read_b64_tr_b16 a[224:225], v7 offset:256
 ds_read_b64_tr_b16 a[226:227], v7 offset:5376
 s_waitcnt lgkmcnt(4)
 ds_read_b64_tr_b16 a[36:37], v7 offset:20480
 ds_read_b64_tr_b16 a[38:39], v7 offset:25600
 ds_read_b64_tr_b16 a[84:85], v7 offset:20544
 ds_read_b64_tr_b16 a[86:87], v7 offset:25664
 ds_read_b64_tr_b16 a[132:133], v7 offset:20608
 ds_read_b64_tr_b16 a[134:135], v7 offset:25728
 ds_read_b64_tr_b16 a[180:181], v7 offset:20672
 ds_read_b64_tr_b16 a[182:183], v7 offset:25792
 ds_read_b64_tr_b16 a[228:229], v7 offset:20736
 ds_read_b64_tr_b16 a[230:231], v7 offset:25856
 s_waitcnt lgkmcnt(0)
 s_waitcnt vmcnt(0)
 s_barrier
 v_add_u32 v7, 40960, v5
 ds_read_b64_tr_b16 a[40:41], v7 offset:0
 ds_read_b64_tr_b16 a[42:43], v7 offset:5120
 ds_read_b64_tr_b16 a[88:89], v7 offset:64
 ds_read_b64_tr_b16 a[90:91], v7 offset:5184
 ds_read_b64_tr_b16 a[136:137], v7 offset:128
 ds_read_b64_tr_b16 a[138:139], v7 offset:5248
 ds_read_b64_tr_b16 a[184:185], v7 offset:192
 ds_read_b64_tr_b16 a[186:187], v7 offset:5312
 ds_read_b64_tr_b16 a[232:233], v7 offset:256
 ds_read_b64_tr_b16 a[234:235], v7 offset:5376
 s_waitcnt lgkmcnt(4)
 ds_read_b64_tr_b16 a[44:45], v7 offset:20480
 ds_read_b64_tr_b16 a[46:47], v7 offset:25600
 ds_read_b64_tr_b16 a[92:93], v7 offset:20544
 ds_read_b64_tr_b16 a[94:95], v7 offset:25664
 ds_read_b64_tr_b16 a[140:141], v7 offset:20608
 ds_read_b64_tr_b16 a[142:143], v7 offset:25728
 ds_read_b64_tr_b16 a[188:189], v7 offset:20672
 ds_read_b64_tr_b16 a[190:191], v7 offset:25792
 ds_read_b64_tr_b16 a[236:237], v7 offset:20736
 ds_read_b64_tr_b16 a[238:239], v7 offset:25856
 s_waitcnt lgkmcnt(0)
 s_barrier
again_o:
 s_sub_u32 s20, s16, 4
 s_lshl_b32 s20, s20, 3
 s_and_b32 s23, s17, 7
 s_add_u32 s20, s20, s23
 v_bfe_u32 v255, v0, 0, 2
 v_lshlrev_b32 v10, 4, v255
 v_bfe_u32 v255, v0, 2, 1
 v_lshl_add_u32 v10, v255, 7, v10
 v_bfe_u32 v255, v0, 3, 1
 v_lshl_add_u32 v10, v255, 6, v10
 v_bfe_u32 v255, v0, 4, 1
 v_lshl_add_u32 v10, v255, 8, v10
 v_bfe_u32 v255, v0, 5, 1
 v_lshl_add_u32 v10, v255, 9, v10
 s_mul_i32 s29, s21, 3072
 v_mov_b32 v9, s29
 v_bfe_u32 v255, v0, 0, 6
 v_lshl_add_u32 v9, v255, 4, v9
 s_mul_i32 s24, s20, 12288
 s_add_u32 s24, s24, 78512128
 s_lshl_b32 s25, s20, 9
 s_add_u32 s25, s25, 103677952
 s_lshl_b32 s23, s20, 7
 s_add_u32 s32, s23, 4096
 s_add_u32 s32, s32, s3
 s_add_u32 s27, s32, 4096
 s_lshr_b32 s23, s20, 3
 s_lshl_b32 s23, s23, 7
 s_and_b32 s26, s20, 7
 s_lshl_b32 s26, s26, 2
 s_add_u32 s23, s23, s26
 s_add_u32 s23, s23, 16384
 s_add_u32 s23, s23, s3
 s_cmp_eq_u32 s21, 0
 s_cselect_b32 s23, s23, 0x80000000
 v_mov_b32 v16, 0x80000000
 v_mov_b32 v255, s27
 v_cmp_eq_u32 vcc, 0, v0
 s_nop 1
 v_cndmask_b32 v16, v16, v255, vcc
 v_writelane_b32 v16, s23, 1
 s_mov_b32 s33, 0
 s_mul_i32 s26, s21, 327680
 v_mov_b32 v11, s26
 v_bfe_u32 v255, v0, 3, 2
 v_lshl_add_u32 v11, v255, 14, v11
 v_bfe_u32 v255, v0, 5, 1
 v_lshl_add_u32 v11, v255, 7, v11
 v_bfe_u32 v255, v0, 0, 3
 v_lshl_add_u32 v11, v255, 4, v11
 s_cmp_gt_u32 s33, 0
 s_cbranch_scc1 fw_done_2015
 s_mov_b32 s100, 0
fw_2016:
 s_load_dword s33, s[4:5], s32 glc
 s_add_u32 s100, s100, 1
 s_cmp_gt_u32 s100, 200000
 s_cbranch_scc1 main_fail
 s_waitcnt lgkmcnt(0)
 s_cmp_gt_u32 s33, 0
 s_cbranch_scc0 fw_2016
fw_done_2015:
 s_mov_b32 m0, s29
 s_nop 0
 buffer_load_dwordx4 v9, s[4:7], s24 offen offset:0 sc1 lds
 buffer_load_dwordx4 v9, s[4:7], s24 offen offset:1024 sc1 lds
 buffer_load_dwordx4 v9, s[4:7], s24 offen offset:2048 sc1 lds
 s_add_u32 s24, s24, 393216
 s_waitcnt vmcnt(0)
 s_barrier
 ds_read_b128 v[64:67], v10 offset:0
 ds_read_b128 v[68:71], v10 offset:1024
 ds_read_b128 v[72:75], v10 offset:2048
 ds_read_b128 v[76:79], v10 offset:3072
 ds_read_b128 v[80:83], v10 offset:4096
 ds_read_b128 v[84:87], v10 offset:5120
 ds_read_b128 v[88:91], v10 offset:6144
 ds_read_b128 v[92:95], v10 offset:7168
 ds_read_b128 v[96:99], v10 offset:8192
 ds_read_b128 v[100:103], v10 offset:9216
 ds_read_b128 v[104:107], v10 offset:10240
 ds_read_b128 v[108:111], v10 offset:11264
 s_mov_b32 s31, 0
 s_mov_b32 s28, 0x20000000
vo_2017:
 s_waitcnt lgkmcnt(0)
 v_mfma_f32_32x32x16_bf16 v[160:175], v[64:67], a[0:3], 0
 s_nop 3
 v_mfma_f32_32x32x16_bf16 v[160:175], v[68:71], a[4:7], v[160:175]
 s_nop 3
 v_mfma_f32_32x32x16_bf16 v[160:175], v[72:75], a[8:11], v[160:175]
 s_load_dword s33, s[4:5], s32 glc
 v_mfma_f32_32x32x16_bf16 v[160:175], v[76:79], a[12:15], v[160:175]
 v_cvt_pk_bf16_f32 v200, v176, v177
 v_cvt_pk_bf16_f32 v201, v178, v179
 v_mfma_f32_32x32x16_bf16 v[160:175], v[80:83], a[16:19], v[160:175]
 v_cvt_pk_bf16_f32 v202, v180, v181
 v_cvt_pk_bf16_f32 v203, v182, v183
 v_mfma_f32_32x32x16_bf16 v[160:175], v[84:87], a[20:23], v[160:175]
 buffer_store_dwordx4 v[200:203], v11, s[4:7], s28 offen sc1
 v_mfma_f32_32x32x16_bf16 v[160:175], v[88:91], a[24:27], v[160:175]
 v_cvt_pk_bf16_f32 v204, v184, v185
 v_cvt_pk_bf16_f32 v205, v186, v187
 v_mfma_f32_32x32x16_bf16 v[160:175], v[92:95], a[28:31], v[160:175]
 v_cvt_pk_bf16_f32 v206, v188, v189
 v_cvt_pk_bf16_f32 v207, v190, v191
 v_mfma_f32_32x32x16_bf16 v[160:175], v[96:99], a[32:35], v[160:175]
 buffer_store_dwordx4 v[204:207], v11, s[4:7], s28 offen offset:256 sc1
 v_mfma_f32_32x32x16_bf16 v[160:175], v[100:103], a[36:39], v[160:175]
 s_add_u32 s28, s25, 0
 v_mfma_f32_32x32x16_bf16 v[160:175], v[104:107], a[40:43], v[160:175]
 s_add_u32 s26, s31, 1
 s_min_u32 s26, s26, 63
 s_cmp_ge_u32 s31, 63
 s_cselect_b32 s24, 0x20000000, s24
 v_mov_b32 v17, s31
 v_mfma_f32_32x32x16_bf16 v[160:175], v[108:111], a[44:47], v[160:175]
 v_mfma_f32_32x32x16_bf16 v[176:191], v[64:67], a[48:51], 0
 s_nop 3
 v_mfma_f32_32x32x16_bf16 v[176:191], v[68:71], a[52:55], v[176:191]
 s_nop 3
 v_mfma_f32_32x32x16_bf16 v[176:191], v[72:75], a[56:59], v[176:191]
 v_mfma_f32_32x32x16_bf16 v[176:191], v[76:79], a[60:63], v[176:191]
 v_cvt_pk_bf16_f32 v192, v160, v161
 v_cvt_pk_bf16_f32 v193, v162, v163
 v_mfma_f32_32x32x16_bf16 v[176:191], v[80:83], a[64:67], v[176:191]
 v_cvt_pk_bf16_f32 v194, v164, v165
 v_cvt_pk_bf16_f32 v195, v166, v167
 v_mfma_f32_32x32x16_bf16 v[176:191], v[84:87], a[68:71], v[176:191]
 buffer_store_dwordx4 v[192:195], v11, s[4:7], s28 offen sc1
 v_mfma_f32_32x32x16_bf16 v[176:191], v[88:91], a[72:75], v[176:191]
 v_cvt_pk_bf16_f32 v196, v168, v169
 v_cvt_pk_bf16_f32 v197, v170, v171
 v_mfma_f32_32x32x16_bf16 v[176:191], v[92:95], a[76:79], v[176:191]
 s_cmp_gt_u32 s33, s26
 s_cbranch_scc0 vsp_2018
vbk_2019:
 s_add_u32 m0, s29, 12288
 v_cvt_pk_bf16_f32 v198, v172, v173
 v_cvt_pk_bf16_f32 v199, v174, v175
 v_mfma_f32_32x32x16_bf16 v[176:191], v[96:99], a[80:83], v[176:191]
 buffer_store_dwordx4 v[196:199], v11, s[4:7], s28 offen offset:256 sc1
 v_mfma_f32_32x32x16_bf16 v[176:191], v[100:103], a[84:87], v[176:191]
 s_add_u32 s28, s25, 65536
 buffer_load_dwordx4 v9, s[4:7], s24 offen offset:0 sc1 lds
 v_mfma_f32_32x32x16_bf16 v[176:191], v[104:107], a[88:91], v[176:191]
 buffer_load_dwordx4 v9, s[4:7], s24 offen offset:1024 sc1 lds
 v_mfma_f32_32x32x16_bf16 v[176:191], v[108:111], a[92:95], v[176:191]
 buffer_load_dwordx4 v9, s[4:7], s24 offen offset:2048 sc1 lds
 v_mfma_f32_32x32x16_bf16 v[160:175], v[64:67], a[96:99], 0
 s_nop 3
 v_mfma_f32_32x32x16_bf16 v[160:175], v[68:71], a[100:103], v[160:175]
 s_nop 3
 v_mfma_f32_32x32x16_bf16 v[160:175], v[72:75], a[104:107], v[160:175]
 v_mfma_f32_32x32x16_bf16 v[160:175], v[76:79], a[108:111], v[160:175]
 v_cvt_pk_bf16_f32 v200, v176, v177
 v_cvt_pk_bf16_f32 v201, v178, v179
 v_mfma_f32_32x32x16_bf16 v[160:175], v[80:83], a[112:115], v[160:175]
 v_cvt_pk_bf16_f32 v202, v180, v181
 v_cvt_pk_bf16_f32 v203, v182, v183
 v_mfma_f32_32x32x16_bf16 v[160:175], v[84:87], a[116:119], v[160:175]
 buffer_store_dwordx4 v[200:203], v11, s[4:7], s28 offen sc1
 v_mfma_f32_32x32x16_bf16 v[160:175], v[88:91], a[120:123], v[160:175]
 v_cvt_pk_bf16_f32 v204, v184, v185
 v_cvt_pk_bf16_f32 v205, v186, v187
 v_mfma_f32_32x32x16_bf16 v[160:175], v[92:95], a[124:127], v[160:175]
 s_waitcnt vmcnt(6)
 s_barrier
 v_cvt_pk_bf16_f32 v206, v188, v189
 v_cvt_pk_bf16_f32 v207, v190, v191
 v_mfma_f32_32x32x16_bf16 v[160:175], v[96:99], a[128:131], v[160:175]
 buffer_store_dwordx4 v[204:207], v11, s[4:7], s28 offen offset:256 sc1
 v_mfma_f32_32x32x16_bf16 v[160:175], v[100:103], a[132:135], v[160:175]
 s_add_u32 s28, s25, 131072
 buffer_store_dword v17, v16, s[4:7], 0 offen sc1
 v_mfma_f32_32x32x16_bf16 v[160:175], v[104:107], a[136:139], v[160:175]
 v_mfma_f32_32x32x16_bf16 v[160:175], v[108:111], a[140:143], v[160:175]
 v_mfma_f32_32x32x16_bf16 v[176:191], v[64:67], a[144:147], 0
 s_nop 3
 v_mfma_f32_32x32x16_bf16 v[176:191], v[68:71], a[148:151], v[176:191]
 s_nop 3
 v_mfma_f32_32x32x16_bf16 v[176:191], v[72:75], a[152:155], v[176:191]
 v_mfma_f32_32x32x16_bf16 v[176:191], v[76:79], a[156:159], v[176:191]
 v_cvt_pk_bf16_f32 v192, v160, v161
 v_cvt_pk_bf16_f32 v193, v162, v163
 v_mfma_f32_32x32x16_bf16 v[176:191], v[80:83], a[160:163], v[176:191]
 v_cvt_pk_bf16_f32 v194, v164, v165
 v_cvt_pk_bf16_f32 v195, v166, v167
 v_mfma_f32_32x32x16_bf16 v[176:191], v[84:87], a[164:167], v[176:191]
 buffer_store_dwordx4 v[192:195], v11, s[4:7], s28 offen sc1
 v_mfma_f32_32x32x16_bf16 v[176:191], v[88:91], a[168:171], v[176:191]
 v_cvt_pk_bf16_f32 v196, v168, v169
 v_cvt_pk_bf16_f32 v197, v170, v171
 v_mfma_f32_32x32x16_bf16 v[176:191], v[92:95], a[172:175], v[176:191]
 v_cvt_pk_bf16_f32 v198, v172, v173
 v_cvt_pk_bf16_f32 v199, v174, v175
 v_mfma_f32_32x32x16_bf16 v[176:191], v[96:99], a[176:179], v[176:191]
 buffer_store_dwordx4 v[196:199], v11, s[4:7], s28 offen offset:256 sc1
 v_mfma_f32_32x32x16_bf16 v[176:191], v[100:103], a[180:183], v[176:191]
 s_add_u32 s28, s25, 196608
 s_waitcnt vmcnt(5)
 s_barrier
 v_mfma_f32_32x32x16_bf16 v[176:191], v[104:107], a[184:187], v[176:191]
 ds_read_b128 v[112:115], v10 offset:12288
 ds_read_b128 v[116:119], v10 offset:13312
 v_mfma_f32_32x32x16_bf16 v[176:191], v[108:111], a[188:191], v[176:191]
 ds_read_b128 v[120:123], v10 offset:14336
 ds_read_b128 v[124:127], v10 offset:15360
 v_mfma_f32_32x32x16_bf16 v[160:175], v[64:67], a[192:195], 0
 s_nop 3
 ds_read_b128 v[128:131], v10 offset:16384
 v_mfma_f32_32x32x16_bf16 v[160:175], v[68:71], a[196:199], v[160:175]
 s_nop 3
 ds_read_b128 v[132:135], v10 offset:17408
 v_mfma_f32_32x32x16_bf16 v[160:175], v[72:75], a[200:203], v[160:175]
 ds_read_b128 v[136:139], v10 offset:18432
 ds_read_b128 v[140:143], v10 offset:19456
 v_mfma_f32_32x32x16_bf16 v[160:175], v[76:79], a[204:207], v[160:175]
 ds_read_b128 v[144:147], v10 offset:20480
 v_cvt_pk_bf16_f32 v200, v176, v177
 v_cvt_pk_bf16_f32 v201, v178, v179
 v_mfma_f32_32x32x16_bf16 v[160:175], v[80:83], a[208:211], v[160:175]
 ds_read_b128 v[148:151], v10 offset:21504
 v_cvt_pk_bf16_f32 v202, v180, v181
 v_cvt_pk_bf16_f32 v203, v182, v183
 v_mfma_f32_32x32x16_bf16 v[160:175], v[84:87], a[212:215], v[160:175]
 buffer_store_dwordx4 v[200:203], v11, s[4:7], s28 offen sc1
 v_mfma_f32_32x32x16_bf16 v[160:175], v[88:91], a[216:219], v[160:175]
 ds_read_b128 v[152:155], v10 offset:22528
 v_cvt_pk_bf16_f32 v204, v184, v185
 v_cvt_pk_bf16_f32 v205, v186, v187
 v_mfma_f32_32x32x16_bf16 v[160:175], v[92:95], a[220:223], v[160:175]
 ds_read_b128 v[156:159], v10 offset:23552
 v_cvt_pk_bf16_f32 v206, v188, v189
 v_cvt_pk_bf16_f32 v207, v190, v191
 v_mfma_f32_32x32x16_bf16 v[160:175], v[96:99], a[224:227], v[160:175]
 buffer_store_dwordx4 v[204:207], v11, s[4:7], s28 offen offset:256 sc1
 v_mfma_f32_32x32x16_bf16 v[160:175], v[100:103], a[228:231], v[160:175]
 s_add_u32 s28, s25, 262144
 v_mfma_f32_32x32x16_bf16 v[160:175], v[104:107], a[232:235], v[160:175]
 s_add_u32 s24, s24, 393216
 s_add_u32 s25, s25, 1310720
 s_add_u32 s31, s31, 1
 s_cmp_lt_u32 s31, 64
 v_mfma_f32_32x32x16_bf16 v[160:175], v[108:111], a[236:239], v[160:175]
 s_waitcnt lgkmcnt(0)
 v_mfma_f32_32x32x16_bf16 v[176:191], v[112:115], a[0:3], 0
 s_nop 3
 v_mfma_f32_32x32x16_bf16 v[176:191], v[116:119], a[4:7], v[176:191]
 s_nop 3
 v_mfma_f32_32x32x16_bf16 v[176:191], v[120:123], a[8:11], v[176:191]
 s_load_dword s33, s[4:5], s32 glc
 v_mfma_f32_32x32x16_bf16 v[176:191], v[124:127], a[12:15], v[176:191]
 v_cvt_pk_bf16_f32 v192, v160, v161
 v_cvt_pk_bf16_f32 v193, v162, v163
 v_mfma_f32_32x32x16_bf16 v[176:191], v[128:131], a[16:19], v[176:191]
 v_cvt_pk_bf16_f32 v194, v164, v165
 v_cvt_pk_bf16_f32 v195, v166, v167
 v_mfma_f32_32x32x16_bf16 v[176:191], v[132:135], a[20:23], v[176:191]
 buffer_store_dwordx4 v[192:195], v11, s[4:7], s28 offen sc1
 v_mfma_f32_32x32x16_bf16 v[176:191], v[136:139], a[24:27], v[176:191]
 v_cvt_pk_bf16_f32 v196, v168, v169
 v_cvt_pk_bf16_f32 v197, v170, v171
 v_mfma_f32_32x32x16_bf16 v[176:191], v[140:143], a[28:31], v[176:191]
 v_cvt_pk_bf16_f32 v198, v172, v173
 v_cvt_pk_bf16_f32 v199, v174, v175
 v_mfma_f32_32x32x16_bf16 v[176:191], v[144:147], a[32:35], v[176:191]
 buffer_store_dwordx4 v[196:199], v11, s[4:7], s28 offen offset:256 sc1
 v_mfma_f32_32x32x16_bf16 v[176:191], v[148:151], a[36:39], v[176:191]
 s_add_u32 s28, s25, 0
 v_mfma_f32_32x32x16_bf16 v[176:191], v[152:155], a[40:43], v[176:191]
 s_add_u32 s26, s31, 1
 s_min_u32 s26, s26, 63
 s_cmp_ge_u32 s31, 63
 s_cselect_b32 s24, 0x20000000, s24
 v_mov_b32 v17, s31
 v_mfma_f32_32x32x16_bf16 v[176:191], v[156:159], a[44:47], v[176:191]
 v_mfma_f32_32x32x16_bf16 v[160:175], v[112:115], a[48:51], 0
 s_nop 3
 v_mfma_f32_32x32x16_bf16 v[160:175], v[116:119], a[52:55], v[160:175]
 s_nop 3
 v_mfma_f32_32x32x16_bf16 v[160:175], v[120:123], a[56:59], v[160:175]
 v_mfma_f32_32x32x16_bf16 v[160:175], v[124:127], a[60:63], v[160:175]
 v_cvt_pk_bf16_f32 v200, v176, v177
 v_cvt_pk_bf16_f32 v201, v178, v179
 v_mfma_f32_32x32x16_bf16 v[160:175], v[128:131], a[64:67], v[160:175]
 v_cvt_pk_bf16_f32 v202, v180, v181
 v_cvt_pk_bf16_f32 v203, v182, v183
 v_mfma_f32_32x32x16_bf16 v[160:175], v[132:135], a[68:71], v[160:175]
 buffer_store_dwordx4 v[200:203], v11, s[4:7], s28 offen sc1
 v_mfma_f32_32x32x16_bf16 v[160:175], v[136:139], a[72:75], v[160:175]
 v_cvt_pk_bf16_f32 v204, v184, v185
 v_cvt_pk_bf16_f32 v205, v186, v187
 v_mfma_f32_32x32x16_bf16 v[160:175], v[140:143], a[76:79], v[160:175]
 s_cmp_gt_u32 s33, s26
 s_cbranch_scc0 vsp_2020
vbk_2021:
 s_add_u32 m0, s29, 0
 v_cvt_pk_bf16_f32 v206, v188, v189
 v_cvt_pk_bf16_f32 v207, v190, v191
 v_mfma_f32_32x32x16_bf16 v[160:175], v[144:147], a[80:83], v[160:175]
 buffer_store_dwordx4 v[204:207], v11, s[4:7], s28 offen offset:256 sc1
 v_mfma_f32_32x32x16_bf16 v[160:175], v[148:151], a[84:87], v[160:175]
 s_add_u32 s28, s25, 65536
 buffer_load_dwordx4 v9, s[4:7], s24 offen offset:0 sc1 lds
 v_mfma_f32_32x32x16_bf16 v[160:175], v[152:155], a[88:91], v[160:175]
 buffer_load_dwordx4 v9, s[4:7], s24 offen offset:1024 sc1 lds
 v_mfma_f32_32x32x16_bf16 v[160:175], v[156:159], a[92:95], v[160:175]
 buffer_load_dwordx4 v9, s[4:7], s24 offen offset:2048 sc1 lds
 v_mfma_f32_32x32x16_bf16 v[176:191], v[112:115], a[96:99], 0
 s_nop 3
 v_mfma_f32_32x32x16_bf16 v[176:191], v[116:119], a[100:103], v[176:191]
 s_nop 3
 v_mfma_f32_32x32x16_bf16 v[176:191], v[120:123], a[104:107], v[176:191]
 v_mfma_f32_32x32x16_bf16 v[176:191], v[124:127], a[108:111], v[176:191]
 v_cvt_pk_bf16_f32 v192, v160, v161
 v_cvt_pk_bf16_f32 v193, v162, v163
 v_mfma_f32_32x32x16_bf16 v[176:191], v[128:131], a[112:115], v[176:191]
 v_cvt_pk_bf16_f32 v194, v164, v165
 v_cvt_pk_bf16_f32 v195, v166, v167
 v_mfma_f32_32x32x16_bf16 v[176:191], v[132:135], a[116:119], v[176:191]
 buffer_store_dwordx4 v[192:195], v11, s[4:7], s28 offen sc1
 v_mfma_f32_32x32x16_bf16 v[176:191], v[136:139], a[120:123], v[176:191]
 v_cvt_pk_bf16_f32 v196, v168, v169
 v_cvt_pk_bf16_f32 v197, v170, v171
 v_mfma_f32_32x32x16_bf16 v[176:191], v[140:143], a[124:127], v[176:191]
 s_waitcnt vmcnt(6)
 s_barrier
 v_cvt_pk_bf16_f32 v198, v172, v173
 v_cvt_pk_bf16_f32 v199, v174, v175
 v_mfma_f32_32x32x16_bf16 v[176:191], v[144:147], a[128:131], v[176:191]
 buffer_store_dwordx4 v[196:199], v11, s[4:7], s28 offen offset:256 sc1
 v_mfma_f32_32x32x16_bf16 v[176:191], v[148:151], a[132:135], v[176:191]
 s_add_u32 s28, s25, 131072
 buffer_store_dword v17, v16, s[4:7], 0 offen sc1
 v_mfma_f32_32x32x16_bf16 v[176:191], v[152:155], a[136:139], v[176:191]
 v_mfma_f32_32x32x16_bf16 v[176:191], v[156:159], a[140:143], v[176:191]
 v_mfma_f32_32x32x16_bf16 v[160:175], v[112:115], a[144:147], 0
 s_nop 3
 v_mfma_f32_32x32x16_bf16 v[160:175], v[116:119], a[148:151], v[160:175]
 s_nop 3
 v_mfma_f32_32x32x16_bf16 v[160:175], v[120:123], a[152:155], v[160:175]
 v_mfma_f32_32x32x16_bf16 v[160:175], v[124:127], a[156:159], v[160:175]
 v_cvt_pk_bf16_f32 v200, v176, v177
 v_cvt_pk_bf16_f32 v201, v178, v179
 v_mfma_f32_32x32x16_bf16 v[160:175], v[128:131], a[160:163], v[160:175]
 v_cvt_pk_bf16_f32 v202, v180, v181
 v_cvt_pk_bf16_f32 v203, v182, v183
 v_mfma_f32_32x32x16_bf16 v[160:175], v[132:135], a[164:167], v[160:175]
 buffer_store_dwordx4 v[200:203], v11, s[4:7], s28 offen sc1
 v_mfma_f32_32x32x16_bf16 v[160:175], v[136:139], a[168:171], v[160:175]
 v_cvt_pk_bf16_f32 v204, v184, v185
 v_cvt_pk_bf16_f32 v205, v186, v187
 v_mfma_f32_32x32x16_bf16 v[160:175], v[140:143], a[172:175], v[160:175]
 v_cvt_pk_bf16_f32 v206, v188, v189
 v_cvt_pk_bf16_f32 v207, v190, v191
 v_mfma_f32_32x32x16_bf16 v[160:175], v[144:147], a[176:179], v[160:175]
 buffer_store_dwordx4 v[204:207], v11, s[4:7], s28 offen offset:256 sc1
 v_mfma_f32_32x32x16_bf16 v[160:175], v[148:151], a[180:183], v[160:175]
 s_add_u32 s28, s25, 196608
 s_waitcnt vmcnt(5)
 s_barrier
 v_mfma_f32_32x32x16_bf16 v[160:175], v[152:155], a[184:187], v[160:175]
 ds_read_b128 v[64:67], v10 offset:0
 ds_read_b128 v[68:71], v10 offset:1024
 v_mfma_f32_32x32x16_bf16 v[160:175], v[156:159], a[188:191], v[160:175]
 ds_read_b128 v[72:75], v10 offset:2048
 ds_read_b128 v[76:79], v10 offset:3072
 v_mfma_f32_32x32x16_bf16 v[176:191], v[112:115], a[192:195], 0
 s_nop 3
 ds_read_b128 v[80:83], v10 offset:4096
 v_mfma_f32_32x32x16_bf16 v[176:191], v[116:119], a[196:199], v[176:191]
 s_nop 3
 ds_read_b128 v[84:87], v10 offset:5120
 v_mfma_f32_32x32x16_bf16 v[176:191], v[120:123], a[200:203], v[176:191]
 ds_read_b128 v[88:91], v10 offset:6144
 ds_read_b128 v[92:95], v10 offset:7168
 v_mfma_f32_32x32x16_bf16 v[176:191], v[124:127], a[204:207], v[176:191]
 ds_read_b128 v[96:99], v10 offset:8192
 v_cvt_pk_bf16_f32 v192, v160, v161
 v_cvt_pk_bf16_f32 v193, v162, v163
 v_mfma_f32_32x32x16_bf16 v[176:191], v[128:131], a[208:211], v[176:191]
 ds_read_b128 v[100:103], v10 offset:9216
 v_cvt_pk_bf16_f32 v194, v164, v165
 v_cvt_pk_bf16_f32 v195, v166, v167
 v_mfma_f32_32x32x16_bf16 v[176:191], v[132:135], a[212:215], v[176:191]
 buffer_store_dwordx4 v[192:195], v11, s[4:7], s28 offen sc1
 v_mfma_f32_32x32x16_bf16 v[176:191], v[136:139], a[216:219], v[176:191]
 ds_read_b128 v[104:107], v10 offset:10240
 v_cvt_pk_bf16_f32 v196, v168, v169
 v_cvt_pk_bf16_f32 v197, v170, v171
 v_mfma_f32_32x32x16_bf16 v[176:191], v[140:143], a[220:223], v[176:191]
 ds_read_b128 v[108:111], v10 offset:11264
 v_cvt_pk_bf16_f32 v198, v172, v173
 v_cvt_pk_bf16_f32 v199, v174, v175
 v_mfma_f32_32x32x16_bf16 v[176:191], v[144:147], a[224:227], v[176:191]
 buffer_store_dwordx4 v[196:199], v11, s[4:7], s28 offen offset:256 sc1
 v_mfma_f32_32x32x16_bf16 v[176:191], v[148:151], a[228:231], v[176:191]
 s_add_u32 s28, s25, 262144
 v_mfma_f32_32x32x16_bf16 v[176:191], v[152:155], a[232:235], v[176:191]
 s_add_u32 s24, s24, 393216
 s_add_u32 s25, s25, 1310720
 s_add_u32 s31, s31, 1
 s_cmp_lt_u32 s31, 64
 v_mfma_f32_32x32x16_bf16 v[176:191], v[156:159], a[236:239], v[176:191]
 s_cbranch_scc1 vo_2017
 s_nop 10
 v_cvt_pk_bf16_f32 v200, v176, v177
 v_cvt_pk_bf16_f32 v201, v178, v179
 v_cvt_pk_bf16_f32 v202, v180, v181
 v_cvt_pk_bf16_f32 v203, v182, v183
 v_cvt_pk_bf16_f32 v204, v184, v185
 v_cvt_pk_bf16_f32 v205, v186, v187
 v_cvt_pk_bf16_f32 v206, v188, v189
 v_cvt_pk_bf16_f32 v207, v190, v191
 buffer_store_dwordx4 v[200:203], v11, s[4:7], s28 offen sc1
 buffer_store_dwordx4 v[204:207], v11, s[4:7], s28 offen offset:256 sc1
 s_waitcnt vmcnt(0) lgkmcnt(0)
 s_barrier
 v_mov_b32 v17, 64
 buffer_store_dword v17, v16, s[4:7], 0 offen sc1
 s_branch second
vsp_2018:
 s_waitcnt lgkmcnt(0)
 s_cmp_gt_u32 s33, s26
 s_cbranch_scc1 fw_done_2022
 s_mov_b32 s100, 0
fw_2023:
 s_load_dword s33, s[4:5], s32 glc
 s_add_u32 s100, s100, 1
 s_cmp_gt_u32 s100, 200000
 s_cbranch_scc1 main_fail
 s_waitcnt lgkmcnt(0)
 s_cmp_gt_u32 s33, s26
 s_cbranch_scc0 fw_2023
fw_done_2022:
 s_branch vbk_2019
vsp_2020:
 s_waitcnt lgkmcnt(0)
 s_cmp_gt_u32 s33, s26
 s_cbranch_scc1 fw_done_2024
 s_mov_b32 s100, 0
fw_2025:
 s_load_dword s33, s[4:5], s32 glc
 s_add_u32 s100, s100, 1
 s_cmp_gt_u32 s100, 200000
 s_cbranch_scc1 main_fail
 s_waitcnt lgkmcnt(0)
 s_cmp_gt_u32 s33, s26
 s_cbranch_scc0 fw_2025
fw_done_2024:
 s_branch vbk_2021
bm_task:
 s_load_dwordx2 s[8:9], s[0:1], 40
 s_mov_b32 s10, 7864320
 s_mov_b32 s11, 0x20000
 s_load_dwordx2 s[12:13], s[0:1], 32
 s_mov_b32 s14, 7864320
 s_mov_b32 s15, 0x20000
 s_mov_b32 s35, s22
 s_lshr_b32 s20, s22, 2
 s_and_b32 s22, s22, 3
 s_waitcnt lgkmcnt(0)
 v_and_b32 v254, 63, v0
 v_add_u32 v254, 0, v254
 v_mul_u32_u24 v253, 2731, v254
 v_lshrrev_b32 v253, 16, v253
 v_mul_u32_u24 v252, 24, v253
 v_sub_u32 v254, v254, v252
 v_lshrrev_b32 v252, 1, v253
 v_xor_b32 v254, v254, v252
 v_bfe_u32 v255, v253, 0, 1
 v_mul_u32_u24 v2, 12288, v255
 v_bfe_u32 v255, v253, 1, 1
 s_mov_b32 s101, 98304
 v_mad_u32_u24 v2, v255, s101, v2
 v_bfe_u32 v255, v253, 2, 1
 s_mov_b32 s101, 49152
 v_mad_u32_u24 v2, v255, s101, v2
 v_lshl_add_u32 v2, v254, 4, v2
 v_xor_b32 v5, 64, v2
 v_and_b32 v254, 63, v0
 v_add_u32 v254, 64, v254
 v_mul_u32_u24 v253, 2731, v254
 v_lshrrev_b32 v253, 16, v253
 v_mul_u32_u24 v252, 24, v253
 v_sub_u32 v254, v254, v252
 v_lshrrev_b32 v252, 1, v253
 v_xor_b32 v254, v254, v252
 v_bfe_u32 v255, v253, 0, 1
 v_mul_u32_u24 v3, 12288, v255
 v_bfe_u32 v255, v253, 1, 1
 s_mov_b32 s101, 98304
 v_mad_u32_u24 v3, v255, s101, v3
 v_bfe_u32 v255, v253, 2, 1
 s_mov_b32 s101, 49152
 v_mad_u32_u24 v3, v255, s101, v3
 v_lshl_add_u32 v3, v254, 4, v3
 v_xor_b32 v6, 64, v3
 v_and_b32 v254, 63, v0
 v_add_u32 v254, 128, v254
 v_mul_u32_u24 v253, 2731, v254
 v_lshrrev_b32 v253, 16, v253
 v_mul_u32_u24 v252, 24, v253
 v_sub_u32 v254, v254, v252
 v_lshrrev_b32 v252, 1, v253
 v_xor_b32 v254, v254, v252
 v_bfe_u32 v255, v253, 0, 1
 v_mul_u32_u24 v4, 12288, v255
 v_bfe_u32 v255, v253, 1, 1
 s_mov_b32 s101, 98304
 v_mad_u32_u24 v4, v255, s101, v4
 v_bfe_u32 v255, v253, 2, 1
 s_mov_b32 s101, 49152
 v_mad_u32_u24 v4, v255, s101, v4
 v_lshl_add_u32 v4, v254, 4, v4
 v_xor_b32 v7, 64, v4
 s_mul_i32 s24, s20, 384
 s_mul_i32 s26, s21, 1966080
 s_add_u32 s24, s24, s26
 s_mul_i32 s29, s21, 24576
 s_add_u32 s29, s29, 61440
 v_and_b32 v254, 63, v0
 v_add_u32 v254, 0, v254
 v_mul_u32_u24 v253, 3277, v254
 v_lshrrev_b32 v253, 16, v253
 v_mul_u32_u24 v252, 20, v253
 v_sub_u32 v254, v254, v252
 v_mul_u32_u24 v253, 1280, v253
 v_lshl_add_u32 v8, v254, 4, v253
 v_and_b32 v254, 63, v0
 v_add_u32 v254, 64, v254
 v_mul_u32_u24 v253, 3277, v254
 v_lshrrev_b32 v253, 16, v253
 v_mul_u32_u24 v252, 20, v253
 v_sub_u32 v254, v254, v252
 v_mul_u32_u24 v253, 1280, v253
 v_lshl_add_u32 v9, v254, 4, v253
 v_and_b32 v254, 63, v0
 v_add_u32 v254, 128, v254
 v_mul_u32_u24 v253, 3277, v254
 v_lshrrev_b32 v253, 16, v253
 v_mul_u32_u24 v252, 20, v253
 v_sub_u32 v254, v254, v252
 v_mul_u32_u24 v253, 1280, v253
 v_lshl_add_u32 v10, v254, 4, v253
 v_and_b32 v254, 63, v0
 v_add_u32 v254, 192, v254
 v_mul_u32_u24 v253, 3277, v254
 v_lshrrev_b32 v253, 16, v253
 v_mul_u32_u24 v252, 20, v253
 v_sub_u32 v254, v254, v252
 v_mul_u32_u24 v253, 1280, v253
 v_lshl_add_u32 v11, v254, 4, v253
 v_and_b32 v254, 63, v0
 v_add_u32 v254, 256, v254
 v_mul_u32_u24 v253, 3277, v254
 v_lshrrev_b32 v253, 16, v253
 v_mul_u32_u24 v252, 20, v253
 v_sub_u32 v254, v254, v252
 v_mul_u32_u24 v253, 1280, v253
 v_lshl_add_u32 v12, v254, 4, v253
 s_mul_i32 s25, s20, 245760
 s_mul_i32 s26, s22, 320
 s_add_u32 s25, s25, s26
 s_mul_i32 s26, s21, 61440
 s_add_u32 s25, s25, s26
 s_mul_i32 s28, s21, 15360
 s_add_u32 s27, s25, 0
 s_add_u32 m0, s28, 0
 s_nop 0
 buffer_load_dwordx4 v8, s[8:11], s27 offen lds
 s_add_u32 m0, s28, 1024
 s_nop 0
 buffer_load_dwordx4 v9, s[8:11], s27 offen lds
 s_add_u32 m0, s28, 2048
 s_nop 0
 buffer_load_dwordx4 v10, s[8:11], s27 offen lds
 s_add_u32 m0, s28, 3072
 s_nop 0
 buffer_load_dwordx4 v11, s[8:11], s27 offen lds
 s_add_u32 m0, s28, 4096
 s_nop 0
 buffer_load_dwordx4 v12, s[8:11], s27 offen lds
 s_add_u32 s27, s25, 20480
 s_add_u32 m0, s28, 5120
 s_nop 0
 buffer_load_dwordx4 v8, s[8:11], s27 offen lds
 s_add_u32 m0, s28, 6144
 s_nop 0
 buffer_load_dwordx4 v9, s[8:11], s27 offen lds
 s_add_u32 m0, s28, 7168
 s_nop 0
 buffer_load_dwordx4 v10, s[8:11], s27 offen lds
 s_add_u32 m0, s28, 8192
 s_nop 0
 buffer_load_dwordx4 v11, s[8:11], s27 offen lds
 s_add_u32 m0, s28, 9216
 s_nop 0
 buffer_load_dwordx4 v12, s[8:11], s27 offen lds
 s_add_u32 s27, s25, 40960
 s_add_u32 m0, s28, 10240
 s_nop 0
 buffer_load_dwordx4 v8, s[8:11], s27 offen lds
 s_add_u32 m0, s28, 11264
 s_nop 0
 buffer_load_dwordx4 v9, s[8:11], s27 offen lds
 s_add_u32 m0, s28, 12288
 s_nop 0
 buffer_load_dwordx4 v10, s[8:11], s27 offen lds
 s_add_u32 m0, s28, 13312
 s_nop 0
 buffer_load_dwordx4 v11, s[8:11], s27 offen lds
 s_add_u32 m0, s28, 14336
 s_nop 0
 buffer_load_dwordx4 v12, s[8:11], s27 offen lds
 s_add_u32 s27, s24, 0
 s_add_u32 m0, s29, 0
 s_nop 0
 buffer_load_dwordx4 v2, s[12:15], s27 offen lds
 s_add_u32 m0, s29, 1024
 s_nop 0
 buffer_load_dwordx4 v3, s[12:15], s27 offen lds
 s_add_u32 m0, s29, 2048
 s_nop 0
 buffer_load_dwordx4 v4, s[12:15], s27 offen lds
 s_add_u32 s27, s24, 24576
 s_add_u32 m0, s29, 3072
 s_nop 0
 buffer_load_dwordx4 v5, s[12:15], s27 offen lds
 s_add_u32 m0, s29, 4096
 s_nop 0
 buffer_load_dwordx4 v6, s[12:15], s27 offen lds
 s_add_u32 m0, s29, 5120
 s_nop 0
 buffer_load_dwordx4 v7, s[12:15], s27 offen lds
 s_add_u32 s27, s24, 196608
 s_add_u32 m0, s29, 6144
 s_nop 0
 buffer_load_dwordx4 v2, s[12:15], s27 offen lds
 s_add_u32 m0, s29, 7168
 s_nop 0
 buffer_load_dwordx4 v3, s[12:15], s27 offen lds
 s_add_u32 m0, s29, 8192
 s_nop 0
 buffer_load_dwordx4 v4, s[12:15], s27 offen lds
 s_add_u32 s27, s24, 221184
 s_add_u32 m0, s29, 9216
 s_nop 0
 buffer_load_dwordx4 v5, s[12:15], s27 offen lds
 s_add_u32 m0, s29, 10240
 s_nop 0
 buffer_load_dwordx4 v6, s[12:15], s27 offen lds
 s_add_u32 m0, s29, 11264
 s_nop 0
 buffer_load_dwordx4 v7, s[12:15], s27 offen lds
 s_add_u32 s27, s24, 393216
 s_add_u32 m0, s29, 12288
 s_nop 0
 buffer_load_dwordx4 v2, s[12:15], s27 offen lds
 s_add_u32 m0, s29, 13312
 s_nop 0
 buffer_load_dwordx4 v3, s[12:15], s27 offen lds
 s_add_u32 m0, s29, 14336
 s_nop 0
 buffer_load_dwordx4 v4, s[12:15], s27 offen lds
 s_add_u32 s27, s24, 417792
 s_add_u32 m0, s29, 15360
 s_nop 0
 buffer_load_dwordx4 v5, s[12:15], s27 offen lds
 s_add_u32 m0, s29, 16384
 s_nop 0
 buffer_load_dwordx4 v6, s[12:15], s27 offen lds
 s_add_u32 m0, s29, 17408
 s_nop 0
 buffer_load_dwordx4 v7, s[12:15], s27 offen lds
 s_add_u32 s27, s24, 589824
 s_add_u32 m0, s29, 18432
 s_nop 0
 buffer_load_dwordx4 v2, s[12:15], s27 offen lds
 s_add_u32 m0, s29, 19456
 s_nop 0
 buffer_load_dwordx4 v3, s[12:15], s27 offen lds
 s_add_u32 m0, s29, 20480
 s_nop 0
 buffer_load_dwordx4 v4, s[12:15], s27 offen lds
 s_add_u32 s27, s24, 614400
 s_add_u32 m0, s29, 21504
 s_nop 0
 buffer_load_dwordx4 v5, s[12:15], s27 offen lds
 s_add_u32 m0, s29, 22528
 s_nop 0
 buffer_load_dwordx4 v6, s[12:15], s27 offen lds
 s_add_u32 m0, s29, 23552
 s_nop 0
 buffer_load_dwordx4 v7, s[12:15], s27 offen lds
 v_bfe_u32 v255, v0, 5, 1
 v_mul_u32_u24 v13, 2560, v255
 v_bfe_u32 v255, v0, 2, 2
 s_mov_b32 s101, 320
 v_mad_u32_u24 v13, v255, s101, v13
 v_bfe_u32 v255, v0, 4, 1
 v_lshl_add_u32 v13, v255, 5, v13
 v_bfe_u32 v255, v0, 0, 2
 v_lshl_add_u32 v13, v255, 3, v13
 v_bfe_u32 v255, v0, 5, 1
 v_lshlrev_b32 v253, 0, v255
 v_bfe_u32 v254, v0, 1, 3
 v_xor_b32 v253, v253, v254
 v_mov_b32 v16, s29
 v_bfe_u32 v255, v0, 0, 5
 s_mov_b32 s101, 384
 v_mad_u32_u24 v16, v255, s101, v16
 v_lshl_add_u32 v16, v253, 4, v16
 v_mov_b32 v253, 2
 v_bfe_u32 v255, v0, 5, 1
 v_lshl_add_u32 v253, v255, 0, v253
 v_bfe_u32 v254, v0, 1, 3
 v_xor_b32 v253, v253, v254
 v_mov_b32 v17, s29
 v_bfe_u32 v255, v0, 0, 5
 s_mov_b32 s101, 384
 v_mad_u32_u24 v17, v255, s101, v17
 v_lshl_add_u32 v17, v253, 4, v17
 v_mov_b32 v253, 4
 v_bfe_u32 v255, v0, 5, 1
 v_lshl_add_u32 v253, v255, 0, v253
 v_bfe_u32 v254, v0, 1, 3
 v_xor_b32 v253, v253, v254
 v_mov_b32 v18, s29
 v_bfe_u32 v255, v0, 0, 5
 s_mov_b32 s101, 384
 v_mad_u32_u24 v18, v255, s101, v18
 v_lshl_add_u32 v18, v253, 4, v18
 v_mov_b32 v253, 6
 v_bfe_u32 v255, v0, 5, 1
 v_lshl_add_u32 v253, v255, 0, v253
 v_bfe_u32 v254, v0, 1, 3
 v_xor_b32 v253, v253, v254
 v_mov_b32 v19, s29
 v_bfe_u32 v255, v0, 0, 5
 s_mov_b32 s101, 384
 v_mad_u32_u24 v19, v255, s101, v19
 v_lshl_add_u32 v19, v253, 4, v19
 s_mul_i32 s26, s22, 327680
 v_mov_b32 v14, s26
 v_bfe_u32 v255, v0, 3, 2
 v_lshl_add_u32 v14, v255, 14, v14
 v_bfe_u32 v255, v0, 5, 1
 v_lshl_add_u32 v14, v255, 7, v14
 v_bfe_u32 v255, v0, 0, 3
 v_lshl_add_u32 v14, v255, 4, v14
 s_lshl_b32 s25, s20, 9
 s_mul_i32 s26, s21, 6553600
 s_add_u32 s25, s25, s26
 s_add_u32 s25, s25, 27131904
 s_waitcnt vmcnt(24)
 s_barrier
 ds_read_b64_tr_b16 a[0:1], v13 offset:0
 ds_read_b64_tr_b16 a[2:3], v13 offset:1280
 ds_read_b64_tr_b16 a[4:5], v13 offset:5120
 ds_read_b64_tr_b16 a[6:7], v13 offset:6400
 ds_read_b64_tr_b16 a[8:9], v13 offset:10240
 ds_read_b64_tr_b16 a[10:11], v13 offset:11520
 ds_read_b64_tr_b16 a[12:13], v13 offset:15360
 ds_read_b64_tr_b16 a[14:15], v13 offset:16640
 s_waitcnt lgkmcnt(6)
 ds_read_b64_tr_b16 a[16:17], v13 offset:20480
 ds_read_b64_tr_b16 a[18:19], v13 offset:21760
 ds_read_b64_tr_b16 a[20:21], v13 offset:25600
 ds_read_b64_tr_b16 a[22:23], v13 offset:26880
 ds_read_b64_tr_b16 a[24:25], v13 offset:30720
 ds_read_b64_tr_b16 a[26:27], v13 offset:32000
 ds_read_b64_tr_b16 a[28:29], v13 offset:35840
 ds_read_b64_tr_b16 a[30:31], v13 offset:37120
 s_waitcnt lgkmcnt(6)
 ds_read_b64_tr_b16 a[32:33], v13 offset:40960
 ds_read_b64_tr_b16 a[34:35], v13 offset:42240
 ds_read_b64_tr_b16 a[36:37], v13 offset:46080
 ds_read_b64_tr_b16 a[38:39], v13 offset:47360
 ds_read_b64_tr_b16 a[40:41], v13 offset:51200
 ds_read_b64_tr_b16 a[42:43], v13 offset:52480
 ds_read_b64_tr_b16 a[44:45], v13 offset:56320
 ds_read_b64_tr_b16 a[46:47], v13 offset:57600
 s_waitcnt lgkmcnt(6)
 ds_read_b64_tr_b16 a[48:49], v13 offset:64
 ds_read_b64_tr_b16 a[50:51], v13 offset:1344
 ds_read_b64_tr_b16 a[52:53], v13 offset:5184
 ds_read_b64_tr_b16 a[54:55], v13 offset:6464
 ds_read_b64_tr_b16 a[56:57], v13 offset:10304
 ds_read_b64_tr_b16 a[58:59], v13 offset:11584
 ds_read_b64_tr_b16 a[60:61], v13 offset:15424
 ds_read_b64_tr_b16 a[62:63], v13 offset:16704
 s_waitcnt lgkmcnt(6)
 ds_read_b64_tr_b16 a[64:65], v13 offset:20544
 ds_read_b64_tr_b16 a[66:67], v13 offset:21824
 ds_read_b64_tr_b16 a[68:69], v13 offset:25664
 ds_read_b64_tr_b16 a[70:71], v13 offset:26944
 ds_read_b64_tr_b16 a[72:73], v13 offset:30784
 ds_read_b64_tr_b16 a[74:75], v13 offset:32064
 ds_read_b64_tr_b16 a[76:77], v13 offset:35904
 ds_read_b64_tr_b16 a[78:79], v13 offset:37184
 s_waitcnt lgkmcnt(6)
 ds_read_b64_tr_b16 a[80:81], v13 offset:41024
 ds_read_b64_tr_b16 a[82:83], v13 offset:42304
 ds_read_b64_tr_b16 a[84:85], v13 offset:46144
 ds_read_b64_tr_b16 a[86:87], v13 offset:47424
 ds_read_b64_tr_b16 a[88:89], v13 offset:51264
 ds_read_b64_tr_b16 a[90:91], v13 offset:52544
 ds_read_b64_tr_b16 a[92:93], v13 offset:56384
 ds_read_b64_tr_b16 a[94:95], v13 offset:57664
 s_waitcnt lgkmcnt(6)
 ds_read_b64_tr_b16 a[96:97], v13 offset:128
 ds_read_b64_tr_b16 a[98:99], v13 offset:1408
 ds_read_b64_tr_b16 a[100:101], v13 offset:5248
 ds_read_b64_tr_b16 a[102:103], v13 offset:6528
 ds_read_b64_tr_b16 a[104:105], v13 offset:10368
 ds_read_b64_tr_b16 a[106:107], v13 offset:11648
 ds_read_b64_tr_b16 a[108:109], v13 offset:15488
 ds_read_b64_tr_b16 a[110:111], v13 offset:16768
 s_waitcnt lgkmcnt(6)
 ds_read_b64_tr_b16 a[112:113], v13 offset:20608
 ds_read_b64_tr_b16 a[114:115], v13 offset:21888
 ds_read_b64_tr_b16 a[116:117], v13 offset:25728
 ds_read_b64_tr_b16 a[118:119], v13 offset:27008
 ds_read_b64_tr_b16 a[120:121], v13 offset:30848
 ds_read_b64_tr_b16 a[122:123], v13 offset:32128
 ds_read_b64_tr_b16 a[124:125], v13 offset:35968
 ds_read_b64_tr_b16 a[126:127], v13 offset:37248
 s_waitcnt lgkmcnt(6)
 ds_read_b64_tr_b16 a[128:129], v13 offset:41088
 ds_read_b64_tr_b16 a[130:131], v13 offset:42368
 ds_read_b64_tr_b16 a[132:133], v13 offset:46208
 ds_read_b64_tr_b16 a[134:135], v13 offset:47488
 ds_read_b64_tr_b16 a[136:137], v13 offset:51328
 ds_read_b64_tr_b16 a[138:139], v13 offset:52608
 ds_read_b64_tr_b16 a[140:141], v13 offset:56448
 ds_read_b64_tr_b16 a[142:143], v13 offset:57728
 s_waitcnt lgkmcnt(6)
 ds_read_b64_tr_b16 a[144:145], v13 offset:192
 ds_read_b64_tr_b16 a[146:147], v13 offset:1472
 ds_read_b64_tr_b16 a[148:149], v13 offset:5312
 ds_read_b64_tr_b16 a[150:151], v13 offset:6592
 ds_read_b64_tr_b16 a[152:153], v13 offset:10432
 ds_read_b64_tr_b16 a[154:155], v13 offset:11712
 ds_read_b64_tr_b16 a[156:157], v13 offset:15552
 ds_read_b64_tr_b16 a[158:159], v13 offset:16832
 s_waitcnt lgkmcnt(6)
 ds_read_b64_tr_b16 a[160:161], v13 offset:20672
 ds_read_b64_tr_b16 a[162:163], v13 offset:21952
 ds_read_b64_tr_b16 a[164:165], v13 offset:25792
 ds_read_b64_tr_b16 a[166:167], v13 offset:27072
 ds_read_b64_tr_b16 a[168:169], v13 offset:30912
 ds_read_b64_tr_b16 a[170:171], v13 offset:32192
 ds_read_b64_tr_b16 a[172:173], v13 offset:36032
 ds_read_b64_tr_b16 a[174:175], v13 offset:37312
 s_waitcnt lgkmcnt(6)
 ds_read_b64_tr_b16 a[176:177], v13 offset:41152
 ds_read_b64_tr_b16 a[178:179], v13 offset:42432
 ds_read_b64_tr_b16 a[180:181], v13 offset:46272
 ds_read_b64_tr_b16 a[182:183], v13 offset:47552
 ds_read_b64_tr_b16 a[184:185], v13 offset:51392
 ds_read_b64_tr_b16 a[186:187], v13 offset:52672
 ds_read_b64_tr_b16 a[188:189], v13 offset:56512
 ds_read_b64_tr_b16 a[190:191], v13 offset:57792
 s_waitcnt lgkmcnt(6)
 ds_read_b64_tr_b16 a[192:193], v13 offset:256
 ds_read_b64_tr_b16 a[194:195], v13 offset:1536
 ds_read_b64_tr_b16 a[196:197], v13 offset:5376
 ds_read_b64_tr_b16 a[198:199], v13 offset:6656
 ds_read_b64_tr_b16 a[200:201], v13 offset:10496
 ds_read_b64_tr_b16 a[202:203], v13 offset:11776
 ds_read_b64_tr_b16 a[204:205], v13 offset:15616
 ds_read_b64_tr_b16 a[206:207], v13 offset:16896
 s_waitcnt lgkmcnt(6)
 ds_read_b64_tr_b16 a[208:209], v13 offset:20736
 ds_read_b64_tr_b16 a[210:211], v13 offset:22016
 ds_read_b64_tr_b16 a[212:213], v13 offset:25856
 ds_read_b64_tr_b16 a[214:215], v13 offset:27136
 ds_read_b64_tr_b16 a[216:217], v13 offset:30976
 ds_read_b64_tr_b16 a[218:219], v13 offset:32256
 ds_read_b64_tr_b16 a[220:221], v13 offset:36096
 ds_read_b64_tr_b16 a[222:223], v13 offset:37376
 s_waitcnt lgkmcnt(6)
 ds_read_b64_tr_b16 a[224:225], v13 offset:41216
 ds_read_b64_tr_b16 a[226:227], v13 offset:42496
 ds_read_b64_tr_b16 a[228:229], v13 offset:46336
 ds_read_b64_tr_b16 a[230:231], v13 offset:47616
 ds_read_b64_tr_b16 a[232:233], v13 offset:51456
 ds_read_b64_tr_b16 a[234:235], v13 offset:52736
 ds_read_b64_tr_b16 a[236:237], v13 offset:56576
 ds_read_b64_tr_b16 a[238:239], v13 offset:57856
 s_waitcnt lgkmcnt(6)
 s_waitcnt vmcnt(12)
 ds_read_b128 v[64:67], v16 offset:0
 ds_read_b128 v[68:71], v17 offset:0
 ds_read_b128 v[72:75], v18 offset:0
 ds_read_b128 v[76:79], v19 offset:0
 ds_read_b128 v[80:83], v16 offset:128
 ds_read_b128 v[84:87], v17 offset:128
 ds_read_b128 v[88:91], v18 offset:128
 ds_read_b128 v[92:95], v19 offset:128
 ds_read_b128 v[96:99], v16 offset:256
 ds_read_b128 v[100:103], v17 offset:256
 ds_read_b128 v[104:107], v18 offset:256
 ds_read_b128 v[108:111], v19 offset:256
 s_waitcnt lgkmcnt(0)
 v_mfma_f32_32x32x16_bf16 v[160:175], v[64:67], a[0:3], 0
 v_mfma_f32_32x32x16_bf16 v[160:175], v[68:71], a[4:7], v[160:175]
 v_mfma_f32_32x32x16_bf16 v[160:175], v[72:75], a[8:11], v[160:175]
 s_add_u32 s27, s24, 786432
 s_add_u32 m0, s29, 0
 s_nop 0
 buffer_load_dwordx4 v2, s[12:15], s27 offen lds
 v_mfma_f32_32x32x16_bf16 v[160:175], v[76:79], a[12:15], v[160:175]
 v_mfma_f32_32x32x16_bf16 v[160:175], v[80:83], a[16:19], v[160:175]
 s_add_u32 m0, s29, 1024
 s_nop 0
 buffer_load_dwordx4 v3, s[12:15], s27 offen lds
 v_mfma_f32_32x32x16_bf16 v[160:175], v[84:87], a[20:23], v[160:175]
 v_mfma_f32_32x32x16_bf16 v[160:175], v[88:91], a[24:27], v[160:175]
 v_mfma_f32_32x32x16_bf16 v[160:175], v[92:95], a[28:31], v[160:175]
 s_add_u32 m0, s29, 2048
 s_nop 0
 buffer_load_dwordx4 v4, s[12:15], s27 offen lds
 v_mfma_f32_32x32x16_bf16 v[160:175], v[96:99], a[32:35], v[160:175]
 v_mfma_f32_32x32x16_bf16 v[160:175], v[100:103], a[36:39], v[160:175]
 s_add_u32 s27, s24, 811008
 s_add_u32 m0, s29, 3072
 s_nop 0
 buffer_load_dwordx4 v5, s[12:15], s27 offen lds
 v_mfma_f32_32x32x16_bf16 v[160:175], v[104:107], a[40:43], v[160:175]
 s_add_u32 m0, s29, 4096
 s_nop 0
 buffer_load_dwordx4 v6, s[12:15], s27 offen lds
 v_mfma_f32_32x32x16_bf16 v[160:175], v[108:111], a[44:47], v[160:175]
 s_add_u32 m0, s29, 5120
 s_nop 0
 buffer_load_dwordx4 v7, s[12:15], s27 offen lds
 v_mfma_f32_32x32x16_bf16 v[176:191], v[64:67], a[48:51], 0
 s_nop 2
 s_add_u32 s28, s25, 0
 v_mfma_f32_32x32x16_bf16 v[176:191], v[68:71], a[52:55], v[176:191]
 s_nop 3
 v_mfma_f32_32x32x16_bf16 v[176:191], v[72:75], a[56:59], v[176:191]
 s_add_u32 s27, s24, 983040
 s_add_u32 m0, s29, 6144
 s_nop 0
 buffer_load_dwordx4 v2, s[12:15], s27 offen lds
 v_mfma_f32_32x32x16_bf16 v[176:191], v[76:79], a[60:63], v[176:191]
 v_cvt_pk_bf16_f32 v192, v160, v161
 v_cvt_pk_bf16_f32 v193, v162, v163
 v_mfma_f32_32x32x16_bf16 v[176:191], v[80:83], a[64:67], v[176:191]
 s_add_u32 m0, s29, 7168
 s_nop 0
 buffer_load_dwordx4 v3, s[12:15], s27 offen lds
 v_cvt_pk_bf16_f32 v194, v164, v165
 v_cvt_pk_bf16_f32 v195, v166, v167
 v_mfma_f32_32x32x16_bf16 v[176:191], v[84:87], a[68:71], v[176:191]
 buffer_store_dwordx4 v[192:195], v14, s[4:7], s28 offen sc1
 v_mfma_f32_32x32x16_bf16 v[176:191], v[88:91], a[72:75], v[176:191]
 v_cvt_pk_bf16_f32 v196, v168, v169
 v_cvt_pk_bf16_f32 v197, v170, v171
 v_mfma_f32_32x32x16_bf16 v[176:191], v[92:95], a[76:79], v[176:191]
 s_add_u32 m0, s29, 8192
 s_nop 0
 buffer_load_dwordx4 v4, s[12:15], s27 offen lds
 v_cvt_pk_bf16_f32 v198, v172, v173
 v_cvt_pk_bf16_f32 v199, v174, v175
 v_mfma_f32_32x32x16_bf16 v[176:191], v[96:99], a[80:83], v[176:191]
 buffer_store_dwordx4 v[196:199], v14, s[4:7], s28 offen offset:256 sc1
 v_mfma_f32_32x32x16_bf16 v[176:191], v[100:103], a[84:87], v[176:191]
 s_add_u32 s27, s24, 1007616
 s_add_u32 m0, s29, 9216
 s_nop 0
 buffer_load_dwordx4 v5, s[12:15], s27 offen lds
 v_mfma_f32_32x32x16_bf16 v[176:191], v[104:107], a[88:91], v[176:191]
 s_add_u32 m0, s29, 10240
 s_nop 0
 buffer_load_dwordx4 v6, s[12:15], s27 offen lds
 v_mfma_f32_32x32x16_bf16 v[176:191], v[108:111], a[92:95], v[176:191]
 s_add_u32 m0, s29, 11264
 s_nop 0
 buffer_load_dwordx4 v7, s[12:15], s27 offen lds
 v_mfma_f32_32x32x16_bf16 v[160:175], v[64:67], a[96:99], 0
 s_nop 2
 s_add_u32 s28, s25, 65536
 v_mfma_f32_32x32x16_bf16 v[160:175], v[68:71], a[100:103], v[160:175]
 s_nop 3
 v_mfma_f32_32x32x16_bf16 v[160:175], v[72:75], a[104:107], v[160:175]
 v_mfma_f32_32x32x16_bf16 v[160:175], v[76:79], a[108:111], v[160:175]
 v_cvt_pk_bf16_f32 v200, v176, v177
 v_cvt_pk_bf16_f32 v201, v178, v179
 v_mfma_f32_32x32x16_bf16 v[160:175], v[80:83], a[112:115], v[160:175]
 v_cvt_pk_bf16_f32 v202, v180, v181
 v_cvt_pk_bf16_f32 v203, v182, v183
 v_mfma_f32_32x32x16_bf16 v[160:175], v[84:87], a[116:119], v[160:175]
 buffer_store_dwordx4 v[200:203], v14, s[4:7], s28 offen sc1
 v_mfma_f32_32x32x16_bf16 v[160:175], v[88:91], a[120:123], v[160:175]
 v_cvt_pk_bf16_f32 v204, v184, v185
 v_cvt_pk_bf16_f32 v205, v186, v187
 v_mfma_f32_32x32x16_bf16 v[160:175], v[92:95], a[124:127], v[160:175]
 v_cvt_pk_bf16_f32 v206, v188, v189
 v_cvt_pk_bf16_f32 v207, v190, v191
 v_mfma_f32_32x32x16_bf16 v[160:175], v[96:99], a[128:131], v[160:175]
 buffer_store_dwordx4 v[204:207], v14, s[4:7], s28 offen offset:256 sc1
 v_mfma_f32_32x32x16_bf16 v[160:175], v[100:103], a[132:135], v[160:175]
 v_mfma_f32_32x32x16_bf16 v[160:175], v[104:107], a[136:139], v[160:175]
 v_mfma_f32_32x32x16_bf16 v[160:175], v[108:111], a[140:143], v[160:175]
 v_mfma_f32_32x32x16_bf16 v[176:191], v[64:67], a[144:147], 0
 s_nop 2
 s_add_u32 s28, s25, 131072
 v_mfma_f32_32x32x16_bf16 v[176:191], v[68:71], a[148:151], v[176:191]
 s_nop 3
 v_mfma_f32_32x32x16_bf16 v[176:191], v[72:75], a[152:155], v[176:191]
 s_waitcnt vmcnt(16)
 ds_read_b128 v[112:115], v16 offset:12288
 v_mfma_f32_32x32x16_bf16 v[176:191], v[76:79], a[156:159], v[176:191]
 ds_read_b128 v[116:119], v17 offset:12288
 v_cvt_pk_bf16_f32 v192, v160, v161
 v_cvt_pk_bf16_f32 v193, v162, v163
 v_mfma_f32_32x32x16_bf16 v[176:191], v[80:83], a[160:163], v[176:191]
 ds_read_b128 v[120:123], v18 offset:12288
 v_cvt_pk_bf16_f32 v194, v164, v165
 v_cvt_pk_bf16_f32 v195, v166, v167
 v_mfma_f32_32x32x16_bf16 v[176:191], v[84:87], a[164:167], v[176:191]
 buffer_store_dwordx4 v[192:195], v14, s[4:7], s28 offen sc1
 v_mfma_f32_32x32x16_bf16 v[176:191], v[88:91], a[168:171], v[176:191]
 ds_read_b128 v[124:127], v19 offset:12288
 v_cvt_pk_bf16_f32 v196, v168, v169
 v_cvt_pk_bf16_f32 v197, v170, v171
 v_mfma_f32_32x32x16_bf16 v[176:191], v[92:95], a[172:175], v[176:191]
 ds_read_b128 v[128:131], v16 offset:12416
 v_cvt_pk_bf16_f32 v198, v172, v173
 v_cvt_pk_bf16_f32 v199, v174, v175
 v_mfma_f32_32x32x16_bf16 v[176:191], v[96:99], a[176:179], v[176:191]
 buffer_store_dwordx4 v[196:199], v14, s[4:7], s28 offen offset:256 sc1
 v_mfma_f32_32x32x16_bf16 v[176:191], v[100:103], a[180:183], v[176:191]
 ds_read_b128 v[132:135], v17 offset:12416
 v_mfma_f32_32x32x16_bf16 v[176:191], v[104:107], a[184:187], v[176:191]
 ds_read_b128 v[136:139], v18 offset:12416
 v_mfma_f32_32x32x16_bf16 v[176:191], v[108:111], a[188:191], v[176:191]
 ds_read_b128 v[140:143], v19 offset:12416
 v_mfma_f32_32x32x16_bf16 v[160:175], v[64:67], a[192:195], 0
 s_nop 2
 s_add_u32 s28, s25, 196608
 v_mfma_f32_32x32x16_bf16 v[160:175], v[68:71], a[196:199], v[160:175]
 s_nop 3
 v_mfma_f32_32x32x16_bf16 v[160:175], v[72:75], a[200:203], v[160:175]
 ds_read_b128 v[144:147], v16 offset:12544
 v_mfma_f32_32x32x16_bf16 v[160:175], v[76:79], a[204:207], v[160:175]
 ds_read_b128 v[148:151], v17 offset:12544
 v_cvt_pk_bf16_f32 v200, v176, v177
 v_cvt_pk_bf16_f32 v201, v178, v179
 v_mfma_f32_32x32x16_bf16 v[160:175], v[80:83], a[208:211], v[160:175]
 ds_read_b128 v[152:155], v18 offset:12544
 v_cvt_pk_bf16_f32 v202, v180, v181
 v_cvt_pk_bf16_f32 v203, v182, v183
 v_mfma_f32_32x32x16_bf16 v[160:175], v[84:87], a[212:215], v[160:175]
 buffer_store_dwordx4 v[200:203], v14, s[4:7], s28 offen sc1
 v_mfma_f32_32x32x16_bf16 v[160:175], v[88:91], a[216:219], v[160:175]
 ds_read_b128 v[156:159], v19 offset:12544
 v_cvt_pk_bf16_f32 v204, v184, v185
 v_cvt_pk_bf16_f32 v205, v186, v187
 v_mfma_f32_32x32x16_bf16 v[160:175], v[92:95], a[220:223], v[160:175]
 v_cvt_pk_bf16_f32 v206, v188, v189
 v_cvt_pk_bf16_f32 v207, v190, v191
 v_mfma_f32_32x32x16_bf16 v[160:175], v[96:99], a[224:227], v[160:175]
 buffer_store_dwordx4 v[204:207], v14, s[4:7], s28 offen offset:256 sc1
 v_mfma_f32_32x32x16_bf16 v[160:175], v[100:103], a[228:231], v[160:175]
 v_mfma_f32_32x32x16_bf16 v[160:175], v[104:107], a[232:235], v[160:175]
 v_mfma_f32_32x32x16_bf16 v[160:175], v[108:111], a[236:239], v[160:175]
 s_waitcnt lgkmcnt(0)
 v_mfma_f32_32x32x16_bf16 v[176:191], v[112:115], a[0:3], 0
 s_nop 2
 s_add_u32 s28, s25, 262144
 v_mfma_f32_32x32x16_bf16 v[176:191], v[116:119], a[4:7], v[176:191]
 s_nop 3
 v_mfma_f32_32x32x16_bf16 v[176:191], v[120:123], a[8:11], v[176:191]
 s_add_u32 s27, s24, 1179648
 s_add_u32 m0, s29, 12288
 s_nop 0
 buffer_load_dwordx4 v2, s[12:15], s27 offen lds
 v_mfma_f32_32x32x16_bf16 v[176:191], v[124:127], a[12:15], v[176:191]
 v_cvt_pk_bf16_f32 v192, v160, v161
 v_cvt_pk_bf16_f32 v193, v162, v163
 v_mfma_f32_32x32x16_bf16 v[176:191], v[128:131], a[16:19], v[176:191]
 s_add_u32 m0, s29, 13312
 s_nop 0
 buffer_load_dwordx4 v3, s[12:15], s27 offen lds
 v_cvt_pk_bf16_f32 v194, v164, v165
 v_cvt_pk_bf16_f32 v195, v166, v167
 v_mfma_f32_32x32x16_bf16 v[176:191], v[132:135], a[20:23], v[176:191]
 buffer_store_dwordx4 v[192:195], v14, s[4:7], s28 offen sc1
 v_mfma_f32_32x32x16_bf16 v[176:191], v[136:139], a[24:27], v[176:191]
 v_cvt_pk_bf16_f32 v196, v168, v169
 v_cvt_pk_bf16_f32 v197, v170, v171
 v_mfma_f32_32x32x16_bf16 v[176:191], v[140:143], a[28:31], v[176:191]
 s_add_u32 m0, s29, 14336
 s_nop 0
 buffer_load_dwordx4 v4, s[12:15], s27 offen lds
 v_cvt_pk_bf16_f32 v198, v172, v173
 v_cvt_pk_bf16_f32 v199, v174, v175
 v_mfma_f32_32x32x16_bf16 v[176:191], v[144:147], a[32:35], v[176:191]
 buffer_store_dwordx4 v[196:199], v14, s[4:7], s28 offen offset:256 sc1
 v_mfma_f32_32x32x16_bf16 v[176:191], v[148:151], a[36:39], v[176:191]
 s_add_u32 s27, s24, 1204224
 s_add_u32 m0, s29, 15360
 s_nop 0
 buffer_load_dwordx4 v5, s[12:15], s27 offen lds
 v_mfma_f32_32x32x16_bf16 v[176:191], v[152:155], a[40:43], v[176:191]
 s_add_u32 m0, s29, 16384
 s_nop 0
 buffer_load_dwordx4 v6, s[12:15], s27 offen lds
 v_mfma_f32_32x32x16_bf16 v[176:191], v[156:159], a[44:47], v[176:191]
 s_add_u32 m0, s29, 17408
 s_nop 0
 buffer_load_dwordx4 v7, s[12:15], s27 offen lds
 v_mfma_f32_32x32x16_bf16 v[160:175], v[112:115], a[48:51], 0
 s_nop 2
 s_add_u32 s28, s25, 1310720
 v_mfma_f32_32x32x16_bf16 v[160:175], v[116:119], a[52:55], v[160:175]
 s_nop 3
 v_mfma_f32_32x32x16_bf16 v[160:175], v[120:123], a[56:59], v[160:175]
 s_add_u32 s27, s24, 1376256
 s_add_u32 m0, s29, 18432
 s_nop 0
 buffer_load_dwordx4 v2, s[12:15], s27 offen lds
 v_mfma_f32_32x32x16_bf16 v[160:175], v[124:127], a[60:63], v[160:175]
 v_cvt_pk_bf16_f32 v200, v176, v177
 v_cvt_pk_bf16_f32 v201, v178, v179
 v_mfma_f32_32x32x16_bf16 v[160:175], v[128:131], a[64:67], v[160:175]
 s_add_u32 m0, s29, 19456
 s_nop 0
 buffer_load_dwordx4 v3, s[12:15], s27 offen lds
 v_cvt_pk_bf16_f32 v202, v180, v181
 v_cvt_pk_bf16_f32 v203, v182, v183
 v_mfma_f32_32x32x16_bf16 v[160:175], v[132:135], a[68:71], v[160:175]
 buffer_store_dwordx4 v[200:203], v14, s[4:7], s28 offen sc1
 v_mfma_f32_32x32x16_bf16 v[160:175], v[136:139], a[72:75], v[160:175]
 v_cvt_pk_bf16_f32 v204, v184, v185
 v_cvt_pk_bf16_f32 v205, v186, v187
 v_mfma_f32_32x32x16_bf16 v[160:175], v[140:143], a[76:79], v[160:175]
 s_add_u32 m0, s29, 20480
 s_nop 0
 buffer_load_dwordx4 v4, s[12:15], s27 offen lds
 v_cvt_pk_bf16_f32 v206, v188, v189
 v_cvt_pk_bf16_f32 v207, v190, v191
 v_mfma_f32_32x32x16_bf16 v[160:175], v[144:147], a[80:83], v[160:175]
 buffer_store_dwordx4 v[204:207], v14, s[4:7], s28 offen offset:256 sc1
 v_mfma_f32_32x32x16_bf16 v[160:175], v[148:151], a[84:87], v[160:175]
 s_add_u32 s27, s24, 1400832
 s_add_u32 m0, s29, 21504
 s_nop 0
 buffer_load_dwordx4 v5, s[12:15], s27 offen lds
 v_mfma_f32_32x32x16_bf16 v[160:175], v[152:155], a[88:91], v[160:175]
 s_add_u32 m0, s29, 22528
 s_nop 0
 buffer_load_dwordx4 v6, s[12:15], s27 offen lds
 v_mfma_f32_32x32x16_bf16 v[160:175], v[156:159], a[92:95], v[160:175]
 s_add_u32 m0, s29, 23552
 s_nop 0
 buffer_load_dwordx4 v7, s[12:15], s27 offen lds
 v_mfma_f32_32x32x16_bf16 v[176:191], v[112:115], a[96:99], 0
 s_nop 2
 s_add_u32 s28, s25, 1376256
 v_mfma_f32_32x32x16_bf16 v[176:191], v[116:119], a[100:103], v[176:191]
 s_nop 3
 v_mfma_f32_32x32x16_bf16 v[176:191], v[120:123], a[104:107], v[176:191]
 v_mfma_f32_32x32x16_bf16 v[176:191], v[124:127], a[108:111], v[176:191]
 v_cvt_pk_bf16_f32 v192, v160, v161
 v_cvt_pk_bf16_f32 v193, v162, v163
 v_mfma_f32_32x32x16_bf16 v[176:191], v[128:131], a[112:115], v[176:191]
 v_cvt_pk_bf16_f32 v194, v164, v165
 v_cvt_pk_bf16_f32 v195, v166, v167
 v_mfma_f32_32x32x16_bf16 v[176:191], v[132:135], a[116:119], v[176:191]
 buffer_store_dwordx4 v[192:195], v14, s[4:7], s28 offen sc1
 v_mfma_f32_32x32x16_bf16 v[176:191], v[136:139], a[120:123], v[176:191]
 v_cvt_pk_bf16_f32 v196, v168, v169
 v_cvt_pk_bf16_f32 v197, v170, v171
 v_mfma_f32_32x32x16_bf16 v[176:191], v[140:143], a[124:127], v[176:191]
 v_cvt_pk_bf16_f32 v198, v172, v173
 v_cvt_pk_bf16_f32 v199, v174, v175
 v_mfma_f32_32x32x16_bf16 v[176:191], v[144:147], a[128:131], v[176:191]
 buffer_store_dwordx4 v[196:199], v14, s[4:7], s28 offen offset:256 sc1
 v_mfma_f32_32x32x16_bf16 v[176:191], v[148:151], a[132:135], v[176:191]
 v_mfma_f32_32x32x16_bf16 v[176:191], v[152:155], a[136:139], v[176:191]
 v_mfma_f32_32x32x16_bf16 v[176:191], v[156:159], a[140:143], v[176:191]
 v_mfma_f32_32x32x16_bf16 v[160:175], v[112:115], a[144:147], 0
 s_nop 2
 s_add_u32 s28, s25, 1441792
 v_mfma_f32_32x32x16_bf16 v[160:175], v[116:119], a[148:151], v[160:175]
 s_nop 3
 v_mfma_f32_32x32x16_bf16 v[160:175], v[120:123], a[152:155], v[160:175]
 s_waitcnt vmcnt(24)
 ds_read_b128 v[64:67], v16 offset:0
 v_mfma_f32_32x32x16_bf16 v[160:175], v[124:127], a[156:159], v[160:175]
 ds_read_b128 v[68:71], v17 offset:0
 v_cvt_pk_bf16_f32 v200, v176, v177
 v_cvt_pk_bf16_f32 v201, v178, v179
 v_mfma_f32_32x32x16_bf16 v[160:175], v[128:131], a[160:163], v[160:175]
 ds_read_b128 v[72:75], v18 offset:0
 v_cvt_pk_bf16_f32 v202, v180, v181
 v_cvt_pk_bf16_f32 v203, v182, v183
 v_mfma_f32_32x32x16_bf16 v[160:175], v[132:135], a[164:167], v[160:175]
 buffer_store_dwordx4 v[200:203], v14, s[4:7], s28 offen sc1
 v_mfma_f32_32x32x16_bf16 v[160:175], v[136:139], a[168:171], v[160:175]
 ds_read_b128 v[76:79], v19 offset:0
 v_cvt_pk_bf16_f32 v204, v184, v185
 v_cvt_pk_bf16_f32 v205, v186, v187
 v_mfma_f32_32x32x16_bf16 v[160:175], v[140:143], a[172:175], v[160:175]
 ds_read_b128 v[80:83], v16 offset:128
 v_cvt_pk_bf16_f32 v206, v188, v189
 v_cvt_pk_bf16_f32 v207, v190, v191
 v_mfma_f32_32x32x16_bf16 v[160:175], v[144:147], a[176:179], v[160:175]
 buffer_store_dwordx4 v[204:207], v14, s[4:7], s28 offen offset:256 sc1
 v_mfma_f32_32x32x16_bf16 v[160:175], v[148:151], a[180:183], v[160:175]
 ds_read_b128 v[84:87], v17 offset:128
 v_mfma_f32_32x32x16_bf16 v[160:175], v[152:155], a[184:187], v[160:175]
 ds_read_b128 v[88:91], v18 offset:128
 v_mfma_f32_32x32x16_bf16 v[160:175], v[156:159], a[188:191], v[160:175]
 ds_read_b128 v[92:95], v19 offset:128
 v_mfma_f32_32x32x16_bf16 v[176:191], v[112:115], a[192:195], 0
 s_nop 2
 s_add_u32 s28, s25, 1507328
 v_mfma_f32_32x32x16_bf16 v[176:191], v[116:119], a[196:199], v[176:191]
 s_nop 3
 v_mfma_f32_32x32x16_bf16 v[176:191], v[120:123], a[200:203], v[176:191]
 ds_read_b128 v[96:99], v16 offset:256
 v_mfma_f32_32x32x16_bf16 v[176:191], v[124:127], a[204:207], v[176:191]
 ds_read_b128 v[100:103], v17 offset:256
 v_cvt_pk_bf16_f32 v192, v160, v161
 v_cvt_pk_bf16_f32 v193, v162, v163
 v_mfma_f32_32x32x16_bf16 v[176:191], v[128:131], a[208:211], v[176:191]
 ds_read_b128 v[104:107], v18 offset:256
 v_cvt_pk_bf16_f32 v194, v164, v165
 v_cvt_pk_bf16_f32 v195, v166, v167
 v_mfma_f32_32x32x16_bf16 v[176:191], v[132:135], a[212:215], v[176:191]
 buffer_store_dwordx4 v[192:195], v14, s[4:7], s28 offen sc1
 v_mfma_f32_32x32x16_bf16 v[176:191], v[136:139], a[216:219], v[176:191]
 ds_read_b128 v[108:111], v19 offset:256
 v_cvt_pk_bf16_f32 v196, v168, v169
 v_cvt_pk_bf16_f32 v197, v170, v171
 v_mfma_f32_32x32x16_bf16 v[176:191], v[140:143], a[220:223], v[176:191]
 v_cvt_pk_bf16_f32 v198, v172, v173
 v_cvt_pk_bf16_f32 v199, v174, v175
 v_mfma_f32_32x32x16_bf16 v[176:191], v[144:147], a[224:227], v[176:191]
 buffer_store_dwordx4 v[196:199], v14, s[4:7], s28 offen offset:256 sc1
 v_mfma_f32_32x32x16_bf16 v[176:191], v[148:151], a[228:231], v[176:191]
 v_mfma_f32_32x32x16_bf16 v[176:191], v[152:155], a[232:235], v[176:191]
 v_mfma_f32_32x32x16_bf16 v[176:191], v[156:159], a[236:239], v[176:191]
 s_waitcnt lgkmcnt(0)
 v_mfma_f32_32x32x16_bf16 v[160:175], v[64:67], a[0:3], 0
 s_nop 2
 s_add_u32 s28, s25, 1572864
 v_mfma_f32_32x32x16_bf16 v[160:175], v[68:71], a[4:7], v[160:175]
 s_nop 3
 v_mfma_f32_32x32x16_bf16 v[160:175], v[72:75], a[8:11], v[160:175]
 s_add_u32 s27, s24, 1572864
 s_add_u32 m0, s29, 0
 s_nop 0
 buffer_load_dwordx4 v2, s[12:15], s27 offen lds
 v_mfma_f32_32x32x16_bf16 v[160:175], v[76:79], a[12:15], v[160:175]
 v_cvt_pk_bf16_f32 v200, v176, v177
 v_cvt_pk_bf16_f32 v201, v178, v179
 v_mfma_f32_32x32x16_bf16 v[160:175], v[80:83], a[16:19], v[160:175]
 s_add_u32 m0, s29, 1024
 s_nop 0
 buffer_load_dwordx4 v3, s[12:15], s27 offen lds
 v_cvt_pk_bf16_f32 v202, v180, v181
 v_cvt_pk_bf16_f32 v203, v182, v183
 v_mfma_f32_32x32x16_bf16 v[160:175], v[84:87], a[20:23], v[160:175]
 buffer_store_dwordx4 v[200:203], v14, s[4:7], s28 offen sc1
 v_mfma_f32_32x32x16_bf16 v[160:175], v[88:91], a[24:27], v[160:175]
 v_cvt_pk_bf16_f32 v204, v184, v185
 v_cvt_pk_bf16_f32 v205, v186, v187
 v_mfma_f32_32x32x16_bf16 v[160:175], v[92:95], a[28:31], v[160:175]
 s_add_u32 m0, s29, 2048
 s_nop 0
 buffer_load_dwordx4 v4, s[12:15], s27 offen lds
 v_cvt_pk_bf16_f32 v206, v188, v189
 v_cvt_pk_bf16_f32 v207, v190, v191
 v_mfma_f32_32x32x16_bf16 v[160:175], v[96:99], a[32:35], v[160:175]
 buffer_store_dwordx4 v[204:207], v14, s[4:7], s28 offen offset:256 sc1
 v_mfma_f32_32x32x16_bf16 v[160:175], v[100:103], a[36:39], v[160:175]
 s_add_u32 s27, s24, 1597440
 s_add_u32 m0, s29, 3072
 s_nop 0
 buffer_load_dwordx4 v5, s[12:15], s27 offen lds
 v_mfma_f32_32x32x16_bf16 v[160:175], v[104:107], a[40:43], v[160:175]
 s_add_u32 m0, s29, 4096
 s_nop 0
 buffer_load_dwordx4 v6, s[12:15], s27 offen lds
 v_mfma_f32_32x32x16_bf16 v[160:175], v[108:111], a[44:47], v[160:175]
 s_add_u32 m0, s29, 5120
 s_nop 0
 buffer_load_dwordx4 v7, s[12:15], s27 offen lds
 v_mfma_f32_32x32x16_bf16 v[176:191], v[64:67], a[48:51], 0
 s_nop 2
 s_add_u32 s28, s25, 2621440
 v_mfma_f32_32x32x16_bf16 v[176:191], v[68:71], a[52:55], v[176:191]
 s_nop 3
 v_mfma_f32_32x32x16_bf16 v[176:191], v[72:75], a[56:59], v[176:191]
 s_add_u32 s27, s24, 1769472
 s_add_u32 m0, s29, 6144
 s_nop 0
 buffer_load_dwordx4 v2, s[12:15], s27 offen lds
 v_mfma_f32_32x32x16_bf16 v[176:191], v[76:79], a[60:63], v[176:191]
 v_cvt_pk_bf16_f32 v192, v160, v161
 v_cvt_pk_bf16_f32 v193, v162, v163
 v_mfma_f32_32x32x16_bf16 v[176:191], v[80:83], a[64:67], v[176:191]
 s_add_u32 m0, s29, 7168
 s_nop 0
 buffer_load_dwordx4 v3, s[12:15], s27 offen lds
 v_cvt_pk_bf16_f32 v194, v164, v165
 v_cvt_pk_bf16_f32 v195, v166, v167
 v_mfma_f32_32x32x16_bf16 v[176:191], v[84:87], a[68:71], v[176:191]
 buffer_store_dwordx4 v[192:195], v14, s[4:7], s28 offen sc1
 v_mfma_f32_32x32x16_bf16 v[176:191], v[88:91], a[72:75], v[176:191]
 v_cvt_pk_bf16_f32 v196, v168, v169
 v_cvt_pk_bf16_f32 v197, v170, v171
 v_mfma_f32_32x32x16_bf16 v[176:191], v[92:95], a[76:79], v[176:191]
 s_add_u32 m0, s29, 8192
 s_nop 0
 buffer_load_dwordx4 v4, s[12:15], s27 offen lds
 v_cvt_pk_bf16_f32 v198, v172, v173
 v_cvt_pk_bf16_f32 v199, v174, v175
 v_mfma_f32_32x32x16_bf16 v[176:191], v[96:99], a[80:83], v[176:191]
 buffer_store_dwordx4 v[196:199], v14, s[4:7], s28 offen offset:256 sc1
 v_mfma_f32_32x32x16_bf16 v[176:191], v[100:103], a[84:87], v[176:191]
 s_add_u32 s27, s24, 1794048
 s_add_u32 m0, s29, 9216
 s_nop 0
 buffer_load_dwordx4 v5, s[12:15], s27 offen lds
 v_mfma_f32_32x32x16_bf16 v[176:191], v[104:107], a[88:91], v[176:191]
 s_add_u32 m0, s29, 10240
 s_nop 0
 buffer_load_dwordx4 v6, s[12:15], s27 offen lds
 v_mfma_f32_32x32x16_bf16 v[176:191], v[108:111], a[92:95], v[176:191]
 s_add_u32 m0, s29, 11264
 s_nop 0
 buffer_load_dwordx4 v7, s[12:15], s27 offen lds
 v_mfma_f32_32x32x16_bf16 v[160:175], v[64:67], a[96:99], 0
 s_nop 2
 s_add_u32 s28, s25, 2686976
 v_mfma_f32_32x32x16_bf16 v[160:175], v[68:71], a[100:103], v[160:175]
 s_nop 3
 v_mfma_f32_32x32x16_bf16 v[160:175], v[72:75], a[104:107], v[160:175]
 v_mfma_f32_32x32x16_bf16 v[160:175], v[76:79], a[108:111], v[160:175]
 v_cvt_pk_bf16_f32 v200, v176, v177
 v_cvt_pk_bf16_f32 v201, v178, v179
 v_mfma_f32_32x32x16_bf16 v[160:175], v[80:83], a[112:115], v[160:175]
 v_cvt_pk_bf16_f32 v202, v180, v181
 v_cvt_pk_bf16_f32 v203, v182, v183
 v_mfma_f32_32x32x16_bf16 v[160:175], v[84:87], a[116:119], v[160:175]
 buffer_store_dwordx4 v[200:203], v14, s[4:7], s28 offen sc1
 v_mfma_f32_32x32x16_bf16 v[160:175], v[88:91], a[120:123], v[160:175]
 v_cvt_pk_bf16_f32 v204, v184, v185
 v_cvt_pk_bf16_f32 v205, v186, v187
 v_mfma_f32_32x32x16_bf16 v[160:175], v[92:95], a[124:127], v[160:175]
 v_cvt_pk_bf16_f32 v206, v188, v189
 v_cvt_pk_bf16_f32 v207, v190, v191
 v_mfma_f32_32x32x16_bf16 v[160:175], v[96:99], a[128:131], v[160:175]
 buffer_store_dwordx4 v[204:207], v14, s[4:7], s28 offen offset:256 sc1
 v_mfma_f32_32x32x16_bf16 v[160:175], v[100:103], a[132:135], v[160:175]
 v_mfma_f32_32x32x16_bf16 v[160:175], v[104:107], a[136:139], v[160:175]
 v_mfma_f32_32x32x16_bf16 v[160:175], v[108:111], a[140:143], v[160:175]
 v_mfma_f32_32x32x16_bf16 v[176:191], v[64:67], a[144:147], 0
 s_nop 2
 s_add_u32 s28, s25, 2752512
 v_mfma_f32_32x32x16_bf16 v[176:191], v[68:71], a[148:151], v[176:191]
 s_nop 3
 v_mfma_f32_32x32x16_bf16 v[176:191], v[72:75], a[152:155], v[176:191]
 s_waitcnt vmcnt(24)
 ds_read_b128 v[112:115], v16 offset:12288
 v_mfma_f32_32x32x16_bf16 v[176:191], v[76:79], a[156:159], v[176:191]
 ds_read_b128 v[116:119], v17 offset:12288
 v_cvt_pk_bf16_f32 v192, v160, v161
 v_cvt_pk_bf16_f32 v193, v162, v163
 v_mfma_f32_32x32x16_bf16 v[176:191], v[80:83], a[160:163], v[176:191]
 ds_read_b128 v[120:123], v18 offset:12288
 v_cvt_pk_bf16_f32 v194, v164, v165
 v_cvt_pk_bf16_f32 v195, v166, v167
 v_mfma_f32_32x32x16_bf16 v[176:191], v[84:87], a[164:167], v[176:191]
 buffer_store_dwordx4 v[192:195], v14, s[4:7], s28 offen sc1
 v_mfma_f32_32x32x16_bf16 v[176:191], v[88:91], a[168:171], v[176:191]
 ds_read_b128 v[124:127], v19 offset:12288
 v_cvt_pk_bf16_f32 v196, v168, v169
 v_cvt_pk_bf16_f32 v197, v170, v171
 v_mfma_f32_32x32x16_bf16 v[176:191], v[92:95], a[172:175], v[176:191]
 ds_read_b128 v[128:131], v16 offset:12416
 v_cvt_pk_bf16_f32 v198, v172, v173
 v_cvt_pk_bf16_f32 v199, v174, v175
 v_mfma_f32_32x32x16_bf16 v[176:191], v[96:99], a[176:179], v[176:191]
 buffer_store_dwordx4 v[196:199], v14, s[4:7], s28 offen offset:256 sc1
 v_mfma_f32_32x32x16_bf16 v[176:191], v[100:103], a[180:183], v[176:191]
 ds_read_b128 v[132:135], v17 offset:12416
 v_mfma_f32_32x32x16_bf16 v[176:191], v[104:107], a[184:187], v[176:191]
 ds_read_b128 v[136:139], v18 offset:12416
 v_mfma_f32_32x32x16_bf16 v[176:191], v[108:111], a[188:191], v[176:191]
 ds_read_b128 v[140:143], v19 offset:12416
 v_mfma_f32_32x32x16_bf16 v[160:175], v[64:67], a[192:195], 0
 s_nop 2
 s_add_u32 s28, s25, 2818048
 v_mfma_f32_32x32x16_bf16 v[160:175], v[68:71], a[196:199], v[160:175]
 s_nop 3
 v_mfma_f32_32x32x16_bf16 v[160:175], v[72:75], a[200:203], v[160:175]
 ds_read_b128 v[144:147], v16 offset:12544
 v_mfma_f32_32x32x16_bf16 v[160:175], v[76:79], a[204:207], v[160:175]
 ds_read_b128 v[148:151], v17 offset:12544
 v_cvt_pk_bf16_f32 v200, v176, v177
 v_cvt_pk_bf16_f32 v201, v178, v179
 v_mfma_f32_32x32x16_bf16 v[160:175], v[80:83], a[208:211], v[160:175]
 ds_read_b128 v[152:155], v18 offset:12544
 v_cvt_pk_bf16_f32 v202, v180, v181
 v_cvt_pk_bf16_f32 v203, v182, v183
 v_mfma_f32_32x32x16_bf16 v[160:175], v[84:87], a[212:215], v[160:175]
 buffer_store_dwordx4 v[200:203], v14, s[4:7], s28 offen sc1
 v_mfma_f32_32x32x16_bf16 v[160:175], v[88:91], a[216:219], v[160:175]
 ds_read_b128 v[156:159], v19 offset:12544
 v_cvt_pk_bf16_f32 v204, v184, v185
 v_cvt_pk_bf16_f32 v205, v186, v187
 v_mfma_f32_32x32x16_bf16 v[160:175], v[92:95], a[220:223], v[160:175]
 v_cvt_pk_bf16_f32 v206, v188, v189
 v_cvt_pk_bf16_f32 v207, v190, v191
 v_mfma_f32_32x32x16_bf16 v[160:175], v[96:99], a[224:227], v[160:175]
 buffer_store_dwordx4 v[204:207], v14, s[4:7], s28 offen offset:256 sc1
 v_mfma_f32_32x32x16_bf16 v[160:175], v[100:103], a[228:231], v[160:175]
 v_mfma_f32_32x32x16_bf16 v[160:175], v[104:107], a[232:235], v[160:175]
 v_mfma_f32_32x32x16_bf16 v[160:175], v[108:111], a[236:239], v[160:175]
 s_waitcnt lgkmcnt(0)
 v_mfma_f32_32x32x16_bf16 v[176:191], v[112:115], a[0:3], 0
 s_nop 2
 s_add_u32 s28, s25, 2883584
 v_mfma_f32_32x32x16_bf16 v[176:191], v[116:119], a[4:7], v[176:191]
 s_nop 3
 v_mfma_f32_32x32x16_bf16 v[176:191], v[120:123], a[8:11], v[176:191]
 v_mfma_f32_32x32x16_bf16 v[176:191], v[124:127], a[12:15], v[176:191]
 v_cvt_pk_bf16_f32 v192, v160, v161
 v_cvt_pk_bf16_f32 v193, v162, v163
 v_mfma_f32_32x32x16_bf16 v[176:191], v[128:131], a[16:19], v[176:191]
 v_cvt_pk_bf16_f32 v194, v164, v165
 v_cvt_pk_bf16_f32 v195, v166, v167
 v_mfma_f32_32x32x16_bf16 v[176:191], v[132:135], a[20:23], v[176:191]
 buffer_store_dwordx4 v[192:195], v14, s[4:7], s28 offen sc1
 v_mfma_f32_32x32x16_bf16 v[176:191], v[136:139], a[24:27], v[176:191]
 v_cvt_pk_bf16_f32 v196, v168, v169
 v_cvt_pk_bf16_f32 v197, v170, v171
 v_mfma_f32_32x32x16_bf16 v[176:191], v[140:143], a[28:31], v[176:191]
 v_cvt_pk_bf16_f32 v198, v172, v173
 v_cvt_pk_bf16_f32 v199, v174, v175
 v_mfma_f32_32x32x16_bf16 v[176:191], v[144:147], a[32:35], v[176:191]
 buffer_store_dwordx4 v[196:199], v14, s[4:7], s28 offen offset:256 sc1
 v_mfma_f32_32x32x16_bf16 v[176:191], v[148:151], a[36:39], v[176:191]
 v_mfma_f32_32x32x16_bf16 v[176:191], v[152:155], a[40:43], v[176:191]
 v_mfma_f32_32x32x16_bf16 v[176:191], v[156:159], a[44:47], v[176:191]
 v_mfma_f32_32x32x16_bf16 v[160:175], v[112:115], a[48:51], 0
 s_nop 2
 s_add_u32 s28, s25, 3932160
 v_mfma_f32_32x32x16_bf16 v[160:175], v[116:119], a[52:55], v[160:175]
 s_nop 3
 v_mfma_f32_32x32x16_bf16 v[160:175], v[120:123], a[56:59], v[160:175]
 v_mfma_f32_32x32x16_bf16 v[160:175], v[124:127], a[60:63], v[160:175]
 v_cvt_pk_bf16_f32 v200, v176, v177
 v_cvt_pk_bf16_f32 v201, v178, v179
 v_mfma_f32_32x32x16_bf16 v[160:175], v[128:131], a[64:67], v[160:175]
 v_cvt_pk_bf16_f32 v202, v180, v181
 v_cvt_pk_bf16_f32 v203, v182, v183
 v_mfma_f32_32x32x16_bf16 v[160:175], v[132:135], a[68:71], v[160:175]
 buffer_store_dwordx4 v[200:203], v14, s[4:7], s28 offen sc1
 v_mfma_f32_32x32x16_bf16 v[160:175], v[136:139], a[72:75], v[160:175]
 v_cvt_pk_bf16_f32 v204, v184, v185
 v_cvt_pk_bf16_f32 v205, v186, v187
 v_mfma_f32_32x32x16_bf16 v[160:175], v[140:143], a[76:79], v[160:175]
 v_cvt_pk_bf16_f32 v206, v188, v189
 v_cvt_pk_bf16_f32 v207, v190, v191
 v_mfma_f32_32x32x16_bf16 v[160:175], v[144:147], a[80:83], v[160:175]
 buffer_store_dwordx4 v[204:207], v14, s[4:7], s28 offen offset:256 sc1
 v_mfma_f32_32x32x16_bf16 v[160:175], v[148:151], a[84:87], v[160:175]
 v_mfma_f32_32x32x16_bf16 v[160:175], v[152:155], a[88:91], v[160:175]
 v_mfma_f32_32x32x16_bf16 v[160:175], v[156:159], a[92:95], v[160:175]
 v_mfma_f32_32x32x16_bf16 v[176:191], v[112:115], a[96:99], 0
 s_nop 2
 s_add_u32 s28, s25, 3997696
 v_mfma_f32_32x32x16_bf16 v[176:191], v[116:119], a[100:103], v[176:191]
 s_nop 3
 v_mfma_f32_32x32x16_bf16 v[176:191], v[120:123], a[104:107], v[176:191]
 v_mfma_f32_32x32x16_bf16 v[176:191], v[124:127], a[108:111], v[176:191]
 v_cvt_pk_bf16_f32 v192, v160, v161
 v_cvt_pk_bf16_f32 v193, v162, v163
 v_mfma_f32_32x32x16_bf16 v[176:191], v[128:131], a[112:115], v[176:191]
 v_cvt_pk_bf16_f32 v194, v164, v165
 v_cvt_pk_bf16_f32 v195, v166, v167
 v_mfma_f32_32x32x16_bf16 v[176:191], v[132:135], a[116:119], v[176:191]
 buffer_store_dwordx4 v[192:195], v14, s[4:7], s28 offen sc1
 v_mfma_f32_32x32x16_bf16 v[176:191], v[136:139], a[120:123], v[176:191]
 v_cvt_pk_bf16_f32 v196, v168, v169
 v_cvt_pk_bf16_f32 v197, v170, v171
 v_mfma_f32_32x32x16_bf16 v[176:191], v[140:143], a[124:127], v[176:191]
 v_cvt_pk_bf16_f32 v198, v172, v173
 v_cvt_pk_bf16_f32 v199, v174, v175
 v_mfma_f32_32x32x16_bf16 v[176:191], v[144:147], a[128:131], v[176:191]
 buffer_store_dwordx4 v[196:199], v14, s[4:7], s28 offen offset:256 sc1
 v_mfma_f32_32x32x16_bf16 v[176:191], v[148:151], a[132:135], v[176:191]
 v_mfma_f32_32x32x16_bf16 v[176:191], v[152:155], a[136:139], v[176:191]
 v_mfma_f32_32x32x16_bf16 v[176:191], v[156:159], a[140:143], v[176:191]
 v_mfma_f32_32x32x16_bf16 v[160:175], v[112:115], a[144:147], 0
 s_nop 2
 s_add_u32 s28, s25, 4063232
 v_mfma_f32_32x32x16_bf16 v[160:175], v[116:119], a[148:151], v[160:175]
 s_nop 3
 v_mfma_f32_32x32x16_bf16 v[160:175], v[120:123], a[152:155], v[160:175]
 s_waitcnt vmcnt(12)
 ds_read_b128 v[64:67], v16 offset:0
 v_mfma_f32_32x32x16_bf16 v[160:175], v[124:127], a[156:159], v[160:175]
 ds_read_b128 v[68:71], v17 offset:0
 v_cvt_pk_bf16_f32 v200, v176, v177
 v_cvt_pk_bf16_f32 v201, v178, v179
 v_mfma_f32_32x32x16_bf16 v[160:175], v[128:131], a[160:163], v[160:175]
 ds_read_b128 v[72:75], v18 offset:0
 v_cvt_pk_bf16_f32 v202, v180, v181
 v_cvt_pk_bf16_f32 v203, v182, v183
 v_mfma_f32_32x32x16_bf16 v[160:175], v[132:135], a[164:167], v[160:175]
 buffer_store_dwordx4 v[200:203], v14, s[4:7], s28 offen sc1
 v_mfma_f32_32x32x16_bf16 v[160:175], v[136:139], a[168:171], v[160:175]
 ds_read_b128 v[76:79], v19 offset:0
 v_cvt_pk_bf16_f32 v204, v184, v185
 v_cvt_pk_bf16_f32 v205, v186, v187
 v_mfma_f32_32x32x16_bf16 v[160:175], v[140:143], a[172:175], v[160:175]
 ds_read_b128 v[80:83], v16 offset:128
 v_cvt_pk_bf16_f32 v206, v188, v189
 v_cvt_pk_bf16_f32 v207, v190, v191
 v_mfma_f32_32x32x16_bf16 v[160:175], v[144:147], a[176:179], v[160:175]
 buffer_store_dwordx4 v[204:207], v14, s[4:7], s28 offen offset:256 sc1
 v_mfma_f32_32x32x16_bf16 v[160:175], v[148:151], a[180:183], v[160:175]
 ds_read_b128 v[84:87], v17 offset:128
 v_mfma_f32_32x32x16_bf16 v[160:175], v[152:155], a[184:187], v[160:175]
 ds_read_b128 v[88:91], v18 offset:128
 v_mfma_f32_32x32x16_bf16 v[160:175], v[156:159], a[188:191], v[160:175]
 ds_read_b128 v[92:95], v19 offset:128
 v_mfma_f32_32x32x16_bf16 v[176:191], v[112:115], a[192:195], 0
 s_nop 2
 s_add_u32 s28, s25, 4128768
 v_mfma_f32_32x32x16_bf16 v[176:191], v[116:119], a[196:199], v[176:191]
 s_nop 3
 v_mfma_f32_32x32x16_bf16 v[176:191], v[120:123], a[200:203], v[176:191]
 ds_read_b128 v[96:99], v16 offset:256
 v_mfma_f32_32x32x16_bf16 v[176:191], v[124:127], a[204:207], v[176:191]
 ds_read_b128 v[100:103], v17 offset:256
 v_cvt_pk_bf16_f32 v192, v160, v161
 v_cvt_pk_bf16_f32 v193, v162, v163
 v_mfma_f32_32x32x16_bf16 v[176:191], v[128:131], a[208:211], v[176:191]
 ds_read_b128 v[104:107], v18 offset:256
 v_cvt_pk_bf16_f32 v194, v164, v165
 v_cvt_pk_bf16_f32 v195, v166, v167
 v_mfma_f32_32x32x16_bf16 v[176:191], v[132:135], a[212:215], v[176:191]
 buffer_store_dwordx4 v[192:195], v14, s[4:7], s28 offen sc1
 v_mfma_f32_32x32x16_bf16 v[176:191], v[136:139], a[216:219], v[176:191]
 ds_read_b128 v[108:111], v19 offset:256
 v_cvt_pk_bf16_f32 v196, v168, v169
 v_cvt_pk_bf16_f32 v197, v170, v171
 v_mfma_f32_32x32x16_bf16 v[176:191], v[140:143], a[220:223], v[176:191]
 v_cvt_pk_bf16_f32 v198, v172, v173
 v_cvt_pk_bf16_f32 v199, v174, v175
 v_mfma_f32_32x32x16_bf16 v[176:191], v[144:147], a[224:227], v[176:191]
 buffer_store_dwordx4 v[196:199], v14, s[4:7], s28 offen offset:256 sc1
 v_mfma_f32_32x32x16_bf16 v[176:191], v[148:151], a[228:231], v[176:191]
 v_mfma_f32_32x32x16_bf16 v[176:191], v[152:155], a[232:235], v[176:191]
 v_mfma_f32_32x32x16_bf16 v[176:191], v[156:159], a[236:239], v[176:191]
 s_waitcnt lgkmcnt(0)
 v_mfma_f32_32x32x16_bf16 v[160:175], v[64:67], a[0:3], 0
 s_nop 2
 s_add_u32 s28, s25, 4194304
 v_mfma_f32_32x32x16_bf16 v[160:175], v[68:71], a[4:7], v[160:175]
 s_nop 3
 v_mfma_f32_32x32x16_bf16 v[160:175], v[72:75], a[8:11], v[160:175]
 v_mfma_f32_32x32x16_bf16 v[160:175], v[76:79], a[12:15], v[160:175]
 v_cvt_pk_bf16_f32 v200, v176, v177
 v_cvt_pk_bf16_f32 v201, v178, v179
 v_mfma_f32_32x32x16_bf16 v[160:175], v[80:83], a[16:19], v[160:175]
 v_cvt_pk_bf16_f32 v202, v180, v181
 v_cvt_pk_bf16_f32 v203, v182, v183
 v_mfma_f32_32x32x16_bf16 v[160:175], v[84:87], a[20:23], v[160:175]
 buffer_store_dwordx4 v[200:203], v14, s[4:7], s28 offen sc1
 v_mfma_f32_32x32x16_bf16 v[160:175], v[88:91], a[24:27], v[160:175]
 v_cvt_pk_bf16_f32 v204, v184, v185
 v_cvt_pk_bf16_f32 v205, v186, v187
 v_mfma_f32_32x32x16_bf16 v[160:175], v[92:95], a[28:31], v[160:175]
 v_cvt_pk_bf16_f32 v206, v188, v189
 v_cvt_pk_bf16_f32 v207, v190, v191
 v_mfma_f32_32x32x16_bf16 v[160:175], v[96:99], a[32:35], v[160:175]
 buffer_store_dwordx4 v[204:207], v14, s[4:7], s28 offen offset:256 sc1
 v_mfma_f32_32x32x16_bf16 v[160:175], v[100:103], a[36:39], v[160:175]
 v_mfma_f32_32x32x16_bf16 v[160:175], v[104:107], a[40:43], v[160:175]
 v_mfma_f32_32x32x16_bf16 v[160:175], v[108:111], a[44:47], v[160:175]
 v_mfma_f32_32x32x16_bf16 v[176:191], v[64:67], a[48:51], 0
 s_nop 2
 s_add_u32 s28, s25, 5242880
 v_mfma_f32_32x32x16_bf16 v[176:191], v[68:71], a[52:55], v[176:191]
 s_nop 3
 v_mfma_f32_32x32x16_bf16 v[176:191], v[72:75], a[56:59], v[176:191]
 v_mfma_f32_32x32x16_bf16 v[176:191], v[76:79], a[60:63], v[176:191]
 v_cvt_pk_bf16_f32 v192, v160, v161
 v_cvt_pk_bf16_f32 v193, v162, v163
 v_mfma_f32_32x32x16_bf16 v[176:191], v[80:83], a[64:67], v[176:191]
 v_cvt_pk_bf16_f32 v194, v164, v165
 v_cvt_pk_bf16_f32 v195, v166, v167
 v_mfma_f32_32x32x16_bf16 v[176:191], v[84:87], a[68:71], v[176:191]
 buffer_store_dwordx4 v[192:195], v14, s[4:7], s28 offen sc1
 v_mfma_f32_32x32x16_bf16 v[176:191], v[88:91], a[72:75], v[176:191]
 v_cvt_pk_bf16_f32 v196, v168, v169
 v_cvt_pk_bf16_f32 v197, v170, v171
 v_mfma_f32_32x32x16_bf16 v[176:191], v[92:95], a[76:79], v[176:191]
 v_cvt_pk_bf16_f32 v198, v172, v173
 v_cvt_pk_bf16_f32 v199, v174, v175
 v_mfma_f32_32x32x16_bf16 v[176:191], v[96:99], a[80:83], v[176:191]
 buffer_store_dwordx4 v[196:199], v14, s[4:7], s28 offen offset:256 sc1
 v_mfma_f32_32x32x16_bf16 v[176:191], v[100:103], a[84:87], v[176:191]
 v_mfma_f32_32x32x16_bf16 v[176:191], v[104:107], a[88:91], v[176:191]
 v_mfma_f32_32x32x16_bf16 v[176:191], v[108:111], a[92:95], v[176:191]
 v_mfma_f32_32x32x16_bf16 v[160:175], v[64:67], a[96:99], 0
 s_nop 2
 s_add_u32 s28, s25, 5308416
 v_mfma_f32_32x32x16_bf16 v[160:175], v[68:71], a[100:103], v[160:175]
 s_nop 3
 v_mfma_f32_32x32x16_bf16 v[160:175], v[72:75], a[104:107], v[160:175]
 v_mfma_f32_32x32x16_bf16 v[160:175], v[76:79], a[108:111], v[160:175]
 v_cvt_pk_bf16_f32 v200, v176, v177
 v_cvt_pk_bf16_f32 v201, v178, v179
 v_mfma_f32_32x32x16_bf16 v[160:175], v[80:83], a[112:115], v[160:175]
 v_cvt_pk_bf16_f32 v202, v180, v181
 v_cvt_pk_bf16_f32 v203, v182, v183
 v_mfma_f32_32x32x16_bf16 v[160:175], v[84:87], a[116:119], v[160:175]
 buffer_store_dwordx4 v[200:203], v14, s[4:7], s28 offen sc1
 v_mfma_f32_32x32x16_bf16 v[160:175], v[88:91], a[120:123], v[160:175]
 v_cvt_pk_bf16_f32 v204, v184, v185
 v_cvt_pk_bf16_f32 v205, v186, v187
 v_mfma_f32_32x32x16_bf16 v[160:175], v[92:95], a[124:127], v[160:175]
 v_cvt_pk_bf16_f32 v206, v188, v189
 v_cvt_pk_bf16_f32 v207, v190, v191
 v_mfma_f32_32x32x16_bf16 v[160:175], v[96:99], a[128:131], v[160:175]
 buffer_store_dwordx4 v[204:207], v14, s[4:7], s28 offen offset:256 sc1
 v_mfma_f32_32x32x16_bf16 v[160:175], v[100:103], a[132:135], v[160:175]
 v_mfma_f32_32x32x16_bf16 v[160:175], v[104:107], a[136:139], v[160:175]
 v_mfma_f32_32x32x16_bf16 v[160:175], v[108:111], a[140:143], v[160:175]
 v_mfma_f32_32x32x16_bf16 v[176:191], v[64:67], a[144:147], 0
 s_nop 2
 s_add_u32 s28, s25, 5373952
 v_mfma_f32_32x32x16_bf16 v[176:191], v[68:71], a[148:151], v[176:191]
 s_nop 3
 v_mfma_f32_32x32x16_bf16 v[176:191], v[72:75], a[152:155], v[176:191]
 v_mfma_f32_32x32x16_bf16 v[176:191], v[76:79], a[156:159], v[176:191]
 v_cvt_pk_bf16_f32 v192, v160, v161
 v_cvt_pk_bf16_f32 v193, v162, v163
 v_mfma_f32_32x32x16_bf16 v[176:191], v[80:83], a[160:163], v[176:191]
 v_cvt_pk_bf16_f32 v194, v164, v165
 v_cvt_pk_bf16_f32 v195, v166, v167
 v_mfma_f32_32x32x16_bf16 v[176:191], v[84:87], a[164:167], v[176:191]
 buffer_store_dwordx4 v[192:195], v14, s[4:7], s28 offen sc1
 v_mfma_f32_32x32x16_bf16 v[176:191], v[88:91], a[168:171], v[176:191]
 v_cvt_pk_bf16_f32 v196, v168, v169
 v_cvt_pk_bf16_f32 v197, v170, v171
 v_mfma_f32_32x32x16_bf16 v[176:191], v[92:95], a[172:175], v[176:191]
 v_cvt_pk_bf16_f32 v198, v172, v173
 v_cvt_pk_bf16_f32 v199, v174, v175
 v_mfma_f32_32x32x16_bf16 v[176:191], v[96:99], a[176:179], v[176:191]
 buffer_store_dwordx4 v[196:199], v14, s[4:7], s28 offen offset:256 sc1
 v_mfma_f32_32x32x16_bf16 v[176:191], v[100:103], a[180:183], v[176:191]
 v_mfma_f32_32x32x16_bf16 v[176:191], v[104:107], a[184:187], v[176:191]
 v_mfma_f32_32x32x16_bf16 v[176:191], v[108:111], a[188:191], v[176:191]
 v_mfma_f32_32x32x16_bf16 v[160:175], v[64:67], a[192:195], 0
 s_nop 2
 s_add_u32 s28, s25, 5439488
 v_mfma_f32_32x32x16_bf16 v[160:175], v[68:71], a[196:199], v[160:175]
 s_nop 3
 v_mfma_f32_32x32x16_bf16 v[160:175], v[72:75], a[200:203], v[160:175]
 v_mfma_f32_32x32x16_bf16 v[160:175], v[76:79], a[204:207], v[160:175]
 v_cvt_pk_bf16_f32 v200, v176, v177
 v_cvt_pk_bf16_f32 v201, v178, v179
 v_mfma_f32_32x32x16_bf16 v[160:175], v[80:83], a[208:211], v[160:175]
 v_cvt_pk_bf16_f32 v202, v180, v181
 v_cvt_pk_bf16_f32 v203, v182, v183
 v_mfma_f32_32x32x16_bf16 v[160:175], v[84:87], a[212:215], v[160:175]
 buffer_store_dwordx4 v[200:203], v14, s[4:7], s28 offen sc1
 v_mfma_f32_32x32x16_bf16 v[160:175], v[88:91], a[216:219], v[160:175]
 v_cvt_pk_bf16_f32 v204, v184, v185
 v_cvt_pk_bf16_f32 v205, v186, v187
 v_mfma_f32_32x32x16_bf16 v[160:175], v[92:95], a[220:223], v[160:175]
 v_cvt_pk_bf16_f32 v206, v188, v189
 v_cvt_pk_bf16_f32 v207, v190, v191
 v_mfma_f32_32x32x16_bf16 v[160:175], v[96:99], a[224:227], v[160:175]
 buffer_store_dwordx4 v[204:207], v14, s[4:7], s28 offen offset:256 sc1
 v_mfma_f32_32x32x16_bf16 v[160:175], v[100:103], a[228:231], v[160:175]
 v_mfma_f32_32x32x16_bf16 v[160:175], v[104:107], a[232:235], v[160:175]
 v_mfma_f32_32x32x16_bf16 v[160:175], v[108:111], a[236:239], v[160:175]
 s_nop 2
 s_add_u32 s28, s25, 5505024
 s_nop 3
 s_nop 3
 v_cvt_pk_bf16_f32 v192, v160, v161
 v_cvt_pk_bf16_f32 v193, v162, v163
 v_cvt_pk_bf16_f32 v194, v164, v165
 v_cvt_pk_bf16_f32 v195, v166, v167
 buffer_store_dwordx4 v[192:195], v14, s[4:7], s28 offen sc1
 v_cvt_pk_bf16_f32 v196, v168, v169
 v_cvt_pk_bf16_f32 v197, v170, v171
 v_cvt_pk_bf16_f32 v198, v172, v173
 v_cvt_pk_bf16_f32 v199, v174, v175
 buffer_store_dwordx4 v[196:199], v14, s[4:7], s28 offen offset:256 sc1
 s_lshl_b32 s95, s35, 7
 s_add_u32 s95, s95, s3
 s_add_u32 s95, s95, 49152
 v_mov_b32 v2, 0x80000000
 v_mov_b32 v255, s95
 v_cmp_eq_u32 vcc, 0, v0
 s_nop 1
 v_cndmask_b32 v2, v2, v255, vcc
 v_mov_b32 v3, 1
 s_waitcnt vmcnt(0) lgkmcnt(0)
 s_barrier
 buffer_store_dword v3, v2, s[4:7], 0 offen sc1
 s_cmp_eq_u32 s85, 1
 s_cbranch_scc1 first_c
 s_cmp_eq_u32 s85, 5
 s_cbranch_scc1 again_pz
 s_sub_u32 s20, s16, 4
 s_lshl_b32 s20, s20, 3
 s_and_b32 s23, s17, 7
 s_add_u32 s20, s20, s23
 s_load_dwordx2 s[8:9], s[0:1], 16
 s_mov_b32 s10, 7864320
 s_mov_b32 s11, 0x20000
 s_waitcnt vmcnt(0) lgkmcnt(0)
 v_and_b32 v254, 63, v0
 v_add_u32 v254, 0, v254
 v_mul_u32_u24 v253, 2731, v254
 v_lshrrev_b32 v253, 16, v253
 v_mul_u32_u24 v252, 24, v253
 v_sub_u32 v254, v254, v252
 v_mul_u32_u24 v253, 12288, v253
 v_lshl_add_u32 v2, v254, 4, v253
 v_and_b32 v254, 63, v0
 v_add_u32 v254, 64, v254
 v_mul_u32_u24 v253, 2731, v254
 v_lshrrev_b32 v253, 16, v253
 v_mul_u32_u24 v252, 24, v253
 v_sub_u32 v254, v254, v252
 v_mul_u32_u24 v253, 12288, v253
 v_lshl_add_u32 v3, v254, 4, v253
 v_and_b32 v254, 63, v0
 v_add_u32 v254, 128, v254
 v_mul_u32_u24 v253, 2731, v254
 v_lshrrev_b32 v253, 16, v253
 v_mul_u32_u24 v252, 24, v253
 v_sub_u32 v254, v254, v252
 v_mul_u32_u24 v253, 12288, v253
 v_lshl_add_u32 v4, v254, 4, v253
 s_mul_i32 s88, s21, 6144
 s_mul_i32 s87, s20, 384
 s_mul_i32 s86, s21, 196608
 s_add_u32 s87, s87, s86
 s_mul_i32 s86, s21, 96
 v_mov_b32 v5, s86
 v_bfe_u32 v255, v0, 4, 2
 s_mov_b32 s101, 3072
 v_mad_u32_u24 v5, v255, s101, v5
 v_bfe_u32 v255, v0, 2, 2
 s_mov_b32 s101, 384
 v_mad_u32_u24 v5, v255, s101, v5
 v_bfe_u32 v255, v0, 0, 2
 v_lshl_add_u32 v5, v255, 4, v5
 v_mov_b32 v6, s86
 v_bfe_u32 v255, v0, 4, 2
 s_mov_b32 s101, 3072
 v_mad_u32_u24 v6, v255, s101, v6
 v_bfe_u32 v255, v0, 2, 2
 s_mov_b32 s101, 384
 v_mad_u32_u24 v6, v255, s101, v6
 v_bfe_u32 v255, v0, 0, 2
 v_lshl_add_u32 v6, v255, 3, v6
 s_add_u32 s89, s87, 0
 s_add_u32 m0, s88, 0
 s_nop 0
 buffer_load_dwordx4 v2, s[8:11], s89 offen lds
 s_add_u32 m0, s88, 1024
 s_nop 0
 buffer_load_dwordx4 v3, s[8:11], s89 offen lds
 s_add_u32 m0, s88, 2048
 s_nop 0
 buffer_load_dwordx4 v4, s[8:11], s89 offen lds
 s_add_u32 s89, s87, 98304
 s_add_u32 m0, s88, 3072
 s_nop 0
 buffer_load_dwordx4 v2, s[8:11], s89 offen lds
 s_add_u32 m0, s88, 4096
 s_nop 0
 buffer_load_dwordx4 v3, s[8:11], s89 offen lds
 s_add_u32 m0, s88, 5120
 s_nop 0
 buffer_load_dwordx4 v4, s[8:11], s89 offen lds
 s_add_u32 s89, s87, 786432
 s_add_u32 m0, s88, 24576
 s_nop 0
 buffer_load_dwordx4 v2, s[8:11], s89 offen lds
 s_add_u32 m0, s88, 25600
 s_nop 0
 buffer_load_dwordx4 v3, s[8:11], s89 offen lds
 s_add_u32 m0, s88, 26624
 s_nop 0
 buffer_load_dwordx4 v4, s[8:11], s89 offen lds
 s_add_u32 s89, s87, 884736
 s_add_u32 m0, s88, 27648
 s_nop 0
 buffer_load_dwordx4 v2, s[8:11], s89 offen lds
 s_add_u32 m0, s88, 28672
 s_nop 0
 buffer_load_dwordx4 v3, s[8:11], s89 offen lds
 s_add_u32 m0, s88, 29696
 s_nop 0
 buffer_load_dwordx4 v4, s[8:11], s89 offen lds
 s_add_u32 s89, s87, 1572864
 s_add_u32 m0, s88, 49152
 s_nop 0
 buffer_load_dwordx4 v2, s[8:11], s89 offen lds
 s_add_u32 m0, s88, 50176
 s_nop 0
 buffer_load_dwordx4 v3, s[8:11], s89 offen lds
 s_add_u32 m0, s88, 51200
 s_nop 0
 buffer_load_dwordx4 v4, s[8:11], s89 offen lds
 s_add_u32 s89, s87, 1671168
 s_add_u32 m0, s88, 52224
 s_nop 0
 buffer_load_dwordx4 v2, s[8:11], s89 offen lds
 s_add_u32 m0, s88, 53248
 s_nop 0
 buffer_load_dwordx4 v3, s[8:11], s89 offen lds
 s_add_u32 m0, s88, 54272
 s_nop 0
 buffer_load_dwordx4 v4, s[8:11], s89 offen lds
 s_add_u32 s89, s87, 2359296
 s_add_u32 m0, s88, 73728
 s_nop 0
 buffer_load_dwordx4 v2, s[8:11], s89 offen lds
 s_add_u32 m0, s88, 74752
 s_nop 0
 buffer_load_dwordx4 v3, s[8:11], s89 offen lds
 s_add_u32 m0, s88, 75776
 s_nop 0
 buffer_load_dwordx4 v4, s[8:11], s89 offen lds
 s_add_u32 s89, s87, 2457600
 s_add_u32 m0, s88, 76800
 s_nop 0
 buffer_load_dwordx4 v2, s[8:11], s89 offen lds
 s_add_u32 m0, s88, 77824
 s_nop 0
 buffer_load_dwordx4 v3, s[8:11], s89 offen lds
 s_add_u32 m0, s88, 78848
 s_nop 0
 buffer_load_dwordx4 v4, s[8:11], s89 offen lds
 s_add_u32 s89, s87, 3145728
 s_add_u32 m0, s88, 98304
 s_nop 0
 buffer_load_dwordx4 v2, s[8:11], s89 offen lds
 s_add_u32 m0, s88, 99328
 s_nop 0
 buffer_load_dwordx4 v3, s[8:11], s89 offen lds
 s_add_u32 m0, s88, 100352
 s_nop 0
 buffer_load_dwordx4 v4, s[8:11], s89 offen lds
 s_add_u32 s89, s87, 3244032
 s_add_u32 m0, s88, 101376
 s_nop 0
 buffer_load_dwordx4 v2, s[8:11], s89 offen lds
 s_add_u32 m0, s88, 102400
 s_nop 0
 buffer_load_dwordx4 v3, s[8:11], s89 offen lds
 s_add_u32 m0, s88, 103424
 s_nop 0
 buffer_load_dwordx4 v4, s[8:11], s89 offen lds
 s_waitcnt vmcnt(24)
 s_barrier
 s_add_u32 s89, s87, 3932160
 s_add_u32 m0, s88, 122880
 s_nop 0
 buffer_load_dwordx4 v2, s[8:11], s89 offen lds
 s_add_u32 m0, s88, 123904
 s_nop 0
 buffer_load_dwordx4 v3, s[8:11], s89 offen lds
 s_add_u32 m0, s88, 124928
 s_nop 0
 buffer_load_dwordx4 v4, s[8:11], s89 offen lds
 s_add_u32 s89, s87, 4030464
 s_add_u32 m0, s88, 125952
 s_nop 0
 buffer_load_dwordx4 v2, s[8:11], s89 offen lds
 s_add_u32 m0, s88, 126976
 s_nop 0
 buffer_load_dwordx4 v3, s[8:11], s89 offen lds
 s_add_u32 m0, s88, 128000
 s_nop 0
 buffer_load_dwordx4 v4, s[8:11], s89 offen lds
 v_add_u32 v7, 0, v5
 v_add_u32 v8, 0, v6
 ds_read_b64_tr_b16 a[0:1], v7 offset:0
 ds_read_b64_tr_b16 a[2:3], v7 offset:1536
 ds_read_b64_tr_b16 a[80:81], v7 offset:8
 ds_read_b64_tr_b16 a[82:83], v7 offset:1544
 ds_read_b64_tr_b16 a[160:161], v8 offset:64
 ds_read_b64_tr_b16 a[162:163], v8 offset:1600
 ds_read_b64_tr_b16 a[4:5], v7 offset:12288
 ds_read_b64_tr_b16 a[6:7], v7 offset:13824
 ds_read_b64_tr_b16 a[84:85], v7 offset:12296
 ds_read_b64_tr_b16 a[86:87], v7 offset:13832
 ds_read_b64_tr_b16 a[164:165], v8 offset:12352
 ds_read_b64_tr_b16 a[166:167], v8 offset:13888
 s_waitcnt lgkmcnt(0)
 s_waitcnt vmcnt(24)
 s_barrier
 s_add_u32 s89, s87, 4718592
 s_add_u32 m0, s88, 0
 s_nop 0
 buffer_load_dwordx4 v2, s[8:11], s89 offen lds
 s_add_u32 m0, s88, 1024
 s_nop 0
 buffer_load_dwordx4 v3, s[8:11], s89 offen lds
 s_add_u32 m0, s88, 2048
 s_nop 0
 buffer_load_dwordx4 v4, s[8:11], s89 offen lds
 s_add_u32 s89, s87, 4816896
 s_add_u32 m0, s88, 3072
 s_nop 0
 buffer_load_dwordx4 v2, s[8:11], s89 offen lds
 s_add_u32 m0, s88, 4096
 s_nop 0
 buffer_load_dwordx4 v3, s[8:11], s89 offen lds
 s_add_u32 m0, s88, 5120
 s_nop 0
 buffer_load_dwordx4 v4, s[8:11], s89 offen lds
 v_add_u32 v7, 24576, v5
 v_add_u32 v8, 24576, v6
 ds_read_b64_tr_b16 a[8:9], v7 offset:0
 ds_read_b64_tr_b16 a[10:11], v7 offset:1536
 ds_read_b64_tr_b16 a[88:89], v7 offset:8
 ds_read_b64_tr_b16 a[90:91], v7 offset:1544
 ds_read_b64_tr_b16 a[168:169], v8 offset:64
 ds_read_b64_tr_b16 a[170:171], v8 offset:1600
 ds_read_b64_tr_b16 a[12:13], v7 offset:12288
 ds_read_b64_tr_b16 a[14:15], v7 offset:13824
 ds_read_b64_tr_b16 a[92:93], v7 offset:12296
 ds_read_b64_tr_b16 a[94:95], v7 offset:13832
 ds_read_b64_tr_b16 a[172:173], v8 offset:12352
 ds_read_b64_tr_b16 a[174:175], v8 offset:13888
 s_waitcnt lgkmcnt(0)
 s_waitcnt vmcnt(24)
 s_barrier
 s_add_u32 s89, s87, 5505024
 s_add_u32 m0, s88, 24576
 s_nop 0
 buffer_load_dwordx4 v2, s[8:11], s89 offen lds
 s_add_u32 m0, s88, 25600
 s_nop 0
 buffer_load_dwordx4 v3, s[8:11], s89 offen lds
 s_add_u32 m0, s88, 26624
 s_nop 0
 buffer_load_dwordx4 v4, s[8:11], s89 offen lds
 s_add_u32 s89, s87, 5603328
 s_add_u32 m0, s88, 27648
 s_nop 0
 buffer_load_dwordx4 v2, s[8:11], s89 offen lds
 s_add_u32 m0, s88, 28672
 s_nop 0
 buffer_load_dwordx4 v3, s[8:11], s89 offen lds
 s_add_u32 m0, s88, 29696
 s_nop 0
 buffer_load_dwordx4 v4, s[8:11], s89 offen lds
 v_add_u32 v7, 49152, v5
 v_add_u32 v8, 49152, v6
 ds_read_b64_tr_b16 a[16:17], v7 offset:0
 ds_read_b64_tr_b16 a[18:19], v7 offset:1536
 ds_read_b64_tr_b16 a[96:97], v7 offset:8
 ds_read_b64_tr_b16 a[98:99], v7 offset:1544
 ds_read_b64_tr_b16 a[176:177], v8 offset:64
 ds_read_b64_tr_b16 a[178:179], v8 offset:1600
 ds_read_b64_tr_b16 a[20:21], v7 offset:12288
 ds_read_b64_tr_b16 a[22:23], v7 offset:13824
 ds_read_b64_tr_b16 a[100:101], v7 offset:12296
 ds_read_b64_tr_b16 a[102:103], v7 offset:13832
 ds_read_b64_tr_b16 a[180:181], v8 offset:12352
 ds_read_b64_tr_b16 a[182:183], v8 offset:13888
 s_waitcnt lgkmcnt(0)
 s_waitcnt vmcnt(24)
 s_barrier
 s_add_u32 s89, s87, 6291456
 s_add_u32 m0, s88, 49152
 s_nop 0
 buffer_load_dwordx4 v2, s[8:11], s89 offen lds
 s_add_u32 m0, s88, 50176
 s_nop 0
 buffer_load_dwordx4 v3, s[8:11], s89 offen lds
 s_add_u32 m0, s88, 51200
 s_nop 0
 buffer_load_dwordx4 v4, s[8:11], s89 offen lds
 s_add_u32 s89, s87, 6389760
 s_add_u32 m0, s88, 52224
 s_nop 0
 buffer_load_dwordx4 v2, s[8:11], s89 offen lds
 s_add_u32 m0, s88, 53248
 s_nop 0
 buffer_load_dwordx4 v3, s[8:11], s89 offen lds
 s_add_u32 m0, s88, 54272
 s_nop 0
 buffer_load_dwordx4 v4, s[8:11], s89 offen lds
 v_add_u32 v7, 73728, v5
 v_add_u32 v8, 73728, v6
 ds_read_b64_tr_b16 a[24:25], v7 offset:0
 ds_read_b64_tr_b16 a[26:27], v7 offset:1536
 ds_read_b64_tr_b16 a[104:105], v7 offset:8
 ds_read_b64_tr_b16 a[106:107], v7 offset:1544
 ds_read_b64_tr_b16 a[184:185], v8 offset:64
 ds_read_b64_tr_b16 a[186:187], v8 offset:1600
 ds_read_b64_tr_b16 a[28:29], v7 offset:12288
 ds_read_b64_tr_b16 a[30:31], v7 offset:13824
 ds_read_b64_tr_b16 a[108:109], v7 offset:12296
 ds_read_b64_tr_b16 a[110:111], v7 offset:13832
 ds_read_b64_tr_b16 a[188:189], v8 offset:12352
 ds_read_b64_tr_b16 a[190:191], v8 offset:13888
 s_waitcnt lgkmcnt(0)
 s_waitcnt vmcnt(24)
 s_barrier
 s_add_u32 s89, s87, 7077888
 s_add_u32 m0, s88, 73728
 s_nop 0
 buffer_load_dwordx4 v2, s[8:11], s89 offen lds
 s_add_u32 m0, s88, 74752
 s_nop 0
 buffer_load_dwordx4 v3, s[8:11], s89 offen lds
 s_add_u32 m0, s88, 75776
 s_nop 0
 buffer_load_dwordx4 v4, s[8:11], s89 offen lds
 s_add_u32 s89, s87, 7176192
 s_add_u32 m0, s88, 76800
 s_nop 0
 buffer_load_dwordx4 v2, s[8:11], s89 offen lds
 s_add_u32 m0, s88, 77824
 s_nop 0
 buffer_load_dwordx4 v3, s[8:11], s89 offen lds
 s_add_u32 m0, s88, 78848
 s_nop 0
 buffer_load_dwordx4 v4, s[8:11], s89 offen lds
 v_add_u32 v7, 98304, v5
 v_add_u32 v8, 98304, v6
 ds_read_b64_tr_b16 a[32:33], v7 offset:0
 ds_read_b64_tr_b16 a[34:35], v7 offset:1536
 ds_read_b64_tr_b16 a[112:113], v7 offset:8
 ds_read_b64_tr_b16 a[114:115], v7 offset:1544
 ds_read_b64_tr_b16 a[192:193], v8 offset:64
 ds_read_b64_tr_b16 a[194:195], v8 offset:1600
 ds_read_b64_tr_b16 a[36:37], v7 offset:12288
 ds_read_b64_tr_b16 a[38:39], v7 offset:13824
 ds_read_b64_tr_b16 a[116:117], v7 offset:12296
 ds_read_b64_tr_b16 a[118:119], v7 offset:13832
 ds_read_b64_tr_b16 a[196:197], v8 offset:12352
 ds_read_b64_tr_b16 a[198:199], v8 offset:13888
 s_waitcnt lgkmcnt(0)
 s_waitcnt vmcnt(24)
 s_barrier
 v_add_u32 v7, 122880, v5
 v_add_u32 v8, 122880, v6
 ds_read_b64_tr_b16 a[40:41], v7 offset:0
 ds_read_b64_tr_b16 a[42:43], v7 offset:1536
 ds_read_b64_tr_b16 a[120:121], v7 offset:8
 ds_read_b64_tr_b16 a[122:123], v7 offset:1544
 ds_read_b64_tr_b16 a[200:201], v8 offset:64
 ds_read_b64_tr_b16 a[202:203], v8 offset:1600
 ds_read_b64_tr_b16 a[44:45], v7 offset:12288
 ds_read_b64_tr_b16 a[46:47], v7 offset:13824
 ds_read_b64_tr_b16 a[124:125], v7 offset:12296
 ds_read_b64_tr_b16 a[126:127], v7 offset:13832
 ds_read_b64_tr_b16 a[204:205], v8 offset:12352
 ds_read_b64_tr_b16 a[206:207], v8 offset:13888
 s_waitcnt lgkmcnt(0)
 s_waitcnt vmcnt(18)
 s_barrier
 v_add_u32 v7, 0, v5
 v_add_u32 v8, 0, v6
 ds_read_b64_tr_b16 a[48:49], v7 offset:0
 ds_read_b64_tr_b16 a[50:51], v7 offset:1536
 ds_read_b64_tr_b16 a[128:129], v7 offset:8
 ds_read_b64_tr_b16 a[130:131], v7 offset:1544
 ds_read_b64_tr_b16 a[208:209], v8 offset:64
 ds_read_b64_tr_b16 a[210:211], v8 offset:1600
 ds_read_b64_tr_b16 a[52:53], v7 offset:12288
 ds_read_b64_tr_b16 a[54:55], v7 offset:13824
 ds_read_b64_tr_b16 a[132:133], v7 offset:12296
 ds_read_b64_tr_b16 a[134:135], v7 offset:13832
 ds_read_b64_tr_b16 a[212:213], v8 offset:12352
 ds_read_b64_tr_b16 a[214:215], v8 offset:13888
 s_waitcnt lgkmcnt(0)
 s_waitcnt vmcnt(12)
 s_barrier
 v_add_u32 v7, 24576, v5
 v_add_u32 v8, 24576, v6
 ds_read_b64_tr_b16 a[56:57], v7 offset:0
 ds_read_b64_tr_b16 a[58:59], v7 offset:1536
 ds_read_b64_tr_b16 a[136:137], v7 offset:8
 ds_read_b64_tr_b16 a[138:139], v7 offset:1544
 ds_read_b64_tr_b16 a[216:217], v8 offset:64
 ds_read_b64_tr_b16 a[218:219], v8 offset:1600
 ds_read_b64_tr_b16 a[60:61], v7 offset:12288
 ds_read_b64_tr_b16 a[62:63], v7 offset:13824
 ds_read_b64_tr_b16 a[140:141], v7 offset:12296
 ds_read_b64_tr_b16 a[142:143], v7 offset:13832
 ds_read_b64_tr_b16 a[220:221], v8 offset:12352
 ds_read_b64_tr_b16 a[222:223], v8 offset:13888
 s_waitcnt lgkmcnt(0)
 s_waitcnt vmcnt(6)
 s_barrier
 v_add_u32 v7, 49152, v5
 v_add_u32 v8, 49152, v6
 ds_read_b64_tr_b16 a[64:65], v7 offset:0
 ds_read_b64_tr_b16 a[66:67], v7 offset:1536
 ds_read_b64_tr_b16 a[144:145], v7 offset:8
 ds_read_b64_tr_b16 a[146:147], v7 offset:1544
 ds_read_b64_tr_b16 a[224:225], v8 offset:64
 ds_read_b64_tr_b16 a[226:227], v8 offset:1600
 ds_read_b64_tr_b16 a[68:69], v7 offset:12288
 ds_read_b64_tr_b16 a[70:71], v7 offset:13824
 ds_read_b64_tr_b16 a[148:149], v7 offset:12296
 ds_read_b64_tr_b16 a[150:151], v7 offset:13832
 ds_read_b64_tr_b16 a[228:229], v8 offset:12352
 ds_read_b64_tr_b16 a[230:231], v8 offset:13888
 s_waitcnt lgkmcnt(0)
 s_waitcnt vmcnt(0)
 s_barrier
 v_add_u32 v7, 73728, v5
 v_add_u32 v8, 73728, v6
 ds_read_b64_tr_b16 a[72:73], v7 offset:0
 ds_read_b64_tr_b16 a[74:75], v7 offset:1536
 ds_read_b64_tr_b16 a[152:153], v7 offset:8
 ds_read_b64_tr_b16 a[154:155], v7 offset:1544
 ds_read_b64_tr_b16 a[232:233], v8 offset:64
 ds_read_b64_tr_b16 a[234:235], v8 offset:1600
 ds_read_b64_tr_b16 a[76:77], v7 offset:12288
 ds_read_b64_tr_b16 a[78:79], v7 offset:13824
 ds_read_b64_tr_b16 a[156:157], v7 offset:12296
 ds_read_b64_tr_b16 a[158:159], v7 offset:13832
 ds_read_b64_tr_b16 a[236:237], v8 offset:12352
 ds_read_b64_tr_b16 a[238:239], v8 offset:13888
 s_waitcnt lgkmcnt(0)
 s_barrier
again_q:
 s_sub_u32 s20, s16, 4
 s_lshl_b32 s20, s20, 3
 s_and_b32 s23, s17, 7
 s_add_u32 s20, s20, s23
 s_add_u32 s15, s3, 65536
 v_mov_b32 v13, s15
 v_bfe_u32 v255, v0, 0, 6
 v_lshl_add_u32 v13, v255, 7, v13
 s_mov_b32 s92, 0
 s_mul_i32 s24, s21, 10240
 v_mov_b32 v9, s24
 v_bfe_u32 v255, v0, 0, 6
 v_lshl_add_u32 v9, v255, 4, v9
 v_bfe_u32 v255, v0, 4, 2
 v_lshlrev_b32 v10, 9, v255
 v_bfe_u32 v255, v0, 0, 4
 v_lshl_add_u32 v10, v255, 4, v10
 s_mul_i32 s86, s21, 3072
 v_mov_b32 v14, s86
 v_bfe_u32 v255, v0, 4, 2
 v_lshl_add_u32 v14, v255, 9, v14
 v_bfe_u32 v255, v0, 0, 4
 v_lshl_add_u32 v14, v255, 4, v14
 s_add_u32 s86, s86, 2048
 v_mov_b32 v15, s86
 v_bfe_u32 v255, v0, 5, 1
 v_lshl_add_u32 v15, v255, 9, v15
 v_bfe_u32 v255, v0, 4, 1
 v_lshl_add_u32 v15, v255, 8, v15
 v_bfe_u32 v255, v0, 0, 4
 v_lshl_add_u32 v15, v255, 4, v15
 v_add_u32 v14, 122880, v14
 v_add_u32 v15, 122880, v15
 v_bfe_u32 v255, v0, 4, 2
 v_lshlrev_b32 v16, 9, v255
 v_bfe_u32 v255, v0, 2, 2
 v_lshl_add_u32 v16, v255, 7, v16
 v_bfe_u32 v255, v0, 0, 2
 v_lshl_add_u32 v16, v255, 4, v16
 v_bfe_u32 v255, v0, 0, 6
 v_lshlrev_b32 v17, 4, v255
 v_mov_b32 v18, 122880
 v_bfe_u32 v255, v0, 4, 2
 v_lshl_add_u32 v18, v255, 9, v18
 v_bfe_u32 v255, v0, 0, 4
 v_lshl_add_u32 v18, v255, 4, v18
 v_bfe_u32 v255, v0, 6, 1
 v_lshl_add_u32 v18, v255, 8, v18
 v_mov_b32 v19, 512
 v_bfe_u32 v255, v0, 4, 2
 v_lshl_add_u32 v19, v255, 9, v19
 v_bfe_u32 v255, v0, 0, 4
 v_lshl_add_u32 v19, v255, 4, v19
 v_bfe_u32 v255, v0, 6, 1
 v_lshl_add_u32 v19, v255, 8, v19
 v_bfe_u32 v255, v0, 4, 1
 v_lshlrev_b32 v20, 3, v255
 v_bfe_u32 v255, v0, 5, 1
 v_lshl_add_u32 v20, v255, 2, v20
 v_bfe_u32 v255, v0, 0, 4
 v_lshl_add_u32 v20, v255, 4, v20
 v_bfe_u32 v255, v0, 6, 1
 v_lshl_add_u32 v20, v255, 8, v20
 v_bfe_u32 v255, v0, 0, 4
 v_lshlrev_b32 v21, 0, v255
 v_bfe_u32 v255, v0, 6, 1
 v_lshl_add_u32 v21, v255, 4, v21
 v_bfe_u32 v255, v0, 4, 2
 v_lshlrev_b32 v22, 3, v255
 v_sub_u32 v21, v21, v22
 v_cmp_le_i32 s[40:41], 0, v21
 v_cmp_le_i32 s[42:43], 1, v21
 v_cmp_le_i32 s[44:45], 2, v21
 v_cmp_le_i32 s[46:47], 3, v21
 v_cmp_le_i32 s[48:49], 4, v21
 v_cmp_le_i32 s[50:51], 5, v21
 v_cmp_le_i32 s[52:53], 6, v21
 v_cmp_le_i32 s[54:55], 7, v21
 v_mov_b32 v23, 0xceabfb8f
 s_mov_b32 s56, 0x3dd53b95
 s_mul_i32 s12, s20, 12288
 s_add_u32 s12, s12, 53346304
 s_mul_i32 s13, s20, 6144
 s_add_u32 s13, s13, 208535552
 s_mul_i32 s14, s20, 2560
 s_add_u32 s14, s14, 221118464
 s_mov_b32 s25, 0x20000000
 s_mov_b32 s26, 0x20000000
 s_mov_b32 s27, 0x20000000
 s_lshl_b32 s32, s20, 7
 s_add_u32 s33, s32, 0
 s_add_u32 s33, s33, s3
 s_add_u32 s32, s32, 12288
 s_add_u32 s32, s32, s3
 s_mov_b32 s34, 0
 s_mov_b32 s35, 0
 s_lshl_b32 s15, s20, 1
 s_add_u32 s15, s15, s21
 s_lshl_b32 s15, s15, 7
 s_add_u32 s15, s15, s3
 s_add_u32 s15, s15, 24576
 v_mov_b32 v24, 0x80000000
 v_writelane_b32 v24, s15, 0
 v_mov_b32 v25, 0
 s_mov_b32 s36, 0
 s_mov_b32 s37, 40960
 s_mov_b32 s38, 81920
 s_mov_b32 s29, 2097152
 s_cmp_gt_u32 s92, 0
 s_cbranch_scc1 hf_2026
 s_mov_b32 s100, 0
hs_2027:
 s_min_u32 s92, s92, 48
 s_lshl_b32 s93, s92, 9
 buffer_load_dword v4, v13, s[4:7], s93 offen sc1
 s_add_u32 s100, s100, 1
 s_cmp_gt_u32 s100, 200000
 s_cbranch_scc1 main_fail
 s_waitcnt vmcnt(0)
 v_cmp_eq_u32 vcc, 0, v4
 s_nop 1
 s_ff1_i32_b64 s93, vcc
 s_min_u32 s93, s93, 64
 s_lshr_b32 s93, s93, 2
 s_add_u32 s92, s92, s93
 s_cmp_gt_u32 s92, 0
 s_cbranch_scc0 hs_2027
hf_2026:
 s_add_u32 s30, s24, 0
 s_add_u32 m0, s30, 0
 s_add_u32 s89, s29, 0
 buffer_load_dwordx4 v9, s[4:7], s89 offen offset:0 sc1 lds
 buffer_load_dwordx4 v9, s[4:7], s89 offen offset:1024 sc1 lds
 buffer_load_dwordx4 v9, s[4:7], s89 offen offset:2048 sc1 lds
 buffer_load_dwordx4 v9, s[4:7], s89 offen offset:3072 sc1 lds
 s_add_u32 m0, s30, 4096
 s_add_u32 s89, s29, 4096
 buffer_load_dwordx4 v9, s[4:7], s89 offen offset:0 sc1 lds
 buffer_load_dwordx4 v9, s[4:7], s89 offen offset:1024 sc1 lds
 buffer_load_dwordx4 v9, s[4:7], s89 offen offset:2048 sc1 lds
 buffer_load_dwordx4 v9, s[4:7], s89 offen offset:3072 sc1 lds
 s_add_u32 m0, s30, 8192
 s_add_u32 s89, s29, 8192
 buffer_load_dwordx4 v9, s[4:7], s89 offen offset:0 sc1 lds
 buffer_load_dwordx4 v9, s[4:7], s89 offen offset:1024 sc1 lds
 s_add_u32 s29, s29, 40960
 s_cmp_gt_u32 s92, 1
 s_cbranch_scc1 hf_2028
 s_mov_b32 s100, 0
hs_2029:
 s_min_u32 s92, s92, 48
 s_lshl_b32 s93, s92, 9
 buffer_load_dword v4, v13, s[4:7], s93 offen sc1
 s_add_u32 s100, s100, 1
 s_cmp_gt_u32 s100, 200000
 s_cbranch_scc1 main_fail
 s_waitcnt vmcnt(0)
 v_cmp_eq_u32 vcc, 0, v4
 s_nop 1
 s_ff1_i32_b64 s93, vcc
 s_min_u32 s93, s93, 64
 s_lshr_b32 s93, s93, 2
 s_add_u32 s92, s92, s93
 s_cmp_gt_u32 s92, 1
 s_cbranch_scc0 hs_2029
hf_2028:
 s_add_u32 s30, s24, 40960
 s_add_u32 m0, s30, 0
 s_add_u32 s89, s29, 0
 buffer_load_dwordx4 v9, s[4:7], s89 offen offset:0 sc1 lds
 buffer_load_dwordx4 v9, s[4:7], s89 offen offset:1024 sc1 lds
 buffer_load_dwordx4 v9, s[4:7], s89 offen offset:2048 sc1 lds
 buffer_load_dwordx4 v9, s[4:7], s89 offen offset:3072 sc1 lds
 s_add_u32 m0, s30, 4096
 s_add_u32 s89, s29, 4096
 buffer_load_dwordx4 v9, s[4:7], s89 offen offset:0 sc1 lds
 buffer_load_dwordx4 v9, s[4:7], s89 offen offset:1024 sc1 lds
 buffer_load_dwordx4 v9, s[4:7], s89 offen offset:2048 sc1 lds
 buffer_load_dwordx4 v9, s[4:7], s89 offen offset:3072 sc1 lds
 s_add_u32 m0, s30, 8192
 s_add_u32 s89, s29, 8192
 buffer_load_dwordx4 v9, s[4:7], s89 offen offset:0 sc1 lds
 buffer_load_dwordx4 v9, s[4:7], s89 offen offset:1024 sc1 lds
 s_add_u32 s29, s29, 40960
 s_waitcnt vmcnt(10)
 s_barrier
 ds_read_b128 v[112:115], v10 offset:0
 ds_read_b128 v[116:119], v10 offset:256
 ds_read_b128 v[120:123], v10 offset:2048
 ds_read_b128 v[124:127], v10 offset:2304
 v_mov_b32 v11, v10
 s_mov_b32 s31, 0
 s_cmp_ge_u32 s21, 2
 s_cbranch_scc1 wqo_2030
wq_2031:
 s_cmp_gt_u32 s34, s31
 s_cbranch_scc1 fw_done_2032
 s_mov_b32 s100, 0
fw_2033:
 s_load_dword s34, s[4:5], s33 glc
 s_add_u32 s100, s100, 1
 s_cmp_gt_u32 s100, 200000
 s_cbranch_scc1 main_fail
 s_waitcnt lgkmcnt(0)
 s_cmp_gt_u32 s34, s31
 s_cbranch_scc0 fw_2033
fw_done_2032:
 s_sub_u32 s15, s31, 1
 s_cbranch_scc1 nw_2034
 v_mov_b32 v25, s15
 s_cmp_gt_u32 s35, s15
 s_cbranch_scc1 nw_2034
 s_load_dword s35, s[4:5], s32 glc
 s_waitcnt vmcnt(0)
 buffer_store_dword v25, v24, s[4:7], 0 offen sc1
 s_waitcnt lgkmcnt(0)
 s_cmp_gt_u32 s35, s15
 s_cbranch_scc1 fw_done_2035
 s_mov_b32 s100, 0
fw_2036:
 s_load_dword s35, s[4:5], s32 glc
 s_add_u32 s100, s100, 1
 s_cmp_gt_u32 s100, 200000
 s_cbranch_scc1 main_fail
 s_waitcnt lgkmcnt(0)
 s_cmp_gt_u32 s35, s15
 s_cbranch_scc0 fw_2036
fw_done_2035:
nw_2034:
 s_waitcnt lgkmcnt(2)
 v_mfma_f32_16x16x32_bf16 v[64:67], a[0:3], v[112:115], 0
 ds_read_b128 v[128:131], v11 offset:4096
 v_mfma_f32_16x16x32_bf16 v[68:71], a[80:83], v[112:115], 0
 ds_read_b128 v[132:135], v11 offset:4352
 v_mfma_f32_16x16x32_bf16 v[72:75], a[160:163], v[112:115], 0
 buffer_load_dwordx4 v[208:211], v17, s[4:7], s26 offen offset:0 sc1
 v_mfma_f32_16x16x32_bf16 v[76:79], a[0:3], v[116:119], 0
 s_add_u32 s57, s12, 4096
 s_add_u32 s58, s12, 8192
 s_add_u32 s59, s26, 4096
 v_mfma_f32_16x16x32_bf16 v[80:83], a[80:83], v[116:119], 0
 buffer_load_dwordx4 v[212:215], v17, s[4:7], s26 offen offset:1024 sc1
 v_mfma_f32_16x16x32_bf16 v[84:87], a[160:163], v[116:119], 0
 s_waitcnt lgkmcnt(2)
 v_mfma_f32_16x16x32_bf16 v[64:67], a[4:7], v[120:123], v[64:67]
 ds_read_b128 v[136:139], v11 offset:6144
 v_mfma_f32_16x16x32_bf16 v[68:71], a[84:87], v[120:123], v[68:71]
 ds_read_b128 v[140:143], v11 offset:6400
 v_mfma_f32_16x16x32_bf16 v[72:75], a[164:167], v[120:123], v[72:75]
 buffer_load_dwordx4 v[216:219], v17, s[4:7], s26 offen offset:2048 sc1
 v_cvt_pk_bf16_f32 v144, v88, v89
 v_mfma_f32_16x16x32_bf16 v[76:79], a[4:7], v[124:127], v[76:79]
 v_cvt_pk_bf16_f32 v145, v90, v91
 v_mfma_f32_16x16x32_bf16 v[80:83], a[84:87], v[124:127], v[80:83]
 buffer_load_dwordx4 v[220:223], v17, s[4:7], s26 offen offset:3072 sc1
 v_cvt_pk_bf16_f32 v146, v92, v93
 v_mfma_f32_16x16x32_bf16 v[84:87], a[164:167], v[124:127], v[84:87]
 s_waitcnt lgkmcnt(2)
 v_cvt_pk_bf16_f32 v147, v94, v95
 v_mfma_f32_16x16x32_bf16 v[64:67], a[8:11], v[128:131], v[64:67]
 ds_read_b128 v[112:115], v11 offset:8192
 v_cvt_pk_bf16_f32 v148, v100, v101
 v_mfma_f32_16x16x32_bf16 v[68:71], a[88:91], v[128:131], v[68:71]
 ds_read_b128 v[116:119], v11 offset:8448
 v_cvt_pk_bf16_f32 v149, v102, v103
 v_mfma_f32_16x16x32_bf16 v[72:75], a[168:171], v[128:131], v[72:75]
 buffer_load_dwordx4 v[224:227], v17, s[4:7], s59 offen offset:0 sc1
 v_cvt_pk_bf16_f32 v150, v104, v105
 v_mfma_f32_16x16x32_bf16 v[76:79], a[8:11], v[132:135], v[76:79]
 v_cvt_pk_bf16_f32 v151, v106, v107
 v_mfma_f32_16x16x32_bf16 v[80:83], a[88:91], v[132:135], v[80:83]
 buffer_load_dwordx4 v[228:231], v17, s[4:7], s59 offen offset:1024 sc1
 v_cvt_pk_bf16_f32 v152, v96, v97
 v_mfma_f32_16x16x32_bf16 v[84:87], a[168:171], v[132:135], v[84:87]
 s_waitcnt lgkmcnt(2)
 v_cvt_pk_bf16_f32 v153, v98, v99
 v_mfma_f32_16x16x32_bf16 v[64:67], a[12:15], v[136:139], v[64:67]
 ds_read_b128 v[120:123], v11 offset:10240
 v_cvt_pk_bf16_f32 v154, v108, v109
 v_mfma_f32_16x16x32_bf16 v[68:71], a[92:95], v[136:139], v[68:71]
 ds_read_b128 v[124:127], v11 offset:10496
 v_cvt_pk_bf16_f32 v155, v110, v111
 v_mfma_f32_16x16x32_bf16 v[72:75], a[172:175], v[136:139], v[72:75]
 v_mfma_f32_16x16x32_bf16 v[76:79], a[12:15], v[140:143], v[76:79]
 v_permlane16_swap_b32 v152, v154
 v_mfma_f32_16x16x32_bf16 v[80:83], a[92:95], v[140:143], v[80:83]
 v_permlane16_swap_b32 v153, v155
 v_mfma_f32_16x16x32_bf16 v[84:87], a[172:175], v[140:143], v[84:87]
 s_waitcnt lgkmcnt(2)
 v_mfma_f32_16x16x32_bf16 v[64:67], a[16:19], v[112:115], v[64:67]
 ds_read_b128 v[128:131], v11 offset:12288
 v_mfma_f32_16x16x32_bf16 v[68:71], a[96:99], v[112:115], v[68:71]
 ds_read_b128 v[132:135], v11 offset:12544
 v_mfma_f32_16x16x32_bf16 v[72:75], a[176:179], v[112:115], v[72:75]
 ds_write_b128 v14, v[144:147] offset:0
 v_mfma_f32_16x16x32_bf16 v[76:79], a[16:19], v[116:119], v[76:79]
 ds_write_b128 v14, v[148:151] offset:256
 v_mfma_f32_16x16x32_bf16 v[80:83], a[96:99], v[116:119], v[80:83]
 ds_write_b128 v15, v[152:155] offset:0
 v_mfma_f32_16x16x32_bf16 v[84:87], a[176:179], v[116:119], v[84:87]
 s_waitcnt lgkmcnt(5)
 v_mfma_f32_16x16x32_bf16 v[64:67], a[20:23], v[120:123], v[64:67]
 ds_read_b128 v[136:139], v11 offset:14336
 v_mfma_f32_16x16x32_bf16 v[68:71], a[100:103], v[120:123], v[68:71]
 ds_read_b128 v[140:143], v11 offset:14592
 v_mfma_f32_16x16x32_bf16 v[72:75], a[180:183], v[120:123], v[72:75]
 s_add_u32 s90, s31, 2
 s_min_u32 s90, s90, 63
 v_mfma_f32_16x16x32_bf16 v[76:79], a[20:23], v[124:127], v[76:79]
 s_cmp_gt_u32 s92, s90
 s_cbranch_scc0 hsp_2037
hbk_2038:
 v_mfma_f32_16x16x32_bf16 v[80:83], a[100:103], v[124:127], v[80:83]
 s_cmp_ge_u32 s31, 62
 s_cselect_b32 s29, 0x20000000, s29
 s_add_u32 s30, s24, s38
 v_mfma_f32_16x16x32_bf16 v[84:87], a[180:183], v[124:127], v[84:87]
 s_waitcnt lgkmcnt(5)
 v_mfma_f32_16x16x32_bf16 v[64:67], a[24:27], v[128:131], v[64:67]
 ds_read_b128 v[112:115], v11 offset:16384
 v_mfma_f32_16x16x32_bf16 v[68:71], a[104:107], v[128:131], v[68:71]
 ds_read_b128 v[116:119], v11 offset:16640
 v_mfma_f32_16x16x32_bf16 v[72:75], a[184:187], v[128:131], v[72:75]
 s_waitcnt vmcnt(6)
 s_waitcnt lgkmcnt(4)
 s_barrier
 v_mfma_f32_16x16x32_bf16 v[76:79], a[24:27], v[132:135], v[76:79]
 v_mfma_f32_16x16x32_bf16 v[80:83], a[104:107], v[132:135], v[80:83]
 buffer_store_dword v25, v24, s[4:7], 0 offen sc1
 v_mfma_f32_16x16x32_bf16 v[84:87], a[184:187], v[132:135], v[84:87]
 s_waitcnt lgkmcnt(2)
 v_mfma_f32_16x16x32_bf16 v[64:67], a[28:31], v[136:139], v[64:67]
 ds_read_b128 v[120:123], v11 offset:18432
 v_mfma_f32_16x16x32_bf16 v[68:71], a[108:111], v[136:139], v[68:71]
 ds_read_b128 v[124:127], v11 offset:18688
 v_mfma_f32_16x16x32_bf16 v[72:75], a[188:191], v[136:139], v[72:75]
 ds_read_b128 v[232:235], v18 offset:0
 v_mfma_f32_16x16x32_bf16 v[76:79], a[28:31], v[140:143], v[76:79]
 s_add_u32 m0, s30, 0
 s_add_u32 s89, s29, 0
 v_mfma_f32_16x16x32_bf16 v[80:83], a[108:111], v[140:143], v[80:83]
 buffer_load_dwordx4 v9, s[4:7], s89 offen offset:0 sc1 lds
 v_mfma_f32_16x16x32_bf16 v[84:87], a[188:191], v[140:143], v[84:87]
 ds_read_b128 v[236:239], v18 offset:2048
 s_waitcnt lgkmcnt(4)
 v_mfma_f32_16x16x32_bf16 v[64:67], a[32:35], v[112:115], v[64:67]
 ds_read_b128 v[128:131], v11 offset:20480
 v_mfma_f32_16x16x32_bf16 v[68:71], a[112:115], v[112:115], v[68:71]
 ds_read_b128 v[132:135], v11 offset:20736
 v_mfma_f32_16x16x32_bf16 v[72:75], a[192:195], v[112:115], v[72:75]
 ds_read_b128 v[240:243], v18 offset:4096
 v_mfma_f32_16x16x32_bf16 v[76:79], a[32:35], v[116:119], v[76:79]
 v_add_u32 v12, s37, v10
 v_mfma_f32_16x16x32_bf16 v[80:83], a[112:115], v[116:119], v[80:83]
 buffer_load_dwordx4 v9, s[4:7], s89 offen offset:1024 sc1 lds
 v_mfma_f32_16x16x32_bf16 v[84:87], a[192:195], v[116:119], v[84:87]
 ds_read_b128 v[244:247], v18 offset:6144
 s_waitcnt lgkmcnt(6)
 v_mfma_f32_16x16x32_bf16 v[64:67], a[36:39], v[120:123], v[64:67]
 ds_read_b128 v[136:139], v11 offset:22528
 v_mfma_f32_16x16x32_bf16 v[68:71], a[116:119], v[120:123], v[68:71]
 ds_read_b128 v[140:143], v11 offset:22784
 v_mfma_f32_16x16x32_bf16 v[72:75], a[196:199], v[120:123], v[72:75]
 ds_read_b128 v[248:251], v18 offset:8192
 v_mfma_f32_16x16x32_bf16 v[76:79], a[36:39], v[124:127], v[76:79]
 v_mfma_f32_16x16x32_bf16 v[80:83], a[116:119], v[124:127], v[80:83]
 buffer_load_dwordx4 v9, s[4:7], s89 offen offset:2048 sc1 lds
 v_mfma_f32_16x16x32_bf16 v[84:87], a[196:199], v[124:127], v[84:87]
 ds_read_b128 v[252:255], v18 offset:10240
 s_waitcnt vmcnt(4)
 s_waitcnt lgkmcnt(4)
 v_mfma_f32_16x16x32_bf16 v[28:31], v[160:163], v[232:235], 0
 v_mfma_f32_16x16x32_bf16 v[32:35], v[164:167], v[232:235], 0
 v_mfma_f32_16x16x32_bf16 v[36:39], v[208:211], v[232:235], 0
 v_mfma_f32_16x16x32_bf16 v[28:31], v[168:171], v[236:239], v[28:31]
 v_mfma_f32_16x16x32_bf16 v[32:35], v[172:175], v[236:239], v[32:35]
 v_mfma_f32_16x16x32_bf16 v[36:39], v[212:215], v[236:239], v[36:39]
 v_mfma_f32_16x16x32_bf16 v[28:31], v[176:179], v[240:243], v[28:31]
 v_mfma_f32_16x16x32_bf16 v[32:35], v[180:183], v[240:243], v[32:35]
 v_mfma_f32_16x16x32_bf16 v[36:39], v[216:219], v[240:243], v[36:39]
 v_mfma_f32_16x16x32_bf16 v[28:31], v[184:187], v[244:247], v[28:31]
 v_mfma_f32_16x16x32_bf16 v[32:35], v[188:191], v[244:247], v[32:35]
 v_mfma_f32_16x16x32_bf16 v[36:39], v[220:223], v[244:247], v[36:39]
 s_waitcnt lgkmcnt(0)
 v_mfma_f32_16x16x32_bf16 v[28:31], v[192:195], v[248:251], v[28:31]
 v_mfma_f32_16x16x32_bf16 v[32:35], v[196:199], v[248:251], v[32:35]
 v_mfma_f32_16x16x32_bf16 v[36:39], v[224:227], v[248:251], v[36:39]
 v_mfma_f32_16x16x32_bf16 v[28:31], v[200:203], v[252:255], v[28:31]
 v_mfma_f32_16x16x32_bf16 v[32:35], v[204:207], v[252:255], v[32:35]
 v_mfma_f32_16x16x32_bf16 v[36:39], v[228:231], v[252:255], v[36:39]
 v_mfma_f32_16x16x32_bf16 v[64:67], a[40:43], v[128:131], v[64:67]
 ds_read_b128 v[112:115], v11 offset:24576
 v_mfma_f32_16x16x32_bf16 v[68:71], a[120:123], v[128:131], v[68:71]
 ds_read_b128 v[116:119], v11 offset:24832
 v_mfma_f32_16x16x32_bf16 v[72:75], a[200:203], v[128:131], v[72:75]
 buffer_load_dwordx4 v[160:163], v16, s[4:7], s12 offen offset:0 sc1
 v_mfma_f32_16x16x32_bf16 v[76:79], a[40:43], v[132:135], v[76:79]
 v_mfma_f32_16x16x32_bf16 v[80:83], a[120:123], v[132:135], v[80:83]
 buffer_load_dwordx4 v9, s[4:7], s89 offen offset:3072 sc1 lds
 v_mfma_f32_16x16x32_bf16 v[84:87], a[200:203], v[132:135], v[84:87]
 buffer_load_dwordx4 v[164:167], v16, s[4:7], s12 offen offset:64 sc1
 v_permlane32_swap_b32 v36, v38
 v_mfma_f32_16x16x32_bf16 v[64:67], a[44:47], v[136:139], v[64:67]
 ds_read_b128 v[120:123], v11 offset:26624
 v_permlane32_swap_b32 v37, v39
 v_mfma_f32_16x16x32_bf16 v[68:71], a[124:127], v[136:139], v[68:71]
 ds_read_b128 v[124:127], v11 offset:26880
 v_mul_f32 v28, s56, v28
 v_mul_f32 v29, s56, v29
 v_mfma_f32_16x16x32_bf16 v[72:75], a[204:207], v[136:139], v[72:75]
 buffer_load_dwordx4 v[168:171], v16, s[4:7], s12 offen offset:2048 sc1
 v_mul_f32 v30, s56, v30
 v_mul_f32 v31, s56, v31
 v_mfma_f32_16x16x32_bf16 v[76:79], a[44:47], v[140:143], v[76:79]
 s_add_u32 m0, s30, 4096
 s_add_u32 s89, s29, 4096
 v_mul_f32 v32, s56, v32
 v_mfma_f32_16x16x32_bf16 v[80:83], a[124:127], v[140:143], v[80:83]
 buffer_load_dwordx4 v9, s[4:7], s89 offen offset:0 sc1 lds
 v_mul_f32 v33, s56, v33
 v_mul_f32 v34, s56, v34
 v_mfma_f32_16x16x32_bf16 v[84:87], a[204:207], v[140:143], v[84:87]
 s_waitcnt lgkmcnt(2)
 v_mul_f32 v35, s56, v35
 v_add_f32 v36, v36, v38
 v_mfma_f32_16x16x32_bf16 v[64:67], a[48:51], v[112:115], v[64:67]
 ds_read_b128 v[128:131], v11 offset:28672
 v_add_f32 v37, v37, v39
 v_cndmask_b32 v28, v23, v28, s[40:41]
 v_mfma_f32_16x16x32_bf16 v[68:71], a[128:131], v[112:115], v[68:71]
 ds_read_b128 v[132:135], v11 offset:28928
 v_cndmask_b32 v29, v23, v29, s[42:43]
 v_cndmask_b32 v30, v23, v30, s[44:45]
 v_mfma_f32_16x16x32_bf16 v[72:75], a[208:211], v[112:115], v[72:75]
 buffer_load_dwordx4 v[172:175], v16, s[4:7], s12 offen offset:2112 sc1
 v_cndmask_b32 v31, v23, v31, s[46:47]
 v_cndmask_b32 v32, v23, v32, s[48:49]
 v_mfma_f32_16x16x32_bf16 v[76:79], a[48:51], v[116:119], v[76:79]
 v_cndmask_b32 v33, v23, v33, s[50:51]
 v_cndmask_b32 v34, v23, v34, s[52:53]
 v_mfma_f32_16x16x32_bf16 v[80:83], a[128:131], v[116:119], v[80:83]
 buffer_load_dwordx4 v9, s[4:7], s89 offen offset:1024 sc1 lds
 v_cndmask_b32 v35, v23, v35, s[54:55]
 v_mul_f32 v36, s56, v36
 v_mfma_f32_16x16x32_bf16 v[84:87], a[208:211], v[116:119], v[84:87]
 s_waitcnt lgkmcnt(2)
 v_mul_f32 v37, s56, v37
 v_max3_f32 v40, v28, v29, v30
 v_mfma_f32_16x16x32_bf16 v[64:67], a[52:55], v[120:123], v[64:67]
 ds_read_b128 v[136:139], v11 offset:30720
 v_max3_f32 v40, v40, v31, v32
 v_max3_f32 v40, v40, v33, v34
 v_mfma_f32_16x16x32_bf16 v[68:71], a[132:135], v[120:123], v[68:71]
 ds_read_b128 v[140:143], v11 offset:30976
 v_max3_f32 v40, v40, v35, v36
 v_max_f32 v41, v40, v37
 v_mfma_f32_16x16x32_bf16 v[72:75], a[212:215], v[120:123], v[72:75]
 buffer_load_dwordx4 v[176:179], v16, s[4:7], s57 offen offset:0 sc1
 v_max_f32 v40, v40, v37
 v_mfma_f32_16x16x32_bf16 v[76:79], a[52:55], v[124:127], v[76:79]
 s_nop 0
 v_permlane16_swap_b32 v41, v40
 v_mfma_f32_16x16x32_bf16 v[80:83], a[132:135], v[124:127], v[80:83]
 buffer_load_dwordx4 v9, s[4:7], s89 offen offset:2048 sc1 lds
 v_max_f32 v42, v40, v41
 v_max_f32 v40, v40, v41
 v_mfma_f32_16x16x32_bf16 v[84:87], a[212:215], v[124:127], v[84:87]
 buffer_load_dwordx4 v[180:183], v16, s[4:7], s57 offen offset:64 sc1
 s_waitcnt lgkmcnt(2)
 v_permlane32_swap_b32 v42, v40
 v_mfma_f32_16x16x32_bf16 v[64:67], a[56:59], v[128:131], v[64:67]
 ds_read_b128 v[112:115], v11 offset:32768
 v_max_f32 v40, v40, v42
 v_sub_f32 v28, v28, v40
 v_mfma_f32_16x16x32_bf16 v[68:71], a[136:139], v[128:131], v[68:71]
 ds_read_b128 v[116:119], v11 offset:33024
 v_sub_f32 v29, v29, v40
 v_sub_f32 v30, v30, v40
 v_mfma_f32_16x16x32_bf16 v[72:75], a[216:219], v[128:131], v[72:75]
 buffer_load_dwordx4 v[184:187], v16, s[4:7], s57 offen offset:2048 sc1
 v_sub_f32 v31, v31, v40
 v_sub_f32 v32, v32, v40
 v_mfma_f32_16x16x32_bf16 v[76:79], a[56:59], v[132:135], v[76:79]
 v_sub_f32 v33, v33, v40
 v_sub_f32 v34, v34, v40
 v_mfma_f32_16x16x32_bf16 v[80:83], a[136:139], v[132:135], v[80:83]
 buffer_load_dwordx4 v9, s[4:7], s89 offen offset:3072 sc1 lds
 v_sub_f32 v35, v35, v40
 v_sub_f32 v36, v36, v40
 v_mfma_f32_16x16x32_bf16 v[84:87], a[216:219], v[132:135], v[84:87]
 s_waitcnt lgkmcnt(2)
 v_sub_f32 v37, v37, v40
 v_mfma_f32_16x16x32_bf16 v[64:67], a[60:63], v[136:139], v[64:67]
 ds_read_b128 v[120:123], v11 offset:34816
 v_exp_f32 v28, v28
 v_mfma_f32_16x16x32_bf16 v[68:71], a[140:143], v[136:139], v[68:71]
 ds_read_b128 v[124:127], v11 offset:35072
 v_exp_f32 v29, v29
 v_mfma_f32_16x16x32_bf16 v[72:75], a[220:223], v[136:139], v[72:75]
 buffer_load_dwordx4 v[188:191], v16, s[4:7], s57 offen offset:2112 sc1
 v_exp_f32 v30, v30
 v_mfma_f32_16x16x32_bf16 v[76:79], a[60:63], v[140:143], v[76:79]
 s_add_u32 m0, s30, 8192
 s_add_u32 s89, s29, 8192
 v_exp_f32 v31, v31
 v_mfma_f32_16x16x32_bf16 v[80:83], a[140:143], v[140:143], v[80:83]
 buffer_load_dwordx4 v9, s[4:7], s89 offen offset:0 sc1 lds
 v_exp_f32 v32, v32
 v_mfma_f32_16x16x32_bf16 v[84:87], a[220:223], v[140:143], v[84:87]
 s_load_dword s35, s[4:5], s32 glc
 s_waitcnt lgkmcnt(2)
 v_exp_f32 v33, v33
 v_mfma_f32_16x16x32_bf16 v[64:67], a[64:67], v[112:115], v[64:67]
 ds_read_b128 v[128:131], v11 offset:36864
 v_exp_f32 v34, v34
 v_mfma_f32_16x16x32_bf16 v[68:71], a[144:147], v[112:115], v[68:71]
 ds_read_b128 v[132:135], v11 offset:37120
 v_exp_f32 v35, v35
 v_mfma_f32_16x16x32_bf16 v[72:75], a[224:227], v[112:115], v[72:75]
 buffer_load_dwordx4 v[192:195], v16, s[4:7], s58 offen offset:0 sc1
 v_exp_f32 v36, v36
 v_mfma_f32_16x16x32_bf16 v[76:79], a[64:67], v[116:119], v[76:79]
 v_exp_f32 v37, v37
 v_mfma_f32_16x16x32_bf16 v[80:83], a[144:147], v[116:119], v[80:83]
 buffer_load_dwordx4 v9, s[4:7], s89 offen offset:1024 sc1 lds
 v_add_f32 v40, v28, v29
 v_add_f32 v40, v40, v30
 v_mfma_f32_16x16x32_bf16 v[84:87], a[224:227], v[116:119], v[84:87]
 buffer_load_dwordx4 v[196:199], v16, s[4:7], s58 offen offset:64 sc1
 s_waitcnt lgkmcnt(2)
 v_add_f32 v40, v40, v31
 v_add_f32 v40, v40, v32
 v_mfma_f32_16x16x32_bf16 v[64:67], a[68:71], v[120:123], v[64:67]
 ds_read_b128 v[136:139], v11 offset:38912
 v_add_f32 v40, v40, v33
 v_add_f32 v40, v40, v34
 v_mfma_f32_16x16x32_bf16 v[68:71], a[148:151], v[120:123], v[68:71]
 ds_read_b128 v[140:143], v11 offset:39168
 v_add_f32 v40, v40, v35
 v_add_f32 v40, v40, v36
 v_mfma_f32_16x16x32_bf16 v[72:75], a[228:231], v[120:123], v[72:75]
 buffer_load_dwordx4 v[200:203], v16, s[4:7], s58 offen offset:2048 sc1
 v_add_f32 v41, v40, v37
 v_add_f32 v40, v40, v37
 v_mfma_f32_16x16x32_bf16 v[76:79], a[68:71], v[124:127], v[76:79]
 s_nop 0
 v_permlane16_swap_b32 v41, v40
 v_mfma_f32_16x16x32_bf16 v[80:83], a[148:151], v[124:127], v[80:83]
 v_add_f32 v42, v40, v41
 v_add_f32 v40, v40, v41
 v_mfma_f32_16x16x32_bf16 v[84:87], a[228:231], v[124:127], v[84:87]
 s_waitcnt lgkmcnt(2)
 v_permlane32_swap_b32 v42, v40
 v_mfma_f32_16x16x32_bf16 v[64:67], a[72:75], v[128:131], v[64:67]
 ds_read_b128 v[112:115], v12 offset:0
 v_add_f32 v40, v40, v42
 v_mfma_f32_16x16x32_bf16 v[68:71], a[152:155], v[128:131], v[68:71]
 ds_read_b128 v[116:119], v12 offset:256
 v_rcp_f32 v40, v40
 v_mfma_f32_16x16x32_bf16 v[72:75], a[232:235], v[128:131], v[72:75]
 buffer_load_dwordx4 v[204:207], v16, s[4:7], s58 offen offset:2112 sc1
 s_add_u32 s29, s29, 40960
 s_mov_b32 s30, s36
 s_mov_b32 s36, s37
 v_mul_f32 v28, v28, v40
 v_mul_f32 v29, v29, v40
 v_mfma_f32_16x16x32_bf16 v[76:79], a[72:75], v[132:135], v[76:79]
 s_mov_b32 s37, s38
 s_mov_b32 s38, s30
 s_add_u32 s31, s31, 1
 v_mul_f32 v30, v30, v40
 v_mul_f32 v31, v31, v40
 v_mfma_f32_16x16x32_bf16 v[80:83], a[152:155], v[132:135], v[80:83]
 v_mul_f32 v32, v32, v40
 v_mul_f32 v33, v33, v40
 v_mfma_f32_16x16x32_bf16 v[84:87], a[232:235], v[132:135], v[84:87]
 s_waitcnt lgkmcnt(2)
 v_mul_f32 v34, v34, v40
 v_mul_f32 v35, v35, v40
 v_mfma_f32_16x16x32_bf16 v[64:67], a[76:79], v[136:139], v[64:67]
 ds_read_b128 v[120:123], v12 offset:2048
 v_mul_f32 v36, v36, v40
 v_mul_f32 v37, v37, v40
 v_mfma_f32_16x16x32_bf16 v[68:71], a[156:159], v[136:139], v[68:71]
 ds_read_b128 v[124:127], v12 offset:2304
 v_cvt_pk_bf16_f32 v44, v28, v29
 v_cvt_pk_bf16_f32 v45, v30, v31
 v_mfma_f32_16x16x32_bf16 v[72:75], a[236:239], v[136:139], v[72:75]
 v_cvt_pk_bf16_f32 v46, v32, v33
 v_cvt_pk_bf16_f32 v47, v34, v35
 v_mfma_f32_16x16x32_bf16 v[76:79], a[76:79], v[140:143], v[76:79]
 v_cvt_pk_bf16_f32 v48, v36, v37
 v_mfma_f32_16x16x32_bf16 v[80:83], a[156:159], v[140:143], v[80:83]
 buffer_store_dwordx4 v[44:47], v19, s[4:7], s27 offen sc1
 v_mfma_f32_16x16x32_bf16 v[84:87], a[236:239], v[140:143], v[84:87]
 buffer_store_dword v48, v20, s[4:7], s27 offen sc1
 s_mov_b32 s26, s13
 s_mov_b32 s27, s14
 s_add_u32 s12, s12, 393216
 s_add_u32 s13, s13, 196608
 s_add_u32 s14, s14, 81920
 s_cmp_gt_u32 s34, s31
 s_cbranch_scc1 fw_done_2039
 s_mov_b32 s100, 0
fw_2040:
 s_load_dword s34, s[4:5], s33 glc
 s_add_u32 s100, s100, 1
 s_cmp_gt_u32 s100, 200000
 s_cbranch_scc1 main_fail
 s_waitcnt lgkmcnt(0)
 s_cmp_gt_u32 s34, s31
 s_cbranch_scc0 fw_2040
fw_done_2039:
 s_sub_u32 s15, s31, 1
 s_cbranch_scc1 nw_2041
 v_mov_b32 v25, s15
 s_cmp_gt_u32 s35, s15
 s_cbranch_scc1 nw_2041
 s_load_dword s35, s[4:5], s32 glc
 s_waitcnt vmcnt(0)
 buffer_store_dword v25, v24, s[4:7], 0 offen sc1
 s_waitcnt lgkmcnt(0)
 s_cmp_gt_u32 s35, s15
 s_cbranch_scc1 fw_done_2042
 s_mov_b32 s100, 0
fw_2043:
 s_load_dword s35, s[4:5], s32 glc
 s_add_u32 s100, s100, 1
 s_cmp_gt_u32 s100, 200000
 s_cbranch_scc1 main_fail
 s_waitcnt lgkmcnt(0)
 s_cmp_gt_u32 s35, s15
 s_cbranch_scc0 fw_2043
fw_done_2042:
nw_2041:
 s_waitcnt lgkmcnt(2)
 v_mfma_f32_16x16x32_bf16 v[88:91], a[0:3], v[112:115], 0
 ds_read_b128 v[128:131], v12 offset:4096
 v_mfma_f32_16x16x32_bf16 v[92:95], a[80:83], v[112:115], 0
 ds_read_b128 v[132:135], v12 offset:4352
 v_mfma_f32_16x16x32_bf16 v[96:99], a[160:163], v[112:115], 0
 buffer_load_dwordx4 v[208:211], v17, s[4:7], s26 offen offset:0 sc1
 v_mfma_f32_16x16x32_bf16 v[100:103], a[0:3], v[116:119], 0
 s_add_u32 s57, s12, 4096
 s_add_u32 s58, s12, 8192
 s_add_u32 s59, s26, 4096
 v_mfma_f32_16x16x32_bf16 v[104:107], a[80:83], v[116:119], 0
 buffer_load_dwordx4 v[212:215], v17, s[4:7], s26 offen offset:1024 sc1
 v_mfma_f32_16x16x32_bf16 v[108:111], a[160:163], v[116:119], 0
 s_waitcnt lgkmcnt(2)
 v_mfma_f32_16x16x32_bf16 v[88:91], a[4:7], v[120:123], v[88:91]
 ds_read_b128 v[136:139], v12 offset:6144
 v_mfma_f32_16x16x32_bf16 v[92:95], a[84:87], v[120:123], v[92:95]
 ds_read_b128 v[140:143], v12 offset:6400
 v_mfma_f32_16x16x32_bf16 v[96:99], a[164:167], v[120:123], v[96:99]
 buffer_load_dwordx4 v[216:219], v17, s[4:7], s26 offen offset:2048 sc1
 v_cvt_pk_bf16_f32 v144, v64, v65
 v_mfma_f32_16x16x32_bf16 v[100:103], a[4:7], v[124:127], v[100:103]
 v_cvt_pk_bf16_f32 v145, v66, v67
 v_mfma_f32_16x16x32_bf16 v[104:107], a[84:87], v[124:127], v[104:107]
 buffer_load_dwordx4 v[220:223], v17, s[4:7], s26 offen offset:3072 sc1
 v_cvt_pk_bf16_f32 v146, v68, v69
 v_mfma_f32_16x16x32_bf16 v[108:111], a[164:167], v[124:127], v[108:111]
 s_waitcnt lgkmcnt(2)
 v_cvt_pk_bf16_f32 v147, v70, v71
 v_mfma_f32_16x16x32_bf16 v[88:91], a[8:11], v[128:131], v[88:91]
 ds_read_b128 v[112:115], v12 offset:8192
 v_cvt_pk_bf16_f32 v148, v76, v77
 v_mfma_f32_16x16x32_bf16 v[92:95], a[88:91], v[128:131], v[92:95]
 ds_read_b128 v[116:119], v12 offset:8448
 v_cvt_pk_bf16_f32 v149, v78, v79
 v_mfma_f32_16x16x32_bf16 v[96:99], a[168:171], v[128:131], v[96:99]
 buffer_load_dwordx4 v[224:227], v17, s[4:7], s59 offen offset:0 sc1
 v_cvt_pk_bf16_f32 v150, v80, v81
 v_mfma_f32_16x16x32_bf16 v[100:103], a[8:11], v[132:135], v[100:103]
 v_cvt_pk_bf16_f32 v151, v82, v83
 v_mfma_f32_16x16x32_bf16 v[104:107], a[88:91], v[132:135], v[104:107]
 buffer_load_dwordx4 v[228:231], v17, s[4:7], s59 offen offset:1024 sc1
 v_cvt_pk_bf16_f32 v152, v72, v73
 v_mfma_f32_16x16x32_bf16 v[108:111], a[168:171], v[132:135], v[108:111]
 s_waitcnt lgkmcnt(2)
 v_cvt_pk_bf16_f32 v153, v74, v75
 v_mfma_f32_16x16x32_bf16 v[88:91], a[12:15], v[136:139], v[88:91]
 ds_read_b128 v[120:123], v12 offset:10240
 v_cvt_pk_bf16_f32 v154, v84, v85
 v_mfma_f32_16x16x32_bf16 v[92:95], a[92:95], v[136:139], v[92:95]
 ds_read_b128 v[124:127], v12 offset:10496
 v_cvt_pk_bf16_f32 v155, v86, v87
 v_mfma_f32_16x16x32_bf16 v[96:99], a[172:175], v[136:139], v[96:99]
 v_mfma_f32_16x16x32_bf16 v[100:103], a[12:15], v[140:143], v[100:103]
 v_permlane16_swap_b32 v152, v154
 v_mfma_f32_16x16x32_bf16 v[104:107], a[92:95], v[140:143], v[104:107]
 v_permlane16_swap_b32 v153, v155
 v_mfma_f32_16x16x32_bf16 v[108:111], a[172:175], v[140:143], v[108:111]
 s_waitcnt lgkmcnt(2)
 v_mfma_f32_16x16x32_bf16 v[88:91], a[16:19], v[112:115], v[88:91]
 ds_read_b128 v[128:131], v12 offset:12288
 v_mfma_f32_16x16x32_bf16 v[92:95], a[96:99], v[112:115], v[92:95]
 ds_read_b128 v[132:135], v12 offset:12544
 v_mfma_f32_16x16x32_bf16 v[96:99], a[176:179], v[112:115], v[96:99]
 ds_write_b128 v14, v[144:147] offset:12288
 v_mfma_f32_16x16x32_bf16 v[100:103], a[16:19], v[116:119], v[100:103]
 ds_write_b128 v14, v[148:151] offset:12544
 v_mfma_f32_16x16x32_bf16 v[104:107], a[96:99], v[116:119], v[104:107]
 ds_write_b128 v15, v[152:155] offset:12288
 v_mfma_f32_16x16x32_bf16 v[108:111], a[176:179], v[116:119], v[108:111]
 s_waitcnt lgkmcnt(5)
 v_mfma_f32_16x16x32_bf16 v[88:91], a[20:23], v[120:123], v[88:91]
 ds_read_b128 v[136:139], v12 offset:14336
 v_mfma_f32_16x16x32_bf16 v[92:95], a[100:103], v[120:123], v[92:95]
 ds_read_b128 v[140:143], v12 offset:14592
 v_mfma_f32_16x16x32_bf16 v[96:99], a[180:183], v[120:123], v[96:99]
 s_add_u32 s90, s31, 2
 s_min_u32 s90, s90, 63
 v_mfma_f32_16x16x32_bf16 v[100:103], a[20:23], v[124:127], v[100:103]
 s_cmp_gt_u32 s92, s90
 s_cbranch_scc0 hsp_2044
hbk_2045:
 v_mfma_f32_16x16x32_bf16 v[104:107], a[100:103], v[124:127], v[104:107]
 s_cmp_ge_u32 s31, 62
 s_cselect_b32 s29, 0x20000000, s29
 s_add_u32 s30, s24, s38
 v_mfma_f32_16x16x32_bf16 v[108:111], a[180:183], v[124:127], v[108:111]
 s_waitcnt lgkmcnt(5)
 v_mfma_f32_16x16x32_bf16 v[88:91], a[24:27], v[128:131], v[88:91]
 ds_read_b128 v[112:115], v12 offset:16384
 v_mfma_f32_16x16x32_bf16 v[92:95], a[104:107], v[128:131], v[92:95]
 ds_read_b128 v[116:119], v12 offset:16640
 v_mfma_f32_16x16x32_bf16 v[96:99], a[184:187], v[128:131], v[96:99]
 s_waitcnt vmcnt(6)
 s_waitcnt lgkmcnt(4)
 s_barrier
 v_mfma_f32_16x16x32_bf16 v[100:103], a[24:27], v[132:135], v[100:103]
 v_mfma_f32_16x16x32_bf16 v[104:107], a[104:107], v[132:135], v[104:107]
 buffer_store_dword v25, v24, s[4:7], 0 offen sc1
 v_mfma_f32_16x16x32_bf16 v[108:111], a[184:187], v[132:135], v[108:111]
 s_waitcnt lgkmcnt(2)
 v_mfma_f32_16x16x32_bf16 v[88:91], a[28:31], v[136:139], v[88:91]
 ds_read_b128 v[120:123], v12 offset:18432
 v_mfma_f32_16x16x32_bf16 v[92:95], a[108:111], v[136:139], v[92:95]
 ds_read_b128 v[124:127], v12 offset:18688
 v_mfma_f32_16x16x32_bf16 v[96:99], a[188:191], v[136:139], v[96:99]
 ds_read_b128 v[232:235], v18 offset:12288
 v_mfma_f32_16x16x32_bf16 v[100:103], a[28:31], v[140:143], v[100:103]
 s_add_u32 m0, s30, 0
 s_add_u32 s89, s29, 0
 v_mfma_f32_16x16x32_bf16 v[104:107], a[108:111], v[140:143], v[104:107]
 buffer_load_dwordx4 v9, s[4:7], s89 offen offset:0 sc1 lds
 v_mfma_f32_16x16x32_bf16 v[108:111], a[188:191], v[140:143], v[108:111]
 ds_read_b128 v[236:239], v18 offset:14336
 s_waitcnt lgkmcnt(4)
 v_mfma_f32_16x16x32_bf16 v[88:91], a[32:35], v[112:115], v[88:91]
 ds_read_b128 v[128:131], v12 offset:20480
 v_mfma_f32_16x16x32_bf16 v[92:95], a[112:115], v[112:115], v[92:95]
 ds_read_b128 v[132:135], v12 offset:20736
 v_mfma_f32_16x16x32_bf16 v[96:99], a[192:195], v[112:115], v[96:99]
 ds_read_b128 v[240:243], v18 offset:16384
 v_mfma_f32_16x16x32_bf16 v[100:103], a[32:35], v[116:119], v[100:103]
 v_add_u32 v11, s37, v10
 v_mfma_f32_16x16x32_bf16 v[104:107], a[112:115], v[116:119], v[104:107]
 buffer_load_dwordx4 v9, s[4:7], s89 offen offset:1024 sc1 lds
 v_mfma_f32_16x16x32_bf16 v[108:111], a[192:195], v[116:119], v[108:111]
 ds_read_b128 v[244:247], v18 offset:18432
 s_waitcnt lgkmcnt(6)
 v_mfma_f32_16x16x32_bf16 v[88:91], a[36:39], v[120:123], v[88:91]
 ds_read_b128 v[136:139], v12 offset:22528
 v_mfma_f32_16x16x32_bf16 v[92:95], a[116:119], v[120:123], v[92:95]
 ds_read_b128 v[140:143], v12 offset:22784
 v_mfma_f32_16x16x32_bf16 v[96:99], a[196:199], v[120:123], v[96:99]
 ds_read_b128 v[248:251], v18 offset:20480
 v_mfma_f32_16x16x32_bf16 v[100:103], a[36:39], v[124:127], v[100:103]
 v_mfma_f32_16x16x32_bf16 v[104:107], a[116:119], v[124:127], v[104:107]
 buffer_load_dwordx4 v9, s[4:7], s89 offen offset:2048 sc1 lds
 v_mfma_f32_16x16x32_bf16 v[108:111], a[196:199], v[124:127], v[108:111]
 ds_read_b128 v[252:255], v18 offset:22528
 s_waitcnt vmcnt(4)
 s_waitcnt lgkmcnt(4)
 v_mfma_f32_16x16x32_bf16 v[28:31], v[160:163], v[232:235], 0
 v_mfma_f32_16x16x32_bf16 v[32:35], v[164:167], v[232:235], 0
 v_mfma_f32_16x16x32_bf16 v[36:39], v[208:211], v[232:235], 0
 v_mfma_f32_16x16x32_bf16 v[28:31], v[168:171], v[236:239], v[28:31]
 v_mfma_f32_16x16x32_bf16 v[32:35], v[172:175], v[236:239], v[32:35]
 v_mfma_f32_16x16x32_bf16 v[36:39], v[212:215], v[236:239], v[36:39]
 v_mfma_f32_16x16x32_bf16 v[28:31], v[176:179], v[240:243], v[28:31]
 v_mfma_f32_16x16x32_bf16 v[32:35], v[180:183], v[240:243], v[32:35]
 v_mfma_f32_16x16x32_bf16 v[36:39], v[216:219], v[240:243], v[36:39]
 v_mfma_f32_16x16x32_bf16 v[28:31], v[184:187], v[244:247], v[28:31]
 v_mfma_f32_16x16x32_bf16 v[32:35], v[188:191], v[244:247], v[32:35]
 v_mfma_f32_16x16x32_bf16 v[36:39], v[220:223], v[244:247], v[36:39]
 s_waitcnt lgkmcnt(0)
 v_mfma_f32_16x16x32_bf16 v[28:31], v[192:195], v[248:251], v[28:31]
 v_mfma_f32_16x16x32_bf16 v[32:35], v[196:199], v[248:251], v[32:35]
 v_mfma_f32_16x16x32_bf16 v[36:39], v[224:227], v[248:251], v[36:39]
 v_mfma_f32_16x16x32_bf16 v[28:31], v[200:203], v[252:255], v[28:31]
 v_mfma_f32_16x16x32_bf16 v[32:35], v[204:207], v[252:255], v[32:35]
 v_mfma_f32_16x16x32_bf16 v[36:39], v[228:231], v[252:255], v[36:39]
 v_mfma_f32_16x16x32_bf16 v[88:91], a[40:43], v[128:131], v[88:91]
 ds_read_b128 v[112:115], v12 offset:24576
 v_mfma_f32_16x16x32_bf16 v[92:95], a[120:123], v[128:131], v[92:95]
 ds_read_b128 v[116:119], v12 offset:24832
 v_mfma_f32_16x16x32_bf16 v[96:99], a[200:203], v[128:131], v[96:99]
 buffer_load_dwordx4 v[160:163], v16, s[4:7], s12 offen offset:0 sc1
 v_mfma_f32_16x16x32_bf16 v[100:103], a[40:43], v[132:135], v[100:103]
 v_mfma_f32_16x16x32_bf16 v[104:107], a[120:123], v[132:135], v[104:107]
 buffer_load_dwordx4 v9, s[4:7], s89 offen offset:3072 sc1 lds
 v_mfma_f32_16x16x32_bf16 v[108:111], a[200:203], v[132:135], v[108:111]
 buffer_load_dwordx4 v[164:167], v16, s[4:7], s12 offen offset:64 sc1
 v_permlane32_swap_b32 v36, v38
 v_mfma_f32_16x16x32_bf16 v[88:91], a[44:47], v[136:139], v[88:91]
 ds_read_b128 v[120:123], v12 offset:26624
 v_permlane32_swap_b32 v37, v39
 v_mfma_f32_16x16x32_bf16 v[92:95], a[124:127], v[136:139], v[92:95]
 ds_read_b128 v[124:127], v12 offset:26880
 v_mul_f32 v28, s56, v28
 v_mul_f32 v29, s56, v29
 v_mfma_f32_16x16x32_bf16 v[96:99], a[204:207], v[136:139], v[96:99]
 buffer_load_dwordx4 v[168:171], v16, s[4:7], s12 offen offset:2048 sc1
 v_mul_f32 v30, s56, v30
 v_mul_f32 v31, s56, v31
 v_mfma_f32_16x16x32_bf16 v[100:103], a[44:47], v[140:143], v[100:103]
 s_add_u32 m0, s30, 4096
 s_add_u32 s89, s29, 4096
 v_mul_f32 v32, s56, v32
 v_mfma_f32_16x16x32_bf16 v[104:107], a[124:127], v[140:143], v[104:107]
 buffer_load_dwordx4 v9, s[4:7], s89 offen offset:0 sc1 lds
 v_mul_f32 v33, s56, v33
 v_mul_f32 v34, s56, v34
 v_mfma_f32_16x16x32_bf16 v[108:111], a[204:207], v[140:143], v[108:111]
 s_waitcnt lgkmcnt(2)
 v_mul_f32 v35, s56, v35
 v_add_f32 v36, v36, v38
 v_mfma_f32_16x16x32_bf16 v[88:91], a[48:51], v[112:115], v[88:91]
 ds_read_b128 v[128:131], v12 offset:28672
 v_add_f32 v37, v37, v39
 v_cndmask_b32 v28, v23, v28, s[40:41]
 v_mfma_f32_16x16x32_bf16 v[92:95], a[128:131], v[112:115], v[92:95]
 ds_read_b128 v[132:135], v12 offset:28928
 v_cndmask_b32 v29, v23, v29, s[42:43]
 v_cndmask_b32 v30, v23, v30, s[44:45]
 v_mfma_f32_16x16x32_bf16 v[96:99], a[208:211], v[112:115], v[96:99]
 buffer_load_dwordx4 v[172:175], v16, s[4:7], s12 offen offset:2112 sc1
 v_cndmask_b32 v31, v23, v31, s[46:47]
 v_cndmask_b32 v32, v23, v32, s[48:49]
 v_mfma_f32_16x16x32_bf16 v[100:103], a[48:51], v[116:119], v[100:103]
 v_cndmask_b32 v33, v23, v33, s[50:51]
 v_cndmask_b32 v34, v23, v34, s[52:53]
 v_mfma_f32_16x16x32_bf16 v[104:107], a[128:131], v[116:119], v[104:107]
 buffer_load_dwordx4 v9, s[4:7], s89 offen offset:1024 sc1 lds
 v_cndmask_b32 v35, v23, v35, s[54:55]
 v_mul_f32 v36, s56, v36
 v_mfma_f32_16x16x32_bf16 v[108:111], a[208:211], v[116:119], v[108:111]
 s_waitcnt lgkmcnt(2)
 v_mul_f32 v37, s56, v37
 v_max3_f32 v40, v28, v29, v30
 v_mfma_f32_16x16x32_bf16 v[88:91], a[52:55], v[120:123], v[88:91]
 ds_read_b128 v[136:139], v12 offset:30720
 v_max3_f32 v40, v40, v31, v32
 v_max3_f32 v40, v40, v33, v34
 v_mfma_f32_16x16x32_bf16 v[92:95], a[132:135], v[120:123], v[92:95]
 ds_read_b128 v[140:143], v12 offset:30976
 v_max3_f32 v40, v40, v35, v36
 v_max_f32 v41, v40, v37
 v_mfma_f32_16x16x32_bf16 v[96:99], a[212:215], v[120:123], v[96:99]
 buffer_load_dwordx4 v[176:179], v16, s[4:7], s57 offen offset:0 sc1
 v_max_f32 v40, v40, v37
 v_mfma_f32_16x16x32_bf16 v[100:103], a[52:55], v[124:127], v[100:103]
 s_nop 0
 v_permlane16_swap_b32 v41, v40
 v_mfma_f32_16x16x32_bf16 v[104:107], a[132:135], v[124:127], v[104:107]
 buffer_load_dwordx4 v9, s[4:7], s89 offen offset:2048 sc1 lds
 v_max_f32 v42, v40, v41
 v_max_f32 v40, v40, v41
 v_mfma_f32_16x16x32_bf16 v[108:111], a[212:215], v[124:127], v[108:111]
 buffer_load_dwordx4 v[180:183], v16, s[4:7], s57 offen offset:64 sc1
 s_waitcnt lgkmcnt(2)
 v_permlane32_swap_b32 v42, v40
 v_mfma_f32_16x16x32_bf16 v[88:91], a[56:59], v[128:131], v[88:91]
 ds_read_b128 v[112:115], v12 offset:32768
 v_max_f32 v40, v40, v42
 v_sub_f32 v28, v28, v40
 v_mfma_f32_16x16x32_bf16 v[92:95], a[136:139], v[128:131], v[92:95]
 ds_read_b128 v[116:119], v12 offset:33024
 v_sub_f32 v29, v29, v40
 v_sub_f32 v30, v30, v40
 v_mfma_f32_16x16x32_bf16 v[96:99], a[216:219], v[128:131], v[96:99]
 buffer_load_dwordx4 v[184:187], v16, s[4:7], s57 offen offset:2048 sc1
 v_sub_f32 v31, v31, v40
 v_sub_f32 v32, v32, v40
 v_mfma_f32_16x16x32_bf16 v[100:103], a[56:59], v[132:135], v[100:103]
 v_sub_f32 v33, v33, v40
 v_sub_f32 v34, v34, v40
 v_mfma_f32_16x16x32_bf16 v[104:107], a[136:139], v[132:135], v[104:107]
 buffer_load_dwordx4 v9, s[4:7], s89 offen offset:3072 sc1 lds
 v_sub_f32 v35, v35, v40
 v_sub_f32 v36, v36, v40
 v_mfma_f32_16x16x32_bf16 v[108:111], a[216:219], v[132:135], v[108:111]
 s_waitcnt lgkmcnt(2)
 v_sub_f32 v37, v37, v40
 v_mfma_f32_16x16x32_bf16 v[88:91], a[60:63], v[136:139], v[88:91]
 ds_read_b128 v[120:123], v12 offset:34816
 v_exp_f32 v28, v28
 v_mfma_f32_16x16x32_bf16 v[92:95], a[140:143], v[136:139], v[92:95]
 ds_read_b128 v[124:127], v12 offset:35072
 v_exp_f32 v29, v29
 v_mfma_f32_16x16x32_bf16 v[96:99], a[220:223], v[136:139], v[96:99]
 buffer_load_dwordx4 v[188:191], v16, s[4:7], s57 offen offset:2112 sc1
 v_exp_f32 v30, v30
 v_mfma_f32_16x16x32_bf16 v[100:103], a[60:63], v[140:143], v[100:103]
 s_add_u32 m0, s30, 8192
 s_add_u32 s89, s29, 8192
 v_exp_f32 v31, v31
 v_mfma_f32_16x16x32_bf16 v[104:107], a[140:143], v[140:143], v[104:107]
 buffer_load_dwordx4 v9, s[4:7], s89 offen offset:0 sc1 lds
 v_exp_f32 v32, v32
 v_mfma_f32_16x16x32_bf16 v[108:111], a[220:223], v[140:143], v[108:111]
 s_load_dword s35, s[4:5], s32 glc
 s_waitcnt lgkmcnt(2)
 v_exp_f32 v33, v33
 v_mfma_f32_16x16x32_bf16 v[88:91], a[64:67], v[112:115], v[88:91]
 ds_read_b128 v[128:131], v12 offset:36864
 v_exp_f32 v34, v34
 v_mfma_f32_16x16x32_bf16 v[92:95], a[144:147], v[112:115], v[92:95]
 ds_read_b128 v[132:135], v12 offset:37120
 v_exp_f32 v35, v35
 v_mfma_f32_16x16x32_bf16 v[96:99], a[224:227], v[112:115], v[96:99]
 buffer_load_dwordx4 v[192:195], v16, s[4:7], s58 offen offset:0 sc1
 v_exp_f32 v36, v36
 v_mfma_f32_16x16x32_bf16 v[100:103], a[64:67], v[116:119], v[100:103]
 v_exp_f32 v37, v37
 v_mfma_f32_16x16x32_bf16 v[104:107], a[144:147], v[116:119], v[104:107]
 buffer_load_dwordx4 v9, s[4:7], s89 offen offset:1024 sc1 lds
 v_add_f32 v40, v28, v29
 v_add_f32 v40, v40, v30
 v_mfma_f32_16x16x32_bf16 v[108:111], a[224:227], v[116:119], v[108:111]
 buffer_load_dwordx4 v[196:199], v16, s[4:7], s58 offen offset:64 sc1
 s_waitcnt lgkmcnt(2)
 v_add_f32 v40, v40, v31
 v_add_f32 v40, v40, v32
 v_mfma_f32_16x16x32_bf16 v[88:91], a[68:71], v[120:123], v[88:91]
 ds_read_b128 v[136:139], v12 offset:38912
 v_add_f32 v40, v40, v33
 v_add_f32 v40, v40, v34
 v_mfma_f32_16x16x32_bf16 v[92:95], a[148:151], v[120:123], v[92:95]
 ds_read_b128 v[140:143], v12 offset:39168
 v_add_f32 v40, v40, v35
 v_add_f32 v40, v40, v36
 v_mfma_f32_16x16x32_bf16 v[96:99], a[228:231], v[120:123], v[96:99]
 buffer_load_dwordx4 v[200:203], v16, s[4:7], s58 offen offset:2048 sc1
 v_add_f32 v41, v40, v37
 v_add_f32 v40, v40, v37
 v_mfma_f32_16x16x32_bf16 v[100:103], a[68:71], v[124:127], v[100:103]
 s_nop 0
 v_permlane16_swap_b32 v41, v40
 v_mfma_f32_16x16x32_bf16 v[104:107], a[148:151], v[124:127], v[104:107]
 v_add_f32 v42, v40, v41
 v_add_f32 v40, v40, v41
 v_mfma_f32_16x16x32_bf16 v[108:111], a[228:231], v[124:127], v[108:111]
 s_waitcnt lgkmcnt(2)
 v_permlane32_swap_b32 v42, v40
 v_mfma_f32_16x16x32_bf16 v[88:91], a[72:75], v[128:131], v[88:91]
 ds_read_b128 v[112:115], v11 offset:0
 v_add_f32 v40, v40, v42
 v_mfma_f32_16x16x32_bf16 v[92:95], a[152:155], v[128:131], v[92:95]
 ds_read_b128 v[116:119], v11 offset:256
 v_rcp_f32 v40, v40
 v_mfma_f32_16x16x32_bf16 v[96:99], a[232:235], v[128:131], v[96:99]
 buffer_load_dwordx4 v[204:207], v16, s[4:7], s58 offen offset:2112 sc1
 s_add_u32 s29, s29, 40960
 s_mov_b32 s30, s36
 s_mov_b32 s36, s37
 v_mul_f32 v28, v28, v40
 v_mul_f32 v29, v29, v40
 v_mfma_f32_16x16x32_bf16 v[100:103], a[72:75], v[132:135], v[100:103]
 s_mov_b32 s37, s38
 s_mov_b32 s38, s30
 s_add_u32 s31, s31, 1
 v_mul_f32 v30, v30, v40
 v_mul_f32 v31, v31, v40
 v_mfma_f32_16x16x32_bf16 v[104:107], a[152:155], v[132:135], v[104:107]
 v_mul_f32 v32, v32, v40
 v_mul_f32 v33, v33, v40
 v_mfma_f32_16x16x32_bf16 v[108:111], a[232:235], v[132:135], v[108:111]
 s_waitcnt lgkmcnt(2)
 v_mul_f32 v34, v34, v40
 v_mul_f32 v35, v35, v40
 v_mfma_f32_16x16x32_bf16 v[88:91], a[76:79], v[136:139], v[88:91]
 ds_read_b128 v[120:123], v11 offset:2048
 v_mul_f32 v36, v36, v40
 v_mul_f32 v37, v37, v40
 v_mfma_f32_16x16x32_bf16 v[92:95], a[156:159], v[136:139], v[92:95]
 ds_read_b128 v[124:127], v11 offset:2304
 v_cvt_pk_bf16_f32 v44, v28, v29
 v_cvt_pk_bf16_f32 v45, v30, v31
 v_mfma_f32_16x16x32_bf16 v[96:99], a[236:239], v[136:139], v[96:99]
 v_cvt_pk_bf16_f32 v46, v32, v33
 v_cvt_pk_bf16_f32 v47, v34, v35
 v_mfma_f32_16x16x32_bf16 v[100:103], a[76:79], v[140:143], v[100:103]
 v_cvt_pk_bf16_f32 v48, v36, v37
 v_mfma_f32_16x16x32_bf16 v[104:107], a[156:159], v[140:143], v[104:107]
 buffer_store_dwordx4 v[44:47], v19, s[4:7], s27 offen sc1
 v_mfma_f32_16x16x32_bf16 v[108:111], a[236:239], v[140:143], v[108:111]
 buffer_store_dword v48, v20, s[4:7], s27 offen sc1
 s_mov_b32 s26, s13
 s_mov_b32 s27, s14
 s_add_u32 s12, s12, 393216
 s_add_u32 s13, s13, 196608
 s_add_u32 s14, s14, 81920
 s_cmp_lt_u32 s31, 64
 s_cbranch_scc1 wq_2031
 v_cvt_pk_bf16_f32 v144, v88, v89
 v_cvt_pk_bf16_f32 v145, v90, v91
 v_cvt_pk_bf16_f32 v146, v92, v93
 v_cvt_pk_bf16_f32 v147, v94, v95
 v_cvt_pk_bf16_f32 v148, v100, v101
 v_cvt_pk_bf16_f32 v149, v102, v103
 v_cvt_pk_bf16_f32 v150, v104, v105
 v_cvt_pk_bf16_f32 v151, v106, v107
 v_cvt_pk_bf16_f32 v152, v96, v97
 v_cvt_pk_bf16_f32 v153, v98, v99
 v_cvt_pk_bf16_f32 v154, v108, v109
 v_cvt_pk_bf16_f32 v155, v110, v111
 s_nop 0
 v_permlane16_swap_b32 v152, v154
 v_permlane16_swap_b32 v153, v155
 ds_write_b128 v14, v[144:147] offset:0
 ds_write_b128 v14, v[148:151] offset:256
 ds_write_b128 v15, v[152:155] offset:0
 s_waitcnt lgkmcnt(0)
 s_barrier
 ds_read_b128 v[232:235], v18 offset:0
 ds_read_b128 v[236:239], v18 offset:2048
 ds_read_b128 v[240:243], v18 offset:4096
 ds_read_b128 v[244:247], v18 offset:6144
 ds_read_b128 v[248:251], v18 offset:8192
 ds_read_b128 v[252:255], v18 offset:10240
 s_sub_u32 s15, s31, 1
 s_cbranch_scc1 nw_2046
 v_mov_b32 v25, s15
 s_cmp_gt_u32 s35, s15
 s_cbranch_scc1 nw_2046
 s_load_dword s35, s[4:5], s32 glc
 s_waitcnt vmcnt(0)
 buffer_store_dword v25, v24, s[4:7], 0 offen sc1
 s_waitcnt lgkmcnt(0)
 s_cmp_gt_u32 s35, s15
 s_cbranch_scc1 fw_done_2047
 s_mov_b32 s100, 0
fw_2048:
 s_load_dword s35, s[4:5], s32 glc
 s_add_u32 s100, s100, 1
 s_cmp_gt_u32 s100, 200000
 s_cbranch_scc1 main_fail
 s_waitcnt lgkmcnt(0)
 s_cmp_gt_u32 s35, s15
 s_cbranch_scc0 fw_2048
fw_done_2047:
nw_2046:
 s_add_u32 s57, s12, 4096
 s_add_u32 s58, s12, 8192
 s_add_u32 s59, s26, 4096
 buffer_load_dwordx4 v[208:211], v17, s[4:7], s26 offen offset:0 sc1
 buffer_load_dwordx4 v[212:215], v17, s[4:7], s26 offen offset:1024 sc1
 buffer_load_dwordx4 v[216:219], v17, s[4:7], s26 offen offset:2048 sc1
 buffer_load_dwordx4 v[220:223], v17, s[4:7], s26 offen offset:3072 sc1
 buffer_load_dwordx4 v[224:227], v17, s[4:7], s59 offen offset:0 sc1
 buffer_load_dwordx4 v[228:231], v17, s[4:7], s59 offen offset:1024 sc1
 s_waitcnt lgkmcnt(0)
 s_waitcnt vmcnt(5)
 v_mfma_f32_16x16x32_bf16 v[28:31], v[160:163], v[232:235], 0
 v_mfma_f32_16x16x32_bf16 v[32:35], v[164:167], v[232:235], 0
 v_mfma_f32_16x16x32_bf16 v[36:39], v[208:211], v[232:235], 0
 s_waitcnt vmcnt(4)
 v_mfma_f32_16x16x32_bf16 v[28:31], v[168:171], v[236:239], v[28:31]
 v_mfma_f32_16x16x32_bf16 v[32:35], v[172:175], v[236:239], v[32:35]
 v_mfma_f32_16x16x32_bf16 v[36:39], v[212:215], v[236:239], v[36:39]
 s_waitcnt vmcnt(3)
 v_mfma_f32_16x16x32_bf16 v[28:31], v[176:179], v[240:243], v[28:31]
 v_mfma_f32_16x16x32_bf16 v[32:35], v[180:183], v[240:243], v[32:35]
 v_mfma_f32_16x16x32_bf16 v[36:39], v[216:219], v[240:243], v[36:39]
 s_waitcnt vmcnt(2)
 v_mfma_f32_16x16x32_bf16 v[28:31], v[184:187], v[244:247], v[28:31]
 v_mfma_f32_16x16x32_bf16 v[32:35], v[188:191], v[244:247], v[32:35]
 v_mfma_f32_16x16x32_bf16 v[36:39], v[220:223], v[244:247], v[36:39]
 s_waitcnt vmcnt(1)
 v_mfma_f32_16x16x32_bf16 v[28:31], v[192:195], v[248:251], v[28:31]
 v_mfma_f32_16x16x32_bf16 v[32:35], v[196:199], v[248:251], v[32:35]
 v_mfma_f32_16x16x32_bf16 v[36:39], v[224:227], v[248:251], v[36:39]
 s_waitcnt vmcnt(0)
 v_mfma_f32_16x16x32_bf16 v[28:31], v[200:203], v[252:255], v[28:31]
 v_mfma_f32_16x16x32_bf16 v[32:35], v[204:207], v[252:255], v[32:35]
 v_mfma_f32_16x16x32_bf16 v[36:39], v[228:231], v[252:255], v[36:39]
 s_nop 7
 v_permlane32_swap_b32 v36, v38
 v_permlane32_swap_b32 v37, v39
 v_mul_f32 v28, s56, v28
 v_mul_f32 v29, s56, v29
 v_mul_f32 v30, s56, v30
 v_mul_f32 v31, s56, v31
 v_mul_f32 v32, s56, v32
 v_mul_f32 v33, s56, v33
 v_mul_f32 v34, s56, v34
 v_mul_f32 v35, s56, v35
 v_add_f32 v36, v36, v38
 v_add_f32 v37, v37, v39
 v_cndmask_b32 v28, v23, v28, s[40:41]
 v_cndmask_b32 v29, v23, v29, s[42:43]
 v_cndmask_b32 v30, v23, v30, s[44:45]
 v_cndmask_b32 v31, v23, v31, s[46:47]
 v_cndmask_b32 v32, v23, v32, s[48:49]
 v_cndmask_b32 v33, v23, v33, s[50:51]
 v_cndmask_b32 v34, v23, v34, s[52:53]
 v_cndmask_b32 v35, v23, v35, s[54:55]
 v_mul_f32 v36, s56, v36
 v_mul_f32 v37, s56, v37
 v_max3_f32 v40, v28, v29, v30
 v_max3_f32 v40, v40, v31, v32
 v_max3_f32 v40, v40, v33, v34
 v_max3_f32 v40, v40, v35, v36
 v_max_f32 v41, v40, v37
 v_max_f32 v40, v40, v37
 s_nop 1
 v_permlane16_swap_b32 v41, v40
 v_max_f32 v42, v40, v41
 v_max_f32 v40, v40, v41
 s_nop 1
 v_permlane32_swap_b32 v42, v40
 v_max_f32 v40, v40, v42
 v_sub_f32 v28, v28, v40
 v_sub_f32 v29, v29, v40
 v_sub_f32 v30, v30, v40
 v_sub_f32 v31, v31, v40
 v_sub_f32 v32, v32, v40
 v_sub_f32 v33, v33, v40
 v_sub_f32 v34, v34, v40
 v_sub_f32 v35, v35, v40
 v_sub_f32 v36, v36, v40
 v_sub_f32 v37, v37, v40
 v_exp_f32 v28, v28
 v_exp_f32 v29, v29
 v_exp_f32 v30, v30
 v_exp_f32 v31, v31
 v_exp_f32 v32, v32
 v_exp_f32 v33, v33
 v_exp_f32 v34, v34
 v_exp_f32 v35, v35
 v_exp_f32 v36, v36
 v_exp_f32 v37, v37
 v_add_f32 v40, v28, v29
 v_add_f32 v40, v40, v30
 v_add_f32 v40, v40, v31
 v_add_f32 v40, v40, v32
 v_add_f32 v40, v40, v33
 v_add_f32 v40, v40, v34
 v_add_f32 v40, v40, v35
 v_add_f32 v40, v40, v36
 v_add_f32 v41, v40, v37
 v_add_f32 v40, v40, v37
 s_nop 1
 v_permlane16_swap_b32 v41, v40
 v_add_f32 v42, v40, v41
 v_add_f32 v40, v40, v41
 s_nop 1
 v_permlane32_swap_b32 v42, v40
 v_add_f32 v40, v40, v42
 v_rcp_f32 v40, v40
 s_nop 0
 v_mul_f32 v28, v28, v40
 v_mul_f32 v29, v29, v40
 v_mul_f32 v30, v30, v40
 v_mul_f32 v31, v31, v40
 v_mul_f32 v32, v32, v40
 v_mul_f32 v33, v33, v40
 v_mul_f32 v34, v34, v40
 v_mul_f32 v35, v35, v40
 v_mul_f32 v36, v36, v40
 v_mul_f32 v37, v37, v40
 v_cvt_pk_bf16_f32 v44, v28, v29
 v_cvt_pk_bf16_f32 v45, v30, v31
 v_cvt_pk_bf16_f32 v46, v32, v33
 v_cvt_pk_bf16_f32 v47, v34, v35
 v_cvt_pk_bf16_f32 v48, v36, v37
 buffer_store_dwordx4 v[44:47], v19, s[4:7], s27 offen sc1
 buffer_store_dword v48, v20, s[4:7], s27 offen sc1
 v_mov_b32 v25, 64
 s_waitcnt vmcnt(0)
 buffer_store_dword v25, v24, s[4:7], 0 offen sc1
 s_branch g2_task
wqo_2030:
wq_2049:
 s_waitcnt lgkmcnt(2)
 v_mfma_f32_16x16x32_bf16 v[64:67], a[0:3], v[112:115], 0
 ds_read_b128 v[128:131], v11 offset:4096
 v_mfma_f32_16x16x32_bf16 v[68:71], a[80:83], v[112:115], 0
 ds_read_b128 v[132:135], v11 offset:4352
 v_mfma_f32_16x16x32_bf16 v[72:75], a[160:163], v[112:115], 0
 v_mfma_f32_16x16x32_bf16 v[76:79], a[0:3], v[116:119], 0
 v_mfma_f32_16x16x32_bf16 v[80:83], a[80:83], v[116:119], 0
 v_mfma_f32_16x16x32_bf16 v[84:87], a[160:163], v[116:119], 0
 s_waitcnt lgkmcnt(2)
 v_mfma_f32_16x16x32_bf16 v[64:67], a[4:7], v[120:123], v[64:67]
 ds_read_b128 v[136:139], v11 offset:6144
 v_mfma_f32_16x16x32_bf16 v[68:71], a[84:87], v[120:123], v[68:71]
 ds_read_b128 v[140:143], v11 offset:6400
 v_mfma_f32_16x16x32_bf16 v[72:75], a[164:167], v[120:123], v[72:75]
 v_cvt_pk_bf16_f32 v144, v88, v89
 v_mfma_f32_16x16x32_bf16 v[76:79], a[4:7], v[124:127], v[76:79]
 v_cvt_pk_bf16_f32 v145, v90, v91
 v_mfma_f32_16x16x32_bf16 v[80:83], a[84:87], v[124:127], v[80:83]
 v_cvt_pk_bf16_f32 v146, v92, v93
 v_mfma_f32_16x16x32_bf16 v[84:87], a[164:167], v[124:127], v[84:87]
 s_waitcnt lgkmcnt(2)
 v_cvt_pk_bf16_f32 v147, v94, v95
 v_mfma_f32_16x16x32_bf16 v[64:67], a[8:11], v[128:131], v[64:67]
 ds_read_b128 v[112:115], v11 offset:8192
 v_cvt_pk_bf16_f32 v148, v100, v101
 v_mfma_f32_16x16x32_bf16 v[68:71], a[88:91], v[128:131], v[68:71]
 ds_read_b128 v[116:119], v11 offset:8448
 v_cvt_pk_bf16_f32 v149, v102, v103
 v_mfma_f32_16x16x32_bf16 v[72:75], a[168:171], v[128:131], v[72:75]
 v_cvt_pk_bf16_f32 v150, v104, v105
 v_mfma_f32_16x16x32_bf16 v[76:79], a[8:11], v[132:135], v[76:79]
 v_cvt_pk_bf16_f32 v151, v106, v107
 v_mfma_f32_16x16x32_bf16 v[80:83], a[88:91], v[132:135], v[80:83]
 v_cvt_pk_bf16_f32 v152, v96, v97
 v_mfma_f32_16x16x32_bf16 v[84:87], a[168:171], v[132:135], v[84:87]
 s_waitcnt lgkmcnt(2)
 v_cvt_pk_bf16_f32 v153, v98, v99
 v_mfma_f32_16x16x32_bf16 v[64:67], a[12:15], v[136:139], v[64:67]
 ds_read_b128 v[120:123], v11 offset:10240
 v_cvt_pk_bf16_f32 v154, v108, v109
 v_mfma_f32_16x16x32_bf16 v[68:71], a[92:95], v[136:139], v[68:71]
 ds_read_b128 v[124:127], v11 offset:10496
 v_cvt_pk_bf16_f32 v155, v110, v111
 v_mfma_f32_16x16x32_bf16 v[72:75], a[172:175], v[136:139], v[72:75]
 v_mfma_f32_16x16x32_bf16 v[76:79], a[12:15], v[140:143], v[76:79]
 v_permlane16_swap_b32 v152, v154
 v_mfma_f32_16x16x32_bf16 v[80:83], a[92:95], v[140:143], v[80:83]
 v_permlane16_swap_b32 v153, v155
 v_mfma_f32_16x16x32_bf16 v[84:87], a[172:175], v[140:143], v[84:87]
 s_waitcnt lgkmcnt(2)
 v_mfma_f32_16x16x32_bf16 v[64:67], a[16:19], v[112:115], v[64:67]
 ds_read_b128 v[128:131], v11 offset:12288
 v_mfma_f32_16x16x32_bf16 v[68:71], a[96:99], v[112:115], v[68:71]
 ds_read_b128 v[132:135], v11 offset:12544
 v_mfma_f32_16x16x32_bf16 v[72:75], a[176:179], v[112:115], v[72:75]
 ds_write_b128 v14, v[144:147] offset:0
 v_mfma_f32_16x16x32_bf16 v[76:79], a[16:19], v[116:119], v[76:79]
 ds_write_b128 v14, v[148:151] offset:256
 v_mfma_f32_16x16x32_bf16 v[80:83], a[96:99], v[116:119], v[80:83]
 ds_write_b128 v15, v[152:155] offset:0
 v_mfma_f32_16x16x32_bf16 v[84:87], a[176:179], v[116:119], v[84:87]
 s_waitcnt lgkmcnt(5)
 v_mfma_f32_16x16x32_bf16 v[64:67], a[20:23], v[120:123], v[64:67]
 ds_read_b128 v[136:139], v11 offset:14336
 v_mfma_f32_16x16x32_bf16 v[68:71], a[100:103], v[120:123], v[68:71]
 ds_read_b128 v[140:143], v11 offset:14592
 v_mfma_f32_16x16x32_bf16 v[72:75], a[180:183], v[120:123], v[72:75]
 s_add_u32 s90, s31, 2
 s_min_u32 s90, s90, 63
 v_mfma_f32_16x16x32_bf16 v[76:79], a[20:23], v[124:127], v[76:79]
 s_cmp_gt_u32 s92, s90
 s_cbranch_scc0 hsp_2050
hbk_2051:
 v_mfma_f32_16x16x32_bf16 v[80:83], a[100:103], v[124:127], v[80:83]
 s_cmp_ge_u32 s31, 62
 s_cselect_b32 s29, 0x20000000, s29
 s_add_u32 s30, s24, s38
 v_mfma_f32_16x16x32_bf16 v[84:87], a[180:183], v[124:127], v[84:87]
 s_waitcnt lgkmcnt(5)
 v_mfma_f32_16x16x32_bf16 v[64:67], a[24:27], v[128:131], v[64:67]
 ds_read_b128 v[112:115], v11 offset:16384
 v_mfma_f32_16x16x32_bf16 v[68:71], a[104:107], v[128:131], v[68:71]
 ds_read_b128 v[116:119], v11 offset:16640
 v_mfma_f32_16x16x32_bf16 v[72:75], a[184:187], v[128:131], v[72:75]
 s_waitcnt vmcnt(0)
 s_waitcnt lgkmcnt(4)
 s_barrier
 v_mfma_f32_16x16x32_bf16 v[76:79], a[24:27], v[132:135], v[76:79]
 v_mfma_f32_16x16x32_bf16 v[80:83], a[104:107], v[132:135], v[80:83]
 v_mfma_f32_16x16x32_bf16 v[84:87], a[184:187], v[132:135], v[84:87]
 s_waitcnt lgkmcnt(2)
 v_mfma_f32_16x16x32_bf16 v[64:67], a[28:31], v[136:139], v[64:67]
 ds_read_b128 v[120:123], v11 offset:18432
 v_mfma_f32_16x16x32_bf16 v[68:71], a[108:111], v[136:139], v[68:71]
 ds_read_b128 v[124:127], v11 offset:18688
 v_mfma_f32_16x16x32_bf16 v[72:75], a[188:191], v[136:139], v[72:75]
 v_mfma_f32_16x16x32_bf16 v[76:79], a[28:31], v[140:143], v[76:79]
 s_add_u32 m0, s30, 0
 s_add_u32 s89, s29, 0
 v_mfma_f32_16x16x32_bf16 v[80:83], a[108:111], v[140:143], v[80:83]
 buffer_load_dwordx4 v9, s[4:7], s89 offen offset:0 sc1 lds
 v_mfma_f32_16x16x32_bf16 v[84:87], a[188:191], v[140:143], v[84:87]
 s_waitcnt lgkmcnt(2)
 v_mfma_f32_16x16x32_bf16 v[64:67], a[32:35], v[112:115], v[64:67]
 ds_read_b128 v[128:131], v11 offset:20480
 v_mfma_f32_16x16x32_bf16 v[68:71], a[112:115], v[112:115], v[68:71]
 ds_read_b128 v[132:135], v11 offset:20736
 v_mfma_f32_16x16x32_bf16 v[72:75], a[192:195], v[112:115], v[72:75]
 v_mfma_f32_16x16x32_bf16 v[76:79], a[32:35], v[116:119], v[76:79]
 v_add_u32 v12, s37, v10
 v_mfma_f32_16x16x32_bf16 v[80:83], a[112:115], v[116:119], v[80:83]
 buffer_load_dwordx4 v9, s[4:7], s89 offen offset:1024 sc1 lds
 v_mfma_f32_16x16x32_bf16 v[84:87], a[192:195], v[116:119], v[84:87]
 s_waitcnt lgkmcnt(2)
 v_mfma_f32_16x16x32_bf16 v[64:67], a[36:39], v[120:123], v[64:67]
 ds_read_b128 v[136:139], v11 offset:22528
 v_mfma_f32_16x16x32_bf16 v[68:71], a[116:119], v[120:123], v[68:71]
 ds_read_b128 v[140:143], v11 offset:22784
 v_mfma_f32_16x16x32_bf16 v[72:75], a[196:199], v[120:123], v[72:75]
 v_mfma_f32_16x16x32_bf16 v[76:79], a[36:39], v[124:127], v[76:79]
 v_mfma_f32_16x16x32_bf16 v[80:83], a[116:119], v[124:127], v[80:83]
 buffer_load_dwordx4 v9, s[4:7], s89 offen offset:2048 sc1 lds
 v_mfma_f32_16x16x32_bf16 v[84:87], a[196:199], v[124:127], v[84:87]
 s_waitcnt lgkmcnt(2)
 v_mfma_f32_16x16x32_bf16 v[64:67], a[40:43], v[128:131], v[64:67]
 ds_read_b128 v[112:115], v11 offset:24576
 v_mfma_f32_16x16x32_bf16 v[68:71], a[120:123], v[128:131], v[68:71]
 ds_read_b128 v[116:119], v11 offset:24832
 v_mfma_f32_16x16x32_bf16 v[72:75], a[200:203], v[128:131], v[72:75]
 v_mfma_f32_16x16x32_bf16 v[76:79], a[40:43], v[132:135], v[76:79]
 v_mfma_f32_16x16x32_bf16 v[80:83], a[120:123], v[132:135], v[80:83]
 buffer_load_dwordx4 v9, s[4:7], s89 offen offset:3072 sc1 lds
 v_mfma_f32_16x16x32_bf16 v[84:87], a[200:203], v[132:135], v[84:87]
 s_waitcnt lgkmcnt(2)
 v_mfma_f32_16x16x32_bf16 v[64:67], a[44:47], v[136:139], v[64:67]
 ds_read_b128 v[120:123], v11 offset:26624
 v_mfma_f32_16x16x32_bf16 v[68:71], a[124:127], v[136:139], v[68:71]
 ds_read_b128 v[124:127], v11 offset:26880
 v_mfma_f32_16x16x32_bf16 v[72:75], a[204:207], v[136:139], v[72:75]
 v_mfma_f32_16x16x32_bf16 v[76:79], a[44:47], v[140:143], v[76:79]
 s_add_u32 m0, s30, 4096
 s_add_u32 s89, s29, 4096
 v_mfma_f32_16x16x32_bf16 v[80:83], a[124:127], v[140:143], v[80:83]
 buffer_load_dwordx4 v9, s[4:7], s89 offen offset:0 sc1 lds
 v_mfma_f32_16x16x32_bf16 v[84:87], a[204:207], v[140:143], v[84:87]
 s_waitcnt lgkmcnt(2)
 v_mfma_f32_16x16x32_bf16 v[64:67], a[48:51], v[112:115], v[64:67]
 ds_read_b128 v[128:131], v11 offset:28672
 v_mfma_f32_16x16x32_bf16 v[68:71], a[128:131], v[112:115], v[68:71]
 ds_read_b128 v[132:135], v11 offset:28928
 v_mfma_f32_16x16x32_bf16 v[72:75], a[208:211], v[112:115], v[72:75]
 v_mfma_f32_16x16x32_bf16 v[76:79], a[48:51], v[116:119], v[76:79]
 v_mfma_f32_16x16x32_bf16 v[80:83], a[128:131], v[116:119], v[80:83]
 buffer_load_dwordx4 v9, s[4:7], s89 offen offset:1024 sc1 lds
 v_mfma_f32_16x16x32_bf16 v[84:87], a[208:211], v[116:119], v[84:87]
 s_waitcnt lgkmcnt(2)
 v_mfma_f32_16x16x32_bf16 v[64:67], a[52:55], v[120:123], v[64:67]
 ds_read_b128 v[136:139], v11 offset:30720
 v_mfma_f32_16x16x32_bf16 v[68:71], a[132:135], v[120:123], v[68:71]
 ds_read_b128 v[140:143], v11 offset:30976
 v_mfma_f32_16x16x32_bf16 v[72:75], a[212:215], v[120:123], v[72:75]
 v_mfma_f32_16x16x32_bf16 v[76:79], a[52:55], v[124:127], v[76:79]
 v_mfma_f32_16x16x32_bf16 v[80:83], a[132:135], v[124:127], v[80:83]
 buffer_load_dwordx4 v9, s[4:7], s89 offen offset:2048 sc1 lds
 v_mfma_f32_16x16x32_bf16 v[84:87], a[212:215], v[124:127], v[84:87]
 s_waitcnt lgkmcnt(2)
 v_mfma_f32_16x16x32_bf16 v[64:67], a[56:59], v[128:131], v[64:67]
 ds_read_b128 v[112:115], v11 offset:32768
 v_mfma_f32_16x16x32_bf16 v[68:71], a[136:139], v[128:131], v[68:71]
 ds_read_b128 v[116:119], v11 offset:33024
 v_mfma_f32_16x16x32_bf16 v[72:75], a[216:219], v[128:131], v[72:75]
 v_mfma_f32_16x16x32_bf16 v[76:79], a[56:59], v[132:135], v[76:79]
 v_mfma_f32_16x16x32_bf16 v[80:83], a[136:139], v[132:135], v[80:83]
 buffer_load_dwordx4 v9, s[4:7], s89 offen offset:3072 sc1 lds
 v_mfma_f32_16x16x32_bf16 v[84:87], a[216:219], v[132:135], v[84:87]
 s_waitcnt lgkmcnt(2)
 v_mfma_f32_16x16x32_bf16 v[64:67], a[60:63], v[136:139], v[64:67]
 ds_read_b128 v[120:123], v11 offset:34816
 v_mfma_f32_16x16x32_bf16 v[68:71], a[140:143], v[136:139], v[68:71]
 ds_read_b128 v[124:127], v11 offset:35072
 v_mfma_f32_16x16x32_bf16 v[72:75], a[220:223], v[136:139], v[72:75]
 v_mfma_f32_16x16x32_bf16 v[76:79], a[60:63], v[140:143], v[76:79]
 s_add_u32 m0, s30, 8192
 s_add_u32 s89, s29, 8192
 v_mfma_f32_16x16x32_bf16 v[80:83], a[140:143], v[140:143], v[80:83]
 buffer_load_dwordx4 v9, s[4:7], s89 offen offset:0 sc1 lds
 v_mfma_f32_16x16x32_bf16 v[84:87], a[220:223], v[140:143], v[84:87]
 s_waitcnt lgkmcnt(2)
 v_mfma_f32_16x16x32_bf16 v[64:67], a[64:67], v[112:115], v[64:67]
 ds_read_b128 v[128:131], v11 offset:36864
 v_mfma_f32_16x16x32_bf16 v[68:71], a[144:147], v[112:115], v[68:71]
 ds_read_b128 v[132:135], v11 offset:37120
 v_mfma_f32_16x16x32_bf16 v[72:75], a[224:227], v[112:115], v[72:75]
 v_mfma_f32_16x16x32_bf16 v[76:79], a[64:67], v[116:119], v[76:79]
 v_mfma_f32_16x16x32_bf16 v[80:83], a[144:147], v[116:119], v[80:83]
 buffer_load_dwordx4 v9, s[4:7], s89 offen offset:1024 sc1 lds
 v_mfma_f32_16x16x32_bf16 v[84:87], a[224:227], v[116:119], v[84:87]
 s_waitcnt lgkmcnt(2)
 v_mfma_f32_16x16x32_bf16 v[64:67], a[68:71], v[120:123], v[64:67]
 ds_read_b128 v[136:139], v11 offset:38912
 v_mfma_f32_16x16x32_bf16 v[68:71], a[148:151], v[120:123], v[68:71]
 ds_read_b128 v[140:143], v11 offset:39168
 v_mfma_f32_16x16x32_bf16 v[72:75], a[228:231], v[120:123], v[72:75]
 v_mfma_f32_16x16x32_bf16 v[76:79], a[68:71], v[124:127], v[76:79]
 v_mfma_f32_16x16x32_bf16 v[80:83], a[148:151], v[124:127], v[80:83]
 v_mfma_f32_16x16x32_bf16 v[84:87], a[228:231], v[124:127], v[84:87]
 s_waitcnt lgkmcnt(2)
 v_mfma_f32_16x16x32_bf16 v[64:67], a[72:75], v[128:131], v[64:67]
 ds_read_b128 v[112:115], v12 offset:0
 v_mfma_f32_16x16x32_bf16 v[68:71], a[152:155], v[128:131], v[68:71]
 ds_read_b128 v[116:119], v12 offset:256
 v_mfma_f32_16x16x32_bf16 v[72:75], a[232:235], v[128:131], v[72:75]
 s_add_u32 s29, s29, 40960
 s_mov_b32 s30, s36
 s_mov_b32 s36, s37
 v_mfma_f32_16x16x32_bf16 v[76:79], a[72:75], v[132:135], v[76:79]
 s_mov_b32 s37, s38
 s_mov_b32 s38, s30
 s_add_u32 s31, s31, 1
 v_mfma_f32_16x16x32_bf16 v[80:83], a[152:155], v[132:135], v[80:83]
 v_mfma_f32_16x16x32_bf16 v[84:87], a[232:235], v[132:135], v[84:87]
 s_waitcnt lgkmcnt(2)
 v_mfma_f32_16x16x32_bf16 v[64:67], a[76:79], v[136:139], v[64:67]
 ds_read_b128 v[120:123], v12 offset:2048
 v_mfma_f32_16x16x32_bf16 v[68:71], a[156:159], v[136:139], v[68:71]
 ds_read_b128 v[124:127], v12 offset:2304
 v_mfma_f32_16x16x32_bf16 v[72:75], a[236:239], v[136:139], v[72:75]
 v_mfma_f32_16x16x32_bf16 v[76:79], a[76:79], v[140:143], v[76:79]
 v_mfma_f32_16x16x32_bf16 v[80:83], a[156:159], v[140:143], v[80:83]
 v_mfma_f32_16x16x32_bf16 v[84:87], a[236:239], v[140:143], v[84:87]
 s_waitcnt lgkmcnt(2)
 v_mfma_f32_16x16x32_bf16 v[88:91], a[0:3], v[112:115], 0
 ds_read_b128 v[128:131], v12 offset:4096
 v_mfma_f32_16x16x32_bf16 v[92:95], a[80:83], v[112:115], 0
 ds_read_b128 v[132:135], v12 offset:4352
 v_mfma_f32_16x16x32_bf16 v[96:99], a[160:163], v[112:115], 0
 v_mfma_f32_16x16x32_bf16 v[100:103], a[0:3], v[116:119], 0
 v_mfma_f32_16x16x32_bf16 v[104:107], a[80:83], v[116:119], 0
 v_mfma_f32_16x16x32_bf16 v[108:111], a[160:163], v[116:119], 0
 s_waitcnt lgkmcnt(2)
 v_mfma_f32_16x16x32_bf16 v[88:91], a[4:7], v[120:123], v[88:91]
 ds_read_b128 v[136:139], v12 offset:6144
 v_mfma_f32_16x16x32_bf16 v[92:95], a[84:87], v[120:123], v[92:95]
 ds_read_b128 v[140:143], v12 offset:6400
 v_mfma_f32_16x16x32_bf16 v[96:99], a[164:167], v[120:123], v[96:99]
 v_cvt_pk_bf16_f32 v144, v64, v65
 v_mfma_f32_16x16x32_bf16 v[100:103], a[4:7], v[124:127], v[100:103]
 v_cvt_pk_bf16_f32 v145, v66, v67
 v_mfma_f32_16x16x32_bf16 v[104:107], a[84:87], v[124:127], v[104:107]
 v_cvt_pk_bf16_f32 v146, v68, v69
 v_mfma_f32_16x16x32_bf16 v[108:111], a[164:167], v[124:127], v[108:111]
 s_waitcnt lgkmcnt(2)
 v_cvt_pk_bf16_f32 v147, v70, v71
 v_mfma_f32_16x16x32_bf16 v[88:91], a[8:11], v[128:131], v[88:91]
 ds_read_b128 v[112:115], v12 offset:8192
 v_cvt_pk_bf16_f32 v148, v76, v77
 v_mfma_f32_16x16x32_bf16 v[92:95], a[88:91], v[128:131], v[92:95]
 ds_read_b128 v[116:119], v12 offset:8448
 v_cvt_pk_bf16_f32 v149, v78, v79
 v_mfma_f32_16x16x32_bf16 v[96:99], a[168:171], v[128:131], v[96:99]
 v_cvt_pk_bf16_f32 v150, v80, v81
 v_mfma_f32_16x16x32_bf16 v[100:103], a[8:11], v[132:135], v[100:103]
 v_cvt_pk_bf16_f32 v151, v82, v83
 v_mfma_f32_16x16x32_bf16 v[104:107], a[88:91], v[132:135], v[104:107]
 v_cvt_pk_bf16_f32 v152, v72, v73
 v_mfma_f32_16x16x32_bf16 v[108:111], a[168:171], v[132:135], v[108:111]
 s_waitcnt lgkmcnt(2)
 v_cvt_pk_bf16_f32 v153, v74, v75
 v_mfma_f32_16x16x32_bf16 v[88:91], a[12:15], v[136:139], v[88:91]
 ds_read_b128 v[120:123], v12 offset:10240
 v_cvt_pk_bf16_f32 v154, v84, v85
 v_mfma_f32_16x16x32_bf16 v[92:95], a[92:95], v[136:139], v[92:95]
 ds_read_b128 v[124:127], v12 offset:10496
 v_cvt_pk_bf16_f32 v155, v86, v87
 v_mfma_f32_16x16x32_bf16 v[96:99], a[172:175], v[136:139], v[96:99]
 v_mfma_f32_16x16x32_bf16 v[100:103], a[12:15], v[140:143], v[100:103]
 v_permlane16_swap_b32 v152, v154
 v_mfma_f32_16x16x32_bf16 v[104:107], a[92:95], v[140:143], v[104:107]
 v_permlane16_swap_b32 v153, v155
 v_mfma_f32_16x16x32_bf16 v[108:111], a[172:175], v[140:143], v[108:111]
 s_waitcnt lgkmcnt(2)
 v_mfma_f32_16x16x32_bf16 v[88:91], a[16:19], v[112:115], v[88:91]
 ds_read_b128 v[128:131], v12 offset:12288
 v_mfma_f32_16x16x32_bf16 v[92:95], a[96:99], v[112:115], v[92:95]
 ds_read_b128 v[132:135], v12 offset:12544
 v_mfma_f32_16x16x32_bf16 v[96:99], a[176:179], v[112:115], v[96:99]
 ds_write_b128 v14, v[144:147] offset:12288
 v_mfma_f32_16x16x32_bf16 v[100:103], a[16:19], v[116:119], v[100:103]
 ds_write_b128 v14, v[148:151] offset:12544
 v_mfma_f32_16x16x32_bf16 v[104:107], a[96:99], v[116:119], v[104:107]
 ds_write_b128 v15, v[152:155] offset:12288
 v_mfma_f32_16x16x32_bf16 v[108:111], a[176:179], v[116:119], v[108:111]
 s_waitcnt lgkmcnt(5)
 v_mfma_f32_16x16x32_bf16 v[88:91], a[20:23], v[120:123], v[88:91]
 ds_read_b128 v[136:139], v12 offset:14336
 v_mfma_f32_16x16x32_bf16 v[92:95], a[100:103], v[120:123], v[92:95]
 ds_read_b128 v[140:143], v12 offset:14592
 v_mfma_f32_16x16x32_bf16 v[96:99], a[180:183], v[120:123], v[96:99]
 s_add_u32 s90, s31, 2
 s_min_u32 s90, s90, 63
 v_mfma_f32_16x16x32_bf16 v[100:103], a[20:23], v[124:127], v[100:103]
 s_cmp_gt_u32 s92, s90
 s_cbranch_scc0 hsp_2052
hbk_2053:
 v_mfma_f32_16x16x32_bf16 v[104:107], a[100:103], v[124:127], v[104:107]
 s_cmp_ge_u32 s31, 62
 s_cselect_b32 s29, 0x20000000, s29
 s_add_u32 s30, s24, s38
 v_mfma_f32_16x16x32_bf16 v[108:111], a[180:183], v[124:127], v[108:111]
 s_waitcnt lgkmcnt(5)
 v_mfma_f32_16x16x32_bf16 v[88:91], a[24:27], v[128:131], v[88:91]
 ds_read_b128 v[112:115], v12 offset:16384
 v_mfma_f32_16x16x32_bf16 v[92:95], a[104:107], v[128:131], v[92:95]
 ds_read_b128 v[116:119], v12 offset:16640
 v_mfma_f32_16x16x32_bf16 v[96:99], a[184:187], v[128:131], v[96:99]
 s_waitcnt vmcnt(0)
 s_waitcnt lgkmcnt(4)
 s_barrier
 v_mfma_f32_16x16x32_bf16 v[100:103], a[24:27], v[132:135], v[100:103]
 v_mfma_f32_16x16x32_bf16 v[104:107], a[104:107], v[132:135], v[104:107]
 v_mfma_f32_16x16x32_bf16 v[108:111], a[184:187], v[132:135], v[108:111]
 s_waitcnt lgkmcnt(2)
 v_mfma_f32_16x16x32_bf16 v[88:91], a[28:31], v[136:139], v[88:91]
 ds_read_b128 v[120:123], v12 offset:18432
 v_mfma_f32_16x16x32_bf16 v[92:95], a[108:111], v[136:139], v[92:95]
 ds_read_b128 v[124:127], v12 offset:18688
 v_mfma_f32_16x16x32_bf16 v[96:99], a[188:191], v[136:139], v[96:99]
 v_mfma_f32_16x16x32_bf16 v[100:103], a[28:31], v[140:143], v[100:103]
 s_add_u32 m0, s30, 0
 s_add_u32 s89, s29, 0
 v_mfma_f32_16x16x32_bf16 v[104:107], a[108:111], v[140:143], v[104:107]
 buffer_load_dwordx4 v9, s[4:7], s89 offen offset:0 sc1 lds
 v_mfma_f32_16x16x32_bf16 v[108:111], a[188:191], v[140:143], v[108:111]
 s_waitcnt lgkmcnt(2)
 v_mfma_f32_16x16x32_bf16 v[88:91], a[32:35], v[112:115], v[88:91]
 ds_read_b128 v[128:131], v12 offset:20480
 v_mfma_f32_16x16x32_bf16 v[92:95], a[112:115], v[112:115], v[92:95]
 ds_read_b128 v[132:135], v12 offset:20736
 v_mfma_f32_16x16x32_bf16 v[96:99], a[192:195], v[112:115], v[96:99]
 v_mfma_f32_16x16x32_bf16 v[100:103], a[32:35], v[116:119], v[100:103]
 v_add_u32 v11, s37, v10
 v_mfma_f32_16x16x32_bf16 v[104:107], a[112:115], v[116:119], v[104:107]
 buffer_load_dwordx4 v9, s[4:7], s89 offen offset:1024 sc1 lds
 v_mfma_f32_16x16x32_bf16 v[108:111], a[192:195], v[116:119], v[108:111]
 s_waitcnt lgkmcnt(2)
 v_mfma_f32_16x16x32_bf16 v[88:91], a[36:39], v[120:123], v[88:91]
 ds_read_b128 v[136:139], v12 offset:22528
 v_mfma_f32_16x16x32_bf16 v[92:95], a[116:119], v[120:123], v[92:95]
 ds_read_b128 v[140:143], v12 offset:22784
 v_mfma_f32_16x16x32_bf16 v[96:99], a[196:199], v[120:123], v[96:99]
 v_mfma_f32_16x16x32_bf16 v[100:103], a[36:39], v[124:127], v[100:103]
 v_mfma_f32_16x16x32_bf16 v[104:107], a[116:119], v[124:127], v[104:107]
 buffer_load_dwordx4 v9, s[4:7], s89 offen offset:2048 sc1 lds
 v_mfma_f32_16x16x32_bf16 v[108:111], a[196:199], v[124:127], v[108:111]
 s_waitcnt lgkmcnt(2)
 v_mfma_f32_16x16x32_bf16 v[88:91], a[40:43], v[128:131], v[88:91]
 ds_read_b128 v[112:115], v12 offset:24576
 v_mfma_f32_16x16x32_bf16 v[92:95], a[120:123], v[128:131], v[92:95]
 ds_read_b128 v[116:119], v12 offset:24832
 v_mfma_f32_16x16x32_bf16 v[96:99], a[200:203], v[128:131], v[96:99]
 v_mfma_f32_16x16x32_bf16 v[100:103], a[40:43], v[132:135], v[100:103]
 v_mfma_f32_16x16x32_bf16 v[104:107], a[120:123], v[132:135], v[104:107]
 buffer_load_dwordx4 v9, s[4:7], s89 offen offset:3072 sc1 lds
 v_mfma_f32_16x16x32_bf16 v[108:111], a[200:203], v[132:135], v[108:111]
 s_waitcnt lgkmcnt(2)
 v_mfma_f32_16x16x32_bf16 v[88:91], a[44:47], v[136:139], v[88:91]
 ds_read_b128 v[120:123], v12 offset:26624
 v_mfma_f32_16x16x32_bf16 v[92:95], a[124:127], v[136:139], v[92:95]
 ds_read_b128 v[124:127], v12 offset:26880
 v_mfma_f32_16x16x32_bf16 v[96:99], a[204:207], v[136:139], v[96:99]
 v_mfma_f32_16x16x32_bf16 v[100:103], a[44:47], v[140:143], v[100:103]
 s_add_u32 m0, s30, 4096
 s_add_u32 s89, s29, 4096
 v_mfma_f32_16x16x32_bf16 v[104:107], a[124:127], v[140:143], v[104:107]
 buffer_load_dwordx4 v9, s[4:7], s89 offen offset:0 sc1 lds
 v_mfma_f32_16x16x32_bf16 v[108:111], a[204:207], v[140:143], v[108:111]
 s_waitcnt lgkmcnt(2)
 v_mfma_f32_16x16x32_bf16 v[88:91], a[48:51], v[112:115], v[88:91]
 ds_read_b128 v[128:131], v12 offset:28672
 v_mfma_f32_16x16x32_bf16 v[92:95], a[128:131], v[112:115], v[92:95]
 ds_read_b128 v[132:135], v12 offset:28928
 v_mfma_f32_16x16x32_bf16 v[96:99], a[208:211], v[112:115], v[96:99]
 v_mfma_f32_16x16x32_bf16 v[100:103], a[48:51], v[116:119], v[100:103]
 v_mfma_f32_16x16x32_bf16 v[104:107], a[128:131], v[116:119], v[104:107]
 buffer_load_dwordx4 v9, s[4:7], s89 offen offset:1024 sc1 lds
 v_mfma_f32_16x16x32_bf16 v[108:111], a[208:211], v[116:119], v[108:111]
 s_waitcnt lgkmcnt(2)
 v_mfma_f32_16x16x32_bf16 v[88:91], a[52:55], v[120:123], v[88:91]
 ds_read_b128 v[136:139], v12 offset:30720
 v_mfma_f32_16x16x32_bf16 v[92:95], a[132:135], v[120:123], v[92:95]
 ds_read_b128 v[140:143], v12 offset:30976
 v_mfma_f32_16x16x32_bf16 v[96:99], a[212:215], v[120:123], v[96:99]
 v_mfma_f32_16x16x32_bf16 v[100:103], a[52:55], v[124:127], v[100:103]
 v_mfma_f32_16x16x32_bf16 v[104:107], a[132:135], v[124:127], v[104:107]
 buffer_load_dwordx4 v9, s[4:7], s89 offen offset:2048 sc1 lds
 v_mfma_f32_16x16x32_bf16 v[108:111], a[212:215], v[124:127], v[108:111]
 s_waitcnt lgkmcnt(2)
 v_mfma_f32_16x16x32_bf16 v[88:91], a[56:59], v[128:131], v[88:91]
 ds_read_b128 v[112:115], v12 offset:32768
 v_mfma_f32_16x16x32_bf16 v[92:95], a[136:139], v[128:131], v[92:95]
 ds_read_b128 v[116:119], v12 offset:33024
 v_mfma_f32_16x16x32_bf16 v[96:99], a[216:219], v[128:131], v[96:99]
 v_mfma_f32_16x16x32_bf16 v[100:103], a[56:59], v[132:135], v[100:103]
 v_mfma_f32_16x16x32_bf16 v[104:107], a[136:139], v[132:135], v[104:107]
 buffer_load_dwordx4 v9, s[4:7], s89 offen offset:3072 sc1 lds
 v_mfma_f32_16x16x32_bf16 v[108:111], a[216:219], v[132:135], v[108:111]
 s_waitcnt lgkmcnt(2)
 v_mfma_f32_16x16x32_bf16 v[88:91], a[60:63], v[136:139], v[88:91]
 ds_read_b128 v[120:123], v12 offset:34816
 v_mfma_f32_16x16x32_bf16 v[92:95], a[140:143], v[136:139], v[92:95]
 ds_read_b128 v[124:127], v12 offset:35072
 v_mfma_f32_16x16x32_bf16 v[96:99], a[220:223], v[136:139], v[96:99]
 v_mfma_f32_16x16x32_bf16 v[100:103], a[60:63], v[140:143], v[100:103]
 s_add_u32 m0, s30, 8192
 s_add_u32 s89, s29, 8192
 v_mfma_f32_16x16x32_bf16 v[104:107], a[140:143], v[140:143], v[104:107]
 buffer_load_dwordx4 v9, s[4:7], s89 offen offset:0 sc1 lds
 v_mfma_f32_16x16x32_bf16 v[108:111], a[220:223], v[140:143], v[108:111]
 s_waitcnt lgkmcnt(2)
 v_mfma_f32_16x16x32_bf16 v[88:91], a[64:67], v[112:115], v[88:91]
 ds_read_b128 v[128:131], v12 offset:36864
 v_mfma_f32_16x16x32_bf16 v[92:95], a[144:147], v[112:115], v[92:95]
 ds_read_b128 v[132:135], v12 offset:37120
 v_mfma_f32_16x16x32_bf16 v[96:99], a[224:227], v[112:115], v[96:99]
 v_mfma_f32_16x16x32_bf16 v[100:103], a[64:67], v[116:119], v[100:103]
 v_mfma_f32_16x16x32_bf16 v[104:107], a[144:147], v[116:119], v[104:107]
 buffer_load_dwordx4 v9, s[4:7], s89 offen offset:1024 sc1 lds
 v_mfma_f32_16x16x32_bf16 v[108:111], a[224:227], v[116:119], v[108:111]
 s_waitcnt lgkmcnt(2)
 v_mfma_f32_16x16x32_bf16 v[88:91], a[68:71], v[120:123], v[88:91]
 ds_read_b128 v[136:139], v12 offset:38912
 v_mfma_f32_16x16x32_bf16 v[92:95], a[148:151], v[120:123], v[92:95]
 ds_read_b128 v[140:143], v12 offset:39168
 v_mfma_f32_16x16x32_bf16 v[96:99], a[228:231], v[120:123], v[96:99]
 v_mfma_f32_16x16x32_bf16 v[100:103], a[68:71], v[124:127], v[100:103]
 v_mfma_f32_16x16x32_bf16 v[104:107], a[148:151], v[124:127], v[104:107]
 v_mfma_f32_16x16x32_bf16 v[108:111], a[228:231], v[124:127], v[108:111]
 s_waitcnt lgkmcnt(2)
 v_mfma_f32_16x16x32_bf16 v[88:91], a[72:75], v[128:131], v[88:91]
 ds_read_b128 v[112:115], v11 offset:0
 v_mfma_f32_16x16x32_bf16 v[92:95], a[152:155], v[128:131], v[92:95]
 ds_read_b128 v[116:119], v11 offset:256
 v_mfma_f32_16x16x32_bf16 v[96:99], a[232:235], v[128:131], v[96:99]
 s_add_u32 s29, s29, 40960
 s_mov_b32 s30, s36
 s_mov_b32 s36, s37
 v_mfma_f32_16x16x32_bf16 v[100:103], a[72:75], v[132:135], v[100:103]
 s_mov_b32 s37, s38
 s_mov_b32 s38, s30
 s_add_u32 s31, s31, 1
 v_mfma_f32_16x16x32_bf16 v[104:107], a[152:155], v[132:135], v[104:107]
 v_mfma_f32_16x16x32_bf16 v[108:111], a[232:235], v[132:135], v[108:111]
 s_waitcnt lgkmcnt(2)
 v_mfma_f32_16x16x32_bf16 v[88:91], a[76:79], v[136:139], v[88:91]
 ds_read_b128 v[120:123], v11 offset:2048
 v_mfma_f32_16x16x32_bf16 v[92:95], a[156:159], v[136:139], v[92:95]
 ds_read_b128 v[124:127], v11 offset:2304
 v_mfma_f32_16x16x32_bf16 v[96:99], a[236:239], v[136:139], v[96:99]
 v_mfma_f32_16x16x32_bf16 v[100:103], a[76:79], v[140:143], v[100:103]
 v_mfma_f32_16x16x32_bf16 v[104:107], a[156:159], v[140:143], v[104:107]
 v_mfma_f32_16x16x32_bf16 v[108:111], a[236:239], v[140:143], v[108:111]
 s_cmp_lt_u32 s31, 64
 s_cbranch_scc1 wq_2049
 v_cvt_pk_bf16_f32 v144, v88, v89
 v_cvt_pk_bf16_f32 v145, v90, v91
 v_cvt_pk_bf16_f32 v146, v92, v93
 v_cvt_pk_bf16_f32 v147, v94, v95
 v_cvt_pk_bf16_f32 v148, v100, v101
 v_cvt_pk_bf16_f32 v149, v102, v103
 v_cvt_pk_bf16_f32 v150, v104, v105
 v_cvt_pk_bf16_f32 v151, v106, v107
 v_cvt_pk_bf16_f32 v152, v96, v97
 v_cvt_pk_bf16_f32 v153, v98, v99
 v_cvt_pk_bf16_f32 v154, v108, v109
 v_cvt_pk_bf16_f32 v155, v110, v111
 s_nop 0
 v_permlane16_swap_b32 v152, v154
 v_permlane16_swap_b32 v153, v155
 ds_write_b128 v14, v[144:147] offset:0
 ds_write_b128 v14, v[148:151] offset:256
 ds_write_b128 v15, v[152:155] offset:0
 s_waitcnt lgkmcnt(0)
 s_barrier
 s_branch g2_task
hsp_2037:
 s_mov_b32 s100, 0
hs_2054:
 s_min_u32 s92, s92, 48
 s_lshl_b32 s93, s92, 9
 buffer_load_dword v4, v13, s[4:7], s93 offen sc1
 s_add_u32 s100, s100, 1
 s_cmp_gt_u32 s100, 200000
 s_cbranch_scc1 main_fail
 s_waitcnt vmcnt(0)
 v_cmp_eq_u32 vcc, 0, v4
 s_nop 1
 s_ff1_i32_b64 s93, vcc
 s_min_u32 s93, s93, 64
 s_lshr_b32 s93, s93, 2
 s_add_u32 s92, s92, s93
 s_cmp_gt_u32 s92, s90
 s_cbranch_scc0 hs_2054
 s_branch hbk_2038
hsp_2044:
 s_mov_b32 s100, 0
hs_2055:
 s_min_u32 s92, s92, 48
 s_lshl_b32 s93, s92, 9
 buffer_load_dword v4, v13, s[4:7], s93 offen sc1
 s_add_u32 s100, s100, 1
 s_cmp_gt_u32 s100, 200000
 s_cbranch_scc1 main_fail
 s_waitcnt vmcnt(0)
 v_cmp_eq_u32 vcc, 0, v4
 s_nop 1
 s_ff1_i32_b64 s93, vcc
 s_min_u32 s93, s93, 64
 s_lshr_b32 s93, s93, 2
 s_add_u32 s92, s92, s93
 s_cmp_gt_u32 s92, s90
 s_cbranch_scc0 hs_2055
 s_branch hbk_2045
hsp_2050:
 s_mov_b32 s100, 0
hs_2056:
 s_min_u32 s92, s92, 48
 s_lshl_b32 s93, s92, 9
 buffer_load_dword v4, v13, s[4:7], s93 offen sc1
 s_add_u32 s100, s100, 1
 s_cmp_gt_u32 s100, 200000
 s_cbranch_scc1 main_fail
 s_waitcnt vmcnt(0)
 v_cmp_eq_u32 vcc, 0, v4
 s_nop 1
 s_ff1_i32_b64 s93, vcc
 s_min_u32 s93, s93, 64
 s_lshr_b32 s93, s93, 2
 s_add_u32 s92, s92, s93
 s_cmp_gt_u32 s92, s90
 s_cbranch_scc0 hs_2056
 s_branch hbk_2051
hsp_2052:
 s_mov_b32 s100, 0
hs_2057:
 s_min_u32 s92, s92, 48
 s_lshl_b32 s93, s92, 9
 buffer_load_dword v4, v13, s[4:7], s93 offen sc1
 s_add_u32 s100, s100, 1
 s_cmp_gt_u32 s100, 200000
 s_cbranch_scc1 main_fail
 s_waitcnt vmcnt(0)
 v_cmp_eq_u32 vcc, 0, v4
 s_nop 1
 s_ff1_i32_b64 s93, vcc
 s_min_u32 s93, s93, 64
 s_lshr_b32 s93, s93, 2
 s_add_u32 s92, s92, s93
 s_cmp_gt_u32 s92, s90
 s_cbranch_scc0 hs_2057
 s_branch hbk_2053
second:
 s_cmp_ge_u32 s17, 8
 s_cbranch_scc1 g1_2058
 s_cmp_ge_u32 s17, 4
 s_cbranch_scc1 zb_2059
 s_sub_u32 s22, s16, 4
 s_lshl_b32 s22, s22, 2
 s_add_u32 s22, s22, s17
 s_waitcnt vmcnt(0) lgkmcnt(0)
 s_barrier
l2_2061:
 s_lshl_b32 s25, s22, 7
 s_add_u32 s25, s25, s3
 s_add_u32 s25, s25, 32768
 s_cmp_lg_u32 s21, 0
 s_cbranch_scc1 lnw_2062
 s_mov_b32 s100, 0
ww_2063:
 s_cmp_eq_u32 s100, 0
 s_cbranch_scc1 w1_2065
 s_sleep 2
w1_2065:
 s_load_dwordx8 s[40:47], s[4:5], s25 glc
 s_add_u32 s100, s100, 1
 s_cmp_gt_u32 s100, 200000
 s_cbranch_scc1 main_fail
 s_waitcnt lgkmcnt(0)
 s_min_u32 s40, s40, s41
 s_min_u32 s40, s40, s42
 s_min_u32 s40, s40, s43
 s_min_u32 s40, s40, s44
 s_min_u32 s40, s40, s45
 s_min_u32 s40, s40, s46
 s_min_u32 s40, s40, s47
 s_cmp_gt_u32 s40, 0
 s_cbranch_scc0 ww_2063
wok_2064:
lnw_2062:
 s_barrier
 s_lshl_b32 s27, s22, 2
 s_add_u32 s25, s27, s3
 s_add_u32 s27, s27, s21
 s_mul_i32 s28, s21, 10496
 s_add_u32 s25, s25, 17408
 s_lshr_b32 s90, s27, 2
 s_mul_i32 s90, s90, 40960
 s_and_b32 s91, s27, 3
 s_lshl_b32 s91, s91, 7
 s_add_u32 s90, s90, s91
 v_bfe_u32 v255, v0, 3, 3
 v_lshlrev_b32 v2, 9, v255
 v_bfe_u32 v255, v0, 0, 3
 v_lshl_add_u32 v2, v255, 4, v2
 s_add_u32 s92, s90, 4718592
 buffer_load_dwordx4 v[16:19], v2, s[4:7], s92 offen sc1
 s_add_u32 s92, s92, 4096
 buffer_load_dwordx4 v[20:23], v2, s[4:7], s92 offen sc1
 s_add_u32 s92, s92, 4096
 buffer_load_dwordx4 v[24:27], v2, s[4:7], s92 offen sc1
 s_add_u32 s92, s92, 4096
 buffer_load_dwordx4 v[28:31], v2, s[4:7], s92 offen sc1
 s_add_u32 s92, s92, 4096
 buffer_load_dwordx4 v[32:35], v2, s[4:7], s92 offen sc1
 s_add_u32 s92, s92, 4096
 buffer_load_dwordx4 v[36:39], v2, s[4:7], s92 offen sc1
 s_add_u32 s92, s92, 4096
 buffer_load_dwordx4 v[40:43], v2, s[4:7], s92 offen sc1
 s_add_u32 s92, s92, 4096
 buffer_load_dwordx4 v[44:47], v2, s[4:7], s92 offen sc1
 s_add_u32 s92, s92, 4096
 buffer_load_dwordx4 v[48:51], v2, s[4:7], s92 offen sc1
 s_add_u32 s92, s92, 4096
 buffer_load_dwordx4 v[52:55], v2, s[4:7], s92 offen sc1
 s_mov_b32 s94, 0xffff0000
 s_waitcnt vmcnt(9)
 v_lshlrev_b32 v64, 16, v16
 v_and_b32 v65, s94, v16
 v_lshlrev_b32 v66, 16, v17
 v_and_b32 v67, s94, v17
 v_lshlrev_b32 v68, 16, v18
 v_and_b32 v69, s94, v18
 v_lshlrev_b32 v70, 16, v19
 v_and_b32 v71, s94, v19
 s_waitcnt vmcnt(8)
 v_lshlrev_b32 v72, 16, v20
 v_and_b32 v73, s94, v20
 v_lshlrev_b32 v74, 16, v21
 v_and_b32 v75, s94, v21
 v_lshlrev_b32 v76, 16, v22
 v_and_b32 v77, s94, v22
 v_lshlrev_b32 v78, 16, v23
 v_and_b32 v79, s94, v23
 s_waitcnt vmcnt(7)
 v_lshlrev_b32 v80, 16, v24
 v_and_b32 v81, s94, v24
 v_lshlrev_b32 v82, 16, v25
 v_and_b32 v83, s94, v25
 v_lshlrev_b32 v84, 16, v26
 v_and_b32 v85, s94, v26
 v_lshlrev_b32 v86, 16, v27
 v_and_b32 v87, s94, v27
 s_waitcnt vmcnt(6)
 v_lshlrev_b32 v88, 16, v28
 v_and_b32 v89, s94, v28
 v_lshlrev_b32 v90, 16, v29
 v_and_b32 v91, s94, v29
 v_lshlrev_b32 v92, 16, v30
 v_and_b32 v93, s94, v30
 v_lshlrev_b32 v94, 16, v31
 v_and_b32 v95, s94, v31
 s_waitcnt vmcnt(5)
 v_lshlrev_b32 v96, 16, v32
 v_and_b32 v97, s94, v32
 v_lshlrev_b32 v98, 16, v33
 v_and_b32 v99, s94, v33
 v_lshlrev_b32 v100, 16, v34
 v_and_b32 v101, s94, v34
 v_lshlrev_b32 v102, 16, v35
 v_and_b32 v103, s94, v35
 s_waitcnt vmcnt(4)
 v_lshlrev_b32 v104, 16, v36
 v_and_b32 v105, s94, v36
 v_lshlrev_b32 v106, 16, v37
 v_and_b32 v107, s94, v37
 v_lshlrev_b32 v108, 16, v38
 v_and_b32 v109, s94, v38
 v_lshlrev_b32 v110, 16, v39
 v_and_b32 v111, s94, v39
 s_waitcnt vmcnt(3)
 v_lshlrev_b32 v112, 16, v40
 v_and_b32 v113, s94, v40
 v_lshlrev_b32 v114, 16, v41
 v_and_b32 v115, s94, v41
 v_lshlrev_b32 v116, 16, v42
 v_and_b32 v117, s94, v42
 v_lshlrev_b32 v118, 16, v43
 v_and_b32 v119, s94, v43
 s_waitcnt vmcnt(2)
 v_lshlrev_b32 v120, 16, v44
 v_and_b32 v121, s94, v44
 v_lshlrev_b32 v122, 16, v45
 v_and_b32 v123, s94, v45
 v_lshlrev_b32 v124, 16, v46
 v_and_b32 v125, s94, v46
 v_lshlrev_b32 v126, 16, v47
 v_and_b32 v127, s94, v47
 s_waitcnt vmcnt(1)
 v_lshlrev_b32 v128, 16, v48
 v_and_b32 v129, s94, v48
 v_lshlrev_b32 v130, 16, v49
 v_and_b32 v131, s94, v49
 v_lshlrev_b32 v132, 16, v50
 v_and_b32 v133, s94, v50
 v_lshlrev_b32 v134, 16, v51
 v_and_b32 v135, s94, v51
 s_waitcnt vmcnt(0)
 v_lshlrev_b32 v136, 16, v52
 v_and_b32 v137, s94, v52
 v_lshlrev_b32 v138, 16, v53
 v_and_b32 v139, s94, v53
 v_lshlrev_b32 v140, 16, v54
 v_and_b32 v141, s94, v54
 v_lshlrev_b32 v142, 16, v55
 v_and_b32 v143, s94, v55
 v_pk_add_f32 v[4:5], v[64:65], v[66:67]
 v_pk_add_f32 v[6:7], v[68:69], v[70:71]
 v_pk_add_f32 v[4:5], v[4:5], v[72:73]
 v_pk_add_f32 v[6:7], v[6:7], v[74:75]
 v_pk_add_f32 v[4:5], v[4:5], v[76:77]
 v_pk_add_f32 v[6:7], v[6:7], v[78:79]
 v_pk_add_f32 v[4:5], v[4:5], v[80:81]
 v_pk_add_f32 v[6:7], v[6:7], v[82:83]
 v_pk_add_f32 v[4:5], v[4:5], v[84:85]
 v_pk_add_f32 v[6:7], v[6:7], v[86:87]
 v_pk_add_f32 v[4:5], v[4:5], v[88:89]
 v_pk_add_f32 v[6:7], v[6:7], v[90:91]
 v_pk_add_f32 v[4:5], v[4:5], v[92:93]
 v_pk_add_f32 v[6:7], v[6:7], v[94:95]
 v_pk_add_f32 v[4:5], v[4:5], v[96:97]
 v_pk_add_f32 v[6:7], v[6:7], v[98:99]
 v_pk_add_f32 v[4:5], v[4:5], v[100:101]
 v_pk_add_f32 v[6:7], v[6:7], v[102:103]
 v_pk_add_f32 v[4:5], v[4:5], v[104:105]
 v_pk_add_f32 v[6:7], v[6:7], v[106:107]
 v_pk_add_f32 v[4:5], v[4:5], v[108:109]
 v_pk_add_f32 v[6:7], v[6:7], v[110:111]
 v_pk_add_f32 v[4:5], v[4:5], v[112:113]
 v_pk_add_f32 v[6:7], v[6:7], v[114:115]
 v_pk_add_f32 v[4:5], v[4:5], v[116:117]
 v_pk_add_f32 v[6:7], v[6:7], v[118:119]
 v_pk_add_f32 v[4:5], v[4:5], v[120:121]
 v_pk_add_f32 v[6:7], v[6:7], v[122:123]
 v_pk_add_f32 v[4:5], v[4:5], v[124:125]
 v_pk_add_f32 v[6:7], v[6:7], v[126:127]
 v_pk_add_f32 v[4:5], v[4:5], v[128:129]
 v_pk_add_f32 v[6:7], v[6:7], v[130:131]
 v_pk_add_f32 v[4:5], v[4:5], v[132:133]
 v_pk_add_f32 v[6:7], v[6:7], v[134:135]
 v_pk_add_f32 v[4:5], v[4:5], v[136:137]
 v_pk_add_f32 v[6:7], v[6:7], v[138:139]
 v_pk_add_f32 v[4:5], v[4:5], v[140:141]
 v_pk_add_f32 v[6:7], v[6:7], v[142:143]
 v_pk_add_f32 v[4:5], v[4:5], v[6:7]
 v_add_f32 v4, v4, v5
 s_nop 1
 v_add_f32_dpp v4, v4, v4 row_ror:8 row_mask:0xf bank_mask:0xf
 v_mov_b32 v8, v4
 s_nop 1
 v_permlane16_swap_b32 v8, v4
 v_add_f32 v4, v4, v8
 v_mov_b32 v8, v4
 s_nop 1
 v_permlane32_swap_b32 v8, v4
 v_add_f32 v4, v4, v8
 v_mul_f32 v4, 0xbacccccd, v4
 v_mov_b32 v5, v4
 v_pk_add_f32 v[64:65], v[64:65], v[4:5]
 v_pk_add_f32 v[66:67], v[66:67], v[4:5]
 v_pk_add_f32 v[68:69], v[68:69], v[4:5]
 v_pk_add_f32 v[70:71], v[70:71], v[4:5]
 v_pk_add_f32 v[72:73], v[72:73], v[4:5]
 v_pk_add_f32 v[74:75], v[74:75], v[4:5]
 v_pk_add_f32 v[76:77], v[76:77], v[4:5]
 v_pk_add_f32 v[78:79], v[78:79], v[4:5]
 v_pk_add_f32 v[80:81], v[80:81], v[4:5]
 v_pk_add_f32 v[82:83], v[82:83], v[4:5]
 v_pk_add_f32 v[84:85], v[84:85], v[4:5]
 v_pk_add_f32 v[86:87], v[86:87], v[4:5]
 v_pk_add_f32 v[88:89], v[88:89], v[4:5]
 v_pk_add_f32 v[90:91], v[90:91], v[4:5]
 v_pk_add_f32 v[92:93], v[92:93], v[4:5]
 v_pk_add_f32 v[94:95], v[94:95], v[4:5]
 v_pk_add_f32 v[96:97], v[96:97], v[4:5]
 v_pk_add_f32 v[98:99], v[98:99], v[4:5]
 v_pk_add_f32 v[100:101], v[100:101], v[4:5]
 v_pk_add_f32 v[102:103], v[102:103], v[4:5]
 v_pk_add_f32 v[104:105], v[104:105], v[4:5]
 v_pk_add_f32 v[106:107], v[106:107], v[4:5]
 v_pk_add_f32 v[108:109], v[108:109], v[4:5]
 v_pk_add_f32 v[110:111], v[110:111], v[4:5]
 v_pk_add_f32 v[112:113], v[112:113], v[4:5]
 v_pk_add_f32 v[114:115], v[114:115], v[4:5]
 v_pk_add_f32 v[116:117], v[116:117], v[4:5]
 v_pk_add_f32 v[118:119], v[118:119], v[4:5]
 v_pk_add_f32 v[120:121], v[120:121], v[4:5]
 v_pk_add_f32 v[122:123], v[122:123], v[4:5]
 v_pk_add_f32 v[124:125], v[124:125], v[4:5]
 v_pk_add_f32 v[126:127], v[126:127], v[4:5]
 v_pk_add_f32 v[128:129], v[128:129], v[4:5]
 v_pk_add_f32 v[130:131], v[130:131], v[4:5]
 v_pk_add_f32 v[132:133], v[132:133], v[4:5]
 v_pk_add_f32 v[134:135], v[134:135], v[4:5]
 v_pk_add_f32 v[136:137], v[136:137], v[4:5]
 v_pk_add_f32 v[138:139], v[138:139], v[4:5]
 v_pk_add_f32 v[140:141], v[140:141], v[4:5]
 v_pk_add_f32 v[142:143], v[142:143], v[4:5]
 v_pk_mul_f32 v[6:7], v[64:65], v[64:65]
 v_pk_mul_f32 v[10:11], v[66:67], v[66:67]
 v_pk_fma_f32 v[6:7], v[68:69], v[68:69], v[6:7]
 v_pk_fma_f32 v[10:11], v[70:71], v[70:71], v[10:11]
 v_pk_fma_f32 v[6:7], v[72:73], v[72:73], v[6:7]
 v_pk_fma_f32 v[10:11], v[74:75], v[74:75], v[10:11]
 v_pk_fma_f32 v[6:7], v[76:77], v[76:77], v[6:7]
 v_pk_fma_f32 v[10:11], v[78:79], v[78:79], v[10:11]
 v_pk_fma_f32 v[6:7], v[80:81], v[80:81], v[6:7]
 v_pk_fma_f32 v[10:11], v[82:83], v[82:83], v[10:11]
 v_pk_fma_f32 v[6:7], v[84:85], v[84:85], v[6:7]
 v_pk_fma_f32 v[10:11], v[86:87], v[86:87], v[10:11]
 v_pk_fma_f32 v[6:7], v[88:89], v[88:89], v[6:7]
 v_pk_fma_f32 v[10:11], v[90:91], v[90:91], v[10:11]
 v_pk_fma_f32 v[6:7], v[92:93], v[92:93], v[6:7]
 v_pk_fma_f32 v[10:11], v[94:95], v[94:95], v[10:11]
 v_pk_fma_f32 v[6:7], v[96:97], v[96:97], v[6:7]
 v_pk_fma_f32 v[10:11], v[98:99], v[98:99], v[10:11]
 v_pk_fma_f32 v[6:7], v[100:101], v[100:101], v[6:7]
 v_pk_fma_f32 v[10:11], v[102:103], v[102:103], v[10:11]
 v_pk_fma_f32 v[6:7], v[104:105], v[104:105], v[6:7]
 v_pk_fma_f32 v[10:11], v[106:107], v[106:107], v[10:11]
 v_pk_fma_f32 v[6:7], v[108:109], v[108:109], v[6:7]
 v_pk_fma_f32 v[10:11], v[110:111], v[110:111], v[10:11]
 v_pk_fma_f32 v[6:7], v[112:113], v[112:113], v[6:7]
 v_pk_fma_f32 v[10:11], v[114:115], v[114:115], v[10:11]
 v_pk_fma_f32 v[6:7], v[116:117], v[116:117], v[6:7]
 v_pk_fma_f32 v[10:11], v[118:119], v[118:119], v[10:11]
 v_pk_fma_f32 v[6:7], v[120:121], v[120:121], v[6:7]
 v_pk_fma_f32 v[10:11], v[122:123], v[122:123], v[10:11]
 v_pk_fma_f32 v[6:7], v[124:125], v[124:125], v[6:7]
 v_pk_fma_f32 v[10:11], v[126:127], v[126:127], v[10:11]
 v_pk_fma_f32 v[6:7], v[128:129], v[128:129], v[6:7]
 v_pk_fma_f32 v[10:11], v[130:131], v[130:131], v[10:11]
 v_pk_fma_f32 v[6:7], v[132:133], v[132:133], v[6:7]
 v_pk_fma_f32 v[10:11], v[134:135], v[134:135], v[10:11]
 v_pk_fma_f32 v[6:7], v[136:137], v[136:137], v[6:7]
 v_pk_fma_f32 v[10:11], v[138:139], v[138:139], v[10:11]
 v_pk_fma_f32 v[6:7], v[140:141], v[140:141], v[6:7]
 v_pk_fma_f32 v[10:11], v[142:143], v[142:143], v[10:11]
 v_pk_add_f32 v[6:7], v[6:7], v[10:11]
 v_add_f32 v6, v6, v7
 s_nop 1
 v_add_f32_dpp v6, v6, v6 row_ror:8 row_mask:0xf bank_mask:0xf
 v_mov_b32 v8, v6
 s_nop 1
 v_permlane16_swap_b32 v8, v6
 v_add_f32 v6, v6, v8
 v_mov_b32 v8, v6
 s_nop 1
 v_permlane32_swap_b32 v8, v6
 v_add_f32 v6, v6, v8
 v_mul_f32 v6, 0x3acccccd, v6
 v_add_f32 v7, 0x3727c5ac, v6
 v_rsq_f32 v4, v7
 s_nop 0
 v_mul_f32 v6, v6, v4
 v_mul_f32 v6, v6, v4
 v_add_f32 v6, 0x3727c5ac, v6
 v_rsq_f32 v6, v6
 s_nop 0
 v_mul_f32 v4, v4, v6
 v_mov_b32 v5, v4
 v_pk_mul_f32 v[64:65], v[64:65], v[4:5]
 v_cvt_pk_bf16_f32 v144, v64, v65
 v_pk_mul_f32 v[66:67], v[66:67], v[4:5]
 v_cvt_pk_bf16_f32 v145, v66, v67
 v_pk_mul_f32 v[68:69], v[68:69], v[4:5]
 v_cvt_pk_bf16_f32 v146, v68, v69
 v_pk_mul_f32 v[70:71], v[70:71], v[4:5]
 v_cvt_pk_bf16_f32 v147, v70, v71
 v_pk_mul_f32 v[72:73], v[72:73], v[4:5]
 v_cvt_pk_bf16_f32 v148, v72, v73
 v_pk_mul_f32 v[74:75], v[74:75], v[4:5]
 v_cvt_pk_bf16_f32 v149, v74, v75
 v_pk_mul_f32 v[76:77], v[76:77], v[4:5]
 v_cvt_pk_bf16_f32 v150, v76, v77
 v_pk_mul_f32 v[78:79], v[78:79], v[4:5]
 v_cvt_pk_bf16_f32 v151, v78, v79
 v_pk_mul_f32 v[80:81], v[80:81], v[4:5]
 v_cvt_pk_bf16_f32 v152, v80, v81
 v_pk_mul_f32 v[82:83], v[82:83], v[4:5]
 v_cvt_pk_bf16_f32 v153, v82, v83
 v_pk_mul_f32 v[84:85], v[84:85], v[4:5]
 v_cvt_pk_bf16_f32 v154, v84, v85
 v_pk_mul_f32 v[86:87], v[86:87], v[4:5]
 v_cvt_pk_bf16_f32 v155, v86, v87
 v_pk_mul_f32 v[88:89], v[88:89], v[4:5]
 v_cvt_pk_bf16_f32 v156, v88, v89
 v_pk_mul_f32 v[90:91], v[90:91], v[4:5]
 v_cvt_pk_bf16_f32 v157, v90, v91
 v_pk_mul_f32 v[92:93], v[92:93], v[4:5]
 v_cvt_pk_bf16_f32 v158, v92, v93
 v_pk_mul_f32 v[94:95], v[94:95], v[4:5]
 v_cvt_pk_bf16_f32 v159, v94, v95
 v_pk_mul_f32 v[96:97], v[96:97], v[4:5]
 v_cvt_pk_bf16_f32 v160, v96, v97
 v_pk_mul_f32 v[98:99], v[98:99], v[4:5]
 v_cvt_pk_bf16_f32 v161, v98, v99
 v_pk_mul_f32 v[100:101], v[100:101], v[4:5]
 v_cvt_pk_bf16_f32 v162, v100, v101
 v_pk_mul_f32 v[102:103], v[102:103], v[4:5]
 v_cvt_pk_bf16_f32 v163, v102, v103
 v_pk_mul_f32 v[104:105], v[104:105], v[4:5]
 v_cvt_pk_bf16_f32 v164, v104, v105
 v_pk_mul_f32 v[106:107], v[106:107], v[4:5]
 v_cvt_pk_bf16_f32 v165, v106, v107
 v_pk_mul_f32 v[108:109], v[108:109], v[4:5]
 v_cvt_pk_bf16_f32 v166, v108, v109
 v_pk_mul_f32 v[110:111], v[110:111], v[4:5]
 v_cvt_pk_bf16_f32 v167, v110, v111
 v_pk_mul_f32 v[112:113], v[112:113], v[4:5]
 v_cvt_pk_bf16_f32 v168, v112, v113
 v_pk_mul_f32 v[114:115], v[114:115], v[4:5]
 v_cvt_pk_bf16_f32 v169, v114, v115
 v_pk_mul_f32 v[116:117], v[116:117], v[4:5]
 v_cvt_pk_bf16_f32 v170, v116, v117
 v_pk_mul_f32 v[118:119], v[118:119], v[4:5]
 v_cvt_pk_bf16_f32 v171, v118, v119
 v_pk_mul_f32 v[120:121], v[120:121], v[4:5]
 v_cvt_pk_bf16_f32 v172, v120, v121
 v_pk_mul_f32 v[122:123], v[122:123], v[4:5]
 v_cvt_pk_bf16_f32 v173, v122, v123
 v_pk_mul_f32 v[124:125], v[124:125], v[4:5]
 v_cvt_pk_bf16_f32 v174, v124, v125
 v_pk_mul_f32 v[126:127], v[126:127], v[4:5]
 v_cvt_pk_bf16_f32 v175, v126, v127
 v_pk_mul_f32 v[128:129], v[128:129], v[4:5]
 v_cvt_pk_bf16_f32 v176, v128, v129
 v_pk_mul_f32 v[130:131], v[130:131], v[4:5]
 v_cvt_pk_bf16_f32 v177, v130, v131
 v_pk_mul_f32 v[132:133], v[132:133], v[4:5]
 v_cvt_pk_bf16_f32 v178, v132, v133
 v_pk_mul_f32 v[134:135], v[134:135], v[4:5]
 v_cvt_pk_bf16_f32 v179, v134, v135
 v_pk_mul_f32 v[136:137], v[136:137], v[4:5]
 v_cvt_pk_bf16_f32 v180, v136, v137
 v_pk_mul_f32 v[138:139], v[138:139], v[4:5]
 v_cvt_pk_bf16_f32 v181, v138, v139
 v_pk_mul_f32 v[140:141], v[140:141], v[4:5]
 v_cvt_pk_bf16_f32 v182, v140, v141
 v_pk_mul_f32 v[142:143], v[142:143], v[4:5]
 v_cvt_pk_bf16_f32 v183, v142, v143
 v_bfe_u32 v255, v0, 0, 6
 v_lshlrev_b32 v3, 4, v255
 s_mul_i32 s92, s27, 10240
 s_add_u32 s92, s92, 9961472
 v_mov_b32 v12, s28
 v_bfe_u32 v255, v0, 0, 3
 s_mov_b32 s101, 1296
 v_mad_u32_u24 v12, v255, s101, v12
 v_bfe_u32 v255, v0, 3, 3
 v_lshl_add_u32 v12, v255, 4, v12
 v_mov_b32 v13, s28
 v_bfe_u32 v255, v0, 2, 2
 s_mov_b32 s101, 1296
 v_mad_u32_u24 v13, v255, s101, v13
 v_bfe_u32 v255, v0, 4, 2
 v_lshl_add_u32 v13, v255, 5, v13
 v_bfe_u32 v255, v0, 0, 2
 v_lshl_add_u32 v13, v255, 3, v13
 ds_write_b128 v12, v[144:147] offset:0
 ds_write_b128 v12, v[148:151] offset:128
 ds_write_b128 v12, v[152:155] offset:256
 ds_write_b128 v12, v[156:159] offset:384
 ds_write_b128 v12, v[160:163] offset:512
 ds_write_b128 v12, v[164:167] offset:640
 ds_write_b128 v12, v[168:171] offset:768
 ds_write_b128 v12, v[172:175] offset:896
 ds_write_b128 v12, v[176:179] offset:1024
 ds_write_b128 v12, v[180:183] offset:1152
 s_waitcnt lgkmcnt(0)
 ds_read_b64_tr_b16 v[64:65], v13 offset:0
 ds_read_b64_tr_b16 v[66:67], v13 offset:5184
 ds_read_b64_tr_b16 v[68:69], v13 offset:128
 ds_read_b64_tr_b16 v[70:71], v13 offset:5312
 ds_read_b64_tr_b16 v[72:73], v13 offset:256
 ds_read_b64_tr_b16 v[74:75], v13 offset:5440
 ds_read_b64_tr_b16 v[76:77], v13 offset:384
 ds_read_b64_tr_b16 v[78:79], v13 offset:5568
 s_waitcnt lgkmcnt(6)
 buffer_store_dwordx4 v[64:67], v3, s[4:7], s92 offen offset:0 sc1
 ds_read_b64_tr_b16 v[80:81], v13 offset:512
 ds_read_b64_tr_b16 v[82:83], v13 offset:5696
 s_waitcnt lgkmcnt(6)
 buffer_store_dwordx4 v[68:71], v3, s[4:7], s92 offen offset:1024 sc1
 ds_read_b64_tr_b16 v[84:85], v13 offset:640
 ds_read_b64_tr_b16 v[86:87], v13 offset:5824
 s_waitcnt lgkmcnt(6)
 buffer_store_dwordx4 v[72:75], v3, s[4:7], s92 offen offset:2048 sc1
 ds_read_b64_tr_b16 v[88:89], v13 offset:768
 ds_read_b64_tr_b16 v[90:91], v13 offset:5952
 s_waitcnt lgkmcnt(6)
 buffer_store_dwordx4 v[76:79], v3, s[4:7], s92 offen offset:3072 sc1
 s_add_u32 s92, s92, 4096
 ds_read_b64_tr_b16 v[92:93], v13 offset:896
 ds_read_b64_tr_b16 v[94:95], v13 offset:6080
 s_waitcnt lgkmcnt(6)
 buffer_store_dwordx4 v[80:83], v3, s[4:7], s92 offen offset:0 sc1
 ds_read_b64_tr_b16 v[96:97], v13 offset:1024
 ds_read_b64_tr_b16 v[98:99], v13 offset:6208
 s_waitcnt lgkmcnt(6)
 buffer_store_dwordx4 v[84:87], v3, s[4:7], s92 offen offset:1024 sc1
 ds_read_b64_tr_b16 v[100:101], v13 offset:1152
 ds_read_b64_tr_b16 v[102:103], v13 offset:6336
 s_waitcnt lgkmcnt(6)
 buffer_store_dwordx4 v[88:91], v3, s[4:7], s92 offen offset:2048 sc1
 s_waitcnt lgkmcnt(4)
 buffer_store_dwordx4 v[92:95], v3, s[4:7], s92 offen offset:3072 sc1
 s_add_u32 s92, s92, 4096
 s_waitcnt lgkmcnt(2)
 buffer_store_dwordx4 v[96:99], v3, s[4:7], s92 offen offset:0 sc1
 s_waitcnt lgkmcnt(0)
 buffer_store_dwordx4 v[100:103], v3, s[4:7], s92 offen offset:1024 sc1
 v_mov_b32 v2, 0x80000000
 v_mov_b32 v255, s25
 v_cmp_eq_u32 vcc, 0, v0
 s_nop 1
 v_cndmask_b32 v2, v2, v255, vcc
 v_mov_b32 v3, 1
 s_waitcnt vmcnt(0)
 s_barrier
 buffer_store_dword v3, v2, s[4:7], 0 offen sc1
 s_add_u32 s22, s22, 16
 s_cmp_lt_u32 s22, 64
 s_cbranch_scc1 l2_2061
 s_branch g2_task
g1_2058:
 s_cmp_lg_u32 s98, 0
 s_cbranch_scc1 nwt_2060
 s_load_dwordx2 s[8:9], s[0:1], 64
 s_mov_b32 s10, 6291456
 s_mov_b32 s11, 0x20000
 s_load_dwordx2 s[12:13], s[0:1], 80
 s_mov_b32 s14, 6291456
 s_mov_b32 s15, 0x20000
 s_lshl_b32 s22, s20, 2
 s_add_u32 s22, s22, s21
 s_mul_i32 s23, s21, 16384
 s_waitcnt vmcnt(0) lgkmcnt(0)
 s_barrier
 s_cmp_eq_u32 s85, 3
 s_cbranch_scc1 w2_2067
w1_2066:
 s_mul_hi_u32 s90, s22, 0x55555556
 s_mul_i32 s91, s90, 3
 s_sub_u32 s91, s22, s91
 s_mul_i32 s90, s90, 24576
 s_lshl_b32 s92, s91, 10
 s_add_u32 s92, s92, s90
 s_lshl_b32 s93, s91, 13
 s_add_u32 s93, s93, s90
 s_add_u32 s93, s93, 14548992
 v_bfe_u32 v255, v0, 0, 3
 v_mul_u32_u24 v3, 3072, v255
 v_bfe_u32 v255, v0, 3, 3
 v_lshl_add_u32 v3, v255, 4, v3
 buffer_load_dwordx4 v[16:19], v3, s[8:11], s92 offen offset:0
 buffer_load_dwordx4 v[20:23], v3, s[8:11], s92 offen offset:128
 buffer_load_dwordx4 v[24:27], v3, s[8:11], s92 offen offset:256
 buffer_load_dwordx4 v[28:31], v3, s[8:11], s92 offen offset:384
 buffer_load_dwordx4 v[32:35], v3, s[8:11], s92 offen offset:512
 buffer_load_dwordx4 v[36:39], v3, s[8:11], s92 offen offset:640
 buffer_load_dwordx4 v[40:43], v3, s[8:11], s92 offen offset:768
 buffer_load_dwordx4 v[44:47], v3, s[8:11], s92 offen offset:896
 v_bfe_u32 v255, v0, 0, 6
 v_lshlrev_b32 v3, 4, v255
 s_waitcnt vmcnt(0)
 v_mov_b32 v12, s23
 v_bfe_u32 v255, v0, 0, 3
 s_mov_b32 s101, 1040
 v_mad_u32_u24 v12, v255, s101, v12
 v_bfe_u32 v255, v0, 3, 3
 v_lshl_add_u32 v12, v255, 4, v12
 v_mov_b32 v13, s23
 v_bfe_u32 v255, v0, 2, 2
 s_mov_b32 s101, 1040
 v_mad_u32_u24 v13, v255, s101, v13
 v_bfe_u32 v255, v0, 4, 2
 v_lshl_add_u32 v13, v255, 5, v13
 v_bfe_u32 v255, v0, 0, 2
 v_lshl_add_u32 v13, v255, 3, v13
 ds_write_b128 v12, v[16:19] offset:0
 ds_write_b128 v12, v[20:23] offset:128
 ds_write_b128 v12, v[24:27] offset:256
 ds_write_b128 v12, v[28:31] offset:384
 ds_write_b128 v12, v[32:35] offset:512
 ds_write_b128 v12, v[36:39] offset:640
 ds_write_b128 v12, v[40:43] offset:768
 ds_write_b128 v12, v[44:47] offset:896
 s_waitcnt lgkmcnt(0)
 ds_read_b64_tr_b16 v[64:65], v13 offset:0
 ds_read_b64_tr_b16 v[66:67], v13 offset:4160
 ds_read_b64_tr_b16 v[68:69], v13 offset:128
 ds_read_b64_tr_b16 v[70:71], v13 offset:4288
 ds_read_b64_tr_b16 v[72:73], v13 offset:256
 ds_read_b64_tr_b16 v[74:75], v13 offset:4416
 ds_read_b64_tr_b16 v[76:77], v13 offset:384
 ds_read_b64_tr_b16 v[78:79], v13 offset:4544
 s_waitcnt lgkmcnt(6)
 buffer_store_dwordx4 v[64:67], v3, s[4:7], s93 offen offset:0 sc1
 ds_read_b64_tr_b16 v[80:81], v13 offset:512
 ds_read_b64_tr_b16 v[82:83], v13 offset:4672
 s_waitcnt lgkmcnt(6)
 buffer_store_dwordx4 v[68:71], v3, s[4:7], s93 offen offset:1024 sc1
 ds_read_b64_tr_b16 v[84:85], v13 offset:640
 ds_read_b64_tr_b16 v[86:87], v13 offset:4800
 s_waitcnt lgkmcnt(6)
 buffer_store_dwordx4 v[72:75], v3, s[4:7], s93 offen offset:2048 sc1
 ds_read_b64_tr_b16 v[88:89], v13 offset:768
 ds_read_b64_tr_b16 v[90:91], v13 offset:4928
 s_waitcnt lgkmcnt(6)
 buffer_store_dwordx4 v[76:79], v3, s[4:7], s93 offen offset:3072 sc1
 s_add_u32 s93, s93, 4096
 ds_read_b64_tr_b16 v[92:93], v13 offset:896
 ds_read_b64_tr_b16 v[94:95], v13 offset:5056
 s_waitcnt lgkmcnt(6)
 buffer_store_dwordx4 v[80:83], v3, s[4:7], s93 offen offset:0 sc1
 s_waitcnt lgkmcnt(4)
 buffer_store_dwordx4 v[84:87], v3, s[4:7], s93 offen offset:1024 sc1
 s_waitcnt lgkmcnt(2)
 buffer_store_dwordx4 v[88:91], v3, s[4:7], s93 offen offset:2048 sc1
 s_waitcnt lgkmcnt(0)
 buffer_store_dwordx4 v[92:95], v3, s[4:7], s93 offen offset:3072 sc1
 s_add_u32 s93, s93, 4096
 s_add_u32 s22, s22, 128
 s_cmp_lt_u32 s22, 768
 s_cbranch_scc1 w1_2066
 s_branch wd_2068
w2_2067:
 s_lshr_b32 s90, s22, 2
 s_and_b32 s91, s22, 3
 s_mul_i32 s90, s90, 32768
 s_lshl_b32 s92, s91, 10
 s_add_u32 s92, s92, s90
 s_lshl_b32 s93, s91, 13
 s_add_u32 s93, s93, s90
 s_add_u32 s93, s93, 20840448
 v_bfe_u32 v255, v0, 0, 3
 v_lshlrev_b32 v3, 12, v255
 v_bfe_u32 v255, v0, 3, 3
 v_lshl_add_u32 v3, v255, 4, v3
 buffer_load_dwordx4 v[16:19], v3, s[12:15], s92 offen offset:0
 buffer_load_dwordx4 v[20:23], v3, s[12:15], s92 offen offset:128
 buffer_load_dwordx4 v[24:27], v3, s[12:15], s92 offen offset:256
 buffer_load_dwordx4 v[28:31], v3, s[12:15], s92 offen offset:384
 buffer_load_dwordx4 v[32:35], v3, s[12:15], s92 offen offset:512
 buffer_load_dwordx4 v[36:39], v3, s[12:15], s92 offen offset:640
 buffer_load_dwordx4 v[40:43], v3, s[12:15], s92 offen offset:768
 buffer_load_dwordx4 v[44:47], v3, s[12:15], s92 offen offset:896
 v_bfe_u32 v255, v0, 0, 6
 v_lshlrev_b32 v3, 4, v255
 s_waitcnt vmcnt(0)
 v_mov_b32 v12, s23
 v_bfe_u32 v255, v0, 0, 3
 s_mov_b32 s101, 1040
 v_mad_u32_u24 v12, v255, s101, v12
 v_bfe_u32 v255, v0, 3, 3
 v_lshl_add_u32 v12, v255, 4, v12
 v_mov_b32 v13, s23
 v_bfe_u32 v255, v0, 2, 2
 s_mov_b32 s101, 1040
 v_mad_u32_u24 v13, v255, s101, v13
 v_bfe_u32 v255, v0, 4, 2
 v_lshl_add_u32 v13, v255, 5, v13
 v_bfe_u32 v255, v0, 0, 2
 v_lshl_add_u32 v13, v255, 3, v13
 ds_write_b128 v12, v[16:19] offset:0
 ds_write_b128 v12, v[20:23] offset:128
 ds_write_b128 v12, v[24:27] offset:256
 ds_write_b128 v12, v[28:31] offset:384
 ds_write_b128 v12, v[32:35] offset:512
 ds_write_b128 v12, v[36:39] offset:640
 ds_write_b128 v12, v[40:43] offset:768
 ds_write_b128 v12, v[44:47] offset:896
 s_waitcnt lgkmcnt(0)
 ds_read_b64_tr_b16 v[64:65], v13 offset:0
 ds_read_b64_tr_b16 v[66:67], v13 offset:4160
 ds_read_b64_tr_b16 v[68:69], v13 offset:128
 ds_read_b64_tr_b16 v[70:71], v13 offset:4288
 ds_read_b64_tr_b16 v[72:73], v13 offset:256
 ds_read_b64_tr_b16 v[74:75], v13 offset:4416
 ds_read_b64_tr_b16 v[76:77], v13 offset:384
 ds_read_b64_tr_b16 v[78:79], v13 offset:4544
 s_waitcnt lgkmcnt(6)
 buffer_store_dwordx4 v[64:67], v3, s[4:7], s93 offen offset:0 sc1
 ds_read_b64_tr_b16 v[80:81], v13 offset:512
 ds_read_b64_tr_b16 v[82:83], v13 offset:4672
 s_waitcnt lgkmcnt(6)
 buffer_store_dwordx4 v[68:71], v3, s[4:7], s93 offen offset:1024 sc1
 ds_read_b64_tr_b16 v[84:85], v13 offset:640
 ds_read_b64_tr_b16 v[86:87], v13 offset:4800
 s_waitcnt lgkmcnt(6)
 buffer_store_dwordx4 v[72:75], v3, s[4:7], s93 offen offset:2048 sc1
 ds_read_b64_tr_b16 v[88:89], v13 offset:768
 ds_read_b64_tr_b16 v[90:91], v13 offset:4928
 s_waitcnt lgkmcnt(6)
 buffer_store_dwordx4 v[76:79], v3, s[4:7], s93 offen offset:3072 sc1
 s_add_u32 s93, s93, 4096
 ds_read_b64_tr_b16 v[92:93], v13 offset:896
 ds_read_b64_tr_b16 v[94:95], v13 offset:5056
 s_waitcnt lgkmcnt(6)
 buffer_store_dwordx4 v[80:83], v3, s[4:7], s93 offen offset:0 sc1
 s_waitcnt lgkmcnt(4)
 buffer_store_dwordx4 v[84:87], v3, s[4:7], s93 offen offset:1024 sc1
 s_waitcnt lgkmcnt(2)
 buffer_store_dwordx4 v[88:91], v3, s[4:7], s93 offen offset:2048 sc1
 s_waitcnt lgkmcnt(0)
 buffer_store_dwordx4 v[92:95], v3, s[4:7], s93 offen offset:3072 sc1
 s_add_u32 s93, s93, 4096
 s_add_u32 s22, s22, 128
 s_cmp_lt_u32 s22, 768
 s_cbranch_scc1 w2_2067
 s_add_u32 s20, s20, 32
wd_2068:
 s_lshl_b32 s95, s20, 2
 s_add_u32 s95, s95, s3
 s_add_u32 s95, s95, 17664
 v_mov_b32 v2, 0x80000000
 v_mov_b32 v255, s95
 v_cmp_eq_u32 vcc, 0, v0
 s_nop 1
 v_cndmask_b32 v2, v2, v255, vcc
 v_mov_b32 v3, 1
 s_waitcnt vmcnt(0) lgkmcnt(0)
 s_barrier
 buffer_store_dword v3, v2, s[4:7], 0 offen sc1
nwt_2060:
 s_and_b32 s24, s2, 7
 s_lshr_b32 s25, s2, 3
 s_lshl_b32 s96, s24, 5
 s_add_u32 s96, s96, s25
 s_mov_b32 s97, 256
 s_cmp_lg_u32 s98, 0
 s_cbranch_scc1 g2go_2069
 s_sub_u32 s96, s96, 32
 s_cmp_lt_u32 s24, 4
 s_cbranch_scc1 g2go_2069
 s_sub_u32 s24, s24, 4
 s_sub_u32 s26, s25, 4
 s_min_u32 s26, s26, s25
 s_mul_i32 s96, s24, 28
 s_add_u32 s96, s96, s26
 s_add_u32 s96, s96, 96
 s_sub_u32 s26, s25, 20
 s_min_u32 s26, s26, s25
 s_mul_i32 s27, s24, 12
 s_add_u32 s26, s26, s27
 s_add_u32 s26, s26, 208
 s_cmp_ge_u32 s85, 4
 s_cselect_b32 s97, s26, s97
g2go_2069:
 s_cmp_lg_u32 s98, 0
 s_cbranch_scc1 nf_2070
 s_add_u32 s95, s3, 17664
 v_mov_b32 v2, s95
 v_bfe_u32 v255, v0, 0, 6
 v_lshl_add_u32 v2, v255, 2, v2
 s_mov_b32 s100, 0
vw_2071:
 buffer_load_dword v3, v2, s[4:7], 0 offen sc1
 s_add_u32 s100, s100, 1
 s_cmp_gt_u32 s100, 200000
 s_cbranch_scc1 main_fail
 s_waitcnt vmcnt(0)
 v_cmp_ge_u32 vcc, 0, v3
 s_cbranch_vccz vok_2072
 s_sleep 2
 s_branch vw_2071
vok_2072:
nf_2070:
 s_waitcnt vmcnt(0) lgkmcnt(0)
 s_barrier
 v_bfe_u32 v255, v0, 4, 2
 v_lshlrev_b32 v3, 15, v255
 v_bfe_u32 v255, v0, 0, 4
 v_lshl_add_u32 v3, v255, 4, v3
 s_mul_i32 s26, s21, 1572864
 s_lshr_b32 s25, s96, 3
 s_lshl_b32 s25, s25, 10
 s_add_u32 s26, s26, s25
 s_add_u32 s26, s26, 20840448
 s_mul_i32 s27, s21, 40960
 s_add_u32 s25, s26, 262144
 s_add_u32 m0, s27, 0
 s_nop 0
 buffer_load_dwordx4 v3, s[4:7], s25 offen sc1 lds
 s_add_u32 s25, s26, 262400
 s_add_u32 m0, s27, 1024
 s_nop 0
 buffer_load_dwordx4 v3, s[4:7], s25 offen sc1 lds
 s_add_u32 s25, s26, 262656
 s_add_u32 m0, s27, 2048
 s_nop 0
 buffer_load_dwordx4 v3, s[4:7], s25 offen sc1 lds
 s_add_u32 s25, s26, 262912
 s_add_u32 m0, s27, 3072
 s_nop 0
 buffer_load_dwordx4 v3, s[4:7], s25 offen sc1 lds
 s_add_u32 s25, s26, 393216
 s_add_u32 m0, s27, 4096
 s_nop 0
 buffer_load_dwordx4 v3, s[4:7], s25 offen sc1 lds
 s_add_u32 s25, s26, 393472
 s_add_u32 m0, s27, 5120
 s_nop 0
 buffer_load_dwordx4 v3, s[4:7], s25 offen sc1 lds
 s_add_u32 s25, s26, 393728
 s_add_u32 m0, s27, 6144
 s_nop 0
 buffer_load_dwordx4 v3, s[4:7], s25 offen sc1 lds
 s_add_u32 s25, s26, 393984
 s_add_u32 m0, s27, 7168
 s_nop 0
 buffer_load_dwordx4 v3, s[4:7], s25 offen sc1 lds
 s_add_u32 s25, s26, 524288
 s_add_u32 m0, s27, 8192
 s_nop 0
 buffer_load_dwordx4 v3, s[4:7], s25 offen sc1 lds
 s_add_u32 s25, s26, 524544
 s_add_u32 m0, s27, 9216
 s_nop 0
 buffer_load_dwordx4 v3, s[4:7], s25 offen sc1 lds
 s_add_u32 s25, s26, 524800
 s_add_u32 m0, s27, 10240
 s_nop 0
 buffer_load_dwordx4 v3, s[4:7], s25 offen sc1 lds
 s_add_u32 s25, s26, 525056
 s_add_u32 m0, s27, 11264
 s_nop 0
 buffer_load_dwordx4 v3, s[4:7], s25 offen sc1 lds
 s_add_u32 s25, s26, 655360
 s_add_u32 m0, s27, 12288
 s_nop 0
 buffer_load_dwordx4 v3, s[4:7], s25 offen sc1 lds
 s_add_u32 s25, s26, 655616
 s_add_u32 m0, s27, 13312
 s_nop 0
 buffer_load_dwordx4 v3, s[4:7], s25 offen sc1 lds
 s_add_u32 s25, s26, 655872
 s_add_u32 m0, s27, 14336
 s_nop 0
 buffer_load_dwordx4 v3, s[4:7], s25 offen sc1 lds
 s_add_u32 s25, s26, 656128
 s_add_u32 m0, s27, 15360
 s_nop 0
 buffer_load_dwordx4 v3, s[4:7], s25 offen sc1 lds
 s_add_u32 s25, s26, 786432
 s_add_u32 m0, s27, 16384
 s_nop 0
 buffer_load_dwordx4 v3, s[4:7], s25 offen sc1 lds
 s_add_u32 s25, s26, 786688
 s_add_u32 m0, s27, 17408
 s_nop 0
 buffer_load_dwordx4 v3, s[4:7], s25 offen sc1 lds
 s_add_u32 s25, s26, 786944
 s_add_u32 m0, s27, 18432
 s_nop 0
 buffer_load_dwordx4 v3, s[4:7], s25 offen sc1 lds
 s_add_u32 s25, s26, 787200
 s_add_u32 m0, s27, 19456
 s_nop 0
 buffer_load_dwordx4 v3, s[4:7], s25 offen sc1 lds
 s_add_u32 s25, s26, 917504
 s_add_u32 m0, s27, 20480
 s_nop 0
 buffer_load_dwordx4 v3, s[4:7], s25 offen sc1 lds
 s_add_u32 s25, s26, 917760
 s_add_u32 m0, s27, 21504
 s_nop 0
 buffer_load_dwordx4 v3, s[4:7], s25 offen sc1 lds
 s_add_u32 s25, s26, 918016
 s_add_u32 m0, s27, 22528
 s_nop 0
 buffer_load_dwordx4 v3, s[4:7], s25 offen sc1 lds
 s_add_u32 s25, s26, 918272
 s_add_u32 m0, s27, 23552
 s_nop 0
 buffer_load_dwordx4 v3, s[4:7], s25 offen sc1 lds
 s_add_u32 s25, s26, 1048576
 s_add_u32 m0, s27, 24576
 s_nop 0
 buffer_load_dwordx4 v3, s[4:7], s25 offen sc1 lds
 s_add_u32 s25, s26, 1048832
 s_add_u32 m0, s27, 25600
 s_nop 0
 buffer_load_dwordx4 v3, s[4:7], s25 offen sc1 lds
 s_add_u32 s25, s26, 1049088
 s_add_u32 m0, s27, 26624
 s_nop 0
 buffer_load_dwordx4 v3, s[4:7], s25 offen sc1 lds
 s_add_u32 s25, s26, 1049344
 s_add_u32 m0, s27, 27648
 s_nop 0
 buffer_load_dwordx4 v3, s[4:7], s25 offen sc1 lds
 s_add_u32 s25, s26, 1179648
 s_add_u32 m0, s27, 28672
 s_nop 0
 buffer_load_dwordx4 v3, s[4:7], s25 offen sc1 lds
 s_add_u32 s25, s26, 1179904
 s_add_u32 m0, s27, 29696
 s_nop 0
 buffer_load_dwordx4 v3, s[4:7], s25 offen sc1 lds
 s_add_u32 s25, s26, 1180160
 s_add_u32 m0, s27, 30720
 s_nop 0
 buffer_load_dwordx4 v3, s[4:7], s25 offen sc1 lds
 s_add_u32 s25, s26, 1180416
 s_add_u32 m0, s27, 31744
 s_nop 0
 buffer_load_dwordx4 v3, s[4:7], s25 offen sc1 lds
 s_add_u32 s25, s26, 1310720
 s_add_u32 m0, s27, 32768
 s_nop 0
 buffer_load_dwordx4 v3, s[4:7], s25 offen sc1 lds
 s_add_u32 s25, s26, 1310976
 s_add_u32 m0, s27, 33792
 s_nop 0
 buffer_load_dwordx4 v3, s[4:7], s25 offen sc1 lds
 s_add_u32 s25, s26, 1311232
 s_add_u32 m0, s27, 34816
 s_nop 0
 buffer_load_dwordx4 v3, s[4:7], s25 offen sc1 lds
 s_add_u32 s25, s26, 1311488
 s_add_u32 m0, s27, 35840
 s_nop 0
 buffer_load_dwordx4 v3, s[4:7], s25 offen sc1 lds
 s_add_u32 s25, s26, 1441792
 s_add_u32 m0, s27, 36864
 s_nop 0
 buffer_load_dwordx4 v3, s[4:7], s25 offen sc1 lds
 s_add_u32 s25, s26, 1442048
 s_add_u32 m0, s27, 37888
 s_nop 0
 buffer_load_dwordx4 v3, s[4:7], s25 offen sc1 lds
 s_add_u32 s25, s26, 1442304
 s_add_u32 m0, s27, 38912
 s_nop 0
 buffer_load_dwordx4 v3, s[4:7], s25 offen sc1 lds
 s_add_u32 s25, s26, 1442560
 s_add_u32 m0, s27, 39936
 s_nop 0
 buffer_load_dwordx4 v3, s[4:7], s25 offen sc1 lds
 s_sub_u32 s22, s16, 4
 s_lshl_b32 s22, s22, 4
 s_add_u32 s22, s22, s17
 s_sub_u32 s22, s22, 8
 s_load_dwordx2 s[8:9], s[0:1], 72
 s_mov_b32 s10, 3072
 s_mov_b32 s11, 0x20000
 s_lshr_b32 s24, s22, 2
 s_lshl_b32 s24, s24, 1
 s_lshr_b32 s25, s21, 1
 s_add_u32 s24, s24, s25
 s_and_b32 s25, s22, 3
 s_lshl_b32 s25, s25, 1
 s_and_b32 s26, s21, 1
 s_add_u32 s25, s25, s26
 s_mul_i32 s32, s24, 768
 s_add_u32 s32, s32, 14548992
 s_mul_i32 s33, s25, 1280
 s_mul_i32 s34, s24, 61440
 s_add_u32 s34, s34, s33
 s_add_u32 s34, s34, 12582912
 s_add_u32 s33, s33, 9961472
 s_mul_i32 s35, s24, 96
 v_bfe_u32 v255, v0, 4, 2
 v_mul_u32_u24 v2, 24576, v255
 v_bfe_u32 v255, v0, 2, 2
 v_lshl_add_u32 v2, v255, 7, v2
 v_bfe_u32 v255, v0, 0, 2
 v_lshl_add_u32 v2, v255, 4, v2
 v_mov_b32 v3, 512
 v_bfe_u32 v255, v0, 4, 2
 s_mov_b32 s101, 24576
 v_mad_u32_u24 v3, v255, s101, v3
 v_bfe_u32 v255, v0, 0, 4
 v_lshl_add_u32 v3, v255, 4, v3
 v_bfe_u32 v255, v0, 4, 2
 v_mul_u32_u24 v4, 10240, v255
 v_bfe_u32 v255, v0, 0, 4
 v_lshl_add_u32 v4, v255, 4, v4
 v_mov_b32 v5, 40960
 v_bfe_u32 v255, v0, 5, 1
 s_mov_b32 s101, 10240
 v_mad_u32_u24 v5, v255, s101, v5
 v_bfe_u32 v255, v0, 4, 1
 v_lshl_add_u32 v5, v255, 3, v5
 v_bfe_u32 v255, v0, 0, 4
 v_lshl_add_u32 v5, v255, 4, v5
 s_add_u32 s26, s3, 17408
 v_mov_b32 v6, s26
 v_bfe_u32 v255, v0, 0, 6
 v_lshl_add_u32 v6, v255, 2, v6
 v_bfe_u32 v255, v0, 4, 2
 v_lshlrev_b32 v7, 4, v255
 v_mov_b32 v8, 64
 v_bfe_u32 v255, v0, 4, 2
 v_lshl_add_u32 v8, v255, 3, v8
 s_waitcnt lgkmcnt(0)
 buffer_load_dwordx4 v[12:15], v7, s[8:11], s35 offen
 buffer_load_dwordx2 v[10:11], v8, s[8:11], s35 offen
 v_mov_b32 v192, 0
 v_mov_b32 v193, 0
 v_mov_b32 v194, 0
 v_mov_b32 v195, 0
 v_mov_b32 v196, 0
 v_mov_b32 v197, 0
 v_mov_b32 v198, 0
 v_mov_b32 v199, 0
 v_mov_b32 v200, 0
 v_mov_b32 v201, 0
 v_mov_b32 v202, 0
 v_mov_b32 v203, 0
 v_mov_b32 v204, 0
 v_mov_b32 v205, 0
 v_mov_b32 v206, 0
 v_mov_b32 v207, 0
 v_mov_b32 v208, 0
 v_mov_b32 v209, 0
 v_mov_b32 v210, 0
 v_mov_b32 v211, 0
 v_mov_b32 v212, 0
 v_mov_b32 v213, 0
 v_mov_b32 v214, 0
 v_mov_b32 v215, 0
 v_mov_b32 v216, 0
 v_mov_b32 v217, 0
 v_mov_b32 v218, 0
 v_mov_b32 v219, 0
 v_mov_b32 v220, 0
 v_mov_b32 v221, 0
 v_mov_b32 v222, 0
 v_mov_b32 v223, 0
 v_mov_b32 v224, 0
 v_mov_b32 v225, 0
 v_mov_b32 v226, 0
 v_mov_b32 v227, 0
 v_mov_b32 v228, 0
 v_mov_b32 v229, 0
 v_mov_b32 v230, 0
 v_mov_b32 v231, 0
 v_mov_b32 v232, 0
 v_mov_b32 v233, 0
 v_mov_b32 v234, 0
 v_mov_b32 v235, 0
 v_mov_b32 v236, 0
 v_mov_b32 v237, 0
 v_mov_b32 v238, 0
 v_mov_b32 v239, 0
 v_mov_b32 v240, 0
 v_mov_b32 v241, 0
 v_mov_b32 v242, 0
 v_mov_b32 v243, 0
 v_mov_b32 v244, 0
 v_mov_b32 v245, 0
 v_mov_b32 v246, 0
 v_mov_b32 v247, 0
 v_mov_b32 v248, 0
 v_mov_b32 v249, 0
 v_mov_b32 v250, 0
 v_mov_b32 v251, 0
 s_mov_b64 s[56:57], 0
 s_mov_b32 s31, 0
 s_mov_b64 s[58:59], 15
g1_2073:
 s_add_u32 s30, s32, 0
 buffer_load_dwordx4 v[64:67], v2, s[4:7], s30 offen offset:0 sc1
 buffer_load_dwordx4 v[68:71], v2, s[4:7], s30 offen offset:64 sc1
 buffer_load_dwordx4 v[72:75], v3, s[4:7], s30 offen sc1
 s_add_u32 s30, s32, 98304
 buffer_load_dwordx4 v[96:99], v2, s[4:7], s30 offen offset:0 sc1
 buffer_load_dwordx4 v[100:103], v2, s[4:7], s30 offen offset:64 sc1
 buffer_load_dwordx4 v[104:107], v3, s[4:7], s30 offen sc1
 s_add_u32 s30, s32, 196608
 buffer_load_dwordx4 v[128:131], v2, s[4:7], s30 offen offset:0 sc1
 buffer_load_dwordx4 v[132:135], v2, s[4:7], s30 offen offset:64 sc1
 buffer_load_dwordx4 v[136:139], v3, s[4:7], s30 offen sc1
 s_add_u32 s30, s32, 294912
 buffer_load_dwordx4 v[160:163], v2, s[4:7], s30 offen offset:0 sc1
 buffer_load_dwordx4 v[164:167], v2, s[4:7], s30 offen offset:64 sc1
 buffer_load_dwordx4 v[168:171], v3, s[4:7], s30 offen sc1
 s_cmp_eq_u32 s31, 15
 s_cbranch_scc1 g1s_2074
 s_andn2_b64 s[54:55], s[58:59], s[56:57]
 s_cbranch_scc0 gok_2076
 s_mov_b32 s100, 0
gr_2075:
 buffer_load_dword v9, v6, s[4:7], 0 offen sc1
 s_add_u32 s100, s100, 1
 s_cmp_gt_u32 s100, 200000
 s_cbranch_scc1 main_fail
 s_waitcnt vmcnt(0)
 v_cmp_ne_u32 s[56:57], 0, v9
 s_nop 1
 s_andn2_b64 s[54:55], s[58:59], s[56:57]
 s_cbranch_scc1 gr_2075
gok_2076:
 s_add_u32 s30, s33, 0
 buffer_load_dwordx4 v[76:79], v4, s[4:7], s30 offen offset:0 sc1
 buffer_load_dwordx4 v[80:83], v4, s[4:7], s30 offen offset:256 sc1
 buffer_load_dwordx4 v[84:87], v4, s[4:7], s30 offen offset:512 sc1
 buffer_load_dwordx4 v[88:91], v4, s[4:7], s30 offen offset:768 sc1
 buffer_load_dwordx4 v[92:95], v4, s[4:7], s30 offen offset:1024 sc1
 s_add_u32 s30, s33, 40960
 buffer_load_dwordx4 v[108:111], v4, s[4:7], s30 offen offset:0 sc1
 buffer_load_dwordx4 v[112:115], v4, s[4:7], s30 offen offset:256 sc1
 buffer_load_dwordx4 v[116:119], v4, s[4:7], s30 offen offset:512 sc1
 buffer_load_dwordx4 v[120:123], v4, s[4:7], s30 offen offset:768 sc1
 buffer_load_dwordx4 v[124:127], v4, s[4:7], s30 offen offset:1024 sc1
 s_add_u32 s30, s33, 81920
 buffer_load_dwordx4 v[140:143], v4, s[4:7], s30 offen offset:0 sc1
 buffer_load_dwordx4 v[144:147], v4, s[4:7], s30 offen offset:256 sc1
 buffer_load_dwordx4 v[148:151], v4, s[4:7], s30 offen offset:512 sc1
 buffer_load_dwordx4 v[152:155], v4, s[4:7], s30 offen offset:768 sc1
 buffer_load_dwordx4 v[156:159], v4, s[4:7], s30 offen offset:1024 sc1
 s_add_u32 s30, s33, 122880
 buffer_load_dwordx4 v[172:175], v4, s[4:7], s30 offen offset:0 sc1
 buffer_load_dwordx4 v[176:179], v4, s[4:7], s30 offen offset:256 sc1
 buffer_load_dwordx4 v[180:183], v4, s[4:7], s30 offen offset:512 sc1
 buffer_load_dwordx4 v[184:187], v4, s[4:7], s30 offen offset:768 sc1
 buffer_load_dwordx4 v[188:191], v4, s[4:7], s30 offen offset:1024 sc1
 s_waitcnt vmcnt(19)
 v_mfma_f32_16x16x32_bf16 v[192:195], v[64:67], v[76:79], v[192:195]
 v_mfma_f32_16x16x32_bf16 v[196:199], v[68:71], v[76:79], v[196:199]
 v_mfma_f32_16x16x32_bf16 v[200:203], v[72:75], v[76:79], v[200:203]
 s_waitcnt vmcnt(18)
 v_mfma_f32_16x16x32_bf16 v[204:207], v[64:67], v[80:83], v[204:207]
 v_mfma_f32_16x16x32_bf16 v[208:211], v[68:71], v[80:83], v[208:211]
 v_mfma_f32_16x16x32_bf16 v[212:215], v[72:75], v[80:83], v[212:215]
 s_waitcnt vmcnt(17)
 v_mfma_f32_16x16x32_bf16 v[216:219], v[64:67], v[84:87], v[216:219]
 v_mfma_f32_16x16x32_bf16 v[220:223], v[68:71], v[84:87], v[220:223]
 v_mfma_f32_16x16x32_bf16 v[224:227], v[72:75], v[84:87], v[224:227]
 s_waitcnt vmcnt(16)
 v_mfma_f32_16x16x32_bf16 v[228:231], v[64:67], v[88:91], v[228:231]
 v_mfma_f32_16x16x32_bf16 v[232:235], v[68:71], v[88:91], v[232:235]
 v_mfma_f32_16x16x32_bf16 v[236:239], v[72:75], v[88:91], v[236:239]
 s_waitcnt vmcnt(15)
 v_mfma_f32_16x16x32_bf16 v[240:243], v[64:67], v[92:95], v[240:243]
 v_mfma_f32_16x16x32_bf16 v[244:247], v[68:71], v[92:95], v[244:247]
 v_mfma_f32_16x16x32_bf16 v[248:251], v[72:75], v[92:95], v[248:251]
 s_waitcnt vmcnt(14)
 v_mfma_f32_16x16x32_bf16 v[192:195], v[96:99], v[108:111], v[192:195]
 v_mfma_f32_16x16x32_bf16 v[196:199], v[100:103], v[108:111], v[196:199]
 v_mfma_f32_16x16x32_bf16 v[200:203], v[104:107], v[108:111], v[200:203]
 s_waitcnt vmcnt(13)
 v_mfma_f32_16x16x32_bf16 v[204:207], v[96:99], v[112:115], v[204:207]
 v_mfma_f32_16x16x32_bf16 v[208:211], v[100:103], v[112:115], v[208:211]
 v_mfma_f32_16x16x32_bf16 v[212:215], v[104:107], v[112:115], v[212:215]
 s_waitcnt vmcnt(12)
 v_mfma_f32_16x16x32_bf16 v[216:219], v[96:99], v[116:119], v[216:219]
 v_mfma_f32_16x16x32_bf16 v[220:223], v[100:103], v[116:119], v[220:223]
 v_mfma_f32_16x16x32_bf16 v[224:227], v[104:107], v[116:119], v[224:227]
 s_waitcnt vmcnt(11)
 v_mfma_f32_16x16x32_bf16 v[228:231], v[96:99], v[120:123], v[228:231]
 v_mfma_f32_16x16x32_bf16 v[232:235], v[100:103], v[120:123], v[232:235]
 v_mfma_f32_16x16x32_bf16 v[236:239], v[104:107], v[120:123], v[236:239]
 s_waitcnt vmcnt(10)
 v_mfma_f32_16x16x32_bf16 v[240:243], v[96:99], v[124:127], v[240:243]
 v_mfma_f32_16x16x32_bf16 v[244:247], v[100:103], v[124:127], v[244:247]
 v_mfma_f32_16x16x32_bf16 v[248:251], v[104:107], v[124:127], v[248:251]
 s_waitcnt vmcnt(9)
 v_mfma_f32_16x16x32_bf16 v[192:195], v[128:131], v[140:143], v[192:195]
 v_mfma_f32_16x16x32_bf16 v[196:199], v[132:135], v[140:143], v[196:199]
 v_mfma_f32_16x16x32_bf16 v[200:203], v[136:139], v[140:143], v[200:203]
 s_waitcnt vmcnt(8)
 v_mfma_f32_16x16x32_bf16 v[204:207], v[128:131], v[144:147], v[204:207]
 v_mfma_f32_16x16x32_bf16 v[208:211], v[132:135], v[144:147], v[208:211]
 v_mfma_f32_16x16x32_bf16 v[212:215], v[136:139], v[144:147], v[212:215]
 s_waitcnt vmcnt(7)
 v_mfma_f32_16x16x32_bf16 v[216:219], v[128:131], v[148:151], v[216:219]
 v_mfma_f32_16x16x32_bf16 v[220:223], v[132:135], v[148:151], v[220:223]
 v_mfma_f32_16x16x32_bf16 v[224:227], v[136:139], v[148:151], v[224:227]
 s_waitcnt vmcnt(6)
 v_mfma_f32_16x16x32_bf16 v[228:231], v[128:131], v[152:155], v[228:231]
 v_mfma_f32_16x16x32_bf16 v[232:235], v[132:135], v[152:155], v[232:235]
 v_mfma_f32_16x16x32_bf16 v[236:239], v[136:139], v[152:155], v[236:239]
 s_waitcnt vmcnt(5)
 v_mfma_f32_16x16x32_bf16 v[240:243], v[128:131], v[156:159], v[240:243]
 v_mfma_f32_16x16x32_bf16 v[244:247], v[132:135], v[156:159], v[244:247]
 v_mfma_f32_16x16x32_bf16 v[248:251], v[136:139], v[156:159], v[248:251]
 s_waitcnt vmcnt(4)
 v_mfma_f32_16x16x32_bf16 v[192:195], v[160:163], v[172:175], v[192:195]
 v_mfma_f32_16x16x32_bf16 v[196:199], v[164:167], v[172:175], v[196:199]
 v_mfma_f32_16x16x32_bf16 v[200:203], v[168:171], v[172:175], v[200:203]
 s_waitcnt vmcnt(3)
 v_mfma_f32_16x16x32_bf16 v[204:207], v[160:163], v[176:179], v[204:207]
 v_mfma_f32_16x16x32_bf16 v[208:211], v[164:167], v[176:179], v[208:211]
 v_mfma_f32_16x16x32_bf16 v[212:215], v[168:171], v[176:179], v[212:215]
 s_waitcnt vmcnt(2)
 v_mfma_f32_16x16x32_bf16 v[216:219], v[160:163], v[180:183], v[216:219]
 v_mfma_f32_16x16x32_bf16 v[220:223], v[164:167], v[180:183], v[220:223]
 v_mfma_f32_16x16x32_bf16 v[224:227], v[168:171], v[180:183], v[224:227]
 s_waitcnt vmcnt(1)
 v_mfma_f32_16x16x32_bf16 v[228:231], v[160:163], v[184:187], v[228:231]
 v_mfma_f32_16x16x32_bf16 v[232:235], v[164:167], v[184:187], v[232:235]
 v_mfma_f32_16x16x32_bf16 v[236:239], v[168:171], v[184:187], v[236:239]
 s_waitcnt vmcnt(0)
 v_mfma_f32_16x16x32_bf16 v[240:243], v[160:163], v[188:191], v[240:243]
 v_mfma_f32_16x16x32_bf16 v[244:247], v[164:167], v[188:191], v[244:247]
 v_mfma_f32_16x16x32_bf16 v[248:251], v[168:171], v[188:191], v[248:251]
 s_add_u32 s32, s32, 393216
 s_add_u32 s33, s33, 163840
 s_lshl_b64 s[58:59], s[58:59], 4
 s_add_u32 s31, s31, 1
 s_branch g1_2073
g1s_2074:
 v_mov_b32 v28, 0xc0135761
 v_mov_b32 v30, 0xbdd2d3e8
 v_mov_b32 v29, 0xc0135761
 v_mov_b32 v31, 0xbdd2d3e8
 v_lshlrev_b32 v16, 16, v12
 v_and_b32 v17, 0xffff0000, v12
 v_lshlrev_b32 v18, 16, v13
 v_and_b32 v19, 0xffff0000, v13
 v_lshlrev_b32 v20, 16, v14
 v_and_b32 v21, 0xffff0000, v14
 v_lshlrev_b32 v22, 16, v15
 v_and_b32 v23, 0xffff0000, v15
 v_lshlrev_b32 v24, 16, v10
 v_and_b32 v25, 0xffff0000, v10
 v_lshlrev_b32 v26, 16, v11
 v_and_b32 v27, 0xffff0000, v11
 s_mov_b32 s58, 0
 s_mov_b32 s59, 0x10000000
 s_andn2_b64 s[54:55], s[58:59], s[56:57]
 s_cbranch_scc0 gok_2078
 s_mov_b32 s100, 0
gr_2077:
 buffer_load_dword v9, v6, s[4:7], 0 offen sc1
 s_add_u32 s100, s100, 1
 s_cmp_gt_u32 s100, 200000
 s_cbranch_scc1 main_fail
 s_waitcnt vmcnt(0)
 v_cmp_ne_u32 s[56:57], 0, v9
 s_nop 1
 s_andn2_b64 s[54:55], s[58:59], s[56:57]
 s_cbranch_scc1 gr_2077
gok_2078:
 s_add_u32 s30, s33, 0
 buffer_load_dwordx4 v[76:79], v4, s[4:7], s30 offen offset:0 sc1
 buffer_load_dwordx4 v[80:83], v4, s[4:7], s30 offen offset:256 sc1
 buffer_load_dwordx4 v[84:87], v4, s[4:7], s30 offen offset:512 sc1
 buffer_load_dwordx4 v[88:91], v4, s[4:7], s30 offen offset:768 sc1
 buffer_load_dwordx4 v[92:95], v4, s[4:7], s30 offen offset:1024 sc1
 s_waitcnt vmcnt(4)
 v_mfma_f32_16x16x32_bf16 v[192:195], v[64:67], v[76:79], v[192:195]
 v_mfma_f32_16x16x32_bf16 v[196:199], v[68:71], v[76:79], v[196:199]
 v_mfma_f32_16x16x32_bf16 v[200:203], v[72:75], v[76:79], v[200:203]
 s_waitcnt vmcnt(3)
 v_mfma_f32_16x16x32_bf16 v[204:207], v[64:67], v[80:83], v[204:207]
 v_mfma_f32_16x16x32_bf16 v[208:211], v[68:71], v[80:83], v[208:211]
 v_mfma_f32_16x16x32_bf16 v[212:215], v[72:75], v[80:83], v[212:215]
 s_waitcnt vmcnt(2)
 v_mfma_f32_16x16x32_bf16 v[216:219], v[64:67], v[84:87], v[216:219]
 v_mfma_f32_16x16x32_bf16 v[220:223], v[68:71], v[84:87], v[220:223]
 v_mfma_f32_16x16x32_bf16 v[224:227], v[72:75], v[84:87], v[224:227]
 s_waitcnt vmcnt(1)
 v_mfma_f32_16x16x32_bf16 v[228:231], v[64:67], v[88:91], v[228:231]
 v_mfma_f32_16x16x32_bf16 v[232:235], v[68:71], v[88:91], v[232:235]
 v_mfma_f32_16x16x32_bf16 v[236:239], v[72:75], v[88:91], v[236:239]
 s_waitcnt vmcnt(0)
 v_mfma_f32_16x16x32_bf16 v[240:243], v[64:67], v[92:95], v[240:243]
 v_mfma_f32_16x16x32_bf16 v[244:247], v[68:71], v[92:95], v[244:247]
 v_mfma_f32_16x16x32_bf16 v[248:251], v[72:75], v[92:95], v[248:251]
 s_mov_b32 s58, 0
 s_mov_b32 s59, 0x20000000
 s_andn2_b64 s[54:55], s[58:59], s[56:57]
 s_cbranch_scc0 gok_2080
 s_mov_b32 s100, 0
gr_2079:
 buffer_load_dword v9, v6, s[4:7], 0 offen sc1
 s_add_u32 s100, s100, 1
 s_cmp_gt_u32 s100, 200000
 s_cbranch_scc1 main_fail
 s_waitcnt vmcnt(0)
 v_cmp_ne_u32 s[56:57], 0, v9
 s_nop 1
 s_andn2_b64 s[54:55], s[58:59], s[56:57]
 s_cbranch_scc1 gr_2079
gok_2080:
 s_add_u32 s30, s33, 40960
 buffer_load_dwordx4 v[108:111], v4, s[4:7], s30 offen offset:0 sc1
 buffer_load_dwordx4 v[112:115], v4, s[4:7], s30 offen offset:256 sc1
 buffer_load_dwordx4 v[116:119], v4, s[4:7], s30 offen offset:512 sc1
 buffer_load_dwordx4 v[120:123], v4, s[4:7], s30 offen offset:768 sc1
 buffer_load_dwordx4 v[124:127], v4, s[4:7], s30 offen offset:1024 sc1
 s_waitcnt vmcnt(4)
 v_mfma_f32_16x16x32_bf16 v[192:195], v[96:99], v[108:111], v[192:195]
 v_mfma_f32_16x16x32_bf16 v[196:199], v[100:103], v[108:111], v[196:199]
 v_mfma_f32_16x16x32_bf16 v[200:203], v[104:107], v[108:111], v[200:203]
 s_waitcnt vmcnt(3)
 v_mfma_f32_16x16x32_bf16 v[204:207], v[96:99], v[112:115], v[204:207]
 v_mfma_f32_16x16x32_bf16 v[208:211], v[100:103], v[112:115], v[208:211]
 v_mfma_f32_16x16x32_bf16 v[212:215], v[104:107], v[112:115], v[212:215]
 s_waitcnt vmcnt(2)
 v_mfma_f32_16x16x32_bf16 v[216:219], v[96:99], v[116:119], v[216:219]
 v_mfma_f32_16x16x32_bf16 v[220:223], v[100:103], v[116:119], v[220:223]
 v_mfma_f32_16x16x32_bf16 v[224:227], v[104:107], v[116:119], v[224:227]
 s_waitcnt vmcnt(1)
 v_mfma_f32_16x16x32_bf16 v[228:231], v[96:99], v[120:123], v[228:231]
 v_mfma_f32_16x16x32_bf16 v[232:235], v[100:103], v[120:123], v[232:235]
 v_mfma_f32_16x16x32_bf16 v[236:239], v[104:107], v[120:123], v[236:239]
 s_waitcnt vmcnt(0)
 v_mfma_f32_16x16x32_bf16 v[240:243], v[96:99], v[124:127], v[240:243]
 v_mfma_f32_16x16x32_bf16 v[244:247], v[100:103], v[124:127], v[244:247]
 v_mfma_f32_16x16x32_bf16 v[248:251], v[104:107], v[124:127], v[248:251]
 s_mov_b32 s58, 0
 s_mov_b32 s59, 0x40000000
 s_andn2_b64 s[54:55], s[58:59], s[56:57]
 s_cbranch_scc0 gok_2082
 s_mov_b32 s100, 0
gr_2081:
 buffer_load_dword v9, v6, s[4:7], 0 offen sc1
 s_add_u32 s100, s100, 1
 s_cmp_gt_u32 s100, 200000
 s_cbranch_scc1 main_fail
 s_waitcnt vmcnt(0)
 v_cmp_ne_u32 s[56:57], 0, v9
 s_nop 1
 s_andn2_b64 s[54:55], s[58:59], s[56:57]
 s_cbranch_scc1 gr_2081
gok_2082:
 s_add_u32 s30, s33, 81920
 buffer_load_dwordx4 v[140:143], v4, s[4:7], s30 offen offset:0 sc1
 buffer_load_dwordx4 v[144:147], v4, s[4:7], s30 offen offset:256 sc1
 buffer_load_dwordx4 v[148:151], v4, s[4:7], s30 offen offset:512 sc1
 buffer_load_dwordx4 v[152:155], v4, s[4:7], s30 offen offset:768 sc1
 buffer_load_dwordx4 v[156:159], v4, s[4:7], s30 offen offset:1024 sc1
 s_waitcnt vmcnt(4)
 v_mfma_f32_16x16x32_bf16 v[192:195], v[128:131], v[140:143], v[192:195]
 v_mfma_f32_16x16x32_bf16 v[196:199], v[132:135], v[140:143], v[196:199]
 v_mfma_f32_16x16x32_bf16 v[200:203], v[136:139], v[140:143], v[200:203]
 s_waitcnt vmcnt(3)
 v_mfma_f32_16x16x32_bf16 v[204:207], v[128:131], v[144:147], v[204:207]
 v_mfma_f32_16x16x32_bf16 v[208:211], v[132:135], v[144:147], v[208:211]
 v_mfma_f32_16x16x32_bf16 v[212:215], v[136:139], v[144:147], v[212:215]
 s_waitcnt vmcnt(2)
 v_mfma_f32_16x16x32_bf16 v[216:219], v[128:131], v[148:151], v[216:219]
 v_mfma_f32_16x16x32_bf16 v[220:223], v[132:135], v[148:151], v[220:223]
 v_mfma_f32_16x16x32_bf16 v[224:227], v[136:139], v[148:151], v[224:227]
 s_waitcnt vmcnt(1)
 v_mfma_f32_16x16x32_bf16 v[228:231], v[128:131], v[152:155], v[228:231]
 v_mfma_f32_16x16x32_bf16 v[232:235], v[132:135], v[152:155], v[232:235]
 v_mfma_f32_16x16x32_bf16 v[236:239], v[136:139], v[152:155], v[236:239]
 s_waitcnt vmcnt(0)
 v_mfma_f32_16x16x32_bf16 v[240:243], v[128:131], v[156:159], v[240:243]
 v_mfma_f32_16x16x32_bf16 v[244:247], v[132:135], v[156:159], v[244:247]
 v_mfma_f32_16x16x32_bf16 v[248:251], v[136:139], v[156:159], v[248:251]
 s_mov_b32 s58, 0
 s_mov_b32 s59, 0x80000000
 s_andn2_b64 s[54:55], s[58:59], s[56:57]
 s_cbranch_scc0 gok_2084
 s_mov_b32 s100, 0
gr_2083:
 buffer_load_dword v9, v6, s[4:7], 0 offen sc1
 s_add_u32 s100, s100, 1
 s_cmp_gt_u32 s100, 200000
 s_cbranch_scc1 main_fail
 s_waitcnt vmcnt(0)
 v_cmp_ne_u32 s[56:57], 0, v9
 s_nop 1
 s_andn2_b64 s[54:55], s[58:59], s[56:57]
 s_cbranch_scc1 gr_2083
gok_2084:
 s_add_u32 s30, s33, 122880
 buffer_load_dwordx4 v[172:175], v4, s[4:7], s30 offen offset:0 sc1
 buffer_load_dwordx4 v[176:179], v4, s[4:7], s30 offen offset:256 sc1
 buffer_load_dwordx4 v[180:183], v4, s[4:7], s30 offen offset:512 sc1
 buffer_load_dwordx4 v[184:187], v4, s[4:7], s30 offen offset:768 sc1
 buffer_load_dwordx4 v[188:191], v4, s[4:7], s30 offen offset:1024 sc1
 s_waitcnt vmcnt(4)
 v_mfma_f32_16x16x32_bf16 v[192:195], v[160:163], v[172:175], v[192:195]
 v_mfma_f32_16x16x32_bf16 v[196:199], v[164:167], v[172:175], v[196:199]
 v_mfma_f32_16x16x32_bf16 v[200:203], v[168:171], v[172:175], v[200:203]
 s_waitcnt vmcnt(3)
 v_mfma_f32_16x16x32_bf16 v[204:207], v[160:163], v[176:179], v[204:207]
 v_mfma_f32_16x16x32_bf16 v[208:211], v[164:167], v[176:179], v[208:211]
 v_mfma_f32_16x16x32_bf16 v[212:215], v[168:171], v[176:179], v[212:215]
 s_waitcnt vmcnt(2)
 v_mfma_f32_16x16x32_bf16 v[216:219], v[160:163], v[180:183], v[216:219]
 v_mfma_f32_16x16x32_bf16 v[220:223], v[164:167], v[180:183], v[220:223]
 v_mfma_f32_16x16x32_bf16 v[224:227], v[168:171], v[180:183], v[224:227]
 s_waitcnt vmcnt(1)
 v_mfma_f32_16x16x32_bf16 v[228:231], v[160:163], v[184:187], v[228:231]
 v_mfma_f32_16x16x32_bf16 v[232:235], v[164:167], v[184:187], v[232:235]
 v_mfma_f32_16x16x32_bf16 v[236:239], v[168:171], v[184:187], v[236:239]
 s_waitcnt vmcnt(0)
 v_mfma_f32_16x16x32_bf16 v[240:243], v[160:163], v[188:191], v[240:243]
 v_mfma_f32_16x16x32_bf16 v[244:247], v[164:167], v[188:191], v[244:247]
 v_mfma_f32_16x16x32_bf16 v[248:251], v[168:171], v[188:191], v[248:251]
 v_pk_add_f32 v[192:193], v[192:193], v[16:17]
 v_pk_add_f32 v[194:195], v[194:195], v[18:19]
 v_pk_add_f32 v[196:197], v[196:197], v[20:21]
 v_pk_add_f32 v[198:199], v[198:199], v[22:23]
 v_pk_add_f32 v[200:201], v[200:201], v[24:25]
 v_pk_add_f32 v[202:203], v[202:203], v[26:27]
 v_pk_mul_f32 v[40:41], v[192:193], v[192:193]
 v_pk_mul_f32 v[42:43], v[194:195], v[194:195]
 v_pk_mul_f32 v[44:45], v[196:197], v[196:197]
 v_pk_mul_f32 v[46:47], v[198:199], v[198:199]
 v_pk_mul_f32 v[48:49], v[200:201], v[200:201]
 v_pk_mul_f32 v[50:51], v[202:203], v[202:203]
 v_pk_fma_f32 v[40:41], v[40:41], v[30:31], v[28:29]
 v_pk_fma_f32 v[42:43], v[42:43], v[30:31], v[28:29]
 v_pk_fma_f32 v[44:45], v[44:45], v[30:31], v[28:29]
 v_pk_fma_f32 v[46:47], v[46:47], v[30:31], v[28:29]
 v_pk_fma_f32 v[48:49], v[48:49], v[30:31], v[28:29]
 v_pk_fma_f32 v[50:51], v[50:51], v[30:31], v[28:29]
 v_pk_mul_f32 v[40:41], v[40:41], v[192:193]
 v_pk_mul_f32 v[42:43], v[42:43], v[194:195]
 v_pk_mul_f32 v[44:45], v[44:45], v[196:197]
 v_pk_mul_f32 v[46:47], v[46:47], v[198:199]
 v_pk_mul_f32 v[48:49], v[48:49], v[200:201]
 v_pk_mul_f32 v[50:51], v[50:51], v[202:203]
 v_exp_f32 v40, v40
 v_exp_f32 v41, v41
 v_exp_f32 v42, v42
 v_exp_f32 v43, v43
 v_exp_f32 v44, v44
 v_exp_f32 v45, v45
 v_exp_f32 v46, v46
 v_exp_f32 v47, v47
 v_exp_f32 v48, v48
 v_exp_f32 v49, v49
 v_exp_f32 v50, v50
 v_exp_f32 v51, v51
 v_pk_add_f32 v[40:41], v[40:41], 1.0 op_sel_hi:[1,0]
 v_pk_add_f32 v[42:43], v[42:43], 1.0 op_sel_hi:[1,0]
 v_pk_add_f32 v[44:45], v[44:45], 1.0 op_sel_hi:[1,0]
 v_pk_add_f32 v[46:47], v[46:47], 1.0 op_sel_hi:[1,0]
 v_pk_add_f32 v[48:49], v[48:49], 1.0 op_sel_hi:[1,0]
 v_pk_add_f32 v[50:51], v[50:51], 1.0 op_sel_hi:[1,0]
 v_rcp_f32 v40, v40
 v_rcp_f32 v41, v41
 v_rcp_f32 v42, v42
 v_rcp_f32 v43, v43
 v_rcp_f32 v44, v44
 v_rcp_f32 v45, v45
 v_rcp_f32 v46, v46
 v_rcp_f32 v47, v47
 v_rcp_f32 v48, v48
 v_rcp_f32 v49, v49
 v_rcp_f32 v50, v50
 v_rcp_f32 v51, v51
 v_pk_mul_f32 v[192:193], v[192:193], v[40:41]
 v_pk_mul_f32 v[194:195], v[194:195], v[42:43]
 v_pk_mul_f32 v[196:197], v[196:197], v[44:45]
 v_pk_mul_f32 v[198:199], v[198:199], v[46:47]
 v_pk_mul_f32 v[200:201], v[200:201], v[48:49]
 v_pk_mul_f32 v[202:203], v[202:203], v[50:51]
 v_cvt_pk_bf16_f32 v64, v192, v193
 v_cvt_pk_bf16_f32 v65, v194, v195
 v_cvt_pk_bf16_f32 v66, v196, v197
 v_cvt_pk_bf16_f32 v67, v198, v199
 v_cvt_pk_bf16_f32 v68, v200, v201
 v_cvt_pk_bf16_f32 v69, v202, v203
 buffer_store_dwordx4 v[64:67], v4, s[4:7], s34 offen offset:0 sc1
 buffer_store_dwordx2 v[68:69], v5, s[4:7], s34 offen offset:0 sc1
 v_pk_add_f32 v[204:205], v[204:205], v[16:17]
 v_pk_add_f32 v[206:207], v[206:207], v[18:19]
 v_pk_add_f32 v[208:209], v[208:209], v[20:21]
 v_pk_add_f32 v[210:211], v[210:211], v[22:23]
 v_pk_add_f32 v[212:213], v[212:213], v[24:25]
 v_pk_add_f32 v[214:215], v[214:215], v[26:27]
 v_pk_mul_f32 v[40:41], v[204:205], v[204:205]
 v_pk_mul_f32 v[42:43], v[206:207], v[206:207]
 v_pk_mul_f32 v[44:45], v[208:209], v[208:209]
 v_pk_mul_f32 v[46:47], v[210:211], v[210:211]
 v_pk_mul_f32 v[48:49], v[212:213], v[212:213]
 v_pk_mul_f32 v[50:51], v[214:215], v[214:215]
 v_pk_fma_f32 v[40:41], v[40:41], v[30:31], v[28:29]
 v_pk_fma_f32 v[42:43], v[42:43], v[30:31], v[28:29]
 v_pk_fma_f32 v[44:45], v[44:45], v[30:31], v[28:29]
 v_pk_fma_f32 v[46:47], v[46:47], v[30:31], v[28:29]
 v_pk_fma_f32 v[48:49], v[48:49], v[30:31], v[28:29]
 v_pk_fma_f32 v[50:51], v[50:51], v[30:31], v[28:29]
 v_pk_mul_f32 v[40:41], v[40:41], v[204:205]
 v_pk_mul_f32 v[42:43], v[42:43], v[206:207]
 v_pk_mul_f32 v[44:45], v[44:45], v[208:209]
 v_pk_mul_f32 v[46:47], v[46:47], v[210:211]
 v_pk_mul_f32 v[48:49], v[48:49], v[212:213]
 v_pk_mul_f32 v[50:51], v[50:51], v[214:215]
 v_exp_f32 v40, v40
 v_exp_f32 v41, v41
 v_exp_f32 v42, v42
 v_exp_f32 v43, v43
 v_exp_f32 v44, v44
 v_exp_f32 v45, v45
 v_exp_f32 v46, v46
 v_exp_f32 v47, v47
 v_exp_f32 v48, v48
 v_exp_f32 v49, v49
 v_exp_f32 v50, v50
 v_exp_f32 v51, v51
 v_pk_add_f32 v[40:41], v[40:41], 1.0 op_sel_hi:[1,0]
 v_pk_add_f32 v[42:43], v[42:43], 1.0 op_sel_hi:[1,0]
 v_pk_add_f32 v[44:45], v[44:45], 1.0 op_sel_hi:[1,0]
 v_pk_add_f32 v[46:47], v[46:47], 1.0 op_sel_hi:[1,0]
 v_pk_add_f32 v[48:49], v[48:49], 1.0 op_sel_hi:[1,0]
 v_pk_add_f32 v[50:51], v[50:51], 1.0 op_sel_hi:[1,0]
 v_rcp_f32 v40, v40
 v_rcp_f32 v41, v41
 v_rcp_f32 v42, v42
 v_rcp_f32 v43, v43
 v_rcp_f32 v44, v44
 v_rcp_f32 v45, v45
 v_rcp_f32 v46, v46
 v_rcp_f32 v47, v47
 v_rcp_f32 v48, v48
 v_rcp_f32 v49, v49
 v_rcp_f32 v50, v50
 v_rcp_f32 v51, v51
 v_pk_mul_f32 v[204:205], v[204:205], v[40:41]
 v_pk_mul_f32 v[206:207], v[206:207], v[42:43]
 v_pk_mul_f32 v[208:209], v[208:209], v[44:45]
 v_pk_mul_f32 v[210:211], v[210:211], v[46:47]
 v_pk_mul_f32 v[212:213], v[212:213], v[48:49]
 v_pk_mul_f32 v[214:215], v[214:215], v[50:51]
 v_cvt_pk_bf16_f32 v72, v204, v205
 v_cvt_pk_bf16_f32 v73, v206, v207
 v_cvt_pk_bf16_f32 v74, v208, v209
 v_cvt_pk_bf16_f32 v75, v210, v211
 v_cvt_pk_bf16_f32 v76, v212, v213
 v_cvt_pk_bf16_f32 v77, v214, v215
 buffer_store_dwordx4 v[72:75], v4, s[4:7], s34 offen offset:256 sc1
 buffer_store_dwordx2 v[76:77], v5, s[4:7], s34 offen offset:256 sc1
 v_pk_add_f32 v[216:217], v[216:217], v[16:17]
 v_pk_add_f32 v[218:219], v[218:219], v[18:19]
 v_pk_add_f32 v[220:221], v[220:221], v[20:21]
 v_pk_add_f32 v[222:223], v[222:223], v[22:23]
 v_pk_add_f32 v[224:225], v[224:225], v[24:25]
 v_pk_add_f32 v[226:227], v[226:227], v[26:27]
 v_pk_mul_f32 v[40:41], v[216:217], v[216:217]
 v_pk_mul_f32 v[42:43], v[218:219], v[218:219]
 v_pk_mul_f32 v[44:45], v[220:221], v[220:221]
 v_pk_mul_f32 v[46:47], v[222:223], v[222:223]
 v_pk_mul_f32 v[48:49], v[224:225], v[224:225]
 v_pk_mul_f32 v[50:51], v[226:227], v[226:227]
 v_pk_fma_f32 v[40:41], v[40:41], v[30:31], v[28:29]
 v_pk_fma_f32 v[42:43], v[42:43], v[30:31], v[28:29]
 v_pk_fma_f32 v[44:45], v[44:45], v[30:31], v[28:29]
 v_pk_fma_f32 v[46:47], v[46:47], v[30:31], v[28:29]
 v_pk_fma_f32 v[48:49], v[48:49], v[30:31], v[28:29]
 v_pk_fma_f32 v[50:51], v[50:51], v[30:31], v[28:29]
 v_pk_mul_f32 v[40:41], v[40:41], v[216:217]
 v_pk_mul_f32 v[42:43], v[42:43], v[218:219]
 v_pk_mul_f32 v[44:45], v[44:45], v[220:221]
 v_pk_mul_f32 v[46:47], v[46:47], v[222:223]
 v_pk_mul_f32 v[48:49], v[48:49], v[224:225]
 v_pk_mul_f32 v[50:51], v[50:51], v[226:227]
 v_exp_f32 v40, v40
 v_exp_f32 v41, v41
 v_exp_f32 v42, v42
 v_exp_f32 v43, v43
 v_exp_f32 v44, v44
 v_exp_f32 v45, v45
 v_exp_f32 v46, v46
 v_exp_f32 v47, v47
 v_exp_f32 v48, v48
 v_exp_f32 v49, v49
 v_exp_f32 v50, v50
 v_exp_f32 v51, v51
 v_pk_add_f32 v[40:41], v[40:41], 1.0 op_sel_hi:[1,0]
 v_pk_add_f32 v[42:43], v[42:43], 1.0 op_sel_hi:[1,0]
 v_pk_add_f32 v[44:45], v[44:45], 1.0 op_sel_hi:[1,0]
 v_pk_add_f32 v[46:47], v[46:47], 1.0 op_sel_hi:[1,0]
 v_pk_add_f32 v[48:49], v[48:49], 1.0 op_sel_hi:[1,0]
 v_pk_add_f32 v[50:51], v[50:51], 1.0 op_sel_hi:[1,0]
 v_rcp_f32 v40, v40
 v_rcp_f32 v41, v41
 v_rcp_f32 v42, v42
 v_rcp_f32 v43, v43
 v_rcp_f32 v44, v44
 v_rcp_f32 v45, v45
 v_rcp_f32 v46, v46
 v_rcp_f32 v47, v47
 v_rcp_f32 v48, v48
 v_rcp_f32 v49, v49
 v_rcp_f32 v50, v50
 v_rcp_f32 v51, v51
 v_pk_mul_f32 v[216:217], v[216:217], v[40:41]
 v_pk_mul_f32 v[218:219], v[218:219], v[42:43]
 v_pk_mul_f32 v[220:221], v[220:221], v[44:45]
 v_pk_mul_f32 v[222:223], v[222:223], v[46:47]
 v_pk_mul_f32 v[224:225], v[224:225], v[48:49]
 v_pk_mul_f32 v[226:227], v[226:227], v[50:51]
 v_cvt_pk_bf16_f32 v80, v216, v217
 v_cvt_pk_bf16_f32 v81, v218, v219
 v_cvt_pk_bf16_f32 v82, v220, v221
 v_cvt_pk_bf16_f32 v83, v222, v223
 v_cvt_pk_bf16_f32 v84, v224, v225
 v_cvt_pk_bf16_f32 v85, v226, v227
 buffer_store_dwordx4 v[80:83], v4, s[4:7], s34 offen offset:512 sc1
 buffer_store_dwordx2 v[84:85], v5, s[4:7], s34 offen offset:512 sc1
 v_pk_add_f32 v[228:229], v[228:229], v[16:17]
 v_pk_add_f32 v[230:231], v[230:231], v[18:19]
 v_pk_add_f32 v[232:233], v[232:233], v[20:21]
 v_pk_add_f32 v[234:235], v[234:235], v[22:23]
 v_pk_add_f32 v[236:237], v[236:237], v[24:25]
 v_pk_add_f32 v[238:239], v[238:239], v[26:27]
 v_pk_mul_f32 v[40:41], v[228:229], v[228:229]
 v_pk_mul_f32 v[42:43], v[230:231], v[230:231]
 v_pk_mul_f32 v[44:45], v[232:233], v[232:233]
 v_pk_mul_f32 v[46:47], v[234:235], v[234:235]
 v_pk_mul_f32 v[48:49], v[236:237], v[236:237]
 v_pk_mul_f32 v[50:51], v[238:239], v[238:239]
 v_pk_fma_f32 v[40:41], v[40:41], v[30:31], v[28:29]
 v_pk_fma_f32 v[42:43], v[42:43], v[30:31], v[28:29]
 v_pk_fma_f32 v[44:45], v[44:45], v[30:31], v[28:29]
 v_pk_fma_f32 v[46:47], v[46:47], v[30:31], v[28:29]
 v_pk_fma_f32 v[48:49], v[48:49], v[30:31], v[28:29]
 v_pk_fma_f32 v[50:51], v[50:51], v[30:31], v[28:29]
 v_pk_mul_f32 v[40:41], v[40:41], v[228:229]
 v_pk_mul_f32 v[42:43], v[42:43], v[230:231]
 v_pk_mul_f32 v[44:45], v[44:45], v[232:233]
 v_pk_mul_f32 v[46:47], v[46:47], v[234:235]
 v_pk_mul_f32 v[48:49], v[48:49], v[236:237]
 v_pk_mul_f32 v[50:51], v[50:51], v[238:239]
 v_exp_f32 v40, v40
 v_exp_f32 v41, v41
 v_exp_f32 v42, v42
 v_exp_f32 v43, v43
 v_exp_f32 v44, v44
 v_exp_f32 v45, v45
 v_exp_f32 v46, v46
 v_exp_f32 v47, v47
 v_exp_f32 v48, v48
 v_exp_f32 v49, v49
 v_exp_f32 v50, v50
 v_exp_f32 v51, v51
 v_pk_add_f32 v[40:41], v[40:41], 1.0 op_sel_hi:[1,0]
 v_pk_add_f32 v[42:43], v[42:43], 1.0 op_sel_hi:[1,0]
 v_pk_add_f32 v[44:45], v[44:45], 1.0 op_sel_hi:[1,0]
 v_pk_add_f32 v[46:47], v[46:47], 1.0 op_sel_hi:[1,0]
 v_pk_add_f32 v[48:49], v[48:49], 1.0 op_sel_hi:[1,0]
 v_pk_add_f32 v[50:51], v[50:51], 1.0 op_sel_hi:[1,0]
 v_rcp_f32 v40, v40
 v_rcp_f32 v41, v41
 v_rcp_f32 v42, v42
 v_rcp_f32 v43, v43
 v_rcp_f32 v44, v44
 v_rcp_f32 v45, v45
 v_rcp_f32 v46, v46
 v_rcp_f32 v47, v47
 v_rcp_f32 v48, v48
 v_rcp_f32 v49, v49
 v_rcp_f32 v50, v50
 v_rcp_f32 v51, v51
 v_pk_mul_f32 v[228:229], v[228:229], v[40:41]
 v_pk_mul_f32 v[230:231], v[230:231], v[42:43]
 v_pk_mul_f32 v[232:233], v[232:233], v[44:45]
 v_pk_mul_f32 v[234:235], v[234:235], v[46:47]
 v_pk_mul_f32 v[236:237], v[236:237], v[48:49]
 v_pk_mul_f32 v[238:239], v[238:239], v[50:51]
 v_cvt_pk_bf16_f32 v88, v228, v229
 v_cvt_pk_bf16_f32 v89, v230, v231
 v_cvt_pk_bf16_f32 v90, v232, v233
 v_cvt_pk_bf16_f32 v91, v234, v235
 v_cvt_pk_bf16_f32 v92, v236, v237
 v_cvt_pk_bf16_f32 v93, v238, v239
 buffer_store_dwordx4 v[88:91], v4, s[4:7], s34 offen offset:768 sc1
 buffer_store_dwordx2 v[92:93], v5, s[4:7], s34 offen offset:768 sc1
 v_pk_add_f32 v[240:241], v[240:241], v[16:17]
 v_pk_add_f32 v[242:243], v[242:243], v[18:19]
 v_pk_add_f32 v[244:245], v[244:245], v[20:21]
 v_pk_add_f32 v[246:247], v[246:247], v[22:23]
 v_pk_add_f32 v[248:249], v[248:249], v[24:25]
 v_pk_add_f32 v[250:251], v[250:251], v[26:27]
 v_pk_mul_f32 v[40:41], v[240:241], v[240:241]
 v_pk_mul_f32 v[42:43], v[242:243], v[242:243]
 v_pk_mul_f32 v[44:45], v[244:245], v[244:245]
 v_pk_mul_f32 v[46:47], v[246:247], v[246:247]
 v_pk_mul_f32 v[48:49], v[248:249], v[248:249]
 v_pk_mul_f32 v[50:51], v[250:251], v[250:251]
 v_pk_fma_f32 v[40:41], v[40:41], v[30:31], v[28:29]
 v_pk_fma_f32 v[42:43], v[42:43], v[30:31], v[28:29]
 v_pk_fma_f32 v[44:45], v[44:45], v[30:31], v[28:29]
 v_pk_fma_f32 v[46:47], v[46:47], v[30:31], v[28:29]
 v_pk_fma_f32 v[48:49], v[48:49], v[30:31], v[28:29]
 v_pk_fma_f32 v[50:51], v[50:51], v[30:31], v[28:29]
 v_pk_mul_f32 v[40:41], v[40:41], v[240:241]
 v_pk_mul_f32 v[42:43], v[42:43], v[242:243]
 v_pk_mul_f32 v[44:45], v[44:45], v[244:245]
 v_pk_mul_f32 v[46:47], v[46:47], v[246:247]
 v_pk_mul_f32 v[48:49], v[48:49], v[248:249]
 v_pk_mul_f32 v[50:51], v[50:51], v[250:251]
 v_exp_f32 v40, v40
 v_exp_f32 v41, v41
 v_exp_f32 v42, v42
 v_exp_f32 v43, v43
 v_exp_f32 v44, v44
 v_exp_f32 v45, v45
 v_exp_f32 v46, v46
 v_exp_f32 v47, v47
 v_exp_f32 v48, v48
 v_exp_f32 v49, v49
 v_exp_f32 v50, v50
 v_exp_f32 v51, v51
 v_pk_add_f32 v[40:41], v[40:41], 1.0 op_sel_hi:[1,0]
 v_pk_add_f32 v[42:43], v[42:43], 1.0 op_sel_hi:[1,0]
 v_pk_add_f32 v[44:45], v[44:45], 1.0 op_sel_hi:[1,0]
 v_pk_add_f32 v[46:47], v[46:47], 1.0 op_sel_hi:[1,0]
 v_pk_add_f32 v[48:49], v[48:49], 1.0 op_sel_hi:[1,0]
 v_pk_add_f32 v[50:51], v[50:51], 1.0 op_sel_hi:[1,0]
 v_rcp_f32 v40, v40
 v_rcp_f32 v41, v41
 v_rcp_f32 v42, v42
 v_rcp_f32 v43, v43
 v_rcp_f32 v44, v44
 v_rcp_f32 v45, v45
 v_rcp_f32 v46, v46
 v_rcp_f32 v47, v47
 v_rcp_f32 v48, v48
 v_rcp_f32 v49, v49
 v_rcp_f32 v50, v50
 v_rcp_f32 v51, v51
 v_pk_mul_f32 v[240:241], v[240:241], v[40:41]
 v_pk_mul_f32 v[242:243], v[242:243], v[42:43]
 v_pk_mul_f32 v[244:245], v[244:245], v[44:45]
 v_pk_mul_f32 v[246:247], v[246:247], v[46:47]
 v_pk_mul_f32 v[248:249], v[248:249], v[48:49]
 v_pk_mul_f32 v[250:251], v[250:251], v[50:51]
 v_cvt_pk_bf16_f32 v96, v240, v241
 v_cvt_pk_bf16_f32 v97, v242, v243
 v_cvt_pk_bf16_f32 v98, v244, v245
 v_cvt_pk_bf16_f32 v99, v246, v247
 v_cvt_pk_bf16_f32 v100, v248, v249
 v_cvt_pk_bf16_f32 v101, v250, v251
 buffer_store_dwordx4 v[96:99], v4, s[4:7], s34 offen offset:1024 sc1
 buffer_store_dwordx2 v[100:101], v5, s[4:7], s34 offen offset:1024 sc1
 s_lshl_b32 s95, s22, 7
 s_add_u32 s95, s95, s3
 s_add_u32 s95, s95, 40960
 v_mov_b32 v2, 0x80000000
 v_mov_b32 v255, s95
 v_cmp_eq_u32 vcc, 0, v0
 s_nop 1
 v_cndmask_b32 v2, v2, v255, vcc
 v_mov_b32 v3, 1
 s_waitcnt vmcnt(0) lgkmcnt(0)
 s_barrier
 buffer_store_dword v3, v2, s[4:7], 0 offen sc1
 s_branch g2_from_g1
g2_from_g1:
 s_branch g2_ready
zb_2059:
 s_mov_b32 s20, 36
 s_mov_b32 s14, 44
 s_mov_b32 s15, 46
 s_branch role_pz
again_pz:
 s_mov_b32 s20, 0
 s_mov_b32 s14, 36
 s_mov_b32 s15, 44
role_pz:
 s_and_b32 s23, s16, 1
 s_add_u32 s20, s20, s23
 s_add_u32 s15, s15, s23
 s_and_b32 s22, s16, 2
 s_lshl_b32 s22, s22, 1
 s_and_b32 s23, s17, 3
 s_add_u32 s22, s22, s23
 s_waitcnt vmcnt(0) lgkmcnt(0)
 s_barrier
 v_bfe_u32 v255, v0, 3, 1
 v_lshlrev_b32 v2, 14, v255
 v_bfe_u32 v255, v0, 4, 2
 v_lshl_add_u32 v2, v255, 7, v2
 v_bfe_u32 v255, v0, 0, 3
 v_lshl_add_u32 v2, v255, 4, v2
 v_bfe_u32 v255, v0, 3, 1
 v_lshlrev_b32 v3, 12, v255
 v_bfe_u32 v255, v0, 4, 2
 v_lshl_add_u32 v3, v255, 7, v3
 v_bfe_u32 v255, v0, 0, 3
 v_lshl_add_u32 v3, v255, 4, v3
 v_mov_b32 v4, 512
 v_bfe_u32 v255, v0, 4, 2
 v_lshl_add_u32 v4, v255, 9, v4
 v_bfe_u32 v255, v0, 0, 4
 v_lshl_add_u32 v4, v255, 4, v4
 v_bfe_u32 v255, v0, 4, 2
 v_mul_u32_u24 v5, 2560, v255
 v_bfe_u32 v255, v0, 0, 4
 v_lshl_add_u32 v5, v255, 4, v5
 s_mul_i32 s56, s22, 163840
 s_lshl_b32 s25, s21, 12
 s_add_u32 s56, s56, s25
 s_add_u32 s56, s56, 103677952
 s_mul_i32 s57, s22, 40960
 s_lshl_b32 s25, s21, 10
 s_add_u32 s57, s57, s25
 s_add_u32 s57, s57, 187564032
 s_mul_i32 s58, s21, 20480
 s_add_u32 s58, s58, 221118464
 s_mul_i32 s59, s22, 5120
 v_lshlrev_b32 v6, 4, v0
 v_add_u32 v7, 4096, v6
 v_cmp_gt_u32 vcc, 64, v0
 v_mov_b32 v23, 0x80000000
 s_nop 0
 v_cndmask_b32 v7, v23, v7, vcc
 s_mul_i32 s86, s21, 10752
 v_mov_b32 v1, s86
 v_bfe_u32 v255, v0, 0, 4
 s_mov_b32 s101, 336
 v_mad_u32_u24 v1, v255, s101, v1
 v_bfe_u32 v255, v0, 4, 2
 v_lshl_add_u32 v1, v255, 4, v1
 v_bfe_u32 v255, v0, 0, 5
 v_mul_u32_u24 v16, 336, v255
 v_bfe_u32 v255, v0, 5, 3
 v_lshl_add_u32 v16, v255, 5, v16
 v_add_u32 v17, 256, v16
 s_lshl_b32 s25, s21, 7
 s_add_u32 s25, s25, s3
 s_add_u32 s32, s25, 16384
 s_lshl_b32 s25, s21, 11
 s_add_u32 s25, s25, s3
 s_add_u32 s25, s25, 24576
 v_mov_b32 v22, s25
 v_bfe_u32 v255, v0, 0, 4
 v_lshl_add_u32 v22, v255, 7, v22
 s_lshl_b32 s25, s22, 2
 s_add_u32 s25, s25, s21
 s_lshl_b32 s25, s25, 7
 s_add_u32 s25, s25, s3
 s_add_u32 s34, s25, 12288
 s_lshl_b32 s25, s22, 6
 s_add_u32 s25, s25, s3
 s_add_u32 s35, s25, 16896
 s_lshl_b32 s25, s22, 2
 s_add_u32 s25, s25, s3
 s_add_u32 s25, s25, 32768
 v_mov_b32 v18, 0x80000000
 v_mov_b32 v255, s25
 v_cmp_eq_u32 vcc, 0, v0
 s_nop 1
 v_cndmask_b32 v18, v18, v255, vcc
 v_mov_b32 v21, 1
 s_mov_b32 s36, 0
 s_mov_b32 s37, 0
 s_mov_b32 s38, 0
 s_mov_b32 s31, 0
 s_cmp_gt_u32 s36, s20
 s_cbranch_scc1 wok_2086
 s_mov_b32 s100, 0
ww_2085:
 s_cmp_eq_u32 s100, 0
 s_cbranch_scc1 w1_2087
 s_sleep 2
w1_2087:
 s_load_dwordx8 s[40:47], s[4:5], s32 glc
 s_add_u32 s100, s100, 1
 s_cmp_gt_u32 s100, 200000
 s_cbranch_scc1 main_fail
 s_waitcnt lgkmcnt(0)
 s_min_u32 s40, s40, s41
 s_min_u32 s40, s40, s42
 s_min_u32 s40, s40, s43
 s_min_u32 s40, s40, s44
 s_min_u32 s40, s40, s45
 s_min_u32 s40, s40, s46
 s_min_u32 s40, s40, s47
 s_mov_b32 s36, s40
 s_cmp_gt_u32 s40, s20
 s_cbranch_scc0 ww_2085
wok_2086:
 s_mul_i32 s24, s20, 1310720
 s_add_u32 s24, s24, s56
 s_add_u32 s8, s24, 0
 s_add_u32 s9, s24, 32768
 s_add_u32 s10, s24, 65536
 s_add_u32 s11, s24, 98304
 s_add_u32 s12, s24, 131072
 buffer_load_dwordx4 a[0:3], v2, s[4:7], s8 offen offset:0 sc1
 buffer_load_dwordx4 a[4:7], v2, s[4:7], s9 offen offset:0 sc1
 buffer_load_dwordx4 a[8:11], v2, s[4:7], s10 offen offset:0 sc1
 buffer_load_dwordx4 a[12:15], v2, s[4:7], s11 offen offset:0 sc1
 buffer_load_dwordx4 a[16:19], v2, s[4:7], s12 offen offset:0 sc1
 buffer_load_dwordx4 a[20:23], v2, s[4:7], s8 offen offset:512 sc1
 buffer_load_dwordx4 a[24:27], v2, s[4:7], s9 offen offset:512 sc1
 buffer_load_dwordx4 a[28:31], v2, s[4:7], s10 offen offset:512 sc1
 buffer_load_dwordx4 a[32:35], v2, s[4:7], s11 offen offset:512 sc1
 buffer_load_dwordx4 a[36:39], v2, s[4:7], s12 offen offset:512 sc1
 buffer_load_dwordx4 a[40:43], v2, s[4:7], s8 offen offset:1024 sc1
 buffer_load_dwordx4 a[44:47], v2, s[4:7], s9 offen offset:1024 sc1
 buffer_load_dwordx4 a[48:51], v2, s[4:7], s10 offen offset:1024 sc1
 buffer_load_dwordx4 a[52:55], v2, s[4:7], s11 offen offset:1024 sc1
 buffer_load_dwordx4 a[56:59], v2, s[4:7], s12 offen offset:1024 sc1
 buffer_load_dwordx4 a[60:63], v2, s[4:7], s8 offen offset:1536 sc1
 buffer_load_dwordx4 a[64:67], v2, s[4:7], s9 offen offset:1536 sc1
 buffer_load_dwordx4 a[68:71], v2, s[4:7], s10 offen offset:1536 sc1
 buffer_load_dwordx4 a[72:75], v2, s[4:7], s11 offen offset:1536 sc1
 buffer_load_dwordx4 a[76:79], v2, s[4:7], s12 offen offset:1536 sc1
 buffer_load_dwordx4 a[80:83], v2, s[4:7], s8 offen offset:2048 sc1
 buffer_load_dwordx4 a[84:87], v2, s[4:7], s9 offen offset:2048 sc1
 buffer_load_dwordx4 a[88:91], v2, s[4:7], s10 offen offset:2048 sc1
 buffer_load_dwordx4 a[92:95], v2, s[4:7], s11 offen offset:2048 sc1
 buffer_load_dwordx4 a[96:99], v2, s[4:7], s12 offen offset:2048 sc1
 buffer_load_dwordx4 a[100:103], v2, s[4:7], s8 offen offset:2560 sc1
 buffer_load_dwordx4 a[104:107], v2, s[4:7], s9 offen offset:2560 sc1
 buffer_load_dwordx4 a[108:111], v2, s[4:7], s10 offen offset:2560 sc1
 buffer_load_dwordx4 a[112:115], v2, s[4:7], s11 offen offset:2560 sc1
 buffer_load_dwordx4 a[116:119], v2, s[4:7], s12 offen offset:2560 sc1
 buffer_load_dwordx4 a[120:123], v2, s[4:7], s8 offen offset:3072 sc1
 buffer_load_dwordx4 a[124:127], v2, s[4:7], s9 offen offset:3072 sc1
 buffer_load_dwordx4 a[128:131], v2, s[4:7], s10 offen offset:3072 sc1
 buffer_load_dwordx4 a[132:135], v2, s[4:7], s11 offen offset:3072 sc1
 buffer_load_dwordx4 a[136:139], v2, s[4:7], s12 offen offset:3072 sc1
 buffer_load_dwordx4 a[140:143], v2, s[4:7], s8 offen offset:3584 sc1
 buffer_load_dwordx4 a[144:147], v2, s[4:7], s9 offen offset:3584 sc1
 buffer_load_dwordx4 a[148:151], v2, s[4:7], s10 offen offset:3584 sc1
 buffer_load_dwordx4 a[152:155], v2, s[4:7], s11 offen offset:3584 sc1
 buffer_load_dwordx4 a[156:159], v2, s[4:7], s12 offen offset:3584 sc1
pz_2088:
 s_mul_i32 s26, s20, 327680
 s_add_u32 s26, s26, s57
 s_mul_i32 s27, s20, 81920
 s_add_u32 s27, s27, s58
 s_mul_i32 s28, s20, 40960
 s_add_u32 s28, s28, s59
 s_add_u32 s29, s28, 7340032
 s_add_u32 s28, s28, 4718592
 s_lshl_b32 s39, s20, 7
 s_add_u32 s23, s20, 2
 s_cmp_ge_u32 s23, s14
 s_cselect_b32 s23, s15, s23
 s_add_u32 s25, s20, 4
 s_cmp_ge_u32 s20, s15
 s_cselect_b32 s23, s25, s23
 s_cmp_gt_u32 s36, s23
 s_cbranch_scc1 wok_2091
 s_mov_b32 s100, 0
ww_2090:
 s_cmp_eq_u32 s100, 0
 s_cbranch_scc1 w1_2092
 s_sleep 2
w1_2092:
 s_load_dwordx8 s[40:47], s[4:5], s32 glc
 s_add_u32 s100, s100, 1
 s_cmp_gt_u32 s100, 200000
 s_cbranch_scc1 main_fail
 s_waitcnt lgkmcnt(0)
 s_min_u32 s40, s40, s41
 s_min_u32 s40, s40, s42
 s_min_u32 s40, s40, s43
 s_min_u32 s40, s40, s44
 s_min_u32 s40, s40, s45
 s_min_u32 s40, s40, s46
 s_min_u32 s40, s40, s47
 s_mov_b32 s36, s40
 s_cmp_gt_u32 s40, s23
 s_cbranch_scc0 ww_2090
wok_2091:
 s_mul_i32 s24, s23, 1310720
 s_add_u32 s24, s24, s56
 s_add_u32 s8, s24, 0
 s_add_u32 s9, s24, 32768
 s_add_u32 s10, s24, 65536
 s_add_u32 s11, s24, 98304
 s_add_u32 s12, s24, 131072
 buffer_load_dwordx4 v[8:11], v6, s[4:7], s29 offen sc1
 buffer_load_dwordx4 v[12:15], v7, s[4:7], s29 offen sc1
 s_mov_b32 s100, 0
vw_2093:
 buffer_load_dword v24, v22, s[4:7], 0 offen sc1
 s_add_u32 s100, s100, 1
 s_cmp_gt_u32 s100, 200000
 s_cbranch_scc1 main_fail
 s_waitcnt vmcnt(0)
 v_cmp_ge_u32 vcc, s20, v24
 s_cbranch_vccz vok_2094
 s_sleep 2
 s_branch vw_2093
vok_2094:
 s_load_dword s37, s[4:5], s34 glc
 s_add_u32 s13, s27, 0
 buffer_load_dwordx4 v[96:99], v4, s[4:7], s13 offen offset:0 sc1
 buffer_load_dwordx4 v[100:103], v4, s[4:7], s13 offen offset:256 sc1
 s_add_u32 s13, s27, 2560
 buffer_load_dwordx4 v[104:107], v4, s[4:7], s13 offen offset:0 sc1
 buffer_load_dwordx4 v[108:111], v4, s[4:7], s13 offen offset:256 sc1
 s_add_u32 s13, s27, 5120
 buffer_load_dwordx4 v[112:115], v4, s[4:7], s13 offen offset:0 sc1
 buffer_load_dwordx4 v[116:119], v4, s[4:7], s13 offen offset:256 sc1
 s_add_u32 s13, s27, 7680
 buffer_load_dwordx4 v[120:123], v4, s[4:7], s13 offen offset:0 sc1
 buffer_load_dwordx4 v[124:127], v4, s[4:7], s13 offen offset:256 sc1
 s_waitcnt vmcnt(6)
 v_mfma_f32_16x16x32_bf16 v[32:35], a[0:3], v[96:99], 0
 s_add_u32 s13, s27, 10240
 buffer_load_dwordx4 v[128:131], v4, s[4:7], s13 offen offset:0 sc1
 v_mfma_f32_16x16x32_bf16 v[36:39], a[0:3], v[100:103], 0
 buffer_load_dwordx4 v[132:135], v4, s[4:7], s13 offen offset:256 sc1
 v_mfma_f32_16x16x32_bf16 v[40:43], a[4:7], v[96:99], 0
 v_mfma_f32_16x16x32_bf16 v[44:47], a[4:7], v[100:103], 0
 v_mfma_f32_16x16x32_bf16 v[48:51], a[8:11], v[96:99], 0
 v_mfma_f32_16x16x32_bf16 v[52:55], a[8:11], v[100:103], 0
 v_mfma_f32_16x16x32_bf16 v[56:59], a[12:15], v[96:99], 0
 v_mfma_f32_16x16x32_bf16 v[60:63], a[12:15], v[100:103], 0
 v_mfma_f32_16x16x32_bf16 v[64:67], a[16:19], v[96:99], 0
 v_mfma_f32_16x16x32_bf16 v[68:71], a[16:19], v[100:103], 0
 s_waitcnt vmcnt(6)
 s_add_u32 s25, s20, 2
 s_cmp_gt_u32 s37, s25
 s_cbranch_scc1 fw_done_2097
 s_mov_b32 s100, 0
fw_2098:
 s_load_dword s37, s[4:5], s34 glc
 s_add_u32 s100, s100, 1
 s_cmp_gt_u32 s100, 200000
 s_cbranch_scc1 main_fail
 s_waitcnt lgkmcnt(0)
 s_cmp_gt_u32 s37, s25
 s_cbranch_scc0 fw_2098
fw_done_2097:
 v_mfma_f32_16x16x32_bf16 v[32:35], a[20:23], v[104:107], v[32:35]
 s_add_u32 s13, s27, 12800
 buffer_load_dwordx4 v[136:139], v4, s[4:7], s13 offen offset:0 sc1
 v_mfma_f32_16x16x32_bf16 v[36:39], a[20:23], v[108:111], v[36:39]
 buffer_load_dwordx4 v[140:143], v4, s[4:7], s13 offen offset:256 sc1
 v_mfma_f32_16x16x32_bf16 v[40:43], a[24:27], v[104:107], v[40:43]
 s_add_u32 s30, s26, 0
 buffer_load_dwordx4 a[160:163], v3, s[4:7], s30 offen offset:0 sc1
 v_mfma_f32_16x16x32_bf16 v[44:47], a[24:27], v[108:111], v[44:47]
 s_add_u32 s30, s26, 8192
 buffer_load_dwordx4 a[164:167], v3, s[4:7], s30 offen offset:0 sc1
 v_mfma_f32_16x16x32_bf16 v[48:51], a[28:31], v[104:107], v[48:51]
 s_add_u32 s30, s26, 16384
 buffer_load_dwordx4 a[168:171], v3, s[4:7], s30 offen offset:0 sc1
 v_mfma_f32_16x16x32_bf16 v[52:55], a[28:31], v[108:111], v[52:55]
 s_add_u32 s30, s26, 24576
 buffer_load_dwordx4 a[172:175], v3, s[4:7], s30 offen offset:0 sc1
 v_mfma_f32_16x16x32_bf16 v[56:59], a[32:35], v[104:107], v[56:59]
 s_add_u32 s30, s26, 32768
 buffer_load_dwordx4 a[176:179], v3, s[4:7], s30 offen offset:0 sc1
 v_mfma_f32_16x16x32_bf16 v[60:63], a[32:35], v[108:111], v[60:63]
 v_mfma_f32_16x16x32_bf16 v[64:67], a[36:39], v[104:107], v[64:67]
 v_mfma_f32_16x16x32_bf16 v[68:71], a[36:39], v[108:111], v[68:71]
 s_waitcnt vmcnt(11)
 v_mfma_f32_16x16x32_bf16 v[32:35], a[40:43], v[112:115], v[32:35]
 s_add_u32 s13, s27, 15360
 buffer_load_dwordx4 v[144:147], v4, s[4:7], s13 offen offset:0 sc1
 v_mfma_f32_16x16x32_bf16 v[36:39], a[40:43], v[116:119], v[36:39]
 buffer_load_dwordx4 v[148:151], v4, s[4:7], s13 offen offset:256 sc1
 v_mfma_f32_16x16x32_bf16 v[40:43], a[44:47], v[112:115], v[40:43]
 s_add_u32 s30, s26, 0
 buffer_load_dwordx4 a[180:183], v3, s[4:7], s30 offen offset:512 sc1
 v_mfma_f32_16x16x32_bf16 v[44:47], a[44:47], v[116:119], v[44:47]
 s_add_u32 s30, s26, 8192
 buffer_load_dwordx4 a[184:187], v3, s[4:7], s30 offen offset:512 sc1
 v_mfma_f32_16x16x32_bf16 v[48:51], a[48:51], v[112:115], v[48:51]
 s_add_u32 s30, s26, 16384
 buffer_load_dwordx4 a[188:191], v3, s[4:7], s30 offen offset:512 sc1
 v_mfma_f32_16x16x32_bf16 v[52:55], a[48:51], v[116:119], v[52:55]
 s_add_u32 s30, s26, 24576
 buffer_load_dwordx4 a[192:195], v3, s[4:7], s30 offen offset:512 sc1
 v_mfma_f32_16x16x32_bf16 v[56:59], a[52:55], v[112:115], v[56:59]
 s_add_u32 s30, s26, 32768
 buffer_load_dwordx4 a[196:199], v3, s[4:7], s30 offen offset:512 sc1
 v_mfma_f32_16x16x32_bf16 v[60:63], a[52:55], v[116:119], v[60:63]
 v_mfma_f32_16x16x32_bf16 v[64:67], a[56:59], v[112:115], v[64:67]
 v_mfma_f32_16x16x32_bf16 v[68:71], a[56:59], v[116:119], v[68:71]
 s_waitcnt vmcnt(16)
 v_mfma_f32_16x16x32_bf16 v[32:35], a[60:63], v[120:123], v[32:35]
 s_add_u32 s13, s27, 17920
 buffer_load_dwordx4 v[152:155], v4, s[4:7], s13 offen offset:0 sc1
 v_mfma_f32_16x16x32_bf16 v[36:39], a[60:63], v[124:127], v[36:39]
 buffer_load_dwordx4 v[156:159], v4, s[4:7], s13 offen offset:256 sc1
 v_mfma_f32_16x16x32_bf16 v[40:43], a[64:67], v[120:123], v[40:43]
 buffer_load_dwordx4 a[0:3], v2, s[4:7], s8 offen offset:0 sc1
 v_mfma_f32_16x16x32_bf16 v[44:47], a[64:67], v[124:127], v[44:47]
 buffer_load_dwordx4 a[4:7], v2, s[4:7], s9 offen offset:0 sc1
 v_mfma_f32_16x16x32_bf16 v[48:51], a[68:71], v[120:123], v[48:51]
 buffer_load_dwordx4 a[8:11], v2, s[4:7], s10 offen offset:0 sc1
 v_mfma_f32_16x16x32_bf16 v[52:55], a[68:71], v[124:127], v[52:55]
 buffer_load_dwordx4 a[12:15], v2, s[4:7], s11 offen offset:0 sc1
 v_mfma_f32_16x16x32_bf16 v[56:59], a[72:75], v[120:123], v[56:59]
 buffer_load_dwordx4 a[16:19], v2, s[4:7], s12 offen offset:0 sc1
 v_mfma_f32_16x16x32_bf16 v[60:63], a[72:75], v[124:127], v[60:63]
 v_mfma_f32_16x16x32_bf16 v[64:67], a[76:79], v[120:123], v[64:67]
 v_mfma_f32_16x16x32_bf16 v[68:71], a[76:79], v[124:127], v[68:71]
 s_waitcnt vmcnt(21)
 v_mfma_f32_16x16x32_bf16 v[32:35], a[80:83], v[128:131], v[32:35]
 s_add_u32 s13, s27, 0
 buffer_load_dwordx4 v[160:163], v5, s[4:7], s13 offen offset:0 sc1
 v_mfma_f32_16x16x32_bf16 v[36:39], a[80:83], v[132:135], v[36:39]
 buffer_load_dwordx4 v[164:167], v5, s[4:7], s13 offen offset:256 sc1
 v_mfma_f32_16x16x32_bf16 v[40:43], a[84:87], v[128:131], v[40:43]
 buffer_load_dwordx4 a[20:23], v2, s[4:7], s8 offen offset:512 sc1
 v_mfma_f32_16x16x32_bf16 v[44:47], a[84:87], v[132:135], v[44:47]
 buffer_load_dwordx4 a[24:27], v2, s[4:7], s9 offen offset:512 sc1
 v_mfma_f32_16x16x32_bf16 v[48:51], a[88:91], v[128:131], v[48:51]
 buffer_load_dwordx4 a[28:31], v2, s[4:7], s10 offen offset:512 sc1
 v_mfma_f32_16x16x32_bf16 v[52:55], a[88:91], v[132:135], v[52:55]
 buffer_load_dwordx4 a[32:35], v2, s[4:7], s11 offen offset:512 sc1
 v_mfma_f32_16x16x32_bf16 v[56:59], a[92:95], v[128:131], v[56:59]
 buffer_load_dwordx4 a[36:39], v2, s[4:7], s12 offen offset:512 sc1
 v_mfma_f32_16x16x32_bf16 v[60:63], a[92:95], v[132:135], v[60:63]
 v_mfma_f32_16x16x32_bf16 v[64:67], a[96:99], v[128:131], v[64:67]
 v_mfma_f32_16x16x32_bf16 v[68:71], a[96:99], v[132:135], v[68:71]
 s_waitcnt vmcnt(26)
 v_mfma_f32_16x16x32_bf16 v[32:35], a[100:103], v[136:139], v[32:35]
 s_add_u32 s13, s27, 10240
 buffer_load_dwordx4 v[168:171], v5, s[4:7], s13 offen offset:0 sc1
 v_mfma_f32_16x16x32_bf16 v[36:39], a[100:103], v[140:143], v[36:39]
 buffer_load_dwordx4 v[172:175], v5, s[4:7], s13 offen offset:256 sc1
 v_mfma_f32_16x16x32_bf16 v[40:43], a[104:107], v[136:139], v[40:43]
 buffer_load_dwordx4 a[40:43], v2, s[4:7], s8 offen offset:1024 sc1
 v_mfma_f32_16x16x32_bf16 v[44:47], a[104:107], v[140:143], v[44:47]
 buffer_load_dwordx4 a[44:47], v2, s[4:7], s9 offen offset:1024 sc1
 v_mfma_f32_16x16x32_bf16 v[48:51], a[108:111], v[136:139], v[48:51]
 buffer_load_dwordx4 a[48:51], v2, s[4:7], s10 offen offset:1024 sc1
 v_mfma_f32_16x16x32_bf16 v[52:55], a[108:111], v[140:143], v[52:55]
 buffer_load_dwordx4 a[52:55], v2, s[4:7], s11 offen offset:1024 sc1
 v_mfma_f32_16x16x32_bf16 v[56:59], a[112:115], v[136:139], v[56:59]
 buffer_load_dwordx4 a[56:59], v2, s[4:7], s12 offen offset:1024 sc1
 v_mfma_f32_16x16x32_bf16 v[60:63], a[112:115], v[140:143], v[60:63]
 v_mfma_f32_16x16x32_bf16 v[64:67], a[116:119], v[136:139], v[64:67]
 v_mfma_f32_16x16x32_bf16 v[68:71], a[116:119], v[140:143], v[68:71]
 s_waitcnt vmcnt(26)
 v_mfma_f32_16x16x32_bf16 v[32:35], a[120:123], v[144:147], v[32:35]
 buffer_load_dwordx4 a[60:63], v2, s[4:7], s8 offen offset:1536 sc1
 v_mfma_f32_16x16x32_bf16 v[36:39], a[120:123], v[148:151], v[36:39]
 buffer_load_dwordx4 a[64:67], v2, s[4:7], s9 offen offset:1536 sc1
 v_mfma_f32_16x16x32_bf16 v[40:43], a[124:127], v[144:147], v[40:43]
 buffer_load_dwordx4 a[68:71], v2, s[4:7], s10 offen offset:1536 sc1
 v_mfma_f32_16x16x32_bf16 v[44:47], a[124:127], v[148:151], v[44:47]
 buffer_load_dwordx4 a[72:75], v2, s[4:7], s11 offen offset:1536 sc1
 v_mfma_f32_16x16x32_bf16 v[48:51], a[128:131], v[144:147], v[48:51]
 buffer_load_dwordx4 a[76:79], v2, s[4:7], s12 offen offset:1536 sc1
 v_mfma_f32_16x16x32_bf16 v[52:55], a[128:131], v[148:151], v[52:55]
 v_mfma_f32_16x16x32_bf16 v[56:59], a[132:135], v[144:147], v[56:59]
 v_mfma_f32_16x16x32_bf16 v[60:63], a[132:135], v[148:151], v[60:63]
 v_mfma_f32_16x16x32_bf16 v[64:67], a[136:139], v[144:147], v[64:67]
 v_mfma_f32_16x16x32_bf16 v[68:71], a[136:139], v[148:151], v[68:71]
 s_waitcnt vmcnt(24)
 v_mfma_f32_16x16x32_bf16 v[32:35], a[140:143], v[152:155], v[32:35]
 buffer_load_dwordx4 a[80:83], v2, s[4:7], s8 offen offset:2048 sc1
 v_mfma_f32_16x16x32_bf16 v[36:39], a[140:143], v[156:159], v[36:39]
 buffer_load_dwordx4 a[84:87], v2, s[4:7], s9 offen offset:2048 sc1
 v_mfma_f32_16x16x32_bf16 v[40:43], a[144:147], v[152:155], v[40:43]
 buffer_load_dwordx4 a[88:91], v2, s[4:7], s10 offen offset:2048 sc1
 v_mfma_f32_16x16x32_bf16 v[44:47], a[144:147], v[156:159], v[44:47]
 buffer_load_dwordx4 a[92:95], v2, s[4:7], s11 offen offset:2048 sc1
 v_mfma_f32_16x16x32_bf16 v[48:51], a[148:151], v[152:155], v[48:51]
 buffer_load_dwordx4 a[96:99], v2, s[4:7], s12 offen offset:2048 sc1
 v_mfma_f32_16x16x32_bf16 v[52:55], a[148:151], v[156:159], v[52:55]
 v_mfma_f32_16x16x32_bf16 v[56:59], a[152:155], v[152:155], v[56:59]
 v_mfma_f32_16x16x32_bf16 v[60:63], a[152:155], v[156:159], v[60:63]
 v_mfma_f32_16x16x32_bf16 v[64:67], a[156:159], v[152:155], v[64:67]
 v_mfma_f32_16x16x32_bf16 v[68:71], a[156:159], v[156:159], v[68:71]
 s_waitcnt vmcnt(22)
 v_mfma_f32_16x16x32_bf16 v[32:35], a[160:163], v[160:163], v[32:35]
 buffer_load_dwordx4 a[100:103], v2, s[4:7], s8 offen offset:2560 sc1
 v_mfma_f32_16x16x32_bf16 v[36:39], a[160:163], v[164:167], v[36:39]
 buffer_load_dwordx4 a[104:107], v2, s[4:7], s9 offen offset:2560 sc1
 v_mfma_f32_16x16x32_bf16 v[40:43], a[164:167], v[160:163], v[40:43]
 buffer_load_dwordx4 a[108:111], v2, s[4:7], s10 offen offset:2560 sc1
 v_mfma_f32_16x16x32_bf16 v[44:47], a[164:167], v[164:167], v[44:47]
 buffer_load_dwordx4 a[112:115], v2, s[4:7], s11 offen offset:2560 sc1
 v_mfma_f32_16x16x32_bf16 v[48:51], a[168:171], v[160:163], v[48:51]
 buffer_load_dwordx4 a[116:119], v2, s[4:7], s12 offen offset:2560 sc1
 v_mfma_f32_16x16x32_bf16 v[52:55], a[168:171], v[164:167], v[52:55]
 v_mfma_f32_16x16x32_bf16 v[56:59], a[172:175], v[160:163], v[56:59]
 v_mfma_f32_16x16x32_bf16 v[60:63], a[172:175], v[164:167], v[60:63]
 v_mfma_f32_16x16x32_bf16 v[64:67], a[176:179], v[160:163], v[64:67]
 v_mfma_f32_16x16x32_bf16 v[68:71], a[176:179], v[164:167], v[68:71]
 s_waitcnt vmcnt(20)
 v_mfma_f32_16x16x32_bf16 v[32:35], a[180:183], v[168:171], v[32:35]
 buffer_load_dwordx4 a[120:123], v2, s[4:7], s8 offen offset:3072 sc1
 v_mfma_f32_16x16x32_bf16 v[36:39], a[180:183], v[172:175], v[36:39]
 buffer_load_dwordx4 a[124:127], v2, s[4:7], s9 offen offset:3072 sc1
 v_mfma_f32_16x16x32_bf16 v[40:43], a[184:187], v[168:171], v[40:43]
 buffer_load_dwordx4 a[128:131], v2, s[4:7], s10 offen offset:3072 sc1
 v_mfma_f32_16x16x32_bf16 v[44:47], a[184:187], v[172:175], v[44:47]
 buffer_load_dwordx4 a[132:135], v2, s[4:7], s11 offen offset:3072 sc1
 v_mfma_f32_16x16x32_bf16 v[48:51], a[188:191], v[168:171], v[48:51]
 buffer_load_dwordx4 a[136:139], v2, s[4:7], s12 offen offset:3072 sc1
 v_mfma_f32_16x16x32_bf16 v[52:55], a[188:191], v[172:175], v[52:55]
 v_mfma_f32_16x16x32_bf16 v[56:59], a[192:195], v[168:171], v[56:59]
 v_mfma_f32_16x16x32_bf16 v[60:63], a[192:195], v[172:175], v[60:63]
 v_mfma_f32_16x16x32_bf16 v[64:67], a[196:199], v[168:171], v[64:67]
 v_mfma_f32_16x16x32_bf16 v[68:71], a[196:199], v[172:175], v[68:71]
 ds_write_b128 v1, v[32:35] offset:0
 ds_write_b128 v1, v[36:39] offset:5376
 ds_write_b128 v1, v[40:43] offset:64
 ds_write_b128 v1, v[44:47] offset:5440
 ds_write_b128 v1, v[48:51] offset:128
 ds_write_b128 v1, v[52:55] offset:5504
 ds_write_b128 v1, v[56:59] offset:192
 ds_write_b128 v1, v[60:63] offset:5568
 ds_write_b128 v1, v[64:67] offset:256
 ds_write_b128 v1, v[68:71] offset:5632
 s_waitcnt lgkmcnt(0)
 s_barrier
 ds_read_b128 v[32:35], v16 offset:0
 ds_read_b128 v[36:39], v16 offset:16
 ds_read_b128 v[40:43], v16 offset:10752
 ds_read_b128 v[44:47], v16 offset:10768
 ds_read_b128 v[48:51], v16 offset:21504
 ds_read_b128 v[52:55], v16 offset:21520
 ds_read_b128 v[56:59], v16 offset:32256
 ds_read_b128 v[60:63], v16 offset:32272
 s_waitcnt lgkmcnt(4)
 v_pk_add_f32 v[32:33], v[32:33], v[40:41]
 v_pk_add_f32 v[34:35], v[34:35], v[42:43]
 v_pk_add_f32 v[36:37], v[36:37], v[44:45]
 v_pk_add_f32 v[38:39], v[38:39], v[46:47]
 s_waitcnt lgkmcnt(0)
 v_pk_add_f32 v[48:49], v[48:49], v[56:57]
 v_pk_add_f32 v[50:51], v[50:51], v[58:59]
 v_pk_add_f32 v[52:53], v[52:53], v[60:61]
 v_pk_add_f32 v[54:55], v[54:55], v[62:63]
 v_pk_add_f32 v[32:33], v[32:33], v[48:49]
 v_pk_add_f32 v[34:35], v[34:35], v[50:51]
 v_pk_add_f32 v[36:37], v[36:37], v[52:53]
 v_pk_add_f32 v[38:39], v[38:39], v[54:55]
 v_lshlrev_b32 v64, 16, v8
 v_and_b32 v65, 0xffff0000, v8
 v_lshlrev_b32 v66, 16, v9
 v_and_b32 v67, 0xffff0000, v9
 v_lshlrev_b32 v68, 16, v10
 v_and_b32 v69, 0xffff0000, v10
 v_lshlrev_b32 v70, 16, v11
 v_and_b32 v71, 0xffff0000, v11
 v_pk_add_f32 v[32:33], v[32:33], v[64:65]
 v_pk_add_f32 v[34:35], v[34:35], v[66:67]
 v_pk_add_f32 v[36:37], v[36:37], v[68:69]
 v_pk_add_f32 v[38:39], v[38:39], v[70:71]
 v_cvt_pk_bf16_f32 v72, v32, v33
 v_cvt_pk_bf16_f32 v73, v34, v35
 v_cvt_pk_bf16_f32 v74, v36, v37
 v_cvt_pk_bf16_f32 v75, v38, v39
 buffer_store_dwordx4 v[72:75], v6, s[4:7], s28 offen sc1
 s_cmp_lg_u32 s21, 0
 s_cbranch_scc1 pzs_2100
 ds_read_b128 v[32:35], v17 offset:0
 ds_read_b128 v[36:39], v17 offset:16
 ds_read_b128 v[40:43], v17 offset:10752
 ds_read_b128 v[44:47], v17 offset:10768
 ds_read_b128 v[48:51], v17 offset:21504
 ds_read_b128 v[52:55], v17 offset:21520
 ds_read_b128 v[56:59], v17 offset:32256
 ds_read_b128 v[60:63], v17 offset:32272
 s_waitcnt lgkmcnt(4)
 v_pk_add_f32 v[32:33], v[32:33], v[40:41]
 v_pk_add_f32 v[34:35], v[34:35], v[42:43]
 v_pk_add_f32 v[36:37], v[36:37], v[44:45]
 v_pk_add_f32 v[38:39], v[38:39], v[46:47]
 s_waitcnt lgkmcnt(0)
 v_pk_add_f32 v[48:49], v[48:49], v[56:57]
 v_pk_add_f32 v[50:51], v[50:51], v[58:59]
 v_pk_add_f32 v[52:53], v[52:53], v[60:61]
 v_pk_add_f32 v[54:55], v[54:55], v[62:63]
 v_pk_add_f32 v[32:33], v[32:33], v[48:49]
 v_pk_add_f32 v[34:35], v[34:35], v[50:51]
 v_pk_add_f32 v[36:37], v[36:37], v[52:53]
 v_pk_add_f32 v[38:39], v[38:39], v[54:55]
 v_lshlrev_b32 v64, 16, v12
 v_and_b32 v65, 0xffff0000, v12
 v_lshlrev_b32 v66, 16, v13
 v_and_b32 v67, 0xffff0000, v13
 v_lshlrev_b32 v68, 16, v14
 v_and_b32 v69, 0xffff0000, v14
 v_lshlrev_b32 v70, 16, v15
 v_and_b32 v71, 0xffff0000, v15
 v_pk_add_f32 v[32:33], v[32:33], v[64:65]
 v_pk_add_f32 v[34:35], v[34:35], v[66:67]
 v_pk_add_f32 v[36:37], v[36:37], v[68:69]
 v_pk_add_f32 v[38:39], v[38:39], v[70:71]
 v_cvt_pk_bf16_f32 v76, v32, v33
 v_cvt_pk_bf16_f32 v77, v34, v35
 v_cvt_pk_bf16_f32 v78, v36, v37
 v_cvt_pk_bf16_f32 v79, v38, v39
 buffer_store_dwordx4 v[76:79], v7, s[4:7], s28 offen sc1
pzs_2100:
 buffer_load_dwordx4 a[140:143], v2, s[4:7], s8 offen offset:3584 sc1
 buffer_load_dwordx4 a[144:147], v2, s[4:7], s9 offen offset:3584 sc1
 buffer_load_dwordx4 a[148:151], v2, s[4:7], s10 offen offset:3584 sc1
 buffer_load_dwordx4 a[152:155], v2, s[4:7], s11 offen offset:3584 sc1
 buffer_load_dwordx4 a[156:159], v2, s[4:7], s12 offen offset:3584 sc1
 s_mov_b32 s20, s23
 s_waitcnt vmcnt(5)
 s_barrier
 buffer_store_dword v21, v18, s[4:7], s39 offen sc1
 s_cmp_lt_u32 s20, 60
 s_cbranch_scc1 pz_2088
 s_mul_i32 s26, s20, 327680
 s_add_u32 s26, s26, s57
 s_mul_i32 s27, s20, 81920
 s_add_u32 s27, s27, s58
 s_mul_i32 s28, s20, 40960
 s_add_u32 s28, s28, s59
 s_add_u32 s29, s28, 7340032
 s_add_u32 s28, s28, 4718592
 s_lshl_b32 s39, s20, 7
 buffer_load_dwordx4 v[8:11], v6, s[4:7], s29 offen sc1
 buffer_load_dwordx4 v[12:15], v7, s[4:7], s29 offen sc1
 s_cmp_ge_u32 s20, 62
 s_cbranch_scc1 pzl_2101
 s_add_u32 s25, s20, 2
 s_cmp_gt_u32 s37, s25
 s_cbranch_scc1 fw_done_2103
 s_mov_b32 s100, 0
fw_2104:
 s_load_dword s37, s[4:5], s34 glc
 s_add_u32 s100, s100, 1
 s_cmp_gt_u32 s100, 200000
 s_cbranch_scc1 main_fail
 s_waitcnt lgkmcnt(0)
 s_cmp_gt_u32 s37, s25
 s_cbranch_scc0 fw_2104
fw_done_2103:
 s_branch pzy_2102
pzl_2101:
 s_mov_b32 s100, 0
ww_2105:
 s_cmp_eq_u32 s100, 0
 s_cbranch_scc1 w1_2107
 s_sleep 2
w1_2107:
 s_load_dwordx16 s[40:55], s[4:5], s35 glc
 s_add_u32 s100, s100, 1
 s_cmp_gt_u32 s100, 200000
 s_cbranch_scc1 main_fail
 s_waitcnt lgkmcnt(0)
 s_min_u32 s40, s40, s41
 s_min_u32 s40, s40, s42
 s_min_u32 s40, s40, s43
 s_min_u32 s40, s40, s44
 s_min_u32 s40, s40, s45
 s_min_u32 s40, s40, s46
 s_min_u32 s40, s40, s47
 s_min_u32 s40, s40, s48
 s_min_u32 s40, s40, s49
 s_cmp_gt_u32 s40, 0
 s_cbranch_scc0 ww_2105
wok_2106:
pzy_2102:
 s_add_u32 s30, s26, 0
 buffer_load_dwordx4 a[160:163], v3, s[4:7], s30 offen offset:0 sc1
 s_add_u32 s30, s26, 8192
 buffer_load_dwordx4 a[164:167], v3, s[4:7], s30 offen offset:0 sc1
 s_add_u32 s30, s26, 16384
 buffer_load_dwordx4 a[168:171], v3, s[4:7], s30 offen offset:0 sc1
 s_add_u32 s30, s26, 24576
 buffer_load_dwordx4 a[172:175], v3, s[4:7], s30 offen offset:0 sc1
 s_add_u32 s30, s26, 32768
 buffer_load_dwordx4 a[176:179], v3, s[4:7], s30 offen offset:0 sc1
 s_add_u32 s30, s26, 0
 buffer_load_dwordx4 a[180:183], v3, s[4:7], s30 offen offset:512 sc1
 s_add_u32 s30, s26, 8192
 buffer_load_dwordx4 a[184:187], v3, s[4:7], s30 offen offset:512 sc1
 s_add_u32 s30, s26, 16384
 buffer_load_dwordx4 a[188:191], v3, s[4:7], s30 offen offset:512 sc1
 s_add_u32 s30, s26, 24576
 buffer_load_dwordx4 a[192:195], v3, s[4:7], s30 offen offset:512 sc1
 s_add_u32 s30, s26, 32768
 buffer_load_dwordx4 a[196:199], v3, s[4:7], s30 offen offset:512 sc1
 s_mov_b32 s100, 0
vw_2108:
 buffer_load_dword v24, v22, s[4:7], 0 offen sc1
 s_add_u32 s100, s100, 1
 s_cmp_gt_u32 s100, 200000
 s_cbranch_scc1 main_fail
 s_waitcnt vmcnt(0)
 v_cmp_ge_u32 vcc, s20, v24
 s_cbranch_vccz vok_2109
 s_branch vw_2108
vok_2109:
 s_add_u32 s13, s27, 0
 buffer_load_dwordx4 v[96:99], v4, s[4:7], s13 offen offset:0 sc1
 buffer_load_dwordx4 v[100:103], v4, s[4:7], s13 offen offset:256 sc1
 s_add_u32 s13, s27, 2560
 buffer_load_dwordx4 v[104:107], v4, s[4:7], s13 offen offset:0 sc1
 buffer_load_dwordx4 v[108:111], v4, s[4:7], s13 offen offset:256 sc1
 s_add_u32 s13, s27, 5120
 buffer_load_dwordx4 v[112:115], v4, s[4:7], s13 offen offset:0 sc1
 buffer_load_dwordx4 v[116:119], v4, s[4:7], s13 offen offset:256 sc1
 s_add_u32 s13, s27, 7680
 buffer_load_dwordx4 v[120:123], v4, s[4:7], s13 offen offset:0 sc1
 buffer_load_dwordx4 v[124:127], v4, s[4:7], s13 offen offset:256 sc1
 s_waitcnt vmcnt(6)
 v_mfma_f32_16x16x32_bf16 v[32:35], a[0:3], v[96:99], 0
 s_add_u32 s13, s27, 10240
 buffer_load_dwordx4 v[128:131], v4, s[4:7], s13 offen offset:0 sc1
 v_mfma_f32_16x16x32_bf16 v[36:39], a[0:3], v[100:103], 0
 buffer_load_dwordx4 v[132:135], v4, s[4:7], s13 offen offset:256 sc1
 v_mfma_f32_16x16x32_bf16 v[40:43], a[4:7], v[96:99], 0
 v_mfma_f32_16x16x32_bf16 v[44:47], a[4:7], v[100:103], 0
 v_mfma_f32_16x16x32_bf16 v[48:51], a[8:11], v[96:99], 0
 v_mfma_f32_16x16x32_bf16 v[52:55], a[8:11], v[100:103], 0
 v_mfma_f32_16x16x32_bf16 v[56:59], a[12:15], v[96:99], 0
 v_mfma_f32_16x16x32_bf16 v[60:63], a[12:15], v[100:103], 0
 v_mfma_f32_16x16x32_bf16 v[64:67], a[16:19], v[96:99], 0
 v_mfma_f32_16x16x32_bf16 v[68:71], a[16:19], v[100:103], 0
 s_waitcnt vmcnt(6)
 v_mfma_f32_16x16x32_bf16 v[32:35], a[20:23], v[104:107], v[32:35]
 s_add_u32 s13, s27, 12800
 buffer_load_dwordx4 v[136:139], v4, s[4:7], s13 offen offset:0 sc1
 v_mfma_f32_16x16x32_bf16 v[36:39], a[20:23], v[108:111], v[36:39]
 buffer_load_dwordx4 v[140:143], v4, s[4:7], s13 offen offset:256 sc1
 v_mfma_f32_16x16x32_bf16 v[40:43], a[24:27], v[104:107], v[40:43]
 v_mfma_f32_16x16x32_bf16 v[44:47], a[24:27], v[108:111], v[44:47]
 v_mfma_f32_16x16x32_bf16 v[48:51], a[28:31], v[104:107], v[48:51]
 v_mfma_f32_16x16x32_bf16 v[52:55], a[28:31], v[108:111], v[52:55]
 v_mfma_f32_16x16x32_bf16 v[56:59], a[32:35], v[104:107], v[56:59]
 v_mfma_f32_16x16x32_bf16 v[60:63], a[32:35], v[108:111], v[60:63]
 v_mfma_f32_16x16x32_bf16 v[64:67], a[36:39], v[104:107], v[64:67]
 v_mfma_f32_16x16x32_bf16 v[68:71], a[36:39], v[108:111], v[68:71]
 s_waitcnt vmcnt(6)
 v_mfma_f32_16x16x32_bf16 v[32:35], a[40:43], v[112:115], v[32:35]
 s_add_u32 s13, s27, 15360
 buffer_load_dwordx4 v[144:147], v4, s[4:7], s13 offen offset:0 sc1
 v_mfma_f32_16x16x32_bf16 v[36:39], a[40:43], v[116:119], v[36:39]
 buffer_load_dwordx4 v[148:151], v4, s[4:7], s13 offen offset:256 sc1
 v_mfma_f32_16x16x32_bf16 v[40:43], a[44:47], v[112:115], v[40:43]
 v_mfma_f32_16x16x32_bf16 v[44:47], a[44:47], v[116:119], v[44:47]
 v_mfma_f32_16x16x32_bf16 v[48:51], a[48:51], v[112:115], v[48:51]
 v_mfma_f32_16x16x32_bf16 v[52:55], a[48:51], v[116:119], v[52:55]
 v_mfma_f32_16x16x32_bf16 v[56:59], a[52:55], v[112:115], v[56:59]
 v_mfma_f32_16x16x32_bf16 v[60:63], a[52:55], v[116:119], v[60:63]
 v_mfma_f32_16x16x32_bf16 v[64:67], a[56:59], v[112:115], v[64:67]
 v_mfma_f32_16x16x32_bf16 v[68:71], a[56:59], v[116:119], v[68:71]
 s_waitcnt vmcnt(6)
 v_mfma_f32_16x16x32_bf16 v[32:35], a[60:63], v[120:123], v[32:35]
 s_add_u32 s13, s27, 17920
 buffer_load_dwordx4 v[152:155], v4, s[4:7], s13 offen offset:0 sc1
 v_mfma_f32_16x16x32_bf16 v[36:39], a[60:63], v[124:127], v[36:39]
 buffer_load_dwordx4 v[156:159], v4, s[4:7], s13 offen offset:256 sc1
 v_mfma_f32_16x16x32_bf16 v[40:43], a[64:67], v[120:123], v[40:43]
 v_mfma_f32_16x16x32_bf16 v[44:47], a[64:67], v[124:127], v[44:47]
 v_mfma_f32_16x16x32_bf16 v[48:51], a[68:71], v[120:123], v[48:51]
 v_mfma_f32_16x16x32_bf16 v[52:55], a[68:71], v[124:127], v[52:55]
 v_mfma_f32_16x16x32_bf16 v[56:59], a[72:75], v[120:123], v[56:59]
 v_mfma_f32_16x16x32_bf16 v[60:63], a[72:75], v[124:127], v[60:63]
 v_mfma_f32_16x16x32_bf16 v[64:67], a[76:79], v[120:123], v[64:67]
 v_mfma_f32_16x16x32_bf16 v[68:71], a[76:79], v[124:127], v[68:71]
 s_waitcnt vmcnt(6)
 v_mfma_f32_16x16x32_bf16 v[32:35], a[80:83], v[128:131], v[32:35]
 s_add_u32 s13, s27, 0
 buffer_load_dwordx4 v[160:163], v5, s[4:7], s13 offen offset:0 sc1
 v_mfma_f32_16x16x32_bf16 v[36:39], a[80:83], v[132:135], v[36:39]
 buffer_load_dwordx4 v[164:167], v5, s[4:7], s13 offen offset:256 sc1
 v_mfma_f32_16x16x32_bf16 v[40:43], a[84:87], v[128:131], v[40:43]
 v_mfma_f32_16x16x32_bf16 v[44:47], a[84:87], v[132:135], v[44:47]
 v_mfma_f32_16x16x32_bf16 v[48:51], a[88:91], v[128:131], v[48:51]
 v_mfma_f32_16x16x32_bf16 v[52:55], a[88:91], v[132:135], v[52:55]
 v_mfma_f32_16x16x32_bf16 v[56:59], a[92:95], v[128:131], v[56:59]
 v_mfma_f32_16x16x32_bf16 v[60:63], a[92:95], v[132:135], v[60:63]
 v_mfma_f32_16x16x32_bf16 v[64:67], a[96:99], v[128:131], v[64:67]
 v_mfma_f32_16x16x32_bf16 v[68:71], a[96:99], v[132:135], v[68:71]
 s_waitcnt vmcnt(6)
 v_mfma_f32_16x16x32_bf16 v[32:35], a[100:103], v[136:139], v[32:35]
 s_add_u32 s13, s27, 10240
 buffer_load_dwordx4 v[168:171], v5, s[4:7], s13 offen offset:0 sc1
 v_mfma_f32_16x16x32_bf16 v[36:39], a[100:103], v[140:143], v[36:39]
 buffer_load_dwordx4 v[172:175], v5, s[4:7], s13 offen offset:256 sc1
 v_mfma_f32_16x16x32_bf16 v[40:43], a[104:107], v[136:139], v[40:43]
 v_mfma_f32_16x16x32_bf16 v[44:47], a[104:107], v[140:143], v[44:47]
 v_mfma_f32_16x16x32_bf16 v[48:51], a[108:111], v[136:139], v[48:51]
 v_mfma_f32_16x16x32_bf16 v[52:55], a[108:111], v[140:143], v[52:55]
 v_mfma_f32_16x16x32_bf16 v[56:59], a[112:115], v[136:139], v[56:59]
 v_mfma_f32_16x16x32_bf16 v[60:63], a[112:115], v[140:143], v[60:63]
 v_mfma_f32_16x16x32_bf16 v[64:67], a[116:119], v[136:139], v[64:67]
 v_mfma_f32_16x16x32_bf16 v[68:71], a[116:119], v[140:143], v[68:71]
 s_waitcnt vmcnt(6)
 v_mfma_f32_16x16x32_bf16 v[32:35], a[120:123], v[144:147], v[32:35]
 v_mfma_f32_16x16x32_bf16 v[36:39], a[120:123], v[148:151], v[36:39]
 v_mfma_f32_16x16x32_bf16 v[40:43], a[124:127], v[144:147], v[40:43]
 v_mfma_f32_16x16x32_bf16 v[44:47], a[124:127], v[148:151], v[44:47]
 v_mfma_f32_16x16x32_bf16 v[48:51], a[128:131], v[144:147], v[48:51]
 v_mfma_f32_16x16x32_bf16 v[52:55], a[128:131], v[148:151], v[52:55]
 v_mfma_f32_16x16x32_bf16 v[56:59], a[132:135], v[144:147], v[56:59]
 v_mfma_f32_16x16x32_bf16 v[60:63], a[132:135], v[148:151], v[60:63]
 v_mfma_f32_16x16x32_bf16 v[64:67], a[136:139], v[144:147], v[64:67]
 v_mfma_f32_16x16x32_bf16 v[68:71], a[136:139], v[148:151], v[68:71]
 s_waitcnt vmcnt(4)
 v_mfma_f32_16x16x32_bf16 v[32:35], a[140:143], v[152:155], v[32:35]
 v_mfma_f32_16x16x32_bf16 v[36:39], a[140:143], v[156:159], v[36:39]
 v_mfma_f32_16x16x32_bf16 v[40:43], a[144:147], v[152:155], v[40:43]
 v_mfma_f32_16x16x32_bf16 v[44:47], a[144:147], v[156:159], v[44:47]
 v_mfma_f32_16x16x32_bf16 v[48:51], a[148:151], v[152:155], v[48:51]
 v_mfma_f32_16x16x32_bf16 v[52:55], a[148:151], v[156:159], v[52:55]
 v_mfma_f32_16x16x32_bf16 v[56:59], a[152:155], v[152:155], v[56:59]
 v_mfma_f32_16x16x32_bf16 v[60:63], a[152:155], v[156:159], v[60:63]
 v_mfma_f32_16x16x32_bf16 v[64:67], a[156:159], v[152:155], v[64:67]
 v_mfma_f32_16x16x32_bf16 v[68:71], a[156:159], v[156:159], v[68:71]
 s_waitcnt vmcnt(2)
 v_mfma_f32_16x16x32_bf16 v[32:35], a[160:163], v[160:163], v[32:35]
 v_mfma_f32_16x16x32_bf16 v[36:39], a[160:163], v[164:167], v[36:39]
 v_mfma_f32_16x16x32_bf16 v[40:43], a[164:167], v[160:163], v[40:43]
 v_mfma_f32_16x16x32_bf16 v[44:47], a[164:167], v[164:167], v[44:47]
 v_mfma_f32_16x16x32_bf16 v[48:51], a[168:171], v[160:163], v[48:51]
 v_mfma_f32_16x16x32_bf16 v[52:55], a[168:171], v[164:167], v[52:55]
 v_mfma_f32_16x16x32_bf16 v[56:59], a[172:175], v[160:163], v[56:59]
 v_mfma_f32_16x16x32_bf16 v[60:63], a[172:175], v[164:167], v[60:63]
 v_mfma_f32_16x16x32_bf16 v[64:67], a[176:179], v[160:163], v[64:67]
 v_mfma_f32_16x16x32_bf16 v[68:71], a[176:179], v[164:167], v[68:71]
 s_waitcnt vmcnt(0)
 v_mfma_f32_16x16x32_bf16 v[32:35], a[180:183], v[168:171], v[32:35]
 v_mfma_f32_16x16x32_bf16 v[36:39], a[180:183], v[172:175], v[36:39]
 v_mfma_f32_16x16x32_bf16 v[40:43], a[184:187], v[168:171], v[40:43]
 v_mfma_f32_16x16x32_bf16 v[44:47], a[184:187], v[172:175], v[44:47]
 v_mfma_f32_16x16x32_bf16 v[48:51], a[188:191], v[168:171], v[48:51]
 v_mfma_f32_16x16x32_bf16 v[52:55], a[188:191], v[172:175], v[52:55]
 v_mfma_f32_16x16x32_bf16 v[56:59], a[192:195], v[168:171], v[56:59]
 v_mfma_f32_16x16x32_bf16 v[60:63], a[192:195], v[172:175], v[60:63]
 v_mfma_f32_16x16x32_bf16 v[64:67], a[196:199], v[168:171], v[64:67]
 v_mfma_f32_16x16x32_bf16 v[68:71], a[196:199], v[172:175], v[68:71]
 ds_write_b128 v1, v[32:35] offset:0
 ds_write_b128 v1, v[36:39] offset:5376
 ds_write_b128 v1, v[40:43] offset:64
 ds_write_b128 v1, v[44:47] offset:5440
 ds_write_b128 v1, v[48:51] offset:128
 ds_write_b128 v1, v[52:55] offset:5504
 ds_write_b128 v1, v[56:59] offset:192
 ds_write_b128 v1, v[60:63] offset:5568
 ds_write_b128 v1, v[64:67] offset:256
 ds_write_b128 v1, v[68:71] offset:5632
 s_waitcnt lgkmcnt(0)
 s_barrier
 ds_read_b128 v[32:35], v16 offset:0
 ds_read_b128 v[36:39], v16 offset:16
 ds_read_b128 v[40:43], v16 offset:10752
 ds_read_b128 v[44:47], v16 offset:10768
 ds_read_b128 v[48:51], v16 offset:21504
 ds_read_b128 v[52:55], v16 offset:21520
 ds_read_b128 v[56:59], v16 offset:32256
 ds_read_b128 v[60:63], v16 offset:32272
 s_waitcnt lgkmcnt(4)
 v_pk_add_f32 v[32:33], v[32:33], v[40:41]
 v_pk_add_f32 v[34:35], v[34:35], v[42:43]
 v_pk_add_f32 v[36:37], v[36:37], v[44:45]
 v_pk_add_f32 v[38:39], v[38:39], v[46:47]
 s_waitcnt lgkmcnt(0)
 v_pk_add_f32 v[48:49], v[48:49], v[56:57]
 v_pk_add_f32 v[50:51], v[50:51], v[58:59]
 v_pk_add_f32 v[52:53], v[52:53], v[60:61]
 v_pk_add_f32 v[54:55], v[54:55], v[62:63]
 v_pk_add_f32 v[32:33], v[32:33], v[48:49]
 v_pk_add_f32 v[34:35], v[34:35], v[50:51]
 v_pk_add_f32 v[36:37], v[36:37], v[52:53]
 v_pk_add_f32 v[38:39], v[38:39], v[54:55]
 v_lshlrev_b32 v64, 16, v8
 v_and_b32 v65, 0xffff0000, v8
 v_lshlrev_b32 v66, 16, v9
 v_and_b32 v67, 0xffff0000, v9
 v_lshlrev_b32 v68, 16, v10
 v_and_b32 v69, 0xffff0000, v10
 v_lshlrev_b32 v70, 16, v11
 v_and_b32 v71, 0xffff0000, v11
 v_pk_add_f32 v[32:33], v[32:33], v[64:65]
 v_pk_add_f32 v[34:35], v[34:35], v[66:67]
 v_pk_add_f32 v[36:37], v[36:37], v[68:69]
 v_pk_add_f32 v[38:39], v[38:39], v[70:71]
 v_cvt_pk_bf16_f32 v72, v32, v33
 v_cvt_pk_bf16_f32 v73, v34, v35
 v_cvt_pk_bf16_f32 v74, v36, v37
 v_cvt_pk_bf16_f32 v75, v38, v39
 buffer_store_dwordx4 v[72:75], v6, s[4:7], s28 offen sc1
 s_cmp_lg_u32 s21, 0
 s_cbranch_scc1 pzs_2111
 ds_read_b128 v[32:35], v17 offset:0
 ds_read_b128 v[36:39], v17 offset:16
 ds_read_b128 v[40:43], v17 offset:10752
 ds_read_b128 v[44:47], v17 offset:10768
 ds_read_b128 v[48:51], v17 offset:21504
 ds_read_b128 v[52:55], v17 offset:21520
 ds_read_b128 v[56:59], v17 offset:32256
 ds_read_b128 v[60:63], v17 offset:32272
 s_waitcnt lgkmcnt(4)
 v_pk_add_f32 v[32:33], v[32:33], v[40:41]
 v_pk_add_f32 v[34:35], v[34:35], v[42:43]
 v_pk_add_f32 v[36:37], v[36:37], v[44:45]
 v_pk_add_f32 v[38:39], v[38:39], v[46:47]
 s_waitcnt lgkmcnt(0)
 v_pk_add_f32 v[48:49], v[48:49], v[56:57]
 v_pk_add_f32 v[50:51], v[50:51], v[58:59]
 v_pk_add_f32 v[52:53], v[52:53], v[60:61]
 v_pk_add_f32 v[54:55], v[54:55], v[62:63]
 v_pk_add_f32 v[32:33], v[32:33], v[48:49]
 v_pk_add_f32 v[34:35], v[34:35], v[50:51]
 v_pk_add_f32 v[36:37], v[36:37], v[52:53]
 v_pk_add_f32 v[38:39], v[38:39], v[54:55]
 v_lshlrev_b32 v64, 16, v12
 v_and_b32 v65, 0xffff0000, v12
 v_lshlrev_b32 v66, 16, v13
 v_and_b32 v67, 0xffff0000, v13
 v_lshlrev_b32 v68, 16, v14
 v_and_b32 v69, 0xffff0000, v14
 v_lshlrev_b32 v70, 16, v15
 v_and_b32 v71, 0xffff0000, v15
 v_pk_add_f32 v[32:33], v[32:33], v[64:65]
 v_pk_add_f32 v[34:35], v[34:35], v[66:67]
 v_pk_add_f32 v[36:37], v[36:37], v[68:69]
 v_pk_add_f32 v[38:39], v[38:39], v[70:71]
 v_cvt_pk_bf16_f32 v76, v32, v33
 v_cvt_pk_bf16_f32 v77, v34, v35
 v_cvt_pk_bf16_f32 v78, v36, v37
 v_cvt_pk_bf16_f32 v79, v38, v39
 buffer_store_dwordx4 v[76:79], v7, s[4:7], s28 offen sc1
pzs_2111:
 s_waitcnt vmcnt(0)
 s_barrier
 buffer_store_dword v21, v18, s[4:7], s39 offen sc1
 s_branch after_pz
after_pz:
 s_cmp_eq_u32 s85, 5
 s_cbranch_scc1 g2_task
 s_cmp_lg_u32 s98, 0
 s_cbranch_scc1 g2_task
 s_mov_b32 s98, 1
 s_add_u32 s3, s3, 655360
 s_add_u32 s18, s18, 655360
 s_branch load_kv
main_fail:
 s_load_dwordx2 s[8:9], s[0:1], 104
 v_mov_b32 v1, 0
 v_mov_b32 v2, s2
 v_or_b32 v2, 0x10000, v2
 v_mov_b32 v3, s31
 s_waitcnt vmcnt(0) lgkmcnt(0)
 global_store_dwordx2 v1, v[2:3], s[8:9]
 s_endpgm
g2_task:
 s_and_b32 s24, s2, 7
 s_lshr_b32 s25, s2, 3
 s_lshl_b32 s96, s24, 5
 s_add_u32 s96, s96, s25
 s_mov_b32 s97, 256
 s_cmp_lg_u32 s98, 0
 s_cbranch_scc1 g2go_2114
 s_sub_u32 s96, s96, 32
 s_cmp_lt_u32 s24, 4
 s_cbranch_scc1 g2go_2114
 s_sub_u32 s24, s24, 4
 s_sub_u32 s26, s25, 4
 s_min_u32 s26, s26, s25
 s_mul_i32 s96, s24, 28
 s_add_u32 s96, s96, s26
 s_add_u32 s96, s96, 96
 s_sub_u32 s26, s25, 20
 s_min_u32 s26, s26, s25
 s_mul_i32 s27, s24, 12
 s_add_u32 s26, s26, s27
 s_add_u32 s26, s26, 208
 s_cmp_ge_u32 s85, 4
 s_cselect_b32 s97, s26, s97
g2go_2114:
 s_cmp_lg_u32 s98, 0
 s_cbranch_scc1 nf_2115
 s_add_u32 s95, s3, 17664
 v_mov_b32 v2, s95
 v_bfe_u32 v191, v0, 0, 6
 v_lshl_add_u32 v2, v191, 2, v2
 s_mov_b32 s100, 0
vw_2116:
 buffer_load_dword v3, v2, s[4:7], 0 offen sc1
 s_add_u32 s100, s100, 1
 s_cmp_gt_u32 s100, 200000
 s_cbranch_scc1 main_fail
 s_waitcnt vmcnt(0)
 v_cmp_ge_u32 vcc, 0, v3
 s_cbranch_vccz vok_2117
 s_sleep 2
 s_branch vw_2116
vok_2117:
nf_2115:
g2l_2112:
 s_waitcnt vmcnt(0) lgkmcnt(0)
 s_barrier
 v_bfe_u32 v191, v0, 4, 2
 v_lshlrev_b32 v3, 15, v191
 v_bfe_u32 v191, v0, 0, 4
 v_lshl_add_u32 v3, v191, 4, v3
 s_mul_i32 s26, s21, 1572864
 s_lshr_b32 s25, s96, 3
 s_lshl_b32 s25, s25, 10
 s_add_u32 s26, s26, s25
 s_add_u32 s26, s26, 20840448
 s_mul_i32 s27, s21, 40960
 s_add_u32 s25, s26, 262144
 s_add_u32 m0, s27, 0
 s_nop 0
 buffer_load_dwordx4 v3, s[4:7], s25 offen sc1 lds
 s_add_u32 s25, s26, 262400
 s_add_u32 m0, s27, 1024
 s_nop 0
 buffer_load_dwordx4 v3, s[4:7], s25 offen sc1 lds
 s_add_u32 s25, s26, 262656
 s_add_u32 m0, s27, 2048
 s_nop 0
 buffer_load_dwordx4 v3, s[4:7], s25 offen sc1 lds
 s_add_u32 s25, s26, 262912
 s_add_u32 m0, s27, 3072
 s_nop 0
 buffer_load_dwordx4 v3, s[4:7], s25 offen sc1 lds
 s_add_u32 s25, s26, 393216
 s_add_u32 m0, s27, 4096
 s_nop 0
 buffer_load_dwordx4 v3, s[4:7], s25 offen sc1 lds
 s_add_u32 s25, s26, 393472
 s_add_u32 m0, s27, 5120
 s_nop 0
 buffer_load_dwordx4 v3, s[4:7], s25 offen sc1 lds
 s_add_u32 s25, s26, 393728
 s_add_u32 m0, s27, 6144
 s_nop 0
 buffer_load_dwordx4 v3, s[4:7], s25 offen sc1 lds
 s_add_u32 s25, s26, 393984
 s_add_u32 m0, s27, 7168
 s_nop 0
 buffer_load_dwordx4 v3, s[4:7], s25 offen sc1 lds
 s_add_u32 s25, s26, 524288
 s_add_u32 m0, s27, 8192
 s_nop 0
 buffer_load_dwordx4 v3, s[4:7], s25 offen sc1 lds
 s_add_u32 s25, s26, 524544
 s_add_u32 m0, s27, 9216
 s_nop 0
 buffer_load_dwordx4 v3, s[4:7], s25 offen sc1 lds
 s_add_u32 s25, s26, 524800
 s_add_u32 m0, s27, 10240
 s_nop 0
 buffer_load_dwordx4 v3, s[4:7], s25 offen sc1 lds
 s_add_u32 s25, s26, 525056
 s_add_u32 m0, s27, 11264
 s_nop 0
 buffer_load_dwordx4 v3, s[4:7], s25 offen sc1 lds
 s_add_u32 s25, s26, 655360
 s_add_u32 m0, s27, 12288
 s_nop 0
 buffer_load_dwordx4 v3, s[4:7], s25 offen sc1 lds
 s_add_u32 s25, s26, 655616
 s_add_u32 m0, s27, 13312
 s_nop 0
 buffer_load_dwordx4 v3, s[4:7], s25 offen sc1 lds
 s_add_u32 s25, s26, 655872
 s_add_u32 m0, s27, 14336
 s_nop 0
 buffer_load_dwordx4 v3, s[4:7], s25 offen sc1 lds
 s_add_u32 s25, s26, 656128
 s_add_u32 m0, s27, 15360
 s_nop 0
 buffer_load_dwordx4 v3, s[4:7], s25 offen sc1 lds
 s_add_u32 s25, s26, 786432
 s_add_u32 m0, s27, 16384
 s_nop 0
 buffer_load_dwordx4 v3, s[4:7], s25 offen sc1 lds
 s_add_u32 s25, s26, 786688
 s_add_u32 m0, s27, 17408
 s_nop 0
 buffer_load_dwordx4 v3, s[4:7], s25 offen sc1 lds
 s_add_u32 s25, s26, 786944
 s_add_u32 m0, s27, 18432
 s_nop 0
 buffer_load_dwordx4 v3, s[4:7], s25 offen sc1 lds
 s_add_u32 s25, s26, 787200
 s_add_u32 m0, s27, 19456
 s_nop 0
 buffer_load_dwordx4 v3, s[4:7], s25 offen sc1 lds
 s_add_u32 s25, s26, 917504
 s_add_u32 m0, s27, 20480
 s_nop 0
 buffer_load_dwordx4 v3, s[4:7], s25 offen sc1 lds
 s_add_u32 s25, s26, 917760
 s_add_u32 m0, s27, 21504
 s_nop 0
 buffer_load_dwordx4 v3, s[4:7], s25 offen sc1 lds
 s_add_u32 s25, s26, 918016
 s_add_u32 m0, s27, 22528
 s_nop 0
 buffer_load_dwordx4 v3, s[4:7], s25 offen sc1 lds
 s_add_u32 s25, s26, 918272
 s_add_u32 m0, s27, 23552
 s_nop 0
 buffer_load_dwordx4 v3, s[4:7], s25 offen sc1 lds
 s_add_u32 s25, s26, 1048576
 s_add_u32 m0, s27, 24576
 s_nop 0
 buffer_load_dwordx4 v3, s[4:7], s25 offen sc1 lds
 s_add_u32 s25, s26, 1048832
 s_add_u32 m0, s27, 25600
 s_nop 0
 buffer_load_dwordx4 v3, s[4:7], s25 offen sc1 lds
 s_add_u32 s25, s26, 1049088
 s_add_u32 m0, s27, 26624
 s_nop 0
 buffer_load_dwordx4 v3, s[4:7], s25 offen sc1 lds
 s_add_u32 s25, s26, 1049344
 s_add_u32 m0, s27, 27648
 s_nop 0
 buffer_load_dwordx4 v3, s[4:7], s25 offen sc1 lds
 s_add_u32 s25, s26, 1179648
 s_add_u32 m0, s27, 28672
 s_nop 0
 buffer_load_dwordx4 v3, s[4:7], s25 offen sc1 lds
 s_add_u32 s25, s26, 1179904
 s_add_u32 m0, s27, 29696
 s_nop 0
 buffer_load_dwordx4 v3, s[4:7], s25 offen sc1 lds
 s_add_u32 s25, s26, 1180160
 s_add_u32 m0, s27, 30720
 s_nop 0
 buffer_load_dwordx4 v3, s[4:7], s25 offen sc1 lds
 s_add_u32 s25, s26, 1180416
 s_add_u32 m0, s27, 31744
 s_nop 0
 buffer_load_dwordx4 v3, s[4:7], s25 offen sc1 lds
 s_add_u32 s25, s26, 1310720
 s_add_u32 m0, s27, 32768
 s_nop 0
 buffer_load_dwordx4 v3, s[4:7], s25 offen sc1 lds
 s_add_u32 s25, s26, 1310976
 s_add_u32 m0, s27, 33792
 s_nop 0
 buffer_load_dwordx4 v3, s[4:7], s25 offen sc1 lds
 s_add_u32 s25, s26, 1311232
 s_add_u32 m0, s27, 34816
 s_nop 0
 buffer_load_dwordx4 v3, s[4:7], s25 offen sc1 lds
 s_add_u32 s25, s26, 1311488
 s_add_u32 m0, s27, 35840
 s_nop 0
 buffer_load_dwordx4 v3, s[4:7], s25 offen sc1 lds
 s_add_u32 s25, s26, 1441792
 s_add_u32 m0, s27, 36864
 s_nop 0
 buffer_load_dwordx4 v3, s[4:7], s25 offen sc1 lds
 s_add_u32 s25, s26, 1442048
 s_add_u32 m0, s27, 37888
 s_nop 0
 buffer_load_dwordx4 v3, s[4:7], s25 offen sc1 lds
 s_add_u32 s25, s26, 1442304
 s_add_u32 m0, s27, 38912
 s_nop 0
 buffer_load_dwordx4 v3, s[4:7], s25 offen sc1 lds
 s_add_u32 s25, s26, 1442560
 s_add_u32 m0, s27, 39936
 s_nop 0
 buffer_load_dwordx4 v3, s[4:7], s25 offen sc1 lds
g2_ready:
 s_load_dwordx2 s[8:9], s[0:1], 88
 s_mov_b32 s10, 4096
 s_mov_b32 s11, 0x20000
 s_load_dwordx2 s[12:13], s[0:1], 96
 s_mov_b32 s14, 2621440
 s_mov_b32 s15, 0x20000
 s_lshr_b32 s20, s96, 3
 s_and_b32 s22, s96, 7
 s_waitcnt lgkmcnt(0)
 v_bfe_u32 v191, v0, 4, 2
 v_mul_u32_u24 v2, 10240, v191
 v_bfe_u32 v191, v0, 0, 4
 v_lshl_add_u32 v2, v191, 4, v2
 v_bfe_u32 v191, v0, 4, 2
 v_lshlrev_b32 v3, 15, v191
 v_bfe_u32 v191, v0, 0, 4
 v_lshl_add_u32 v3, v191, 4, v3
 s_mul_i32 s24, s21, 491520
 s_mul_i32 s25, s22, 1280
 s_add_u32 s24, s24, s25
 s_add_u32 s24, s24, 12582912
 s_mul_i32 s26, s21, 1572864
 s_lshl_b32 s25, s20, 10
 s_add_u32 s26, s26, s25
 s_add_u32 s26, s26, 20840448
 s_add_u32 s31, s26, 0
 buffer_load_dwordx4 v[112:115], v3, s[4:7], s31 offen offset:0 sc1
 buffer_load_dwordx4 v[116:119], v3, s[4:7], s31 offen offset:256 sc1
 buffer_load_dwordx4 v[120:123], v3, s[4:7], s31 offen offset:512 sc1
 buffer_load_dwordx4 v[124:127], v3, s[4:7], s31 offen offset:768 sc1
 s_add_u32 s31, s26, 131072
 buffer_load_dwordx4 v[128:131], v3, s[4:7], s31 offen offset:0 sc1
 buffer_load_dwordx4 v[132:135], v3, s[4:7], s31 offen offset:256 sc1
 buffer_load_dwordx4 v[136:139], v3, s[4:7], s31 offen offset:512 sc1
 buffer_load_dwordx4 v[140:143], v3, s[4:7], s31 offen offset:768 sc1
 s_lshl_b32 s27, s20, 7
 s_mul_i32 s28, s20, 81920
 s_mul_i32 s25, s22, 5120
 s_add_u32 s28, s28, s25
 s_add_u32 s29, s28, 4718592
 s_add_u32 s28, s28, 7340032
 s_mul_i32 s33, s20, 81920
 s_mul_i32 s25, s22, 160
 s_add_u32 s33, s33, s25
 s_cmp_eq_u32 s98, 0
 s_cselect_b32 s28, s28, 0x20000000
 s_cselect_b32 s33, 0x20000000, s33
 v_bfe_u32 v191, v0, 0, 6
 v_lshlrev_b32 v4, 1, v191
 v_bfe_u32 v191, v0, 0, 5
 v_lshlrev_b32 v6, 4, v191
 v_bfe_u32 v191, v0, 5, 1
 s_mov_b32 s101, 40960
 v_mad_u32_u24 v6, v191, s101, v6
 v_bfe_u32 v191, v0, 6, 2
 v_lshl_add_u32 v6, v191, 9, v6
 v_add_u32 v7, 4096, v6
 v_cmp_gt_u32 vcc, 128, v0
 v_mov_b32 v23, 0x80000000
 s_nop 0
 v_cndmask_b32 v7, v23, v7, vcc
 v_bfe_u32 v191, v0, 0, 6
 v_mul_u32_u24 v24, 1280, v191
 v_bfe_u32 v191, v0, 6, 2
 v_lshl_add_u32 v24, v191, 4, v24
 buffer_load_ushort v5, v4, s[8:11], s27 offen
 v_bfe_u32 v191, v0, 0, 6
 v_lshlrev_b32 v28, 4, v191
 v_bfe_u32 v191, v0, 6, 2
 s_mov_b32 s101, 40960
 v_mad_u32_u24 v28, v191, s101, v28
 v_bfe_u32 v191, v0, 0, 4
 v_mul_u32_u24 v1, 336, v191
 v_bfe_u32 v191, v0, 4, 2
 v_lshl_add_u32 v1, v191, 4, v1
 v_bfe_u32 v191, v0, 6, 2
 s_mov_b32 s101, 40960
 v_mad_u32_u24 v1, v191, s101, v1
 v_bfe_u32 v191, v0, 0, 6
 v_mul_u32_u24 v25, 336, v191
 v_bfe_u32 v191, v0, 6, 2
 v_lshl_add_u32 v25, v191, 5, v25
 v_add_u32 v29, 81920, v25
 s_lshl_b32 s23, s21, 4
 s_lshr_b32 s25, s22, 1
 s_add_u32 s23, s23, s25
 s_lshl_b32 s23, s23, 7
 s_add_u32 s95, s3, 40960
 s_add_u32 s95, s95, s23
 v_mov_b32 v20, s95
 v_bfe_u32 v191, v0, 0, 2
 v_lshl_add_u32 v20, v191, 9, v20
 s_mov_b32 s100, 0
vw_2118:
 buffer_load_dword v21, v20, s[4:7], 0 offen sc1
 s_add_u32 s100, s100, 1
 s_cmp_gt_u32 s100, 200000
 s_cbranch_scc1 main_fail
 s_waitcnt vmcnt(0)
 v_cmp_ge_u32 vcc, 0, v21
 s_cbranch_vccz vok_2119
 s_sleep 1
 s_branch vw_2118
vok_2119:
 s_add_u32 s30, s24, 0
 buffer_load_dwordx4 v[144:147], v2, s[4:7], s30 offen offset:0 sc1
 buffer_load_dwordx4 v[148:151], v2, s[4:7], s30 offen offset:256 sc1
 buffer_load_dwordx4 v[152:155], v2, s[4:7], s30 offen offset:512 sc1
 buffer_load_dwordx4 v[156:159], v2, s[4:7], s30 offen offset:768 sc1
 buffer_load_dwordx4 v[160:163], v2, s[4:7], s30 offen offset:1024 sc1
 s_add_u32 s30, s24, 40960
 buffer_load_dwordx4 v[164:167], v2, s[4:7], s30 offen offset:0 sc1
 buffer_load_dwordx4 v[168:171], v2, s[4:7], s30 offen offset:256 sc1
 buffer_load_dwordx4 v[172:175], v2, s[4:7], s30 offen offset:512 sc1
 buffer_load_dwordx4 v[176:179], v2, s[4:7], s30 offen offset:768 sc1
 buffer_load_dwordx4 v[180:183], v2, s[4:7], s30 offen offset:1024 sc1
 s_waitcnt vmcnt(9)
 v_mfma_f32_16x16x32_bf16 v[32:35], v[144:147], v[112:115], 0
 v_mfma_f32_16x16x32_bf16 v[36:39], v[144:147], v[116:119], 0
 v_mfma_f32_16x16x32_bf16 v[40:43], v[144:147], v[120:123], 0
 v_mfma_f32_16x16x32_bf16 v[44:47], v[144:147], v[124:127], 0
 s_add_u32 s30, s24, 81920
 buffer_load_dwordx4 v[144:147], v2, s[4:7], s30 offen offset:0 sc1
 s_waitcnt vmcnt(9)
 v_mfma_f32_16x16x32_bf16 v[48:51], v[148:151], v[112:115], 0
 v_mfma_f32_16x16x32_bf16 v[52:55], v[148:151], v[116:119], 0
 v_mfma_f32_16x16x32_bf16 v[56:59], v[148:151], v[120:123], 0
 v_mfma_f32_16x16x32_bf16 v[60:63], v[148:151], v[124:127], 0
 buffer_load_dwordx4 v[148:151], v2, s[4:7], s30 offen offset:256 sc1
 s_waitcnt vmcnt(9)
 v_mfma_f32_16x16x32_bf16 v[64:67], v[152:155], v[112:115], 0
 v_mfma_f32_16x16x32_bf16 v[68:71], v[152:155], v[116:119], 0
 v_mfma_f32_16x16x32_bf16 v[72:75], v[152:155], v[120:123], 0
 v_mfma_f32_16x16x32_bf16 v[76:79], v[152:155], v[124:127], 0
 buffer_load_dwordx4 v[152:155], v2, s[4:7], s30 offen offset:512 sc1
 s_waitcnt vmcnt(9)
 v_mfma_f32_16x16x32_bf16 v[80:83], v[156:159], v[112:115], 0
 v_mfma_f32_16x16x32_bf16 v[84:87], v[156:159], v[116:119], 0
 v_mfma_f32_16x16x32_bf16 v[88:91], v[156:159], v[120:123], 0
 v_mfma_f32_16x16x32_bf16 v[92:95], v[156:159], v[124:127], 0
 buffer_load_dwordx4 v[156:159], v2, s[4:7], s30 offen offset:768 sc1
 s_waitcnt vmcnt(9)
 v_mfma_f32_16x16x32_bf16 v[96:99], v[160:163], v[112:115], 0
 ds_read_b128 v[112:115], v28 offset:0
 v_mfma_f32_16x16x32_bf16 v[100:103], v[160:163], v[116:119], 0
 ds_read_b128 v[116:119], v28 offset:1024
 v_mfma_f32_16x16x32_bf16 v[104:107], v[160:163], v[120:123], 0
 ds_read_b128 v[120:123], v28 offset:2048
 v_mfma_f32_16x16x32_bf16 v[108:111], v[160:163], v[124:127], 0
 ds_read_b128 v[124:127], v28 offset:3072
 buffer_load_dwordx4 v[160:163], v2, s[4:7], s30 offen offset:1024 sc1
 s_waitcnt vmcnt(9)
 v_mfma_f32_16x16x32_bf16 v[32:35], v[164:167], v[128:131], v[32:35]
 v_mfma_f32_16x16x32_bf16 v[36:39], v[164:167], v[132:135], v[36:39]
 v_mfma_f32_16x16x32_bf16 v[40:43], v[164:167], v[136:139], v[40:43]
 v_mfma_f32_16x16x32_bf16 v[44:47], v[164:167], v[140:143], v[44:47]
 s_add_u32 s30, s24, 122880
 buffer_load_dwordx4 v[164:167], v2, s[4:7], s30 offen offset:0 sc1
 s_waitcnt vmcnt(9)
 v_mfma_f32_16x16x32_bf16 v[48:51], v[168:171], v[128:131], v[48:51]
 v_mfma_f32_16x16x32_bf16 v[52:55], v[168:171], v[132:135], v[52:55]
 v_mfma_f32_16x16x32_bf16 v[56:59], v[168:171], v[136:139], v[56:59]
 v_mfma_f32_16x16x32_bf16 v[60:63], v[168:171], v[140:143], v[60:63]
 buffer_load_dwordx4 v[168:171], v2, s[4:7], s30 offen offset:256 sc1
 s_waitcnt vmcnt(9)
 v_mfma_f32_16x16x32_bf16 v[64:67], v[172:175], v[128:131], v[64:67]
 v_mfma_f32_16x16x32_bf16 v[68:71], v[172:175], v[132:135], v[68:71]
 v_mfma_f32_16x16x32_bf16 v[72:75], v[172:175], v[136:139], v[72:75]
 v_mfma_f32_16x16x32_bf16 v[76:79], v[172:175], v[140:143], v[76:79]
 buffer_load_dwordx4 v[172:175], v2, s[4:7], s30 offen offset:512 sc1
 s_waitcnt vmcnt(9)
 v_mfma_f32_16x16x32_bf16 v[80:83], v[176:179], v[128:131], v[80:83]
 v_mfma_f32_16x16x32_bf16 v[84:87], v[176:179], v[132:135], v[84:87]
 v_mfma_f32_16x16x32_bf16 v[88:91], v[176:179], v[136:139], v[88:91]
 v_mfma_f32_16x16x32_bf16 v[92:95], v[176:179], v[140:143], v[92:95]
 buffer_load_dwordx4 v[176:179], v2, s[4:7], s30 offen offset:768 sc1
 s_waitcnt vmcnt(9)
 v_mfma_f32_16x16x32_bf16 v[96:99], v[180:183], v[128:131], v[96:99]
 ds_read_b128 v[128:131], v28 offset:4096
 v_mfma_f32_16x16x32_bf16 v[100:103], v[180:183], v[132:135], v[100:103]
 ds_read_b128 v[132:135], v28 offset:5120
 v_mfma_f32_16x16x32_bf16 v[104:107], v[180:183], v[136:139], v[104:107]
 ds_read_b128 v[136:139], v28 offset:6144
 v_mfma_f32_16x16x32_bf16 v[108:111], v[180:183], v[140:143], v[108:111]
 ds_read_b128 v[140:143], v28 offset:7168
 buffer_load_dwordx4 v[180:183], v2, s[4:7], s30 offen offset:1024 sc1
 s_waitcnt lgkmcnt(4)
 s_waitcnt vmcnt(9)
 v_mfma_f32_16x16x32_bf16 v[32:35], v[144:147], v[112:115], v[32:35]
 v_mfma_f32_16x16x32_bf16 v[36:39], v[144:147], v[116:119], v[36:39]
 v_mfma_f32_16x16x32_bf16 v[40:43], v[144:147], v[120:123], v[40:43]
 v_mfma_f32_16x16x32_bf16 v[44:47], v[144:147], v[124:127], v[44:47]
 s_add_u32 s30, s24, 163840
 buffer_load_dwordx4 v[144:147], v2, s[4:7], s30 offen offset:0 sc1
 s_waitcnt vmcnt(9)
 v_mfma_f32_16x16x32_bf16 v[48:51], v[148:151], v[112:115], v[48:51]
 v_mfma_f32_16x16x32_bf16 v[52:55], v[148:151], v[116:119], v[52:55]
 v_mfma_f32_16x16x32_bf16 v[56:59], v[148:151], v[120:123], v[56:59]
 v_mfma_f32_16x16x32_bf16 v[60:63], v[148:151], v[124:127], v[60:63]
 buffer_load_dwordx4 v[148:151], v2, s[4:7], s30 offen offset:256 sc1
 s_waitcnt vmcnt(9)
 v_mfma_f32_16x16x32_bf16 v[64:67], v[152:155], v[112:115], v[64:67]
 v_mfma_f32_16x16x32_bf16 v[68:71], v[152:155], v[116:119], v[68:71]
 v_mfma_f32_16x16x32_bf16 v[72:75], v[152:155], v[120:123], v[72:75]
 v_mfma_f32_16x16x32_bf16 v[76:79], v[152:155], v[124:127], v[76:79]
 buffer_load_dwordx4 v[152:155], v2, s[4:7], s30 offen offset:512 sc1
 s_waitcnt vmcnt(9)
 v_mfma_f32_16x16x32_bf16 v[80:83], v[156:159], v[112:115], v[80:83]
 v_mfma_f32_16x16x32_bf16 v[84:87], v[156:159], v[116:119], v[84:87]
 v_mfma_f32_16x16x32_bf16 v[88:91], v[156:159], v[120:123], v[88:91]
 v_mfma_f32_16x16x32_bf16 v[92:95], v[156:159], v[124:127], v[92:95]
 buffer_load_dwordx4 v[156:159], v2, s[4:7], s30 offen offset:768 sc1
 s_waitcnt vmcnt(9)
 v_mfma_f32_16x16x32_bf16 v[96:99], v[160:163], v[112:115], v[96:99]
 ds_read_b128 v[112:115], v28 offset:8192
 v_mfma_f32_16x16x32_bf16 v[100:103], v[160:163], v[116:119], v[100:103]
 ds_read_b128 v[116:119], v28 offset:9216
 v_mfma_f32_16x16x32_bf16 v[104:107], v[160:163], v[120:123], v[104:107]
 ds_read_b128 v[120:123], v28 offset:10240
 v_mfma_f32_16x16x32_bf16 v[108:111], v[160:163], v[124:127], v[108:111]
 ds_read_b128 v[124:127], v28 offset:11264
 buffer_load_dwordx4 v[160:163], v2, s[4:7], s30 offen offset:1024 sc1
 s_waitcnt lgkmcnt(4)
 s_waitcnt vmcnt(9)
 v_mfma_f32_16x16x32_bf16 v[32:35], v[164:167], v[128:131], v[32:35]
 v_mfma_f32_16x16x32_bf16 v[36:39], v[164:167], v[132:135], v[36:39]
 v_mfma_f32_16x16x32_bf16 v[40:43], v[164:167], v[136:139], v[40:43]
 v_mfma_f32_16x16x32_bf16 v[44:47], v[164:167], v[140:143], v[44:47]
 s_add_u32 s30, s24, 204800
 buffer_load_dwordx4 v[164:167], v2, s[4:7], s30 offen offset:0 sc1
 s_waitcnt vmcnt(9)
 v_mfma_f32_16x16x32_bf16 v[48:51], v[168:171], v[128:131], v[48:51]
 v_mfma_f32_16x16x32_bf16 v[52:55], v[168:171], v[132:135], v[52:55]
 v_mfma_f32_16x16x32_bf16 v[56:59], v[168:171], v[136:139], v[56:59]
 v_mfma_f32_16x16x32_bf16 v[60:63], v[168:171], v[140:143], v[60:63]
 buffer_load_dwordx4 v[168:171], v2, s[4:7], s30 offen offset:256 sc1
 s_waitcnt vmcnt(9)
 v_mfma_f32_16x16x32_bf16 v[64:67], v[172:175], v[128:131], v[64:67]
 v_mfma_f32_16x16x32_bf16 v[68:71], v[172:175], v[132:135], v[68:71]
 v_mfma_f32_16x16x32_bf16 v[72:75], v[172:175], v[136:139], v[72:75]
 v_mfma_f32_16x16x32_bf16 v[76:79], v[172:175], v[140:143], v[76:79]
 buffer_load_dwordx4 v[172:175], v2, s[4:7], s30 offen offset:512 sc1
 s_waitcnt vmcnt(9)
 v_mfma_f32_16x16x32_bf16 v[80:83], v[176:179], v[128:131], v[80:83]
 v_mfma_f32_16x16x32_bf16 v[84:87], v[176:179], v[132:135], v[84:87]
 v_mfma_f32_16x16x32_bf16 v[88:91], v[176:179], v[136:139], v[88:91]
 v_mfma_f32_16x16x32_bf16 v[92:95], v[176:179], v[140:143], v[92:95]
 buffer_load_dwordx4 v[176:179], v2, s[4:7], s30 offen offset:768 sc1
 s_waitcnt vmcnt(9)
 v_mfma_f32_16x16x32_bf16 v[96:99], v[180:183], v[128:131], v[96:99]
 ds_read_b128 v[128:131], v28 offset:12288
 v_mfma_f32_16x16x32_bf16 v[100:103], v[180:183], v[132:135], v[100:103]
 ds_read_b128 v[132:135], v28 offset:13312
 v_mfma_f32_16x16x32_bf16 v[104:107], v[180:183], v[136:139], v[104:107]
 ds_read_b128 v[136:139], v28 offset:14336
 v_mfma_f32_16x16x32_bf16 v[108:111], v[180:183], v[140:143], v[108:111]
 ds_read_b128 v[140:143], v28 offset:15360
 buffer_load_dwordx4 v[180:183], v2, s[4:7], s30 offen offset:1024 sc1
 s_waitcnt lgkmcnt(4)
 s_waitcnt vmcnt(9)
 v_mfma_f32_16x16x32_bf16 v[32:35], v[144:147], v[112:115], v[32:35]
 v_mfma_f32_16x16x32_bf16 v[36:39], v[144:147], v[116:119], v[36:39]
 v_mfma_f32_16x16x32_bf16 v[40:43], v[144:147], v[120:123], v[40:43]
 v_mfma_f32_16x16x32_bf16 v[44:47], v[144:147], v[124:127], v[44:47]
 s_add_u32 s30, s24, 245760
 buffer_load_dwordx4 v[144:147], v2, s[4:7], s30 offen offset:0 sc1
 s_waitcnt vmcnt(9)
 v_mfma_f32_16x16x32_bf16 v[48:51], v[148:151], v[112:115], v[48:51]
 v_mfma_f32_16x16x32_bf16 v[52:55], v[148:151], v[116:119], v[52:55]
 v_mfma_f32_16x16x32_bf16 v[56:59], v[148:151], v[120:123], v[56:59]
 v_mfma_f32_16x16x32_bf16 v[60:63], v[148:151], v[124:127], v[60:63]
 buffer_load_dwordx4 v[148:151], v2, s[4:7], s30 offen offset:256 sc1
 s_waitcnt vmcnt(9)
 v_mfma_f32_16x16x32_bf16 v[64:67], v[152:155], v[112:115], v[64:67]
 v_mfma_f32_16x16x32_bf16 v[68:71], v[152:155], v[116:119], v[68:71]
 v_mfma_f32_16x16x32_bf16 v[72:75], v[152:155], v[120:123], v[72:75]
 v_mfma_f32_16x16x32_bf16 v[76:79], v[152:155], v[124:127], v[76:79]
 buffer_load_dwordx4 v[152:155], v2, s[4:7], s30 offen offset:512 sc1
 s_waitcnt vmcnt(9)
 v_mfma_f32_16x16x32_bf16 v[80:83], v[156:159], v[112:115], v[80:83]
 v_mfma_f32_16x16x32_bf16 v[84:87], v[156:159], v[116:119], v[84:87]
 v_mfma_f32_16x16x32_bf16 v[88:91], v[156:159], v[120:123], v[88:91]
 v_mfma_f32_16x16x32_bf16 v[92:95], v[156:159], v[124:127], v[92:95]
 buffer_load_dwordx4 v[156:159], v2, s[4:7], s30 offen offset:768 sc1
 s_waitcnt vmcnt(9)
 v_mfma_f32_16x16x32_bf16 v[96:99], v[160:163], v[112:115], v[96:99]
 ds_read_b128 v[112:115], v28 offset:16384
 v_mfma_f32_16x16x32_bf16 v[100:103], v[160:163], v[116:119], v[100:103]
 ds_read_b128 v[116:119], v28 offset:17408
 v_mfma_f32_16x16x32_bf16 v[104:107], v[160:163], v[120:123], v[104:107]
 ds_read_b128 v[120:123], v28 offset:18432
 v_mfma_f32_16x16x32_bf16 v[108:111], v[160:163], v[124:127], v[108:111]
 ds_read_b128 v[124:127], v28 offset:19456
 buffer_load_dwordx4 v[160:163], v2, s[4:7], s30 offen offset:1024 sc1
 s_waitcnt lgkmcnt(4)
 s_waitcnt vmcnt(9)
 v_mfma_f32_16x16x32_bf16 v[32:35], v[164:167], v[128:131], v[32:35]
 v_mfma_f32_16x16x32_bf16 v[36:39], v[164:167], v[132:135], v[36:39]
 v_mfma_f32_16x16x32_bf16 v[40:43], v[164:167], v[136:139], v[40:43]
 v_mfma_f32_16x16x32_bf16 v[44:47], v[164:167], v[140:143], v[44:47]
 s_add_u32 s30, s24, 286720
 buffer_load_dwordx4 v[164:167], v2, s[4:7], s30 offen offset:0 sc1
 s_waitcnt vmcnt(9)
 v_mfma_f32_16x16x32_bf16 v[48:51], v[168:171], v[128:131], v[48:51]
 v_mfma_f32_16x16x32_bf16 v[52:55], v[168:171], v[132:135], v[52:55]
 v_mfma_f32_16x16x32_bf16 v[56:59], v[168:171], v[136:139], v[56:59]
 v_mfma_f32_16x16x32_bf16 v[60:63], v[168:171], v[140:143], v[60:63]
 buffer_load_dwordx4 v[168:171], v2, s[4:7], s30 offen offset:256 sc1
 s_waitcnt vmcnt(9)
 v_mfma_f32_16x16x32_bf16 v[64:67], v[172:175], v[128:131], v[64:67]
 v_mfma_f32_16x16x32_bf16 v[68:71], v[172:175], v[132:135], v[68:71]
 v_mfma_f32_16x16x32_bf16 v[72:75], v[172:175], v[136:139], v[72:75]
 v_mfma_f32_16x16x32_bf16 v[76:79], v[172:175], v[140:143], v[76:79]
 buffer_load_dwordx4 v[172:175], v2, s[4:7], s30 offen offset:512 sc1
 s_waitcnt vmcnt(9)
 v_mfma_f32_16x16x32_bf16 v[80:83], v[176:179], v[128:131], v[80:83]
 v_mfma_f32_16x16x32_bf16 v[84:87], v[176:179], v[132:135], v[84:87]
 v_mfma_f32_16x16x32_bf16 v[88:91], v[176:179], v[136:139], v[88:91]
 v_mfma_f32_16x16x32_bf16 v[92:95], v[176:179], v[140:143], v[92:95]
 buffer_load_dwordx4 v[176:179], v2, s[4:7], s30 offen offset:768 sc1
 s_waitcnt vmcnt(9)
 v_mfma_f32_16x16x32_bf16 v[96:99], v[180:183], v[128:131], v[96:99]
 ds_read_b128 v[128:131], v28 offset:20480
 v_mfma_f32_16x16x32_bf16 v[100:103], v[180:183], v[132:135], v[100:103]
 ds_read_b128 v[132:135], v28 offset:21504
 v_mfma_f32_16x16x32_bf16 v[104:107], v[180:183], v[136:139], v[104:107]
 ds_read_b128 v[136:139], v28 offset:22528
 v_mfma_f32_16x16x32_bf16 v[108:111], v[180:183], v[140:143], v[108:111]
 ds_read_b128 v[140:143], v28 offset:23552
 buffer_load_dwordx4 v[180:183], v2, s[4:7], s30 offen offset:1024 sc1
 s_waitcnt lgkmcnt(4)
 s_waitcnt vmcnt(9)
 v_mfma_f32_16x16x32_bf16 v[32:35], v[144:147], v[112:115], v[32:35]
 v_mfma_f32_16x16x32_bf16 v[36:39], v[144:147], v[116:119], v[36:39]
 v_mfma_f32_16x16x32_bf16 v[40:43], v[144:147], v[120:123], v[40:43]
 v_mfma_f32_16x16x32_bf16 v[44:47], v[144:147], v[124:127], v[44:47]
 s_add_u32 s30, s24, 327680
 buffer_load_dwordx4 v[144:147], v2, s[4:7], s30 offen offset:0 sc1
 s_waitcnt vmcnt(9)
 v_mfma_f32_16x16x32_bf16 v[48:51], v[148:151], v[112:115], v[48:51]
 v_mfma_f32_16x16x32_bf16 v[52:55], v[148:151], v[116:119], v[52:55]
 v_mfma_f32_16x16x32_bf16 v[56:59], v[148:151], v[120:123], v[56:59]
 v_mfma_f32_16x16x32_bf16 v[60:63], v[148:151], v[124:127], v[60:63]
 buffer_load_dwordx4 v[148:151], v2, s[4:7], s30 offen offset:256 sc1
 s_waitcnt vmcnt(9)
 v_mfma_f32_16x16x32_bf16 v[64:67], v[152:155], v[112:115], v[64:67]
 v_mfma_f32_16x16x32_bf16 v[68:71], v[152:155], v[116:119], v[68:71]
 v_mfma_f32_16x16x32_bf16 v[72:75], v[152:155], v[120:123], v[72:75]
 v_mfma_f32_16x16x32_bf16 v[76:79], v[152:155], v[124:127], v[76:79]
 buffer_load_dwordx4 v[152:155], v2, s[4:7], s30 offen offset:512 sc1
 s_waitcnt vmcnt(9)
 v_mfma_f32_16x16x32_bf16 v[80:83], v[156:159], v[112:115], v[80:83]
 v_mfma_f32_16x16x32_bf16 v[84:87], v[156:159], v[116:119], v[84:87]
 v_mfma_f32_16x16x32_bf16 v[88:91], v[156:159], v[120:123], v[88:91]
 v_mfma_f32_16x16x32_bf16 v[92:95], v[156:159], v[124:127], v[92:95]
 buffer_load_dwordx4 v[156:159], v2, s[4:7], s30 offen offset:768 sc1
 s_waitcnt vmcnt(9)
 v_mfma_f32_16x16x32_bf16 v[96:99], v[160:163], v[112:115], v[96:99]
 ds_read_b128 v[112:115], v28 offset:24576
 v_mfma_f32_16x16x32_bf16 v[100:103], v[160:163], v[116:119], v[100:103]
 ds_read_b128 v[116:119], v28 offset:25600
 v_mfma_f32_16x16x32_bf16 v[104:107], v[160:163], v[120:123], v[104:107]
 ds_read_b128 v[120:123], v28 offset:26624
 v_mfma_f32_16x16x32_bf16 v[108:111], v[160:163], v[124:127], v[108:111]
 ds_read_b128 v[124:127], v28 offset:27648
 buffer_load_dwordx4 v[160:163], v2, s[4:7], s30 offen offset:1024 sc1
 s_waitcnt lgkmcnt(4)
 s_waitcnt vmcnt(9)
 v_mfma_f32_16x16x32_bf16 v[32:35], v[164:167], v[128:131], v[32:35]
 v_mfma_f32_16x16x32_bf16 v[36:39], v[164:167], v[132:135], v[36:39]
 v_mfma_f32_16x16x32_bf16 v[40:43], v[164:167], v[136:139], v[40:43]
 v_mfma_f32_16x16x32_bf16 v[44:47], v[164:167], v[140:143], v[44:47]
 s_add_u32 s30, s24, 368640
 buffer_load_dwordx4 v[164:167], v2, s[4:7], s30 offen offset:0 sc1
 s_waitcnt vmcnt(9)
 v_mfma_f32_16x16x32_bf16 v[48:51], v[168:171], v[128:131], v[48:51]
 v_mfma_f32_16x16x32_bf16 v[52:55], v[168:171], v[132:135], v[52:55]
 v_mfma_f32_16x16x32_bf16 v[56:59], v[168:171], v[136:139], v[56:59]
 v_mfma_f32_16x16x32_bf16 v[60:63], v[168:171], v[140:143], v[60:63]
 buffer_load_dwordx4 v[168:171], v2, s[4:7], s30 offen offset:256 sc1
 s_waitcnt vmcnt(9)
 v_mfma_f32_16x16x32_bf16 v[64:67], v[172:175], v[128:131], v[64:67]
 v_mfma_f32_16x16x32_bf16 v[68:71], v[172:175], v[132:135], v[68:71]
 v_mfma_f32_16x16x32_bf16 v[72:75], v[172:175], v[136:139], v[72:75]
 v_mfma_f32_16x16x32_bf16 v[76:79], v[172:175], v[140:143], v[76:79]
 buffer_load_dwordx4 v[172:175], v2, s[4:7], s30 offen offset:512 sc1
 s_waitcnt vmcnt(9)
 v_mfma_f32_16x16x32_bf16 v[80:83], v[176:179], v[128:131], v[80:83]
 v_mfma_f32_16x16x32_bf16 v[84:87], v[176:179], v[132:135], v[84:87]
 v_mfma_f32_16x16x32_bf16 v[88:91], v[176:179], v[136:139], v[88:91]
 v_mfma_f32_16x16x32_bf16 v[92:95], v[176:179], v[140:143], v[92:95]
 buffer_load_dwordx4 v[176:179], v2, s[4:7], s30 offen offset:768 sc1
 s_waitcnt vmcnt(9)
 v_mfma_f32_16x16x32_bf16 v[96:99], v[180:183], v[128:131], v[96:99]
 ds_read_b128 v[128:131], v28 offset:28672
 v_mfma_f32_16x16x32_bf16 v[100:103], v[180:183], v[132:135], v[100:103]
 ds_read_b128 v[132:135], v28 offset:29696
 v_mfma_f32_16x16x32_bf16 v[104:107], v[180:183], v[136:139], v[104:107]
 ds_read_b128 v[136:139], v28 offset:30720
 v_mfma_f32_16x16x32_bf16 v[108:111], v[180:183], v[140:143], v[108:111]
 ds_read_b128 v[140:143], v28 offset:31744
 buffer_load_dwordx4 v[180:183], v2, s[4:7], s30 offen offset:1024 sc1
 s_waitcnt lgkmcnt(4)
 s_waitcnt vmcnt(9)
 v_mfma_f32_16x16x32_bf16 v[32:35], v[144:147], v[112:115], v[32:35]
 v_mfma_f32_16x16x32_bf16 v[36:39], v[144:147], v[116:119], v[36:39]
 v_mfma_f32_16x16x32_bf16 v[40:43], v[144:147], v[120:123], v[40:43]
 v_mfma_f32_16x16x32_bf16 v[44:47], v[144:147], v[124:127], v[44:47]
 s_add_u32 s30, s24, 409600
 buffer_load_dwordx4 v[144:147], v2, s[4:7], s30 offen offset:0 sc1
 s_waitcnt vmcnt(9)
 v_mfma_f32_16x16x32_bf16 v[48:51], v[148:151], v[112:115], v[48:51]
 v_mfma_f32_16x16x32_bf16 v[52:55], v[148:151], v[116:119], v[52:55]
 v_mfma_f32_16x16x32_bf16 v[56:59], v[148:151], v[120:123], v[56:59]
 v_mfma_f32_16x16x32_bf16 v[60:63], v[148:151], v[124:127], v[60:63]
 buffer_load_dwordx4 v[148:151], v2, s[4:7], s30 offen offset:256 sc1
 s_waitcnt vmcnt(9)
 v_mfma_f32_16x16x32_bf16 v[64:67], v[152:155], v[112:115], v[64:67]
 v_mfma_f32_16x16x32_bf16 v[68:71], v[152:155], v[116:119], v[68:71]
 v_mfma_f32_16x16x32_bf16 v[72:75], v[152:155], v[120:123], v[72:75]
 v_mfma_f32_16x16x32_bf16 v[76:79], v[152:155], v[124:127], v[76:79]
 buffer_load_dwordx4 v[152:155], v2, s[4:7], s30 offen offset:512 sc1
 s_waitcnt vmcnt(9)
 v_mfma_f32_16x16x32_bf16 v[80:83], v[156:159], v[112:115], v[80:83]
 v_mfma_f32_16x16x32_bf16 v[84:87], v[156:159], v[116:119], v[84:87]
 v_mfma_f32_16x16x32_bf16 v[88:91], v[156:159], v[120:123], v[88:91]
 v_mfma_f32_16x16x32_bf16 v[92:95], v[156:159], v[124:127], v[92:95]
 buffer_load_dwordx4 v[156:159], v2, s[4:7], s30 offen offset:768 sc1
 s_waitcnt vmcnt(9)
 v_mfma_f32_16x16x32_bf16 v[96:99], v[160:163], v[112:115], v[96:99]
 ds_read_b128 v[112:115], v28 offset:32768
 v_mfma_f32_16x16x32_bf16 v[100:103], v[160:163], v[116:119], v[100:103]
 ds_read_b128 v[116:119], v28 offset:33792
 v_mfma_f32_16x16x32_bf16 v[104:107], v[160:163], v[120:123], v[104:107]
 ds_read_b128 v[120:123], v28 offset:34816
 v_mfma_f32_16x16x32_bf16 v[108:111], v[160:163], v[124:127], v[108:111]
 ds_read_b128 v[124:127], v28 offset:35840
 buffer_load_dwordx4 v[160:163], v2, s[4:7], s30 offen offset:1024 sc1
 s_waitcnt lgkmcnt(4)
 s_waitcnt vmcnt(9)
 v_mfma_f32_16x16x32_bf16 v[32:35], v[164:167], v[128:131], v[32:35]
 v_mfma_f32_16x16x32_bf16 v[36:39], v[164:167], v[132:135], v[36:39]
 v_mfma_f32_16x16x32_bf16 v[40:43], v[164:167], v[136:139], v[40:43]
 v_mfma_f32_16x16x32_bf16 v[44:47], v[164:167], v[140:143], v[44:47]
 s_add_u32 s30, s24, 450560
 buffer_load_dwordx4 v[164:167], v2, s[4:7], s30 offen offset:0 sc1
 s_waitcnt vmcnt(9)
 v_mfma_f32_16x16x32_bf16 v[48:51], v[168:171], v[128:131], v[48:51]
 v_mfma_f32_16x16x32_bf16 v[52:55], v[168:171], v[132:135], v[52:55]
 v_mfma_f32_16x16x32_bf16 v[56:59], v[168:171], v[136:139], v[56:59]
 v_mfma_f32_16x16x32_bf16 v[60:63], v[168:171], v[140:143], v[60:63]
 buffer_load_dwordx4 v[168:171], v2, s[4:7], s30 offen offset:256 sc1
 s_waitcnt vmcnt(9)
 v_mfma_f32_16x16x32_bf16 v[64:67], v[172:175], v[128:131], v[64:67]
 v_mfma_f32_16x16x32_bf16 v[68:71], v[172:175], v[132:135], v[68:71]
 v_mfma_f32_16x16x32_bf16 v[72:75], v[172:175], v[136:139], v[72:75]
 v_mfma_f32_16x16x32_bf16 v[76:79], v[172:175], v[140:143], v[76:79]
 buffer_load_dwordx4 v[172:175], v2, s[4:7], s30 offen offset:512 sc1
 s_waitcnt vmcnt(9)
 v_mfma_f32_16x16x32_bf16 v[80:83], v[176:179], v[128:131], v[80:83]
 v_mfma_f32_16x16x32_bf16 v[84:87], v[176:179], v[132:135], v[84:87]
 v_mfma_f32_16x16x32_bf16 v[88:91], v[176:179], v[136:139], v[88:91]
 v_mfma_f32_16x16x32_bf16 v[92:95], v[176:179], v[140:143], v[92:95]
 buffer_load_dwordx4 v[176:179], v2, s[4:7], s30 offen offset:768 sc1
 s_waitcnt vmcnt(9)
 v_mfma_f32_16x16x32_bf16 v[96:99], v[180:183], v[128:131], v[96:99]
 ds_read_b128 v[128:131], v28 offset:36864
 v_mfma_f32_16x16x32_bf16 v[100:103], v[180:183], v[132:135], v[100:103]
 ds_read_b128 v[132:135], v28 offset:37888
 v_mfma_f32_16x16x32_bf16 v[104:107], v[180:183], v[136:139], v[104:107]
 ds_read_b128 v[136:139], v28 offset:38912
 v_mfma_f32_16x16x32_bf16 v[108:111], v[180:183], v[140:143], v[108:111]
 ds_read_b128 v[140:143], v28 offset:39936
 buffer_load_dwordx4 v[180:183], v2, s[4:7], s30 offen offset:1024 sc1
 s_waitcnt lgkmcnt(4)
 s_waitcnt vmcnt(9)
 v_mfma_f32_16x16x32_bf16 v[32:35], v[144:147], v[112:115], v[32:35]
 v_mfma_f32_16x16x32_bf16 v[36:39], v[144:147], v[116:119], v[36:39]
 v_mfma_f32_16x16x32_bf16 v[40:43], v[144:147], v[120:123], v[40:43]
 v_mfma_f32_16x16x32_bf16 v[44:47], v[144:147], v[124:127], v[44:47]
 buffer_load_dwordx4 v[8:11], v6, s[4:7], s29 offen sc1
 s_waitcnt vmcnt(9)
 v_mfma_f32_16x16x32_bf16 v[48:51], v[148:151], v[112:115], v[48:51]
 v_mfma_f32_16x16x32_bf16 v[52:55], v[148:151], v[116:119], v[52:55]
 v_mfma_f32_16x16x32_bf16 v[56:59], v[148:151], v[120:123], v[56:59]
 v_mfma_f32_16x16x32_bf16 v[60:63], v[148:151], v[124:127], v[60:63]
 buffer_load_dwordx4 v[12:15], v6, s[4:7], s29 offen offset:2048 sc1
 s_waitcnt vmcnt(9)
 v_mfma_f32_16x16x32_bf16 v[64:67], v[152:155], v[112:115], v[64:67]
 v_mfma_f32_16x16x32_bf16 v[68:71], v[152:155], v[116:119], v[68:71]
 v_mfma_f32_16x16x32_bf16 v[72:75], v[152:155], v[120:123], v[72:75]
 v_mfma_f32_16x16x32_bf16 v[76:79], v[152:155], v[124:127], v[76:79]
 buffer_load_dwordx4 v[16:19], v7, s[4:7], s29 offen sc1
 s_waitcnt vmcnt(9)
 v_mfma_f32_16x16x32_bf16 v[80:83], v[156:159], v[112:115], v[80:83]
 v_mfma_f32_16x16x32_bf16 v[84:87], v[156:159], v[116:119], v[84:87]
 v_mfma_f32_16x16x32_bf16 v[88:91], v[156:159], v[120:123], v[88:91]
 v_mfma_f32_16x16x32_bf16 v[92:95], v[156:159], v[124:127], v[92:95]
 s_waitcnt vmcnt(8)
 v_mfma_f32_16x16x32_bf16 v[96:99], v[160:163], v[112:115], v[96:99]
 v_mfma_f32_16x16x32_bf16 v[100:103], v[160:163], v[116:119], v[100:103]
 v_mfma_f32_16x16x32_bf16 v[104:107], v[160:163], v[120:123], v[104:107]
 v_mfma_f32_16x16x32_bf16 v[108:111], v[160:163], v[124:127], v[108:111]
 s_waitcnt lgkmcnt(0)
 s_waitcnt vmcnt(7)
 v_mfma_f32_16x16x32_bf16 v[32:35], v[164:167], v[128:131], v[32:35]
 v_mfma_f32_16x16x32_bf16 v[36:39], v[164:167], v[132:135], v[36:39]
 v_mfma_f32_16x16x32_bf16 v[40:43], v[164:167], v[136:139], v[40:43]
 v_mfma_f32_16x16x32_bf16 v[44:47], v[164:167], v[140:143], v[44:47]
 s_waitcnt vmcnt(6)
 v_mfma_f32_16x16x32_bf16 v[48:51], v[168:171], v[128:131], v[48:51]
 v_mfma_f32_16x16x32_bf16 v[52:55], v[168:171], v[132:135], v[52:55]
 v_mfma_f32_16x16x32_bf16 v[56:59], v[168:171], v[136:139], v[56:59]
 v_mfma_f32_16x16x32_bf16 v[60:63], v[168:171], v[140:143], v[60:63]
 s_waitcnt vmcnt(5)
 v_mfma_f32_16x16x32_bf16 v[64:67], v[172:175], v[128:131], v[64:67]
 v_mfma_f32_16x16x32_bf16 v[68:71], v[172:175], v[132:135], v[68:71]
 v_mfma_f32_16x16x32_bf16 v[72:75], v[172:175], v[136:139], v[72:75]
 v_mfma_f32_16x16x32_bf16 v[76:79], v[172:175], v[140:143], v[76:79]
 s_waitcnt vmcnt(4)
 v_mfma_f32_16x16x32_bf16 v[80:83], v[176:179], v[128:131], v[80:83]
 v_mfma_f32_16x16x32_bf16 v[84:87], v[176:179], v[132:135], v[84:87]
 v_mfma_f32_16x16x32_bf16 v[88:91], v[176:179], v[136:139], v[88:91]
 v_mfma_f32_16x16x32_bf16 v[92:95], v[176:179], v[140:143], v[92:95]
 s_waitcnt vmcnt(3)
 v_mfma_f32_16x16x32_bf16 v[96:99], v[180:183], v[128:131], v[96:99]
 v_mfma_f32_16x16x32_bf16 v[100:103], v[180:183], v[132:135], v[100:103]
 v_mfma_f32_16x16x32_bf16 v[104:107], v[180:183], v[136:139], v[104:107]
 v_mfma_f32_16x16x32_bf16 v[108:111], v[180:183], v[140:143], v[108:111]
 ds_write_b128 v1, v[32:35] offset:0
 ds_write_b128 v1, v[36:39] offset:5376
 ds_write_b128 v1, v[40:43] offset:10752
 ds_write_b128 v1, v[44:47] offset:16128
 ds_write_b128 v1, v[48:51] offset:64
 ds_write_b128 v1, v[52:55] offset:5440
 ds_write_b128 v1, v[56:59] offset:10816
 ds_write_b128 v1, v[60:63] offset:16192
 ds_write_b128 v1, v[64:67] offset:128
 ds_write_b128 v1, v[68:71] offset:5504
 ds_write_b128 v1, v[72:75] offset:10880
 ds_write_b128 v1, v[76:79] offset:16256
 ds_write_b128 v1, v[80:83] offset:192
 ds_write_b128 v1, v[84:87] offset:5568
 ds_write_b128 v1, v[88:91] offset:10944
 ds_write_b128 v1, v[92:95] offset:16320
 ds_write_b128 v1, v[96:99] offset:256
 ds_write_b128 v1, v[100:103] offset:5632
 ds_write_b128 v1, v[104:107] offset:11008
 ds_write_b128 v1, v[108:111] offset:16384
 v_lshlrev_b32 v26, 16, v5
 v_mov_b32 v27, v26
 s_waitcnt vmcnt(0) lgkmcnt(0)
 s_barrier
 ds_read_b128 v[32:35], v25 offset:0
 ds_read_b128 v[36:39], v25 offset:16
 ds_read_b128 v[40:43], v25 offset:40960
 ds_read_b128 v[44:47], v25 offset:40976
 ds_read_b128 v[48:51], v29 offset:0
 ds_read_b128 v[52:55], v29 offset:16
 ds_read_b128 v[56:59], v29 offset:40960
 ds_read_b128 v[60:63], v29 offset:40976
 v_lshlrev_b32 v128, 16, v8
 v_and_b32 v129, 0xffff0000, v8
 v_lshlrev_b32 v130, 16, v9
 v_and_b32 v131, 0xffff0000, v9
 v_lshlrev_b32 v132, 16, v10
 v_and_b32 v133, 0xffff0000, v10
 v_lshlrev_b32 v134, 16, v11
 v_and_b32 v135, 0xffff0000, v11
 v_pk_add_f32 v[128:129], v[128:129], v[26:27]
 v_pk_add_f32 v[130:131], v[130:131], v[26:27]
 v_pk_add_f32 v[132:133], v[132:133], v[26:27]
 v_pk_add_f32 v[134:135], v[134:135], v[26:27]
 s_waitcnt lgkmcnt(4)
 ds_read_b128 v[64:67], v25 offset:128
 ds_read_b128 v[68:71], v25 offset:144
 ds_read_b128 v[72:75], v25 offset:41088
 ds_read_b128 v[76:79], v25 offset:41104
 ds_read_b128 v[80:83], v29 offset:128
 ds_read_b128 v[84:87], v29 offset:144
 ds_read_b128 v[88:91], v29 offset:41088
 ds_read_b128 v[92:95], v29 offset:41104
 v_pk_add_f32 v[32:33], v[32:33], v[40:41]
 v_pk_add_f32 v[34:35], v[34:35], v[42:43]
 v_pk_add_f32 v[36:37], v[36:37], v[44:45]
 v_pk_add_f32 v[38:39], v[38:39], v[46:47]
 s_waitcnt lgkmcnt(8)
 v_pk_add_f32 v[48:49], v[48:49], v[56:57]
 v_pk_add_f32 v[50:51], v[50:51], v[58:59]
 v_pk_add_f32 v[52:53], v[52:53], v[60:61]
 v_pk_add_f32 v[54:55], v[54:55], v[62:63]
 v_pk_add_f32 v[32:33], v[32:33], v[48:49]
 v_pk_add_f32 v[34:35], v[34:35], v[50:51]
 v_pk_add_f32 v[36:37], v[36:37], v[52:53]
 v_pk_add_f32 v[38:39], v[38:39], v[54:55]
 v_pk_add_f32 v[32:33], v[32:33], v[128:129]
 v_pk_add_f32 v[34:35], v[34:35], v[130:131]
 v_pk_add_f32 v[36:37], v[36:37], v[132:133]
 v_pk_add_f32 v[38:39], v[38:39], v[134:135]
 v_cvt_pk_bf16_f32 v136, v32, v33
 v_cvt_pk_bf16_f32 v137, v34, v35
 v_cvt_pk_bf16_f32 v138, v36, v37
 v_cvt_pk_bf16_f32 v139, v38, v39
 buffer_store_dwordx4 v[136:139], v24, s[12:15], s33 offen offset:0
 buffer_store_dwordx4 v[136:139], v6, s[4:7], s28 offen offset:0 sc1
 v_lshlrev_b32 v128, 16, v12
 v_and_b32 v129, 0xffff0000, v12
 v_lshlrev_b32 v130, 16, v13
 v_and_b32 v131, 0xffff0000, v13
 v_lshlrev_b32 v132, 16, v14
 v_and_b32 v133, 0xffff0000, v14
 v_lshlrev_b32 v134, 16, v15
 v_and_b32 v135, 0xffff0000, v15
 v_pk_add_f32 v[128:129], v[128:129], v[26:27]
 v_pk_add_f32 v[130:131], v[130:131], v[26:27]
 v_pk_add_f32 v[132:133], v[132:133], v[26:27]
 v_pk_add_f32 v[134:135], v[134:135], v[26:27]
 s_waitcnt lgkmcnt(4)
 ds_read_b128 v[96:99], v25 offset:256
 ds_read_b128 v[100:103], v25 offset:272
 ds_read_b128 v[104:107], v25 offset:41216
 ds_read_b128 v[108:111], v25 offset:41232
 ds_read_b128 v[112:115], v29 offset:256
 ds_read_b128 v[116:119], v29 offset:272
 ds_read_b128 v[120:123], v29 offset:41216
 ds_read_b128 v[124:127], v29 offset:41232
 v_pk_add_f32 v[64:65], v[64:65], v[72:73]
 v_pk_add_f32 v[66:67], v[66:67], v[74:75]
 v_pk_add_f32 v[68:69], v[68:69], v[76:77]
 v_pk_add_f32 v[70:71], v[70:71], v[78:79]
 s_waitcnt lgkmcnt(8)
 v_pk_add_f32 v[80:81], v[80:81], v[88:89]
 v_pk_add_f32 v[82:83], v[82:83], v[90:91]
 v_pk_add_f32 v[84:85], v[84:85], v[92:93]
 v_pk_add_f32 v[86:87], v[86:87], v[94:95]
 v_pk_add_f32 v[64:65], v[64:65], v[80:81]
 v_pk_add_f32 v[66:67], v[66:67], v[82:83]
 v_pk_add_f32 v[68:69], v[68:69], v[84:85]
 v_pk_add_f32 v[70:71], v[70:71], v[86:87]
 v_pk_add_f32 v[64:65], v[64:65], v[128:129]
 v_pk_add_f32 v[66:67], v[66:67], v[130:131]
 v_pk_add_f32 v[68:69], v[68:69], v[132:133]
 v_pk_add_f32 v[70:71], v[70:71], v[134:135]
 v_cvt_pk_bf16_f32 v140, v64, v65
 v_cvt_pk_bf16_f32 v141, v66, v67
 v_cvt_pk_bf16_f32 v142, v68, v69
 v_cvt_pk_bf16_f32 v143, v70, v71
 buffer_store_dwordx4 v[140:143], v24, s[12:15], s33 offen offset:64
 buffer_store_dwordx4 v[140:143], v6, s[4:7], s28 offen offset:2048 sc1
 s_cmp_ge_u32 s21, 2
 s_cbranch_scc1 g2s_2122
 v_lshlrev_b32 v128, 16, v16
 v_and_b32 v129, 0xffff0000, v16
 v_lshlrev_b32 v130, 16, v17
 v_and_b32 v131, 0xffff0000, v17
 v_lshlrev_b32 v132, 16, v18
 v_and_b32 v133, 0xffff0000, v18
 v_lshlrev_b32 v134, 16, v19
 v_and_b32 v135, 0xffff0000, v19
 v_pk_add_f32 v[128:129], v[128:129], v[26:27]
 v_pk_add_f32 v[130:131], v[130:131], v[26:27]
 v_pk_add_f32 v[132:133], v[132:133], v[26:27]
 v_pk_add_f32 v[134:135], v[134:135], v[26:27]
 s_waitcnt lgkmcnt(4)
 v_pk_add_f32 v[96:97], v[96:97], v[104:105]
 v_pk_add_f32 v[98:99], v[98:99], v[106:107]
 v_pk_add_f32 v[100:101], v[100:101], v[108:109]
 v_pk_add_f32 v[102:103], v[102:103], v[110:111]
 s_waitcnt lgkmcnt(0)
 v_pk_add_f32 v[112:113], v[112:113], v[120:121]
 v_pk_add_f32 v[114:115], v[114:115], v[122:123]
 v_pk_add_f32 v[116:117], v[116:117], v[124:125]
 v_pk_add_f32 v[118:119], v[118:119], v[126:127]
 v_pk_add_f32 v[96:97], v[96:97], v[112:113]
 v_pk_add_f32 v[98:99], v[98:99], v[114:115]
 v_pk_add_f32 v[100:101], v[100:101], v[116:117]
 v_pk_add_f32 v[102:103], v[102:103], v[118:119]
 v_pk_add_f32 v[96:97], v[96:97], v[128:129]
 v_pk_add_f32 v[98:99], v[98:99], v[130:131]
 v_pk_add_f32 v[100:101], v[100:101], v[132:133]
 v_pk_add_f32 v[102:103], v[102:103], v[134:135]
 v_cvt_pk_bf16_f32 v144, v96, v97
 v_cvt_pk_bf16_f32 v145, v98, v99
 v_cvt_pk_bf16_f32 v146, v100, v101
 v_cvt_pk_bf16_f32 v147, v102, v103
 buffer_store_dwordx4 v[144:147], v24, s[12:15], s33 offen offset:128
 buffer_store_dwordx4 v[144:147], v7, s[4:7], s28 offen sc1
g2s_2122:
 s_cmp_eq_u32 s98, 0
 s_cbranch_scc1 ne_2123
 s_endpgm
ne_2123:
 s_lshl_b32 s25, s20, 5
 s_add_u32 s25, s25, s22
 s_lshl_b32 s95, s25, 2
 s_add_u32 s95, s95, s3
 s_add_u32 s95, s95, 20480
 v_mov_b32 v2, 0x80000000
 v_mov_b32 v191, s95
 v_cmp_eq_u32 vcc, 0, v0
 s_nop 1
 v_cndmask_b32 v2, v2, v191, vcc
 v_mov_b32 v3, 1
 s_waitcnt vmcnt(0) lgkmcnt(0)
 s_barrier
 buffer_store_dword v3, v2, s[4:7], 0 offen sc1
 s_cmp_lg_u32 s21, 0
 s_cbranch_scc1 nl_2124
 s_lshl_b32 s25, s20, 7
 s_add_u32 s25, s25, s3
 s_add_u32 s25, s25, 20480
 s_mov_b32 s100, 0
ww_2125:
 s_cmp_eq_u32 s100, 0
 s_cbranch_scc1 w1_2127
 s_sleep 2
w1_2127:
 s_load_dwordx8 s[40:47], s[4:5], s25 glc
 s_add_u32 s100, s100, 1
 s_cmp_gt_u32 s100, 200000
 s_cbranch_scc1 main_fail
 s_waitcnt lgkmcnt(0)
 s_min_u32 s40, s40, s41
 s_min_u32 s40, s40, s42
 s_min_u32 s40, s40, s43
 s_min_u32 s40, s40, s44
 s_min_u32 s40, s40, s45
 s_min_u32 s40, s40, s46
 s_min_u32 s40, s40, s47
 s_cmp_gt_u32 s40, 0
 s_cbranch_scc0 ww_2125
wok_2126:
 s_lshr_b32 s90, s96, 2
 s_mul_i32 s90, s90, 40960
 s_and_b32 s91, s96, 3
 s_lshl_b32 s91, s91, 7
 s_add_u32 s90, s90, s91
 v_bfe_u32 v191, v0, 3, 3
 v_lshlrev_b32 v2, 9, v191
 v_bfe_u32 v191, v0, 0, 3
 v_lshl_add_u32 v2, v191, 4, v2
 s_add_u32 s92, s90, 7340032
 buffer_load_dwordx4 v[16:19], v2, s[4:7], s92 offen sc1
 s_add_u32 s92, s92, 4096
 buffer_load_dwordx4 v[20:23], v2, s[4:7], s92 offen sc1
 s_add_u32 s92, s92, 4096
 buffer_load_dwordx4 v[24:27], v2, s[4:7], s92 offen sc1
 s_add_u32 s92, s92, 4096
 buffer_load_dwordx4 v[28:31], v2, s[4:7], s92 offen sc1
 s_add_u32 s92, s92, 4096
 buffer_load_dwordx4 v[32:35], v2, s[4:7], s92 offen sc1
 s_add_u32 s92, s92, 4096
 buffer_load_dwordx4 v[36:39], v2, s[4:7], s92 offen sc1
 s_add_u32 s92, s92, 4096
 buffer_load_dwordx4 v[40:43], v2, s[4:7], s92 offen sc1
 s_add_u32 s92, s92, 4096
 buffer_load_dwordx4 v[44:47], v2, s[4:7], s92 offen sc1
 s_add_u32 s92, s92, 4096
 buffer_load_dwordx4 v[48:51], v2, s[4:7], s92 offen sc1
 s_add_u32 s92, s92, 4096
 buffer_load_dwordx4 v[52:55], v2, s[4:7], s92 offen sc1
 s_mov_b32 s94, 0xffff0000
 s_waitcnt vmcnt(9)
 v_lshlrev_b32 v64, 16, v16
 v_and_b32 v65, s94, v16
 v_lshlrev_b32 v66, 16, v17
 v_and_b32 v67, s94, v17
 v_lshlrev_b32 v68, 16, v18
 v_and_b32 v69, s94, v18
 v_lshlrev_b32 v70, 16, v19
 v_and_b32 v71, s94, v19
 s_waitcnt vmcnt(8)
 v_lshlrev_b32 v72, 16, v20
 v_and_b32 v73, s94, v20
 v_lshlrev_b32 v74, 16, v21
 v_and_b32 v75, s94, v21
 v_lshlrev_b32 v76, 16, v22
 v_and_b32 v77, s94, v22
 v_lshlrev_b32 v78, 16, v23
 v_and_b32 v79, s94, v23
 s_waitcnt vmcnt(7)
 v_lshlrev_b32 v80, 16, v24
 v_and_b32 v81, s94, v24
 v_lshlrev_b32 v82, 16, v25
 v_and_b32 v83, s94, v25
 v_lshlrev_b32 v84, 16, v26
 v_and_b32 v85, s94, v26
 v_lshlrev_b32 v86, 16, v27
 v_and_b32 v87, s94, v27
 s_waitcnt vmcnt(6)
 v_lshlrev_b32 v88, 16, v28
 v_and_b32 v89, s94, v28
 v_lshlrev_b32 v90, 16, v29
 v_and_b32 v91, s94, v29
 v_lshlrev_b32 v92, 16, v30
 v_and_b32 v93, s94, v30
 v_lshlrev_b32 v94, 16, v31
 v_and_b32 v95, s94, v31
 s_waitcnt vmcnt(5)
 v_lshlrev_b32 v96, 16, v32
 v_and_b32 v97, s94, v32
 v_lshlrev_b32 v98, 16, v33
 v_and_b32 v99, s94, v33
 v_lshlrev_b32 v100, 16, v34
 v_and_b32 v101, s94, v34
 v_lshlrev_b32 v102, 16, v35
 v_and_b32 v103, s94, v35
 s_waitcnt vmcnt(4)
 v_lshlrev_b32 v104, 16, v36
 v_and_b32 v105, s94, v36
 v_lshlrev_b32 v106, 16, v37
 v_and_b32 v107, s94, v37
 v_lshlrev_b32 v108, 16, v38
 v_and_b32 v109, s94, v38
 v_lshlrev_b32 v110, 16, v39
 v_and_b32 v111, s94, v39
 s_waitcnt vmcnt(3)
 v_lshlrev_b32 v112, 16, v40
 v_and_b32 v113, s94, v40
 v_lshlrev_b32 v114, 16, v41
 v_and_b32 v115, s94, v41
 v_lshlrev_b32 v116, 16, v42
 v_and_b32 v117, s94, v42
 v_lshlrev_b32 v118, 16, v43
 v_and_b32 v119, s94, v43
 s_waitcnt vmcnt(2)
 v_lshlrev_b32 v120, 16, v44
 v_and_b32 v121, s94, v44
 v_lshlrev_b32 v122, 16, v45
 v_and_b32 v123, s94, v45
 v_lshlrev_b32 v124, 16, v46
 v_and_b32 v125, s94, v46
 v_lshlrev_b32 v126, 16, v47
 v_and_b32 v127, s94, v47
 s_waitcnt vmcnt(1)
 v_lshlrev_b32 v128, 16, v48
 v_and_b32 v129, s94, v48
 v_lshlrev_b32 v130, 16, v49
 v_and_b32 v131, s94, v49
 v_lshlrev_b32 v132, 16, v50
 v_and_b32 v133, s94, v50
 v_lshlrev_b32 v134, 16, v51
 v_and_b32 v135, s94, v51
 s_waitcnt vmcnt(0)
 v_lshlrev_b32 v136, 16, v52
 v_and_b32 v137, s94, v52
 v_lshlrev_b32 v138, 16, v53
 v_and_b32 v139, s94, v53
 v_lshlrev_b32 v140, 16, v54
 v_and_b32 v141, s94, v54
 v_lshlrev_b32 v142, 16, v55
 v_and_b32 v143, s94, v55
 v_pk_add_f32 v[4:5], v[64:65], v[66:67]
 v_pk_add_f32 v[6:7], v[68:69], v[70:71]
 v_pk_add_f32 v[4:5], v[4:5], v[72:73]
 v_pk_add_f32 v[6:7], v[6:7], v[74:75]
 v_pk_add_f32 v[4:5], v[4:5], v[76:77]
 v_pk_add_f32 v[6:7], v[6:7], v[78:79]
 v_pk_add_f32 v[4:5], v[4:5], v[80:81]
 v_pk_add_f32 v[6:7], v[6:7], v[82:83]
 v_pk_add_f32 v[4:5], v[4:5], v[84:85]
 v_pk_add_f32 v[6:7], v[6:7], v[86:87]
 v_pk_add_f32 v[4:5], v[4:5], v[88:89]
 v_pk_add_f32 v[6:7], v[6:7], v[90:91]
 v_pk_add_f32 v[4:5], v[4:5], v[92:93]
 v_pk_add_f32 v[6:7], v[6:7], v[94:95]
 v_pk_add_f32 v[4:5], v[4:5], v[96:97]
 v_pk_add_f32 v[6:7], v[6:7], v[98:99]
 v_pk_add_f32 v[4:5], v[4:5], v[100:101]
 v_pk_add_f32 v[6:7], v[6:7], v[102:103]
 v_pk_add_f32 v[4:5], v[4:5], v[104:105]
 v_pk_add_f32 v[6:7], v[6:7], v[106:107]
 v_pk_add_f32 v[4:5], v[4:5], v[108:109]
 v_pk_add_f32 v[6:7], v[6:7], v[110:111]
 v_pk_add_f32 v[4:5], v[4:5], v[112:113]
 v_pk_add_f32 v[6:7], v[6:7], v[114:115]
 v_pk_add_f32 v[4:5], v[4:5], v[116:117]
 v_pk_add_f32 v[6:7], v[6:7], v[118:119]
 v_pk_add_f32 v[4:5], v[4:5], v[120:121]
 v_pk_add_f32 v[6:7], v[6:7], v[122:123]
 v_pk_add_f32 v[4:5], v[4:5], v[124:125]
 v_pk_add_f32 v[6:7], v[6:7], v[126:127]
 v_pk_add_f32 v[4:5], v[4:5], v[128:129]
 v_pk_add_f32 v[6:7], v[6:7], v[130:131]
 v_pk_add_f32 v[4:5], v[4:5], v[132:133]
 v_pk_add_f32 v[6:7], v[6:7], v[134:135]
 v_pk_add_f32 v[4:5], v[4:5], v[136:137]
 v_pk_add_f32 v[6:7], v[6:7], v[138:139]
 v_pk_add_f32 v[4:5], v[4:5], v[140:141]
 v_pk_add_f32 v[6:7], v[6:7], v[142:143]
 v_pk_add_f32 v[4:5], v[4:5], v[6:7]
 v_add_f32 v4, v4, v5
 s_nop 1
 v_add_f32_dpp v4, v4, v4 row_ror:8 row_mask:0xf bank_mask:0xf
 v_mov_b32 v8, v4
 s_nop 1
 v_permlane16_swap_b32 v8, v4
 v_add_f32 v4, v4, v8
 v_mov_b32 v8, v4
 s_nop 1
 v_permlane32_swap_b32 v8, v4
 v_add_f32 v4, v4, v8
 v_mul_f32 v4, 0xbacccccd, v4
 v_mov_b32 v5, v4
 v_pk_add_f32 v[64:65], v[64:65], v[4:5]
 v_pk_add_f32 v[66:67], v[66:67], v[4:5]
 v_pk_add_f32 v[68:69], v[68:69], v[4:5]
 v_pk_add_f32 v[70:71], v[70:71], v[4:5]
 v_pk_add_f32 v[72:73], v[72:73], v[4:5]
 v_pk_add_f32 v[74:75], v[74:75], v[4:5]
 v_pk_add_f32 v[76:77], v[76:77], v[4:5]
 v_pk_add_f32 v[78:79], v[78:79], v[4:5]
 v_pk_add_f32 v[80:81], v[80:81], v[4:5]
 v_pk_add_f32 v[82:83], v[82:83], v[4:5]
 v_pk_add_f32 v[84:85], v[84:85], v[4:5]
 v_pk_add_f32 v[86:87], v[86:87], v[4:5]
 v_pk_add_f32 v[88:89], v[88:89], v[4:5]
 v_pk_add_f32 v[90:91], v[90:91], v[4:5]
 v_pk_add_f32 v[92:93], v[92:93], v[4:5]
 v_pk_add_f32 v[94:95], v[94:95], v[4:5]
 v_pk_add_f32 v[96:97], v[96:97], v[4:5]
 v_pk_add_f32 v[98:99], v[98:99], v[4:5]
 v_pk_add_f32 v[100:101], v[100:101], v[4:5]
 v_pk_add_f32 v[102:103], v[102:103], v[4:5]
 v_pk_add_f32 v[104:105], v[104:105], v[4:5]
 v_pk_add_f32 v[106:107], v[106:107], v[4:5]
 v_pk_add_f32 v[108:109], v[108:109], v[4:5]
 v_pk_add_f32 v[110:111], v[110:111], v[4:5]
 v_pk_add_f32 v[112:113], v[112:113], v[4:5]
 v_pk_add_f32 v[114:115], v[114:115], v[4:5]
 v_pk_add_f32 v[116:117], v[116:117], v[4:5]
 v_pk_add_f32 v[118:119], v[118:119], v[4:5]
 v_pk_add_f32 v[120:121], v[120:121], v[4:5]
 v_pk_add_f32 v[122:123], v[122:123], v[4:5]
 v_pk_add_f32 v[124:125], v[124:125], v[4:5]
 v_pk_add_f32 v[126:127], v[126:127], v[4:5]
 v_pk_add_f32 v[128:129], v[128:129], v[4:5]
 v_pk_add_f32 v[130:131], v[130:131], v[4:5]
 v_pk_add_f32 v[132:133], v[132:133], v[4:5]
 v_pk_add_f32 v[134:135], v[134:135], v[4:5]
 v_pk_add_f32 v[136:137], v[136:137], v[4:5]
 v_pk_add_f32 v[138:139], v[138:139], v[4:5]
 v_pk_add_f32 v[140:141], v[140:141], v[4:5]
 v_pk_add_f32 v[142:143], v[142:143], v[4:5]
 v_pk_mul_f32 v[6:7], v[64:65], v[64:65]
 v_pk_mul_f32 v[10:11], v[66:67], v[66:67]
 v_pk_fma_f32 v[6:7], v[68:69], v[68:69], v[6:7]
 v_pk_fma_f32 v[10:11], v[70:71], v[70:71], v[10:11]
 v_pk_fma_f32 v[6:7], v[72:73], v[72:73], v[6:7]
 v_pk_fma_f32 v[10:11], v[74:75], v[74:75], v[10:11]
 v_pk_fma_f32 v[6:7], v[76:77], v[76:77], v[6:7]
 v_pk_fma_f32 v[10:11], v[78:79], v[78:79], v[10:11]
 v_pk_fma_f32 v[6:7], v[80:81], v[80:81], v[6:7]
 v_pk_fma_f32 v[10:11], v[82:83], v[82:83], v[10:11]
 v_pk_fma_f32 v[6:7], v[84:85], v[84:85], v[6:7]
 v_pk_fma_f32 v[10:11], v[86:87], v[86:87], v[10:11]
 v_pk_fma_f32 v[6:7], v[88:89], v[88:89], v[6:7]
 v_pk_fma_f32 v[10:11], v[90:91], v[90:91], v[10:11]
 v_pk_fma_f32 v[6:7], v[92:93], v[92:93], v[6:7]
 v_pk_fma_f32 v[10:11], v[94:95], v[94:95], v[10:11]
 v_pk_fma_f32 v[6:7], v[96:97], v[96:97], v[6:7]
 v_pk_fma_f32 v[10:11], v[98:99], v[98:99], v[10:11]
 v_pk_fma_f32 v[6:7], v[100:101], v[100:101], v[6:7]
 v_pk_fma_f32 v[10:11], v[102:103], v[102:103], v[10:11]
 v_pk_fma_f32 v[6:7], v[104:105], v[104:105], v[6:7]
 v_pk_fma_f32 v[10:11], v[106:107], v[106:107], v[10:11]
 v_pk_fma_f32 v[6:7], v[108:109], v[108:109], v[6:7]
 v_pk_fma_f32 v[10:11], v[110:111], v[110:111], v[10:11]
 v_pk_fma_f32 v[6:7], v[112:113], v[112:113], v[6:7]
 v_pk_fma_f32 v[10:11], v[114:115], v[114:115], v[10:11]
 v_pk_fma_f32 v[6:7], v[116:117], v[116:117], v[6:7]
 v_pk_fma_f32 v[10:11], v[118:119], v[118:119], v[10:11]
 v_pk_fma_f32 v[6:7], v[120:121], v[120:121], v[6:7]
 v_pk_fma_f32 v[10:11], v[122:123], v[122:123], v[10:11]
 v_pk_fma_f32 v[6:7], v[124:125], v[124:125], v[6:7]
 v_pk_fma_f32 v[10:11], v[126:127], v[126:127], v[10:11]
 v_pk_fma_f32 v[6:7], v[128:129], v[128:129], v[6:7]
 v_pk_fma_f32 v[10:11], v[130:131], v[130:131], v[10:11]
 v_pk_fma_f32 v[6:7], v[132:133], v[132:133], v[6:7]
 v_pk_fma_f32 v[10:11], v[134:135], v[134:135], v[10:11]
 v_pk_fma_f32 v[6:7], v[136:137], v[136:137], v[6:7]
 v_pk_fma_f32 v[10:11], v[138:139], v[138:139], v[10:11]
 v_pk_fma_f32 v[6:7], v[140:141], v[140:141], v[6:7]
 v_pk_fma_f32 v[10:11], v[142:143], v[142:143], v[10:11]
 v_pk_add_f32 v[6:7], v[6:7], v[10:11]
 v_add_f32 v6, v6, v7
 s_nop 1
 v_add_f32_dpp v6, v6, v6 row_ror:8 row_mask:0xf bank_mask:0xf
 v_mov_b32 v8, v6
 s_nop 1
 v_permlane16_swap_b32 v8, v6
 v_add_f32 v6, v6, v8
 v_mov_b32 v8, v6
 s_nop 1
 v_permlane32_swap_b32 v8, v6
 v_add_f32 v6, v6, v8
 v_mul_f32 v6, 0x3acccccd, v6
 v_add_f32 v7, 0x3727c5ac, v6
 v_rsq_f32 v4, v7
 s_nop 0
 v_mov_b32 v5, v4
 v_pk_mul_f32 v[64:65], v[64:65], v[4:5]
 v_cvt_pk_bf16_f32 v144, v64, v65
 v_pk_mul_f32 v[66:67], v[66:67], v[4:5]
 v_cvt_pk_bf16_f32 v145, v66, v67
 v_pk_mul_f32 v[68:69], v[68:69], v[4:5]
 v_cvt_pk_bf16_f32 v146, v68, v69
 v_pk_mul_f32 v[70:71], v[70:71], v[4:5]
 v_cvt_pk_bf16_f32 v147, v70, v71
 v_pk_mul_f32 v[72:73], v[72:73], v[4:5]
 v_cvt_pk_bf16_f32 v148, v72, v73
 v_pk_mul_f32 v[74:75], v[74:75], v[4:5]
 v_cvt_pk_bf16_f32 v149, v74, v75
 v_pk_mul_f32 v[76:77], v[76:77], v[4:5]
 v_cvt_pk_bf16_f32 v150, v76, v77
 v_pk_mul_f32 v[78:79], v[78:79], v[4:5]
 v_cvt_pk_bf16_f32 v151, v78, v79
 v_pk_mul_f32 v[80:81], v[80:81], v[4:5]
 v_cvt_pk_bf16_f32 v152, v80, v81
 v_pk_mul_f32 v[82:83], v[82:83], v[4:5]
 v_cvt_pk_bf16_f32 v153, v82, v83
 v_pk_mul_f32 v[84:85], v[84:85], v[4:5]
 v_cvt_pk_bf16_f32 v154, v84, v85
 v_pk_mul_f32 v[86:87], v[86:87], v[4:5]
 v_cvt_pk_bf16_f32 v155, v86, v87
 v_pk_mul_f32 v[88:89], v[88:89], v[4:5]
 v_cvt_pk_bf16_f32 v156, v88, v89
 v_pk_mul_f32 v[90:91], v[90:91], v[4:5]
 v_cvt_pk_bf16_f32 v157, v90, v91
 v_pk_mul_f32 v[92:93], v[92:93], v[4:5]
 v_cvt_pk_bf16_f32 v158, v92, v93
 v_pk_mul_f32 v[94:95], v[94:95], v[4:5]
 v_cvt_pk_bf16_f32 v159, v94, v95
 v_pk_mul_f32 v[96:97], v[96:97], v[4:5]
 v_cvt_pk_bf16_f32 v160, v96, v97
 v_pk_mul_f32 v[98:99], v[98:99], v[4:5]
 v_cvt_pk_bf16_f32 v161, v98, v99
 v_pk_mul_f32 v[100:101], v[100:101], v[4:5]
 v_cvt_pk_bf16_f32 v162, v100, v101
 v_pk_mul_f32 v[102:103], v[102:103], v[4:5]
 v_cvt_pk_bf16_f32 v163, v102, v103
 v_pk_mul_f32 v[104:105], v[104:105], v[4:5]
 v_cvt_pk_bf16_f32 v164, v104, v105
 v_pk_mul_f32 v[106:107], v[106:107], v[4:5]
 v_cvt_pk_bf16_f32 v165, v106, v107
 v_pk_mul_f32 v[108:109], v[108:109], v[4:5]
 v_cvt_pk_bf16_f32 v166, v108, v109
 v_pk_mul_f32 v[110:111], v[110:111], v[4:5]
 v_cvt_pk_bf16_f32 v167, v110, v111
 v_pk_mul_f32 v[112:113], v[112:113], v[4:5]
 v_cvt_pk_bf16_f32 v168, v112, v113
 v_pk_mul_f32 v[114:115], v[114:115], v[4:5]
 v_cvt_pk_bf16_f32 v169, v114, v115
 v_pk_mul_f32 v[116:117], v[116:117], v[4:5]
 v_cvt_pk_bf16_f32 v170, v116, v117
 v_pk_mul_f32 v[118:119], v[118:119], v[4:5]
 v_cvt_pk_bf16_f32 v171, v118, v119
 v_pk_mul_f32 v[120:121], v[120:121], v[4:5]
 v_cvt_pk_bf16_f32 v172, v120, v121
 v_pk_mul_f32 v[122:123], v[122:123], v[4:5]
 v_cvt_pk_bf16_f32 v173, v122, v123
 v_pk_mul_f32 v[124:125], v[124:125], v[4:5]
 v_cvt_pk_bf16_f32 v174, v124, v125
 v_pk_mul_f32 v[126:127], v[126:127], v[4:5]
 v_cvt_pk_bf16_f32 v175, v126, v127
 v_pk_mul_f32 v[128:129], v[128:129], v[4:5]
 v_cvt_pk_bf16_f32 v176, v128, v129
 v_pk_mul_f32 v[130:131], v[130:131], v[4:5]
 v_cvt_pk_bf16_f32 v177, v130, v131
 v_pk_mul_f32 v[132:133], v[132:133], v[4:5]
 v_cvt_pk_bf16_f32 v178, v132, v133
 v_pk_mul_f32 v[134:135], v[134:135], v[4:5]
 v_cvt_pk_bf16_f32 v179, v134, v135
 v_pk_mul_f32 v[136:137], v[136:137], v[4:5]
 v_cvt_pk_bf16_f32 v180, v136, v137
 v_pk_mul_f32 v[138:139], v[138:139], v[4:5]
 v_cvt_pk_bf16_f32 v181, v138, v139
 v_pk_mul_f32 v[140:141], v[140:141], v[4:5]
 v_cvt_pk_bf16_f32 v182, v140, v141
 v_pk_mul_f32 v[142:143], v[142:143], v[4:5]
 v_cvt_pk_bf16_f32 v183, v142, v143
 s_add_u32 s92, s90, 2097152
 s_add_u32 s93, s90, 7340032
 buffer_store_dwordx4 v[144:147], v2, s[4:7], s92 offen sc1
 s_add_u32 s92, s92, 4096
 s_add_u32 s93, s93, 4096
 buffer_store_dwordx4 v[148:151], v2, s[4:7], s92 offen sc1
 s_add_u32 s92, s92, 4096
 s_add_u32 s93, s93, 4096
 buffer_store_dwordx4 v[152:155], v2, s[4:7], s92 offen sc1
 s_add_u32 s92, s92, 4096
 s_add_u32 s93, s93, 4096
 buffer_store_dwordx4 v[156:159], v2, s[4:7], s92 offen sc1
 s_add_u32 s92, s92, 4096
 s_add_u32 s93, s93, 4096
 buffer_store_dwordx4 v[160:163], v2, s[4:7], s92 offen sc1
 s_add_u32 s92, s92, 4096
 s_add_u32 s93, s93, 4096
 buffer_store_dwordx4 v[164:167], v2, s[4:7], s92 offen sc1
 s_add_u32 s92, s92, 4096
 s_add_u32 s93, s93, 4096
 buffer_store_dwordx4 v[168:171], v2, s[4:7], s92 offen sc1
 s_add_u32 s92, s92, 4096
 s_add_u32 s93, s93, 4096
 buffer_store_dwordx4 v[172:175], v2, s[4:7], s92 offen sc1
 s_add_u32 s92, s92, 4096
 s_add_u32 s93, s93, 4096
 buffer_store_dwordx4 v[176:179], v2, s[4:7], s92 offen sc1
 s_add_u32 s92, s92, 4096
 s_add_u32 s93, s93, 4096
 buffer_store_dwordx4 v[180:183], v2, s[4:7], s92 offen sc1
 s_add_u32 s92, s92, 4096
 s_add_u32 s93, s93, 4096
 s_add_u32 s25, s96, 5120
 s_lshl_b32 s95, s25, 7
 s_add_u32 s95, s95, s3
 s_add_u32 s95, s95, 65536
 v_mov_b32 v2, 0x80000000
 v_writelane_b32 v2, s95, 0
 v_mov_b32 v3, 1
 s_waitcnt vmcnt(0) lgkmcnt(0)
 buffer_store_dword v3, v2, s[4:7], 0 offen sc1
nl_2124:
 s_mov_b32 s96, s97
 s_mov_b32 s97, 256
 s_cmp_lt_u32 s96, 256
 s_cbranch_scc1 g2l_2112
 s_mov_b32 s98, 1
 s_add_u32 s3, s3, 655360
 s_add_u32 s18, s18, 655360
 s_cmp_eq_u32 s85, 1
 s_cbranch_scc1 again_c
 s_cmp_eq_u32 s85, 2
 s_cbranch_scc1 again_kv
 s_cmp_eq_u32 s85, 3
 s_cbranch_scc1 again_o
 s_cmp_eq_u32 s85, 4
 s_cbranch_scc1 again_q
 s_branch again_pz
first_c:
 s_sub_u32 s20, s16, 1
 s_mul_i32 s20, s20, 27
 s_add_u32 s20, s20, s17
 s_mul_hi_u32 s22, s20, 0xccccccd
 s_lshl_b32 s23, s21, 5
 s_add_u32 s23, s23, s22
 s_lshl_b32 s23, s23, 7
 s_add_u32 s95, s3, 49152
 s_add_u32 s95, s95, s23
 v_mov_b32 v2, s95
 v_bfe_u32 v255, v0, 0, 3
 v_lshl_add_u32 v2, v255, 9, v2
 s_mov_b32 s100, 0
vw_2128:
 buffer_load_dword v3, v2, s[4:7], 0 offen sc1
 s_add_u32 s100, s100, 1
 s_cmp_gt_u32 s100, 200000
 s_cbranch_scc1 main_fail
 s_waitcnt vmcnt(0)
 v_cmp_ge_u32 vcc, 0, v3
 s_cbranch_vccz vok_2129
 s_sleep 1
 s_branch vw_2128
vok_2129:
 v_bfe_u32 v120, v0, 3, 1
 v_lshlrev_b32 v2, 9, v120
 v_bfe_u32 v120, v0, 4, 2
 v_lshl_add_u32 v2, v120, 7, v2
 v_bfe_u32 v120, v0, 0, 3
 v_lshl_add_u32 v2, v120, 4, v2
 s_lshl_b32 s24, s20, 14
 s_lshl_b32 s25, s21, 12
 s_add_u32 s24, s24, s25
 s_add_u32 s25, s24, 27131904
 buffer_load_dwordx4 v[192:195], v2, s[4:7], s25 offen offset:0 sc1
 buffer_load_dwordx4 a[16:19], v2, s[4:7], s25 offen offset:1024 sc1
 buffer_load_dwordx4 a[96:99], v2, s[4:7], s25 offen offset:2048 sc1
 buffer_load_dwordx4 a[176:179], v2, s[4:7], s25 offen offset:3072 sc1
 s_add_u32 s25, s25, 1310720
 buffer_load_dwordx4 v[196:199], v2, s[4:7], s25 offen offset:0 sc1
 buffer_load_dwordx4 a[20:23], v2, s[4:7], s25 offen offset:1024 sc1
 buffer_load_dwordx4 a[100:103], v2, s[4:7], s25 offen offset:2048 sc1
 buffer_load_dwordx4 a[180:183], v2, s[4:7], s25 offen offset:3072 sc1
 s_add_u32 s25, s25, 1310720
 buffer_load_dwordx4 v[200:203], v2, s[4:7], s25 offen offset:0 sc1
 buffer_load_dwordx4 a[24:27], v2, s[4:7], s25 offen offset:1024 sc1
 buffer_load_dwordx4 a[104:107], v2, s[4:7], s25 offen offset:2048 sc1
 buffer_load_dwordx4 a[184:187], v2, s[4:7], s25 offen offset:3072 sc1
 s_add_u32 s25, s25, 1310720
 buffer_load_dwordx4 v[204:207], v2, s[4:7], s25 offen offset:0 sc1
 buffer_load_dwordx4 a[28:31], v2, s[4:7], s25 offen offset:1024 sc1
 buffer_load_dwordx4 a[108:111], v2, s[4:7], s25 offen offset:2048 sc1
 buffer_load_dwordx4 a[188:191], v2, s[4:7], s25 offen offset:3072 sc1
 s_add_u32 s25, s25, 1310720
 buffer_load_dwordx4 v[208:211], v2, s[4:7], s25 offen offset:0 sc1
 buffer_load_dwordx4 a[32:35], v2, s[4:7], s25 offen offset:1024 sc1
 buffer_load_dwordx4 a[112:115], v2, s[4:7], s25 offen offset:2048 sc1
 buffer_load_dwordx4 a[192:195], v2, s[4:7], s25 offen offset:3072 sc1
 s_add_u32 s25, s25, 1310720
 buffer_load_dwordx4 v[212:215], v2, s[4:7], s25 offen offset:0 sc1
 buffer_load_dwordx4 a[36:39], v2, s[4:7], s25 offen offset:1024 sc1
 buffer_load_dwordx4 a[116:119], v2, s[4:7], s25 offen offset:2048 sc1
 buffer_load_dwordx4 a[196:199], v2, s[4:7], s25 offen offset:3072 sc1
 s_add_u32 s25, s25, 1310720
 buffer_load_dwordx4 v[216:219], v2, s[4:7], s25 offen offset:0 sc1
 buffer_load_dwordx4 a[40:43], v2, s[4:7], s25 offen offset:1024 sc1
 buffer_load_dwordx4 a[120:123], v2, s[4:7], s25 offen offset:2048 sc1
 buffer_load_dwordx4 a[200:203], v2, s[4:7], s25 offen offset:3072 sc1
 s_add_u32 s25, s25, 1310720
 buffer_load_dwordx4 v[220:223], v2, s[4:7], s25 offen offset:0 sc1
 buffer_load_dwordx4 a[44:47], v2, s[4:7], s25 offen offset:1024 sc1
 buffer_load_dwordx4 a[124:127], v2, s[4:7], s25 offen offset:2048 sc1
 buffer_load_dwordx4 a[204:207], v2, s[4:7], s25 offen offset:3072 sc1
 s_add_u32 s25, s25, 1310720
 buffer_load_dwordx4 v[224:227], v2, s[4:7], s25 offen offset:0 sc1
 buffer_load_dwordx4 a[48:51], v2, s[4:7], s25 offen offset:1024 sc1
 buffer_load_dwordx4 a[128:131], v2, s[4:7], s25 offen offset:2048 sc1
 buffer_load_dwordx4 a[208:211], v2, s[4:7], s25 offen offset:3072 sc1
 s_add_u32 s25, s25, 1310720
 buffer_load_dwordx4 v[228:231], v2, s[4:7], s25 offen offset:0 sc1
 buffer_load_dwordx4 a[52:55], v2, s[4:7], s25 offen offset:1024 sc1
 buffer_load_dwordx4 a[132:135], v2, s[4:7], s25 offen offset:2048 sc1
 buffer_load_dwordx4 a[212:215], v2, s[4:7], s25 offen offset:3072 sc1
 s_add_u32 s25, s25, 1310720
 buffer_load_dwordx4 v[232:235], v2, s[4:7], s25 offen offset:0 sc1
 buffer_load_dwordx4 a[56:59], v2, s[4:7], s25 offen offset:1024 sc1
 buffer_load_dwordx4 a[136:139], v2, s[4:7], s25 offen offset:2048 sc1
 buffer_load_dwordx4 a[216:219], v2, s[4:7], s25 offen offset:3072 sc1
 s_add_u32 s25, s25, 1310720
 buffer_load_dwordx4 v[236:239], v2, s[4:7], s25 offen offset:0 sc1
 buffer_load_dwordx4 a[60:63], v2, s[4:7], s25 offen offset:1024 sc1
 buffer_load_dwordx4 a[140:143], v2, s[4:7], s25 offen offset:2048 sc1
 buffer_load_dwordx4 a[220:223], v2, s[4:7], s25 offen offset:3072 sc1
 s_add_u32 s25, s25, 1310720
 buffer_load_dwordx4 v[240:243], v2, s[4:7], s25 offen offset:0 sc1
 buffer_load_dwordx4 a[64:67], v2, s[4:7], s25 offen offset:1024 sc1
 buffer_load_dwordx4 a[144:147], v2, s[4:7], s25 offen offset:2048 sc1
 buffer_load_dwordx4 a[224:227], v2, s[4:7], s25 offen offset:3072 sc1
 s_add_u32 s25, s25, 1310720
 buffer_load_dwordx4 v[244:247], v2, s[4:7], s25 offen offset:0 sc1
 buffer_load_dwordx4 a[68:71], v2, s[4:7], s25 offen offset:1024 sc1
 buffer_load_dwordx4 a[148:151], v2, s[4:7], s25 offen offset:2048 sc1
 buffer_load_dwordx4 a[228:231], v2, s[4:7], s25 offen offset:3072 sc1
 s_add_u32 s25, s25, 1310720
 buffer_load_dwordx4 v[248:251], v2, s[4:7], s25 offen offset:0 sc1
 buffer_load_dwordx4 a[72:75], v2, s[4:7], s25 offen offset:1024 sc1
 buffer_load_dwordx4 a[152:155], v2, s[4:7], s25 offen offset:2048 sc1
 buffer_load_dwordx4 a[232:235], v2, s[4:7], s25 offen offset:3072 sc1
 s_add_u32 s25, s25, 1310720
 s_waitcnt vmcnt(56)
 buffer_load_dwordx4 v[252:255], v2, s[4:7], s25 offen offset:0 sc1
 buffer_load_dwordx4 a[76:79], v2, s[4:7], s25 offen offset:1024 sc1
 buffer_load_dwordx4 a[156:159], v2, s[4:7], s25 offen offset:2048 sc1
 buffer_load_dwordx4 a[236:239], v2, s[4:7], s25 offen offset:3072 sc1
 s_add_u32 s25, s25, 1310720
 s_waitcnt vmcnt(56)
 buffer_load_dwordx4 a[0:3], v2, s[4:7], s25 offen offset:0 sc1
 buffer_load_dwordx4 a[80:83], v2, s[4:7], s25 offen offset:1024 sc1
 buffer_load_dwordx4 a[160:163], v2, s[4:7], s25 offen offset:2048 sc1
 buffer_load_dwordx4 a[240:243], v2, s[4:7], s25 offen offset:3072 sc1
 s_add_u32 s25, s25, 1310720
 s_waitcnt vmcnt(56)
 buffer_load_dwordx4 a[4:7], v2, s[4:7], s25 offen offset:0 sc1
 buffer_load_dwordx4 a[84:87], v2, s[4:7], s25 offen offset:1024 sc1
 buffer_load_dwordx4 a[164:167], v2, s[4:7], s25 offen offset:2048 sc1
 buffer_load_dwordx4 a[244:247], v2, s[4:7], s25 offen offset:3072 sc1
 s_add_u32 s25, s25, 1310720
 s_waitcnt vmcnt(56)
 buffer_load_dwordx4 a[8:11], v2, s[4:7], s25 offen offset:0 sc1
 buffer_load_dwordx4 a[88:91], v2, s[4:7], s25 offen offset:1024 sc1
 buffer_load_dwordx4 a[168:171], v2, s[4:7], s25 offen offset:2048 sc1
 buffer_load_dwordx4 a[248:251], v2, s[4:7], s25 offen offset:3072 sc1
 s_add_u32 s25, s25, 1310720
 s_waitcnt vmcnt(56)
 buffer_load_dwordx4 a[12:15], v2, s[4:7], s25 offen offset:0 sc1
 buffer_load_dwordx4 a[92:95], v2, s[4:7], s25 offen offset:1024 sc1
 buffer_load_dwordx4 a[172:175], v2, s[4:7], s25 offen offset:2048 sc1
 buffer_load_dwordx4 a[252:255], v2, s[4:7], s25 offen offset:3072 sc1
 s_add_u32 s25, s25, 1310720
 s_waitcnt vmcnt(56)
again_c:
 s_sub_u32 s20, s16, 1
 s_mul_i32 s20, s20, 27
 s_add_u32 s20, s20, s17
 v_mov_b32 v2, 1572864
 s_mov_b32 s100, 0
pw_2130:
 buffer_load_dword v3, v2, s[4:7], 0 offen sc1
 s_add_u32 s100, s100, 1
 s_cmp_gt_u32 s100, 200000
 s_cbranch_scc1 main_fail
 s_waitcnt vmcnt(0)
 v_cmp_eq_u32 vcc, -1, v3
 s_cbranch_vccnz pw_2130
 v_readfirstlane_b32 s19, v3
 s_nop 1
 s_and_b32 s19, s19, 0x2000
 s_add_u32 s19, s19, s18
 v_bfe_u32 v120, v0, 3, 1
 v_lshlrev_b32 v2, 9, v120
 v_bfe_u32 v120, v0, 4, 2
 v_lshl_add_u32 v2, v120, 7, v2
 v_bfe_u32 v120, v0, 0, 3
 v_lshl_add_u32 v2, v120, 4, v2
 s_lshl_b32 s24, s20, 14
 s_lshl_b32 s25, s21, 12
 s_add_u32 s24, s24, s25
 s_add_u32 s24, s24, 103677952
 v_bfe_u32 v120, v0, 0, 8
 v_lshlrev_b32 v3, 4, v120
 v_bfe_u32 v120, v0, 0, 6
 v_lshlrev_b32 v5, 4, v120
 s_lshl_b32 s25, s21, 14
 s_add_u32 s25, s25, 32768
 s_add_u32 s26, s25, 128
 v_mov_b32 v6, s26
 v_bfe_u32 v120, v0, 3, 1
 s_mov_b32 s101, 640
 v_mad_u32_u24 v6, v120, s101, v6
 v_bfe_u32 v120, v0, 4, 2
 v_lshl_add_u32 v6, v120, 7, v6
 v_bfe_u32 v120, v0, 0, 3
 v_lshl_add_u32 v6, v120, 4, v6
 v_mov_b32 v7, s25
 v_bfe_u32 v120, v0, 3, 1
 s_mov_b32 s101, 640
 v_mad_u32_u24 v7, v120, s101, v7
 v_bfe_u32 v120, v0, 4, 2
 s_mov_b32 s101, 1280
 v_mad_u32_u24 v7, v120, s101, v7
 v_bfe_u32 v120, v0, 0, 3
 v_lshl_add_u32 v7, v120, 4, v7
 v_mov_b32 v8, 10240
 v_bfe_u32 v120, v0, 2, 3
 v_lshl_add_u32 v8, v120, 4, v8
 v_bfe_u32 v120, v0, 1, 1
 v_lshl_add_u32 v8, v120, 8, v8
 v_bfe_u32 v120, v0, 0, 1
 v_lshl_add_u32 v8, v120, 3, v8
 v_add_u32 v122, 640, v8
 s_lshl_b32 s25, s20, 7
 s_add_u32 s26, s25, 8192
 s_cmp_ge_u32 s20, 64
 s_cselect_b32 s25, s26, s25
 v_mov_b32 v9, s25
 v_bfe_u32 v120, v0, 0, 5
 v_lshl_add_u32 v9, v120, 2, v9
 v_bfe_u32 v120, v0, 5, 1
 s_mov_b32 s101, 98304
 v_mad_u32_u24 v9, v120, s101, v9
 v_mov_b32 v10, -1
 v_and_b32 v120, 8, v0
 v_cmp_eq_u32 vcc, 0, v120
 v_mov_b32 v120, 0xeeee
 v_mov_b32 v15, 0x4444
 v_cndmask_b32 v15, v120, v15, vcc
 s_lshl_b32 s27, s20, 12
 s_add_u32 s27, s27, 187564032
 s_lshl_b32 s28, s21, 10
 s_add_u32 s28, s28, 8192
 s_add_u32 s28, s28, s3
 v_mov_b32 v13, s28
 v_bfe_u32 v120, v0, 0, 3
 v_lshl_add_u32 v13, v120, 7, v13
 s_lshl_b32 s50, s20, 7
 s_add_u32 s101, s50, 8192
 s_cmp_ge_u32 s20, 64
 s_cselect_b32 s50, s101, s50
 s_add_u32 s50, s50, s19
 s_add_u32 s50, s50, 524288
 s_add_u32 s25, s19, 544768
 s_cmp_eq_u32 s20, 40
 s_cselect_b32 s25, s25, 0x80000000
 v_mov_b32 v11, s25
 v_bfe_u32 v120, v0, 0, 5
 v_lshl_add_u32 v11, v120, 7, v11
 v_and_b32 v4, 32, v0
 v_cmp_eq_u32 vcc, 0, v4
 v_mov_b32 v120, 0x80000000
 s_nop 0
 v_cndmask_b32 v11, v120, v11, vcc
 s_mov_b32 s52, 0
 v_mov_b32 v4, 0
 s_add_u32 s36, s19, 0
 s_add_u32 s37, s19, 131072
 s_add_u32 s38, s19, 262144
 s_add_u32 s39, s19, 393216
 v_mov_b32 v14, 0
 s_mov_b32 s31, 0
 s_mov_b32 s59, 0x20000000
 s_cmp_eq_u32 s21, 0
 s_cbranch_scc1 cw_2132
 s_cmp_eq_u32 s21, 1
 s_cbranch_scc1 cw_2133
 s_cmp_eq_u32 s21, 2
 s_cbranch_scc1 cw_2134
 s_branch cw_2135
cw_2132:
 s_add_u32 s51, s36, 98304
 s_add_u32 s57, s36, 102400
 s_add_u32 s58, s36, 114688
 s_add_u32 s96, s31, 1
 s_min_u32 s29, s31, 62
 s_mov_b32 s97, 0
 s_cmp_ge_u32 s31, 63
 s_cselect_b32 s24, 0x20000000, s24
 s_mov_b32 s99, 0
 s_waitcnt vmcnt(0)
 s_barrier
 buffer_load_dwordx4 v[32:35], v5, s[4:7], s51 offen offset:0 sc1
 v_mov_b32 v16, 0
 v_mov_b32 v17, 0
 v_mov_b32 v18, 0
 v_mov_b32 v19, 0
 v_mov_b32 v20, 0
 v_mov_b32 v21, 0
 buffer_load_dwordx4 v[36:39], v5, s[4:7], s57 offen offset:0 sc1
 v_mov_b32 v22, 0
 v_mov_b32 v23, 0
 v_mov_b32 v24, 0
 v_mov_b32 v25, 0
 v_mov_b32 v26, 0
 v_mov_b32 v27, 0
 buffer_load_dwordx4 v[40:43], v5, s[4:7], s58 offen offset:0 sc1
 v_mov_b32 v28, 0
 v_mov_b32 v29, 0
 v_mov_b32 v30, 0
 v_mov_b32 v31, 0
cst_2137:
 s_waitcnt vmcnt(2)
 v_smfmac_f32_16x16x64_bf16 v[16:19], v[32:35], v[192:199], v15
 ds_write_b128 v5, v[32:35] offset:0
 v_smfmac_f32_16x16x64_bf16 v[20:23], v[32:35], a[16:23], v15
 v_max3_u32 v121, v32, v33, v34
 v_smfmac_f32_16x16x64_bf16 v[24:27], v[32:35], a[96:103], v15
 s_waitcnt vmcnt(1)
 ds_write_b128 v5, v[36:39] offset:4096
 v_smfmac_f32_16x16x64_bf16 v[28:31], v[32:35], a[176:183], v15
 v_max3_u32 v121, v121, v35, v36
 v_smfmac_f32_16x16x64_bf16 v[16:19], v[36:39], v[224:231], v15
 v_max3_u32 v121, v121, v37, v38
 v_smfmac_f32_16x16x64_bf16 v[20:23], v[36:39], a[48:55], v15
 s_waitcnt vmcnt(0)
 ds_write_b128 v5, v[40:43] offset:8192
 v_smfmac_f32_16x16x64_bf16 v[24:27], v[36:39], a[128:135], v15
 v_max3_u32 v121, v121, v39, v40
 v_max3_u32 v121, v121, v41, v42
 v_smfmac_f32_16x16x64_bf16 v[28:31], v[36:39], a[208:215], v15
 v_max_u32 v121, v121, v43
 v_cmp_eq_u32 vcc, -1, v121
 v_smfmac_f32_16x16x64_bf16 v[16:19], v[40:43], a[0:7], v15
 v_smfmac_f32_16x16x64_bf16 v[20:23], v[40:43], a[80:87], v15
 s_cbranch_vccnz crt_2138
 s_waitcnt lgkmcnt(0)
 s_barrier
 ds_read_b128 v[44:47], v5 offset:1024
 v_smfmac_f32_16x16x64_bf16 v[24:27], v[40:43], a[160:167], v15
 ds_read_b128 v[48:51], v5 offset:2048
 v_smfmac_f32_16x16x64_bf16 v[28:31], v[40:43], a[240:247], v15
 ds_read_b128 v[52:55], v5 offset:3072
 ds_read_b128 v[56:59], v5 offset:5120
 s_waitcnt lgkmcnt(3)
 v_smfmac_f32_16x16x64_bf16 v[16:19], v[44:47], v[200:207], v15
 ds_read_b128 v[32:35], v5 offset:6144
 v_cmp_ge_u32 vcc, s29, v14
 v_smfmac_f32_16x16x64_bf16 v[20:23], v[44:47], a[24:31], v15
 ds_read_b128 v[36:39], v5 offset:7168
 v_smfmac_f32_16x16x64_bf16 v[24:27], v[44:47], a[104:111], v15
 ds_read_b128 v[40:43], v5 offset:9216
 s_cbranch_vccnz cfs_2139
cfb_2140:
 v_smfmac_f32_16x16x64_bf16 v[28:31], v[44:47], a[184:191], v15
 buffer_load_dwordx4 v[60:63], v2, s[4:7], s24 offen offset:0 sc1
 s_waitcnt lgkmcnt(5)
 v_smfmac_f32_16x16x64_bf16 v[16:19], v[48:51], v[208:215], v15
 v_smfmac_f32_16x16x64_bf16 v[20:23], v[48:51], a[32:39], v15
 buffer_load_dwordx4 v[64:67], v2, s[4:7], s24 offen offset:1024 sc1
 v_smfmac_f32_16x16x64_bf16 v[24:27], v[48:51], a[112:119], v15
 v_smfmac_f32_16x16x64_bf16 v[28:31], v[48:51], a[192:199], v15
 buffer_load_dwordx4 v[68:71], v2, s[4:7], s24 offen offset:2048 sc1
 s_waitcnt lgkmcnt(4)
 v_smfmac_f32_16x16x64_bf16 v[16:19], v[52:55], v[216:223], v15
 v_smfmac_f32_16x16x64_bf16 v[20:23], v[52:55], a[40:47], v15
 buffer_load_dwordx4 v[72:75], v2, s[4:7], s24 offen offset:3072 sc1
 v_smfmac_f32_16x16x64_bf16 v[24:27], v[52:55], a[120:127], v15
 s_add_u32 s24, s24, 1310720
 buffer_load_dword v14, v13, s[4:7], 0 offen sc1
 v_smfmac_f32_16x16x64_bf16 v[28:31], v[52:55], a[200:207], v15
 s_waitcnt lgkmcnt(3)
 v_smfmac_f32_16x16x64_bf16 v[16:19], v[56:59], v[232:239], v15
 buffer_store_dwordx4 v[92:95], v3, s[4:7], s59 offen sc1
 s_mov_b32 s59, s27
 s_add_u32 s27, s27, 327680
 v_smfmac_f32_16x16x64_bf16 v[20:23], v[56:59], a[56:63], v15
 v_smfmac_f32_16x16x64_bf16 v[24:27], v[56:59], a[136:143], v15
 buffer_store_dword v10, v9, s[4:7], s39 offen sc1
 v_smfmac_f32_16x16x64_bf16 v[28:31], v[56:59], a[216:223], v15
 s_waitcnt lgkmcnt(2)
 v_smfmac_f32_16x16x64_bf16 v[16:19], v[32:35], v[240:247], v15
 v_smfmac_f32_16x16x64_bf16 v[20:23], v[32:35], a[64:71], v15
 v_smfmac_f32_16x16x64_bf16 v[24:27], v[32:35], a[144:151], v15
 v_smfmac_f32_16x16x64_bf16 v[28:31], v[32:35], a[224:231], v15
 s_waitcnt lgkmcnt(1)
 v_smfmac_f32_16x16x64_bf16 v[16:19], v[36:39], v[248:255], v15
 v_smfmac_f32_16x16x64_bf16 v[20:23], v[36:39], a[72:79], v15
 v_smfmac_f32_16x16x64_bf16 v[24:27], v[36:39], a[152:159], v15
 v_smfmac_f32_16x16x64_bf16 v[28:31], v[36:39], a[232:239], v15
 s_waitcnt lgkmcnt(0)
 v_smfmac_f32_16x16x64_bf16 v[16:19], v[40:43], a[8:15], v15
 v_smfmac_f32_16x16x64_bf16 v[20:23], v[40:43], a[88:95], v15
 v_smfmac_f32_16x16x64_bf16 v[24:27], v[40:43], a[168:175], v15
 v_smfmac_f32_16x16x64_bf16 v[28:31], v[40:43], a[248:255], v15
 s_nop 6
 v_permlane32_swap_b32 v16, v24
 v_permlane32_swap_b32 v17, v25
 v_permlane32_swap_b32 v18, v26
 v_permlane32_swap_b32 v19, v27
 v_pk_add_f32 v[16:17], v[16:17], v[24:25]
 v_pk_add_f32 v[18:19], v[18:19], v[26:27]
 v_cvt_pk_bf16_f32 v92, v16, v17
 v_cvt_pk_bf16_f32 v93, v18, v19
 v_permlane32_swap_b32 v20, v28
 v_permlane32_swap_b32 v21, v29
 v_permlane32_swap_b32 v22, v30
 v_permlane32_swap_b32 v23, v31
 v_pk_add_f32 v[20:21], v[20:21], v[28:29]
 v_pk_add_f32 v[22:23], v[22:23], v[30:31]
 v_cvt_pk_bf16_f32 v94, v20, v21
 v_cvt_pk_bf16_f32 v95, v22, v23
 s_nop 0
 v_permlane16_swap_b32 v92, v94
 v_permlane16_swap_b32 v93, v95
 s_cmp_eq_u32 s31, 63
 s_cbranch_scc1 cdone_2136
 s_barrier
 s_mov_b32 s99, 0
 buffer_load_dwordx4 v[96:99], v7, s[4:7], s36 offen sc1
 buffer_load_dwordx4 v[100:103], v6, s[4:7], s36 offen offset:0 sc1
 buffer_load_dwordx4 v[104:107], v6, s[4:7], s36 offen offset:1280 sc1
 buffer_load_dwordx4 v[108:111], v6, s[4:7], s36 offen offset:2560 sc1
 buffer_load_dwordx4 v[112:115], v6, s[4:7], s36 offen offset:3840 sc1
 s_waitcnt vmcnt(4)
 v_max3_u32 v121, v96, v97, v98
 v_max_u32 v121, v121, v99
 v_cmp_eq_u32 vcc, -1, v121
 s_cbranch_vccnz pea_2143
pco_2144:
 v_mfma_f32_16x16x32_bf16 v[116:119], v[92:95], v[96:99], 0
 s_waitcnt vmcnt(3)
 v_mfma_f32_16x16x32_bf16 v[116:119], v[60:63], v[100:103], v[116:119]
 v_max3_u32 v121, v121, v100, v101
 v_max3_u32 v121, v121, v102, v103
 s_waitcnt vmcnt(2)
 v_mfma_f32_16x16x32_bf16 v[116:119], v[64:67], v[104:107], v[116:119]
 v_max3_u32 v121, v121, v104, v105
 v_max3_u32 v121, v121, v106, v107
 s_waitcnt vmcnt(1)
 v_mfma_f32_16x16x32_bf16 v[116:119], v[68:71], v[108:111], v[116:119]
 v_max3_u32 v121, v121, v108, v109
 v_max3_u32 v121, v121, v110, v111
 s_waitcnt vmcnt(0)
 v_mfma_f32_16x16x32_bf16 v[116:119], v[72:75], v[112:115], v[116:119]
 v_max3_u32 v121, v121, v112, v113
 v_max3_u32 v121, v121, v114, v115
 v_cmp_eq_u32 vcc, -1, v121
 s_cbranch_vccnz prt_2141
 s_nop 3
 ds_write_b128 v3, v[116:119] offset:10240
 s_waitcnt lgkmcnt(0)
 s_barrier
 ds_read2st64_b64 v[96:99], v122 offset0:0 offset1:2
 ds_read2st64_b64 v[100:103], v8 offset0:0 offset1:2
 ds_read2st64_b64 v[104:107], v122 offset0:4 offset1:6
 ds_read2st64_b64 v[108:111], v8 offset0:4 offset1:6
 s_waitcnt lgkmcnt(3)
 v_pk_add_f32 v[96:97], v[96:97], v[98:99]
 s_waitcnt lgkmcnt(2)
 v_pk_add_f32 v[100:101], v[100:101], v[102:103]
 v_pk_add_f32 v[96:97], v[96:97], v[100:101]
 s_waitcnt lgkmcnt(1)
 v_pk_add_f32 v[104:105], v[104:105], v[106:107]
 v_pk_add_f32 v[96:97], v[96:97], v[104:105]
 s_waitcnt lgkmcnt(0)
 v_pk_add_f32 v[108:109], v[108:109], v[110:111]
 v_pk_add_f32 v[96:97], v[96:97], v[108:109]
 v_cvt_pk_bf16_f32 v121, v96, v97
 v_min_u32 v121, -2, v121
 buffer_store_dword v121, v9, s[4:7], s37 offen sc1
 s_mov_b32 s30, s36
 s_mov_b32 s36, s37
 s_mov_b32 s37, s38
 s_mov_b32 s38, s39
 s_mov_b32 s39, s30
 s_add_u32 s31, s31, 1
 s_branch cw_2132
cdone_2136:
 buffer_store_dwordx4 v[92:95], v3, s[4:7], s59 offen sc1
 s_branch cexit_2131
crt_2138:
 s_waitcnt lgkmcnt(0)
mr_2145:
 buffer_load_dwordx4 v[32:35], v5, s[4:7], s51 offen offset:0 sc1
 buffer_load_dwordx4 v[36:39], v5, s[4:7], s57 offen offset:0 sc1
 buffer_load_dwordx4 v[40:43], v5, s[4:7], s58 offen offset:0 sc1
 s_add_u32 s99, s99, 1
 s_cmp_gt_u32 s99, 200000
 s_cbranch_scc1 main_fail
 s_waitcnt vmcnt(0)
 v_max3_u32 v121, v32, v33, v34
 v_max3_u32 v121, v121, v35, v36
 v_max3_u32 v121, v121, v37, v38
 v_max3_u32 v121, v121, v39, v40
 v_max3_u32 v121, v121, v41, v42
 v_max_u32 v121, v121, v43
 v_cmp_eq_u32 vcc, -1, v121
 s_cbranch_vccnz mr_2145
 v_mov_b32 v16, 0
 v_mov_b32 v17, 0
 v_mov_b32 v18, 0
 v_mov_b32 v19, 0
 v_mov_b32 v20, 0
 v_mov_b32 v21, 0
 v_mov_b32 v22, 0
 v_mov_b32 v23, 0
 v_mov_b32 v24, 0
 v_mov_b32 v25, 0
 v_mov_b32 v26, 0
 v_mov_b32 v27, 0
 v_mov_b32 v28, 0
 v_mov_b32 v29, 0
 v_mov_b32 v30, 0
 v_mov_b32 v31, 0
 s_branch cst_2137
cfs_2139:
 s_mov_b32 s100, 0
fo_2146:
 buffer_load_dword v14, v13, s[4:7], 0 offen sc1
 s_add_u32 s100, s100, 1
 s_cmp_gt_u32 s100, 200000
 s_cbranch_scc1 main_fail
 s_waitcnt vmcnt(0)
 v_cmp_ge_u32 vcc, s29, v14
 s_cbranch_vccnz fo_2146
 s_branch cfb_2140
prt_2141:
pea_2143:
ppl_2147:
 buffer_load_dwordx4 v[96:99], v7, s[4:7], s36 offen sc1
 s_waitcnt vmcnt(4)
 buffer_load_dwordx4 v[100:103], v6, s[4:7], s36 offen offset:0 sc1
 s_waitcnt vmcnt(4)
 buffer_load_dwordx4 v[104:107], v6, s[4:7], s36 offen offset:1280 sc1
 s_waitcnt vmcnt(4)
 buffer_load_dwordx4 v[108:111], v6, s[4:7], s36 offen offset:2560 sc1
 s_waitcnt vmcnt(4)
 buffer_load_dwordx4 v[112:115], v6, s[4:7], s36 offen offset:3840 sc1
 s_add_u32 s99, s99, 1
 s_cmp_gt_u32 s99, 200000
 s_cbranch_scc1 main_fail
 s_waitcnt vmcnt(4)
 v_max3_u32 v121, v96, v97, v98
 v_max_u32 v121, v121, v99
 v_cmp_eq_u32 vcc, -1, v121
 s_cbranch_vccnz ppl_2147
 s_branch pco_2144
cw_2133:
 s_add_u32 s51, s36, 98304
 s_add_u32 s57, s36, 102400
 s_add_u32 s58, s36, 114688
 s_add_u32 s96, s31, 1
 s_min_u32 s29, s31, 62
 s_mov_b32 s97, 0
 s_cmp_ge_u32 s31, 63
 s_cselect_b32 s24, 0x20000000, s24
 s_mov_b32 s99, 0
 s_barrier
 buffer_load_dwordx4 v[32:35], v5, s[4:7], s51 offen offset:1024 sc1
 v_mov_b32 v16, 0
 v_mov_b32 v17, 0
 v_mov_b32 v18, 0
 v_mov_b32 v19, 0
 v_mov_b32 v20, 0
 v_mov_b32 v21, 0
 buffer_load_dwordx4 v[36:39], v5, s[4:7], s57 offen offset:1024 sc1
 v_mov_b32 v22, 0
 v_mov_b32 v23, 0
 v_mov_b32 v24, 0
 v_mov_b32 v25, 0
 v_mov_b32 v26, 0
 v_mov_b32 v27, 0
 buffer_load_dwordx4 v[40:43], v5, s[4:7], s58 offen offset:1024 sc1
 v_mov_b32 v28, 0
 v_mov_b32 v29, 0
 v_mov_b32 v30, 0
 v_mov_b32 v31, 0
cst_2149:
 s_waitcnt vmcnt(2)
 v_smfmac_f32_16x16x64_bf16 v[16:19], v[32:35], v[200:207], v15
 ds_write_b128 v5, v[32:35] offset:1024
 v_smfmac_f32_16x16x64_bf16 v[20:23], v[32:35], a[24:31], v15
 v_max3_u32 v121, v32, v33, v34
 v_smfmac_f32_16x16x64_bf16 v[24:27], v[32:35], a[104:111], v15
 s_waitcnt vmcnt(1)
 ds_write_b128 v5, v[36:39] offset:5120
 v_smfmac_f32_16x16x64_bf16 v[28:31], v[32:35], a[184:191], v15
 v_max3_u32 v121, v121, v35, v36
 v_smfmac_f32_16x16x64_bf16 v[16:19], v[36:39], v[232:239], v15
 v_max3_u32 v121, v121, v37, v38
 v_smfmac_f32_16x16x64_bf16 v[20:23], v[36:39], a[56:63], v15
 s_waitcnt vmcnt(0)
 ds_write_b128 v5, v[40:43] offset:9216
 v_smfmac_f32_16x16x64_bf16 v[24:27], v[36:39], a[136:143], v15
 v_max3_u32 v121, v121, v39, v40
 v_max3_u32 v121, v121, v41, v42
 v_smfmac_f32_16x16x64_bf16 v[28:31], v[36:39], a[216:223], v15
 v_max_u32 v121, v121, v43
 v_cmp_eq_u32 vcc, -1, v121
 v_smfmac_f32_16x16x64_bf16 v[16:19], v[40:43], a[8:15], v15
 v_smfmac_f32_16x16x64_bf16 v[20:23], v[40:43], a[88:95], v15
 s_cbranch_vccnz crt_2150
 s_waitcnt lgkmcnt(0)
 s_barrier
 ds_read_b128 v[44:47], v5 offset:0
 v_smfmac_f32_16x16x64_bf16 v[24:27], v[40:43], a[168:175], v15
 ds_read_b128 v[48:51], v5 offset:2048
 v_smfmac_f32_16x16x64_bf16 v[28:31], v[40:43], a[248:255], v15
 ds_read_b128 v[52:55], v5 offset:3072
 ds_read_b128 v[56:59], v5 offset:4096
 s_waitcnt lgkmcnt(3)
 v_smfmac_f32_16x16x64_bf16 v[16:19], v[44:47], v[192:199], v15
 ds_read_b128 v[32:35], v5 offset:6144
 v_cmp_ge_u32 vcc, s29, v14
 v_smfmac_f32_16x16x64_bf16 v[20:23], v[44:47], a[16:23], v15
 ds_read_b128 v[36:39], v5 offset:7168
 v_smfmac_f32_16x16x64_bf16 v[24:27], v[44:47], a[96:103], v15
 ds_read_b128 v[40:43], v5 offset:8192
 s_cbranch_vccnz cfs_2151
cfb_2152:
 v_smfmac_f32_16x16x64_bf16 v[28:31], v[44:47], a[176:183], v15
 buffer_load_dwordx4 v[60:63], v2, s[4:7], s24 offen offset:0 sc1
 s_waitcnt lgkmcnt(5)
 v_smfmac_f32_16x16x64_bf16 v[16:19], v[48:51], v[208:215], v15
 v_smfmac_f32_16x16x64_bf16 v[20:23], v[48:51], a[32:39], v15
 buffer_load_dwordx4 v[64:67], v2, s[4:7], s24 offen offset:1024 sc1
 v_smfmac_f32_16x16x64_bf16 v[24:27], v[48:51], a[112:119], v15
 v_smfmac_f32_16x16x64_bf16 v[28:31], v[48:51], a[192:199], v15
 buffer_load_dwordx4 v[68:71], v2, s[4:7], s24 offen offset:2048 sc1
 s_waitcnt lgkmcnt(4)
 v_smfmac_f32_16x16x64_bf16 v[16:19], v[52:55], v[216:223], v15
 v_smfmac_f32_16x16x64_bf16 v[20:23], v[52:55], a[40:47], v15
 buffer_load_dwordx4 v[72:75], v2, s[4:7], s24 offen offset:3072 sc1
 v_smfmac_f32_16x16x64_bf16 v[24:27], v[52:55], a[120:127], v15
 s_add_u32 s24, s24, 1310720
 buffer_load_dword v14, v13, s[4:7], 0 offen sc1
 v_smfmac_f32_16x16x64_bf16 v[28:31], v[52:55], a[200:207], v15
 s_waitcnt lgkmcnt(3)
 v_smfmac_f32_16x16x64_bf16 v[16:19], v[56:59], v[224:231], v15
 buffer_store_dwordx4 v[92:95], v3, s[4:7], s59 offen sc1
 s_mov_b32 s59, s27
 s_add_u32 s27, s27, 327680
 v_smfmac_f32_16x16x64_bf16 v[20:23], v[56:59], a[48:55], v15
 v_smfmac_f32_16x16x64_bf16 v[24:27], v[56:59], a[128:135], v15
 v_smfmac_f32_16x16x64_bf16 v[28:31], v[56:59], a[208:215], v15
 s_waitcnt lgkmcnt(2)
 v_smfmac_f32_16x16x64_bf16 v[16:19], v[32:35], v[240:247], v15
 v_smfmac_f32_16x16x64_bf16 v[20:23], v[32:35], a[64:71], v15
 v_smfmac_f32_16x16x64_bf16 v[24:27], v[32:35], a[144:151], v15
 v_smfmac_f32_16x16x64_bf16 v[28:31], v[32:35], a[224:231], v15
 s_waitcnt lgkmcnt(1)
 v_smfmac_f32_16x16x64_bf16 v[16:19], v[36:39], v[248:255], v15
 v_smfmac_f32_16x16x64_bf16 v[20:23], v[36:39], a[72:79], v15
 v_smfmac_f32_16x16x64_bf16 v[24:27], v[36:39], a[152:159], v15
 v_smfmac_f32_16x16x64_bf16 v[28:31], v[36:39], a[232:239], v15
 s_waitcnt lgkmcnt(0)
 v_smfmac_f32_16x16x64_bf16 v[16:19], v[40:43], a[0:7], v15
 v_smfmac_f32_16x16x64_bf16 v[20:23], v[40:43], a[80:87], v15
 v_smfmac_f32_16x16x64_bf16 v[24:27], v[40:43], a[160:167], v15
 v_smfmac_f32_16x16x64_bf16 v[28:31], v[40:43], a[240:247], v15
 s_nop 6
 v_permlane32_swap_b32 v16, v24
 v_permlane32_swap_b32 v17, v25
 v_permlane32_swap_b32 v18, v26
 v_permlane32_swap_b32 v19, v27
 v_pk_add_f32 v[16:17], v[16:17], v[24:25]
 v_pk_add_f32 v[18:19], v[18:19], v[26:27]
 v_cvt_pk_bf16_f32 v92, v16, v17
 v_cvt_pk_bf16_f32 v93, v18, v19
 v_permlane32_swap_b32 v20, v28
 v_permlane32_swap_b32 v21, v29
 v_permlane32_swap_b32 v22, v30
 v_permlane32_swap_b32 v23, v31
 v_pk_add_f32 v[20:21], v[20:21], v[28:29]
 v_pk_add_f32 v[22:23], v[22:23], v[30:31]
 v_cvt_pk_bf16_f32 v94, v20, v21
 v_cvt_pk_bf16_f32 v95, v22, v23
 s_nop 0
 v_permlane16_swap_b32 v92, v94
 v_permlane16_swap_b32 v93, v95
 s_cmp_eq_u32 s31, 63
 s_cbranch_scc1 cdone_2148
 s_barrier
 s_mov_b32 s99, 0
 buffer_load_dwordx4 v[96:99], v7, s[4:7], s36 offen sc1
 buffer_load_dwordx4 v[100:103], v6, s[4:7], s36 offen offset:0 sc1
 buffer_load_dwordx4 v[104:107], v6, s[4:7], s36 offen offset:1280 sc1
 buffer_load_dwordx4 v[108:111], v6, s[4:7], s36 offen offset:2560 sc1
 buffer_load_dwordx4 v[112:115], v6, s[4:7], s36 offen offset:3840 sc1
 s_waitcnt vmcnt(4)
 v_max3_u32 v121, v96, v97, v98
 v_max_u32 v121, v121, v99
 v_cmp_eq_u32 vcc, -1, v121
 s_cbranch_vccnz pea_2155
pco_2156:
 v_mfma_f32_16x16x32_bf16 v[116:119], v[92:95], v[96:99], 0
 s_waitcnt vmcnt(3)
 v_mfma_f32_16x16x32_bf16 v[116:119], v[60:63], v[100:103], v[116:119]
 v_max3_u32 v121, v121, v100, v101
 v_max3_u32 v121, v121, v102, v103
 s_waitcnt vmcnt(2)
 v_mfma_f32_16x16x32_bf16 v[116:119], v[64:67], v[104:107], v[116:119]
 v_max3_u32 v121, v121, v104, v105
 v_max3_u32 v121, v121, v106, v107
 s_waitcnt vmcnt(1)
 v_mfma_f32_16x16x32_bf16 v[116:119], v[68:71], v[108:111], v[116:119]
 v_max3_u32 v121, v121, v108, v109
 v_max3_u32 v121, v121, v110, v111
 s_waitcnt vmcnt(0)
 v_mfma_f32_16x16x32_bf16 v[116:119], v[72:75], v[112:115], v[116:119]
 v_max3_u32 v121, v121, v112, v113
 v_max3_u32 v121, v121, v114, v115
 v_cmp_eq_u32 vcc, -1, v121
 s_cbranch_vccnz prt_2153
 s_nop 3
 ds_write_b128 v3, v[116:119] offset:10240
 s_waitcnt lgkmcnt(0)
 s_barrier
 s_mov_b32 s30, s36
 s_mov_b32 s36, s37
 s_mov_b32 s37, s38
 s_mov_b32 s38, s39
 s_mov_b32 s39, s30
 s_add_u32 s31, s31, 1
 s_branch cw_2133
cdone_2148:
 buffer_store_dwordx4 v[92:95], v3, s[4:7], s59 offen sc1
 s_branch cexit_2131
crt_2150:
 s_waitcnt lgkmcnt(0)
mr_2157:
 buffer_load_dwordx4 v[32:35], v5, s[4:7], s51 offen offset:1024 sc1
 buffer_load_dwordx4 v[36:39], v5, s[4:7], s57 offen offset:1024 sc1
 buffer_load_dwordx4 v[40:43], v5, s[4:7], s58 offen offset:1024 sc1
 s_add_u32 s99, s99, 1
 s_cmp_gt_u32 s99, 200000
 s_cbranch_scc1 main_fail
 s_waitcnt vmcnt(0)
 v_max3_u32 v121, v32, v33, v34
 v_max3_u32 v121, v121, v35, v36
 v_max3_u32 v121, v121, v37, v38
 v_max3_u32 v121, v121, v39, v40
 v_max3_u32 v121, v121, v41, v42
 v_max_u32 v121, v121, v43
 v_cmp_eq_u32 vcc, -1, v121
 s_cbranch_vccnz mr_2157
 v_mov_b32 v16, 0
 v_mov_b32 v17, 0
 v_mov_b32 v18, 0
 v_mov_b32 v19, 0
 v_mov_b32 v20, 0
 v_mov_b32 v21, 0
 v_mov_b32 v22, 0
 v_mov_b32 v23, 0
 v_mov_b32 v24, 0
 v_mov_b32 v25, 0
 v_mov_b32 v26, 0
 v_mov_b32 v27, 0
 v_mov_b32 v28, 0
 v_mov_b32 v29, 0
 v_mov_b32 v30, 0
 v_mov_b32 v31, 0
 s_branch cst_2149
cfs_2151:
 s_mov_b32 s100, 0
fo_2158:
 buffer_load_dword v14, v13, s[4:7], 0 offen sc1
 s_add_u32 s100, s100, 1
 s_cmp_gt_u32 s100, 200000
 s_cbranch_scc1 main_fail
 s_waitcnt vmcnt(0)
 v_cmp_ge_u32 vcc, s29, v14
 s_cbranch_vccnz fo_2158
 s_branch cfb_2152
prt_2153:
pea_2155:
ppl_2159:
 buffer_load_dwordx4 v[96:99], v7, s[4:7], s36 offen sc1
 s_waitcnt vmcnt(4)
 buffer_load_dwordx4 v[100:103], v6, s[4:7], s36 offen offset:0 sc1
 s_waitcnt vmcnt(4)
 buffer_load_dwordx4 v[104:107], v6, s[4:7], s36 offen offset:1280 sc1
 s_waitcnt vmcnt(4)
 buffer_load_dwordx4 v[108:111], v6, s[4:7], s36 offen offset:2560 sc1
 s_waitcnt vmcnt(4)
 buffer_load_dwordx4 v[112:115], v6, s[4:7], s36 offen offset:3840 sc1
 s_add_u32 s99, s99, 1
 s_cmp_gt_u32 s99, 200000
 s_cbranch_scc1 main_fail
 s_waitcnt vmcnt(4)
 v_max3_u32 v121, v96, v97, v98
 v_max_u32 v121, v121, v99
 v_cmp_eq_u32 vcc, -1, v121
 s_cbranch_vccnz ppl_2159
 s_branch pco_2156
cw_2134:
 s_add_u32 s51, s36, 98304
 s_add_u32 s57, s36, 102400
 s_add_u32 s58, s36, 114688
 s_add_u32 s96, s31, 1
 s_min_u32 s29, s31, 62
 s_mov_b32 s97, 0
 s_cmp_ge_u32 s31, 63
 s_cselect_b32 s24, 0x20000000, s24
 s_mov_b32 s99, 0
 s_barrier
 buffer_load_dwordx4 v[32:35], v5, s[4:7], s51 offen offset:2048 sc1
 v_mov_b32 v16, 0
 v_mov_b32 v17, 0
 v_mov_b32 v18, 0
 v_mov_b32 v19, 0
 v_mov_b32 v20, 0
 v_mov_b32 v21, 0
 buffer_load_dwordx4 v[36:39], v5, s[4:7], s57 offen offset:2048 sc1
 v_mov_b32 v22, 0
 v_mov_b32 v23, 0
 v_mov_b32 v24, 0
 v_mov_b32 v25, 0
 v_mov_b32 v26, 0
 v_mov_b32 v27, 0
 buffer_load_dwordx4 v[40:43], v5, s[4:7], s58 offen offset:0 sc1
 v_mov_b32 v28, 0
 v_mov_b32 v29, 0
 v_mov_b32 v30, 0
 v_mov_b32 v31, 0
cst_2161:
 s_waitcnt vmcnt(2)
 v_smfmac_f32_16x16x64_bf16 v[16:19], v[32:35], v[208:215], v15
 ds_write_b128 v5, v[32:35] offset:2048
 v_smfmac_f32_16x16x64_bf16 v[20:23], v[32:35], a[32:39], v15
 v_max3_u32 v121, v32, v33, v34
 v_smfmac_f32_16x16x64_bf16 v[24:27], v[32:35], a[112:119], v15
 s_waitcnt vmcnt(1)
 ds_write_b128 v5, v[36:39] offset:6144
 v_smfmac_f32_16x16x64_bf16 v[28:31], v[32:35], a[192:199], v15
 v_max3_u32 v121, v121, v35, v36
 v_smfmac_f32_16x16x64_bf16 v[16:19], v[36:39], v[240:247], v15
 v_max3_u32 v121, v121, v37, v38
 v_smfmac_f32_16x16x64_bf16 v[20:23], v[36:39], a[64:71], v15
 s_waitcnt vmcnt(0)
 v_smfmac_f32_16x16x64_bf16 v[24:27], v[36:39], a[144:151], v15
 v_max3_u32 v121, v121, v39, v40
 v_max3_u32 v121, v121, v41, v42
 v_smfmac_f32_16x16x64_bf16 v[28:31], v[36:39], a[224:231], v15
 v_max_u32 v121, v121, v43
 v_cmp_eq_u32 vcc, -1, v121
 v_smfmac_f32_16x16x64_bf16 v[16:19], v[40:43], a[0:7], v15
 v_smfmac_f32_16x16x64_bf16 v[20:23], v[40:43], a[80:87], v15
 s_cbranch_vccnz crt_2162
 s_waitcnt lgkmcnt(0)
 s_barrier
 ds_read_b128 v[44:47], v5 offset:0
 v_smfmac_f32_16x16x64_bf16 v[24:27], v[40:43], a[160:167], v15
 ds_read_b128 v[48:51], v5 offset:1024
 v_smfmac_f32_16x16x64_bf16 v[28:31], v[40:43], a[240:247], v15
 ds_read_b128 v[52:55], v5 offset:3072
 ds_read_b128 v[56:59], v5 offset:4096
 s_waitcnt lgkmcnt(3)
 v_smfmac_f32_16x16x64_bf16 v[16:19], v[44:47], v[192:199], v15
 ds_read_b128 v[32:35], v5 offset:5120
 v_cmp_ge_u32 vcc, s29, v14
 v_smfmac_f32_16x16x64_bf16 v[20:23], v[44:47], a[16:23], v15
 ds_read_b128 v[36:39], v5 offset:7168
 v_smfmac_f32_16x16x64_bf16 v[24:27], v[44:47], a[96:103], v15
 ds_read_b128 v[40:43], v5 offset:9216
 s_cbranch_vccnz cfs_2163
cfb_2164:
 v_smfmac_f32_16x16x64_bf16 v[28:31], v[44:47], a[176:183], v15
 buffer_load_dwordx4 v[60:63], v2, s[4:7], s24 offen offset:0 sc1
 s_waitcnt lgkmcnt(5)
 v_smfmac_f32_16x16x64_bf16 v[16:19], v[48:51], v[200:207], v15
 v_smfmac_f32_16x16x64_bf16 v[20:23], v[48:51], a[24:31], v15
 buffer_load_dwordx4 v[64:67], v2, s[4:7], s24 offen offset:1024 sc1
 v_smfmac_f32_16x16x64_bf16 v[24:27], v[48:51], a[104:111], v15
 v_smfmac_f32_16x16x64_bf16 v[28:31], v[48:51], a[184:191], v15
 buffer_load_dwordx4 v[68:71], v2, s[4:7], s24 offen offset:2048 sc1
 s_waitcnt lgkmcnt(4)
 v_smfmac_f32_16x16x64_bf16 v[16:19], v[52:55], v[216:223], v15
 v_smfmac_f32_16x16x64_bf16 v[20:23], v[52:55], a[40:47], v15
 buffer_load_dwordx4 v[72:75], v2, s[4:7], s24 offen offset:3072 sc1
 v_smfmac_f32_16x16x64_bf16 v[24:27], v[52:55], a[120:127], v15
 s_add_u32 s24, s24, 1310720
 buffer_load_dword v14, v13, s[4:7], 0 offen sc1
 v_smfmac_f32_16x16x64_bf16 v[28:31], v[52:55], a[200:207], v15
 s_waitcnt lgkmcnt(3)
 v_smfmac_f32_16x16x64_bf16 v[16:19], v[56:59], v[224:231], v15
 buffer_store_dwordx4 v[92:95], v3, s[4:7], s59 offen sc1
 s_mov_b32 s59, s27
 s_add_u32 s27, s27, 327680
 v_smfmac_f32_16x16x64_bf16 v[20:23], v[56:59], a[48:55], v15
 v_smfmac_f32_16x16x64_bf16 v[24:27], v[56:59], a[128:135], v15
 v_smfmac_f32_16x16x64_bf16 v[28:31], v[56:59], a[208:215], v15
 s_waitcnt lgkmcnt(2)
 v_smfmac_f32_16x16x64_bf16 v[16:19], v[32:35], v[232:239], v15
 v_smfmac_f32_16x16x64_bf16 v[20:23], v[32:35], a[56:63], v15
 v_smfmac_f32_16x16x64_bf16 v[24:27], v[32:35], a[136:143], v15
 v_smfmac_f32_16x16x64_bf16 v[28:31], v[32:35], a[216:223], v15
 s_waitcnt lgkmcnt(1)
 v_smfmac_f32_16x16x64_bf16 v[16:19], v[36:39], v[248:255], v15
 v_smfmac_f32_16x16x64_bf16 v[20:23], v[36:39], a[72:79], v15
 v_smfmac_f32_16x16x64_bf16 v[24:27], v[36:39], a[152:159], v15
 v_smfmac_f32_16x16x64_bf16 v[28:31], v[36:39], a[232:239], v15
 s_waitcnt lgkmcnt(0)
 v_smfmac_f32_16x16x64_bf16 v[16:19], v[40:43], a[8:15], v15
 v_smfmac_f32_16x16x64_bf16 v[20:23], v[40:43], a[88:95], v15
 v_smfmac_f32_16x16x64_bf16 v[24:27], v[40:43], a[168:175], v15
 v_smfmac_f32_16x16x64_bf16 v[28:31], v[40:43], a[248:255], v15
 s_nop 6
 v_permlane32_swap_b32 v16, v24
 v_permlane32_swap_b32 v17, v25
 v_permlane32_swap_b32 v18, v26
 v_permlane32_swap_b32 v19, v27
 v_pk_add_f32 v[16:17], v[16:17], v[24:25]
 v_pk_add_f32 v[18:19], v[18:19], v[26:27]
 v_cvt_pk_bf16_f32 v92, v16, v17
 v_cvt_pk_bf16_f32 v93, v18, v19
 v_permlane32_swap_b32 v20, v28
 v_permlane32_swap_b32 v21, v29
 v_permlane32_swap_b32 v22, v30
 v_permlane32_swap_b32 v23, v31
 v_pk_add_f32 v[20:21], v[20:21], v[28:29]
 v_pk_add_f32 v[22:23], v[22:23], v[30:31]
 v_cvt_pk_bf16_f32 v94, v20, v21
 v_cvt_pk_bf16_f32 v95, v22, v23
 s_nop 0
 v_permlane16_swap_b32 v92, v94
 v_permlane16_swap_b32 v93, v95
 s_cmp_eq_u32 s31, 63
 s_cbranch_scc1 cdone_2160
 s_barrier
 s_mov_b32 s99, 0
 buffer_load_dwordx4 v[96:99], v7, s[4:7], s36 offen sc1
 buffer_load_dwordx4 v[100:103], v6, s[4:7], s36 offen offset:0 sc1
 buffer_load_dwordx4 v[104:107], v6, s[4:7], s36 offen offset:1280 sc1
 buffer_load_dwordx4 v[108:111], v6, s[4:7], s36 offen offset:2560 sc1
 buffer_load_dwordx4 v[112:115], v6, s[4:7], s36 offen offset:3840 sc1
 s_waitcnt vmcnt(4)
 v_max3_u32 v121, v96, v97, v98
 v_max_u32 v121, v121, v99
 v_cmp_eq_u32 vcc, -1, v121
 s_cbranch_vccnz pea_2167
pco_2168:
 v_mfma_f32_16x16x32_bf16 v[116:119], v[92:95], v[96:99], 0
 s_waitcnt vmcnt(3)
 v_mfma_f32_16x16x32_bf16 v[116:119], v[60:63], v[100:103], v[116:119]
 v_max3_u32 v121, v121, v100, v101
 v_max3_u32 v121, v121, v102, v103
 s_waitcnt vmcnt(2)
 v_mfma_f32_16x16x32_bf16 v[116:119], v[64:67], v[104:107], v[116:119]
 v_max3_u32 v121, v121, v104, v105
 v_max3_u32 v121, v121, v106, v107
 s_waitcnt vmcnt(1)
 v_mfma_f32_16x16x32_bf16 v[116:119], v[68:71], v[108:111], v[116:119]
 v_max3_u32 v121, v121, v108, v109
 v_max3_u32 v121, v121, v110, v111
 s_waitcnt vmcnt(0)
 v_mfma_f32_16x16x32_bf16 v[116:119], v[72:75], v[112:115], v[116:119]
 v_max3_u32 v121, v121, v112, v113
 v_max3_u32 v121, v121, v114, v115
 v_cmp_eq_u32 vcc, -1, v121
 s_cbranch_vccnz prt_2165
 s_nop 3
 ds_write_b128 v3, v[116:119] offset:10240
 s_waitcnt lgkmcnt(0)
 s_barrier
 s_mov_b32 s30, s36
 s_mov_b32 s36, s37
 s_mov_b32 s37, s38
 s_mov_b32 s38, s39
 s_mov_b32 s39, s30
 s_add_u32 s31, s31, 1
 s_branch cw_2134
cdone_2160:
 buffer_store_dwordx4 v[92:95], v3, s[4:7], s59 offen sc1
 s_branch cexit_2131
crt_2162:
 s_waitcnt lgkmcnt(0)
mr_2169:
 buffer_load_dwordx4 v[32:35], v5, s[4:7], s51 offen offset:2048 sc1
 buffer_load_dwordx4 v[36:39], v5, s[4:7], s57 offen offset:2048 sc1
 buffer_load_dwordx4 v[40:43], v5, s[4:7], s58 offen offset:0 sc1
 s_add_u32 s99, s99, 1
 s_cmp_gt_u32 s99, 200000
 s_cbranch_scc1 main_fail
 s_waitcnt vmcnt(0)
 v_max3_u32 v121, v32, v33, v34
 v_max3_u32 v121, v121, v35, v36
 v_max3_u32 v121, v121, v37, v38
 v_max3_u32 v121, v121, v39, v40
 v_max3_u32 v121, v121, v41, v42
 v_max_u32 v121, v121, v43
 v_cmp_eq_u32 vcc, -1, v121
 s_cbranch_vccnz mr_2169
 v_mov_b32 v16, 0
 v_mov_b32 v17, 0
 v_mov_b32 v18, 0
 v_mov_b32 v19, 0
 v_mov_b32 v20, 0
 v_mov_b32 v21, 0
 v_mov_b32 v22, 0
 v_mov_b32 v23, 0
 v_mov_b32 v24, 0
 v_mov_b32 v25, 0
 v_mov_b32 v26, 0
 v_mov_b32 v27, 0
 v_mov_b32 v28, 0
 v_mov_b32 v29, 0
 v_mov_b32 v30, 0
 v_mov_b32 v31, 0
 s_branch cst_2161
cfs_2163:
 s_mov_b32 s100, 0
fo_2170:
 buffer_load_dword v14, v13, s[4:7], 0 offen sc1
 s_add_u32 s100, s100, 1
 s_cmp_gt_u32 s100, 200000
 s_cbranch_scc1 main_fail
 s_waitcnt vmcnt(0)
 v_cmp_ge_u32 vcc, s29, v14
 s_cbranch_vccnz fo_2170
 s_branch cfb_2164
prt_2165:
pea_2167:
ppl_2171:
 buffer_load_dwordx4 v[96:99], v7, s[4:7], s36 offen sc1
 s_waitcnt vmcnt(4)
 buffer_load_dwordx4 v[100:103], v6, s[4:7], s36 offen offset:0 sc1
 s_waitcnt vmcnt(4)
 buffer_load_dwordx4 v[104:107], v6, s[4:7], s36 offen offset:1280 sc1
 s_waitcnt vmcnt(4)
 buffer_load_dwordx4 v[108:111], v6, s[4:7], s36 offen offset:2560 sc1
 s_waitcnt vmcnt(4)
 buffer_load_dwordx4 v[112:115], v6, s[4:7], s36 offen offset:3840 sc1
 s_add_u32 s99, s99, 1
 s_cmp_gt_u32 s99, 200000
 s_cbranch_scc1 main_fail
 s_waitcnt vmcnt(4)
 v_max3_u32 v121, v96, v97, v98
 v_max_u32 v121, v121, v99
 v_cmp_eq_u32 vcc, -1, v121
 s_cbranch_vccnz ppl_2171
 s_branch pco_2168
cw_2135:
 s_add_u32 s51, s36, 98304
 s_add_u32 s57, s36, 102400
 s_add_u32 s58, s36, 114688
 s_add_u32 s96, s31, 1
 s_min_u32 s29, s31, 62
 s_mov_b32 s97, 0
 s_cmp_ge_u32 s31, 63
 s_cselect_b32 s24, 0x20000000, s24
 s_mov_b32 s99, 0
 s_barrier
 buffer_store_dword v4, v11, s[4:7], 0 offen sc1
 v_mov_b32 v4, s96
 buffer_load_dwordx4 v[32:35], v5, s[4:7], s51 offen offset:3072 sc1
 v_mov_b32 v16, 0
 v_mov_b32 v17, 0
 v_mov_b32 v18, 0
 v_mov_b32 v19, 0
 v_mov_b32 v20, 0
 v_mov_b32 v21, 0
 buffer_load_dwordx4 v[36:39], v5, s[4:7], s57 offen offset:3072 sc1
 v_mov_b32 v22, 0
 v_mov_b32 v23, 0
 v_mov_b32 v24, 0
 v_mov_b32 v25, 0
 v_mov_b32 v26, 0
 v_mov_b32 v27, 0
 buffer_load_dwordx4 v[40:43], v5, s[4:7], s58 offen offset:1024 sc1
 v_mov_b32 v28, 0
 v_mov_b32 v29, 0
 v_mov_b32 v30, 0
 v_mov_b32 v31, 0
cst_2173:
 s_waitcnt vmcnt(2)
 v_smfmac_f32_16x16x64_bf16 v[16:19], v[32:35], v[216:223], v15
 ds_write_b128 v5, v[32:35] offset:3072
 v_smfmac_f32_16x16x64_bf16 v[20:23], v[32:35], a[40:47], v15
 v_max3_u32 v121, v32, v33, v34
 v_smfmac_f32_16x16x64_bf16 v[24:27], v[32:35], a[120:127], v15
 s_waitcnt vmcnt(1)
 ds_write_b128 v5, v[36:39] offset:7168
 v_smfmac_f32_16x16x64_bf16 v[28:31], v[32:35], a[200:207], v15
 v_max3_u32 v121, v121, v35, v36
 v_smfmac_f32_16x16x64_bf16 v[16:19], v[36:39], v[248:255], v15
 v_max3_u32 v121, v121, v37, v38
 v_smfmac_f32_16x16x64_bf16 v[20:23], v[36:39], a[72:79], v15
 s_waitcnt vmcnt(0)
 v_smfmac_f32_16x16x64_bf16 v[24:27], v[36:39], a[152:159], v15
 v_max3_u32 v121, v121, v39, v40
 v_max3_u32 v121, v121, v41, v42
 v_smfmac_f32_16x16x64_bf16 v[28:31], v[36:39], a[232:239], v15
 v_max_u32 v121, v121, v43
 v_cmp_eq_u32 vcc, -1, v121
 v_smfmac_f32_16x16x64_bf16 v[16:19], v[40:43], a[8:15], v15
 v_smfmac_f32_16x16x64_bf16 v[20:23], v[40:43], a[88:95], v15
 s_cbranch_vccnz crt_2174
 s_waitcnt lgkmcnt(0)
 s_barrier
 ds_read_b128 v[44:47], v5 offset:0
 v_smfmac_f32_16x16x64_bf16 v[24:27], v[40:43], a[168:175], v15
 ds_read_b128 v[48:51], v5 offset:1024
 v_smfmac_f32_16x16x64_bf16 v[28:31], v[40:43], a[248:255], v15
 ds_read_b128 v[52:55], v5 offset:2048
 ds_read_b128 v[56:59], v5 offset:4096
 s_waitcnt lgkmcnt(3)
 v_smfmac_f32_16x16x64_bf16 v[16:19], v[44:47], v[192:199], v15
 ds_read_b128 v[32:35], v5 offset:5120
 v_cmp_ge_u32 vcc, s29, v14
 v_smfmac_f32_16x16x64_bf16 v[20:23], v[44:47], a[16:23], v15
 ds_read_b128 v[36:39], v5 offset:6144
 v_smfmac_f32_16x16x64_bf16 v[24:27], v[44:47], a[96:103], v15
 ds_read_b128 v[40:43], v5 offset:8192
 s_cbranch_vccnz cfs_2175
cfb_2176:
 v_smfmac_f32_16x16x64_bf16 v[28:31], v[44:47], a[176:183], v15
 buffer_load_dwordx4 v[60:63], v2, s[4:7], s24 offen offset:0 sc1
 s_waitcnt lgkmcnt(5)
 v_smfmac_f32_16x16x64_bf16 v[16:19], v[48:51], v[200:207], v15
 v_smfmac_f32_16x16x64_bf16 v[20:23], v[48:51], a[24:31], v15
 buffer_load_dwordx4 v[64:67], v2, s[4:7], s24 offen offset:1024 sc1
 v_smfmac_f32_16x16x64_bf16 v[24:27], v[48:51], a[104:111], v15
 v_smfmac_f32_16x16x64_bf16 v[28:31], v[48:51], a[184:191], v15
 buffer_load_dwordx4 v[68:71], v2, s[4:7], s24 offen offset:2048 sc1
 s_waitcnt lgkmcnt(4)
 v_smfmac_f32_16x16x64_bf16 v[16:19], v[52:55], v[208:215], v15
 v_smfmac_f32_16x16x64_bf16 v[20:23], v[52:55], a[32:39], v15
 buffer_load_dwordx4 v[72:75], v2, s[4:7], s24 offen offset:3072 sc1
 v_smfmac_f32_16x16x64_bf16 v[24:27], v[52:55], a[112:119], v15
 s_add_u32 s24, s24, 1310720
 buffer_load_dword v14, v13, s[4:7], 0 offen sc1
 v_smfmac_f32_16x16x64_bf16 v[28:31], v[52:55], a[192:199], v15
 s_waitcnt lgkmcnt(3)
 v_smfmac_f32_16x16x64_bf16 v[16:19], v[56:59], v[224:231], v15
 buffer_store_dwordx4 v[92:95], v3, s[4:7], s59 offen sc1
 s_mov_b32 s59, s27
 s_add_u32 s27, s27, 327680
 v_smfmac_f32_16x16x64_bf16 v[20:23], v[56:59], a[48:55], v15
 v_smfmac_f32_16x16x64_bf16 v[24:27], v[56:59], a[128:135], v15
 v_smfmac_f32_16x16x64_bf16 v[28:31], v[56:59], a[208:215], v15
 s_waitcnt lgkmcnt(2)
 v_smfmac_f32_16x16x64_bf16 v[16:19], v[32:35], v[232:239], v15
 v_smfmac_f32_16x16x64_bf16 v[20:23], v[32:35], a[56:63], v15
 v_smfmac_f32_16x16x64_bf16 v[24:27], v[32:35], a[136:143], v15
 v_smfmac_f32_16x16x64_bf16 v[28:31], v[32:35], a[216:223], v15
 s_waitcnt lgkmcnt(1)
 v_smfmac_f32_16x16x64_bf16 v[16:19], v[36:39], v[240:247], v15
 v_smfmac_f32_16x16x64_bf16 v[20:23], v[36:39], a[64:71], v15
 v_smfmac_f32_16x16x64_bf16 v[24:27], v[36:39], a[144:151], v15
 v_smfmac_f32_16x16x64_bf16 v[28:31], v[36:39], a[224:231], v15
 s_waitcnt lgkmcnt(0)
 v_smfmac_f32_16x16x64_bf16 v[16:19], v[40:43], a[0:7], v15
 v_smfmac_f32_16x16x64_bf16 v[20:23], v[40:43], a[80:87], v15
 v_smfmac_f32_16x16x64_bf16 v[24:27], v[40:43], a[160:167], v15
 v_smfmac_f32_16x16x64_bf16 v[28:31], v[40:43], a[240:247], v15
 s_nop 6
 v_permlane32_swap_b32 v16, v24
 v_permlane32_swap_b32 v17, v25
 v_permlane32_swap_b32 v18, v26
 v_permlane32_swap_b32 v19, v27
 v_pk_add_f32 v[16:17], v[16:17], v[24:25]
 v_pk_add_f32 v[18:19], v[18:19], v[26:27]
 v_cvt_pk_bf16_f32 v92, v16, v17
 v_cvt_pk_bf16_f32 v93, v18, v19
 v_permlane32_swap_b32 v20, v28
 v_permlane32_swap_b32 v21, v29
 v_permlane32_swap_b32 v22, v30
 v_permlane32_swap_b32 v23, v31
 v_pk_add_f32 v[20:21], v[20:21], v[28:29]
 v_pk_add_f32 v[22:23], v[22:23], v[30:31]
 v_cvt_pk_bf16_f32 v94, v20, v21
 v_cvt_pk_bf16_f32 v95, v22, v23
 s_nop 0
 v_permlane16_swap_b32 v92, v94
 v_permlane16_swap_b32 v93, v95
 s_cmp_eq_u32 s31, 63
 s_cbranch_scc1 cdone_2172
 s_mov_b32 s100, 0
db_2177:
 s_load_dword s52, s[4:5], s50 glc
 s_add_u32 s100, s100, 1
 s_cmp_gt_u32 s100, 800000
 s_cbranch_scc1 main_fail
 s_waitcnt lgkmcnt(3)
 s_cmp_gt_u32 s52, s31
 s_cbranch_scc0 db_2177
 s_barrier
 s_mov_b32 s99, 0
 buffer_load_dwordx4 v[96:99], v7, s[4:7], s36 offen sc1
 buffer_load_dwordx4 v[100:103], v6, s[4:7], s36 offen offset:0 sc1
 buffer_load_dwordx4 v[104:107], v6, s[4:7], s36 offen offset:1280 sc1
 buffer_load_dwordx4 v[108:111], v6, s[4:7], s36 offen offset:2560 sc1
 buffer_load_dwordx4 v[112:115], v6, s[4:7], s36 offen offset:3840 sc1
 s_waitcnt vmcnt(4)
 v_max3_u32 v121, v96, v97, v98
 v_max_u32 v121, v121, v99
 v_cmp_eq_u32 vcc, -1, v121
 s_cbranch_vccnz pea_2180
pco_2181:
 v_mfma_f32_16x16x32_bf16 v[116:119], v[92:95], v[96:99], 0
 s_waitcnt vmcnt(3)
 v_mfma_f32_16x16x32_bf16 v[116:119], v[60:63], v[100:103], v[116:119]
 v_max3_u32 v121, v121, v100, v101
 v_max3_u32 v121, v121, v102, v103
 s_waitcnt vmcnt(2)
 v_mfma_f32_16x16x32_bf16 v[116:119], v[64:67], v[104:107], v[116:119]
 v_max3_u32 v121, v121, v104, v105
 v_max3_u32 v121, v121, v106, v107
 s_waitcnt vmcnt(1)
 v_mfma_f32_16x16x32_bf16 v[116:119], v[68:71], v[108:111], v[116:119]
 v_max3_u32 v121, v121, v108, v109
 v_max3_u32 v121, v121, v110, v111
 s_waitcnt vmcnt(0)
 v_mfma_f32_16x16x32_bf16 v[116:119], v[72:75], v[112:115], v[116:119]
 buffer_store_dword v4, v11, s[4:7], s97 offen sc1
 v_max3_u32 v121, v121, v112, v113
 v_max3_u32 v121, v121, v114, v115
 v_cmp_eq_u32 vcc, -1, v121
 s_cbranch_vccnz prt_2178
 s_nop 2
 ds_write_b128 v3, v[116:119] offset:10240
 s_waitcnt lgkmcnt(0)
 s_barrier
 s_mov_b32 s30, s36
 s_mov_b32 s36, s37
 s_mov_b32 s37, s38
 s_mov_b32 s38, s39
 s_mov_b32 s39, s30
 s_add_u32 s31, s31, 1
 s_branch cw_2135
cdone_2172:
 buffer_store_dwordx4 v[92:95], v3, s[4:7], s59 offen sc1
 s_branch cexit_2131
crt_2174:
 s_waitcnt lgkmcnt(0)
mr_2182:
 buffer_load_dwordx4 v[32:35], v5, s[4:7], s51 offen offset:3072 sc1
 buffer_load_dwordx4 v[36:39], v5, s[4:7], s57 offen offset:3072 sc1
 buffer_load_dwordx4 v[40:43], v5, s[4:7], s58 offen offset:1024 sc1
 s_add_u32 s99, s99, 1
 s_cmp_gt_u32 s99, 200000
 s_cbranch_scc1 main_fail
 s_waitcnt vmcnt(0)
 v_max3_u32 v121, v32, v33, v34
 v_max3_u32 v121, v121, v35, v36
 v_max3_u32 v121, v121, v37, v38
 v_max3_u32 v121, v121, v39, v40
 v_max3_u32 v121, v121, v41, v42
 v_max_u32 v121, v121, v43
 v_cmp_eq_u32 vcc, -1, v121
 s_cbranch_vccnz mr_2182
 v_mov_b32 v16, 0
 v_mov_b32 v17, 0
 v_mov_b32 v18, 0
 v_mov_b32 v19, 0
 v_mov_b32 v20, 0
 v_mov_b32 v21, 0
 v_mov_b32 v22, 0
 v_mov_b32 v23, 0
 v_mov_b32 v24, 0
 v_mov_b32 v25, 0
 v_mov_b32 v26, 0
 v_mov_b32 v27, 0
 v_mov_b32 v28, 0
 v_mov_b32 v29, 0
 v_mov_b32 v30, 0
 v_mov_b32 v31, 0
 s_branch cst_2173
cfs_2175:
 s_mov_b32 s100, 0
fo_2183:
 buffer_load_dword v14, v13, s[4:7], 0 offen sc1
 s_add_u32 s100, s100, 1
 s_cmp_gt_u32 s100, 200000
 s_cbranch_scc1 main_fail
 s_waitcnt vmcnt(0)
 v_cmp_ge_u32 vcc, s29, v14
 s_cbranch_vccnz fo_2183
 s_branch cfb_2176
prt_2178:
pea_2180:
ppl_2184:
 buffer_load_dwordx4 v[96:99], v7, s[4:7], s36 offen sc1
 s_waitcnt vmcnt(4)
 buffer_load_dwordx4 v[100:103], v6, s[4:7], s36 offen offset:0 sc1
 s_waitcnt vmcnt(4)
 buffer_load_dwordx4 v[104:107], v6, s[4:7], s36 offen offset:1280 sc1
 s_waitcnt vmcnt(4)
 buffer_load_dwordx4 v[108:111], v6, s[4:7], s36 offen offset:2560 sc1
 s_waitcnt vmcnt(4)
 buffer_load_dwordx4 v[112:115], v6, s[4:7], s36 offen offset:3840 sc1
 s_add_u32 s99, s99, 1
 s_cmp_gt_u32 s99, 200000
 s_cbranch_scc1 main_fail
 s_waitcnt vmcnt(4)
 v_max3_u32 v121, v96, v97, v98
 v_max_u32 v121, v121, v99
 v_cmp_eq_u32 vcc, -1, v121
 s_cbranch_vccnz ppl_2184
 s_branch pco_2181
cexit_2131:
 s_mul_hi_u32 s25, s20, 0x1999999a
 s_mul_i32 s26, s25, 6
 s_add_u32 s25, s26, s20
 s_lshl_b32 s95, s25, 2
 s_add_u32 s95, s95, s3
 s_add_u32 s95, s95, 16896
 v_mov_b32 v2, 0x80000000
 v_mov_b32 v120, s95
 v_cmp_eq_u32 vcc, 0, v0
 s_nop 1
 v_cndmask_b32 v2, v2, v120, vcc
 v_mov_b32 v3, 1
 s_waitcnt vmcnt(0) lgkmcnt(0)
 s_barrier
 buffer_store_dword v3, v2, s[4:7], 0 offen sc1
 s_branch g2_task
first_s:
 s_load_dwordx2 s[8:9], s[0:1], 16
 s_mov_b32 s10, 7864320
 s_mov_b32 s11, 0x20000
 s_load_dwordx2 s[12:13], s[0:1], 24
 s_mov_b32 s14, 7864320
 s_mov_b32 s15, 0x20000
 s_mov_b32 s20, s17
 s_waitcnt lgkmcnt(0)
 v_and_b32 v254, 63, v0
 v_add_u32 v254, 0, v254
 v_mul_u32_u24 v253, 2731, v254
 v_lshrrev_b32 v253, 16, v253
 v_mul_u32_u24 v252, 24, v253
 v_sub_u32 v254, v254, v252
 v_mul_u32_u24 v253, 12288, v253
 v_lshl_add_u32 v2, v254, 4, v253
 v_and_b32 v254, 63, v0
 v_add_u32 v254, 64, v254
 v_mul_u32_u24 v253, 2731, v254
 v_lshrrev_b32 v253, 16, v253
 v_mul_u32_u24 v252, 24, v253
 v_sub_u32 v254, v254, v252
 v_mul_u32_u24 v253, 12288, v253
 v_lshl_add_u32 v3, v254, 4, v253
 v_and_b32 v254, 63, v0
 v_add_u32 v254, 128, v254
 v_mul_u32_u24 v253, 2731, v254
 v_lshrrev_b32 v253, 16, v253
 v_mul_u32_u24 v252, 24, v253
 v_sub_u32 v254, v254, v252
 v_mul_u32_u24 v253, 12288, v253
 v_lshl_add_u32 v4, v254, 4, v253
 s_mul_i32 s88, s21, 6144
 s_mul_i32 s87, s20, 384
 s_mul_i32 s86, s21, 196608
 s_add_u32 s87, s87, s86
 s_mul_i32 s86, s21, 96
 v_mov_b32 v5, s86
 v_bfe_u32 v255, v0, 5, 1
 s_mov_b32 s101, 6144
 v_mad_u32_u24 v5, v255, s101, v5
 v_bfe_u32 v255, v0, 4, 1
 s_mov_b32 s101, 1536
 v_mad_u32_u24 v5, v255, s101, v5
 v_bfe_u32 v255, v0, 2, 1
 s_mov_b32 s101, 384
 v_mad_u32_u24 v5, v255, s101, v5
 v_bfe_u32 v255, v0, 3, 1
 s_mov_b32 s101, 3072
 v_mad_u32_u24 v5, v255, s101, v5
 v_bfe_u32 v255, v0, 0, 2
 v_lshl_add_u32 v5, v255, 3, v5
 s_mul_i32 s86, s21, 20480
 s_add_u32 s86, s86, 81920
 v_mov_b32 v6, s86
 v_bfe_u32 v255, v0, 0, 6
 v_lshl_add_u32 v6, v255, 4, v6
 s_cmp_eq_u32 s21, 0
 s_cbranch_scc1 sw_2185
 s_cmp_eq_u32 s21, 1
 s_cbranch_scc1 sw_2186
 s_cmp_eq_u32 s21, 2
 s_cbranch_scc1 sw_2187
 s_branch sw_2188
sw_2185:
 s_add_u32 s89, s87, 0
 s_add_u32 m0, s88, 0
 s_nop 0
 buffer_load_dwordx4 v2, s[8:11], s89 offen lds
 s_add_u32 m0, s88, 1024
 s_nop 0
 buffer_load_dwordx4 v3, s[8:11], s89 offen lds
 s_add_u32 m0, s88, 2048
 s_nop 0
 buffer_load_dwordx4 v4, s[8:11], s89 offen lds
 s_add_u32 s89, s87, 98304
 s_add_u32 m0, s88, 3072
 s_nop 0
 buffer_load_dwordx4 v2, s[8:11], s89 offen lds
 s_add_u32 m0, s88, 4096
 s_nop 0
 buffer_load_dwordx4 v3, s[8:11], s89 offen lds
 s_add_u32 m0, s88, 5120
 s_nop 0
 buffer_load_dwordx4 v4, s[8:11], s89 offen lds
 s_add_u32 s89, s87, 786432
 s_add_u32 m0, s88, 24576
 s_nop 0
 buffer_load_dwordx4 v2, s[8:11], s89 offen lds
 s_add_u32 m0, s88, 25600
 s_nop 0
 buffer_load_dwordx4 v3, s[8:11], s89 offen lds
 s_add_u32 m0, s88, 26624
 s_nop 0
 buffer_load_dwordx4 v4, s[8:11], s89 offen lds
 s_add_u32 s89, s87, 884736
 s_add_u32 m0, s88, 27648
 s_nop 0
 buffer_load_dwordx4 v2, s[8:11], s89 offen lds
 s_add_u32 m0, s88, 28672
 s_nop 0
 buffer_load_dwordx4 v3, s[8:11], s89 offen lds
 s_add_u32 m0, s88, 29696
 s_nop 0
 buffer_load_dwordx4 v4, s[8:11], s89 offen lds
 s_add_u32 s89, s87, 1572864
 s_add_u32 m0, s88, 49152
 s_nop 0
 buffer_load_dwordx4 v2, s[8:11], s89 offen lds
 s_add_u32 m0, s88, 50176
 s_nop 0
 buffer_load_dwordx4 v3, s[8:11], s89 offen lds
 s_add_u32 m0, s88, 51200
 s_nop 0
 buffer_load_dwordx4 v4, s[8:11], s89 offen lds
 s_add_u32 s89, s87, 1671168
 s_add_u32 m0, s88, 52224
 s_nop 0
 buffer_load_dwordx4 v2, s[8:11], s89 offen lds
 s_add_u32 m0, s88, 53248
 s_nop 0
 buffer_load_dwordx4 v3, s[8:11], s89 offen lds
 s_add_u32 m0, s88, 54272
 s_nop 0
 buffer_load_dwordx4 v4, s[8:11], s89 offen lds
 s_add_u32 s89, s87, 2359296
 s_add_u32 m0, s88, 73728
 s_nop 0
 buffer_load_dwordx4 v2, s[8:11], s89 offen lds
 s_add_u32 m0, s88, 74752
 s_nop 0
 buffer_load_dwordx4 v3, s[8:11], s89 offen lds
 s_add_u32 m0, s88, 75776
 s_nop 0
 buffer_load_dwordx4 v4, s[8:11], s89 offen lds
 s_add_u32 s89, s87, 2457600
 s_add_u32 m0, s88, 76800
 s_nop 0
 buffer_load_dwordx4 v2, s[8:11], s89 offen lds
 s_add_u32 m0, s88, 77824
 s_nop 0
 buffer_load_dwordx4 v3, s[8:11], s89 offen lds
 s_add_u32 m0, s88, 78848
 s_nop 0
 buffer_load_dwordx4 v4, s[8:11], s89 offen lds
 s_add_u32 s89, s87, 3145728
 s_add_u32 m0, s88, 98304
 s_nop 0
 buffer_load_dwordx4 v2, s[8:11], s89 offen lds
 s_add_u32 m0, s88, 99328
 s_nop 0
 buffer_load_dwordx4 v3, s[8:11], s89 offen lds
 s_add_u32 m0, s88, 100352
 s_nop 0
 buffer_load_dwordx4 v4, s[8:11], s89 offen lds
 s_add_u32 s89, s87, 3244032
 s_add_u32 m0, s88, 101376
 s_nop 0
 buffer_load_dwordx4 v2, s[8:11], s89 offen lds
 s_add_u32 m0, s88, 102400
 s_nop 0
 buffer_load_dwordx4 v3, s[8:11], s89 offen lds
 s_add_u32 m0, s88, 103424
 s_nop 0
 buffer_load_dwordx4 v4, s[8:11], s89 offen lds
 s_waitcnt vmcnt(24)
 s_barrier
 s_add_u32 s89, s87, 3932160
 s_add_u32 m0, s88, 122880
 s_nop 0
 buffer_load_dwordx4 v2, s[8:11], s89 offen lds
 s_add_u32 m0, s88, 123904
 s_nop 0
 buffer_load_dwordx4 v3, s[8:11], s89 offen lds
 s_add_u32 m0, s88, 124928
 s_nop 0
 buffer_load_dwordx4 v4, s[8:11], s89 offen lds
 s_add_u32 s89, s87, 4030464
 s_add_u32 m0, s88, 125952
 s_nop 0
 buffer_load_dwordx4 v2, s[8:11], s89 offen lds
 s_add_u32 m0, s88, 126976
 s_nop 0
 buffer_load_dwordx4 v3, s[8:11], s89 offen lds
 s_add_u32 m0, s88, 128000
 s_nop 0
 buffer_load_dwordx4 v4, s[8:11], s89 offen lds
 v_add_u32 v7, 0, v5
 ds_read_b64_tr_b16 v[112:113], v7 offset:0
 ds_read_b64_tr_b16 v[114:115], v7 offset:768
 ds_read_b64_tr_b16 v[116:117], v7 offset:12288
 ds_read_b64_tr_b16 v[118:119], v7 offset:13056
 ds_read_b64_tr_b16 v[184:185], v7 offset:32
 ds_read_b64_tr_b16 v[186:187], v7 offset:800
 ds_read_b64_tr_b16 v[188:189], v7 offset:12320
 ds_read_b64_tr_b16 v[190:191], v7 offset:13088
 ds_read_b64_tr_b16 a[8:9], v7 offset:64
 ds_read_b64_tr_b16 a[10:11], v7 offset:832
 ds_read_b64_tr_b16 a[12:13], v7 offset:12352
 ds_read_b64_tr_b16 a[14:15], v7 offset:13120
 s_waitcnt lgkmcnt(0)
 s_waitcnt vmcnt(24)
 s_barrier
 s_add_u32 s89, s87, 4718592
 s_add_u32 m0, s88, 0
 s_nop 0
 buffer_load_dwordx4 v2, s[8:11], s89 offen lds
 s_add_u32 m0, s88, 1024
 s_nop 0
 buffer_load_dwordx4 v3, s[8:11], s89 offen lds
 s_add_u32 m0, s88, 2048
 s_nop 0
 buffer_load_dwordx4 v4, s[8:11], s89 offen lds
 s_add_u32 s89, s87, 4816896
 s_add_u32 m0, s88, 3072
 s_nop 0
 buffer_load_dwordx4 v2, s[8:11], s89 offen lds
 s_add_u32 m0, s88, 4096
 s_nop 0
 buffer_load_dwordx4 v3, s[8:11], s89 offen lds
 s_add_u32 m0, s88, 5120
 s_nop 0
 buffer_load_dwordx4 v4, s[8:11], s89 offen lds
 v_add_u32 v7, 24576, v5
 ds_read_b64_tr_b16 v[128:129], v7 offset:0
 ds_read_b64_tr_b16 v[130:131], v7 offset:768
 ds_read_b64_tr_b16 v[132:133], v7 offset:12288
 ds_read_b64_tr_b16 v[134:135], v7 offset:13056
 ds_read_b64_tr_b16 v[208:209], v7 offset:32
 ds_read_b64_tr_b16 v[210:211], v7 offset:800
 ds_read_b64_tr_b16 v[212:213], v7 offset:12320
 ds_read_b64_tr_b16 v[214:215], v7 offset:13088
 ds_read_b64_tr_b16 a[32:33], v7 offset:64
 ds_read_b64_tr_b16 a[34:35], v7 offset:832
 ds_read_b64_tr_b16 a[36:37], v7 offset:12352
 ds_read_b64_tr_b16 a[38:39], v7 offset:13120
 s_waitcnt lgkmcnt(0)
 s_waitcnt vmcnt(24)
 s_barrier
 s_add_u32 s89, s87, 5505024
 s_add_u32 m0, s88, 24576
 s_nop 0
 buffer_load_dwordx4 v2, s[8:11], s89 offen lds
 s_add_u32 m0, s88, 25600
 s_nop 0
 buffer_load_dwordx4 v3, s[8:11], s89 offen lds
 s_add_u32 m0, s88, 26624
 s_nop 0
 buffer_load_dwordx4 v4, s[8:11], s89 offen lds
 s_add_u32 s89, s87, 5603328
 s_add_u32 m0, s88, 27648
 s_nop 0
 buffer_load_dwordx4 v2, s[8:11], s89 offen lds
 s_add_u32 m0, s88, 28672
 s_nop 0
 buffer_load_dwordx4 v3, s[8:11], s89 offen lds
 s_add_u32 m0, s88, 29696
 s_nop 0
 buffer_load_dwordx4 v4, s[8:11], s89 offen lds
 v_add_u32 v7, 49152, v5
 ds_read_b64_tr_b16 v[136:137], v7 offset:0
 ds_read_b64_tr_b16 v[138:139], v7 offset:768
 ds_read_b64_tr_b16 v[140:141], v7 offset:12288
 ds_read_b64_tr_b16 v[142:143], v7 offset:13056
 ds_read_b64_tr_b16 v[216:217], v7 offset:32
 ds_read_b64_tr_b16 v[218:219], v7 offset:800
 ds_read_b64_tr_b16 v[220:221], v7 offset:12320
 ds_read_b64_tr_b16 v[222:223], v7 offset:13088
 ds_read_b64_tr_b16 a[40:41], v7 offset:64
 ds_read_b64_tr_b16 a[42:43], v7 offset:832
 ds_read_b64_tr_b16 a[44:45], v7 offset:12352
 ds_read_b64_tr_b16 a[46:47], v7 offset:13120
 s_waitcnt lgkmcnt(0)
 s_waitcnt vmcnt(24)
 s_barrier
 s_add_u32 s89, s87, 6291456
 s_add_u32 m0, s88, 49152
 s_nop 0
 buffer_load_dwordx4 v2, s[8:11], s89 offen lds
 s_add_u32 m0, s88, 50176
 s_nop 0
 buffer_load_dwordx4 v3, s[8:11], s89 offen lds
 s_add_u32 m0, s88, 51200
 s_nop 0
 buffer_load_dwordx4 v4, s[8:11], s89 offen lds
 s_add_u32 s89, s87, 6389760
 s_add_u32 m0, s88, 52224
 s_nop 0
 buffer_load_dwordx4 v2, s[8:11], s89 offen lds
 s_add_u32 m0, s88, 53248
 s_nop 0
 buffer_load_dwordx4 v3, s[8:11], s89 offen lds
 s_add_u32 m0, s88, 54272
 s_nop 0
 buffer_load_dwordx4 v4, s[8:11], s89 offen lds
 v_add_u32 v7, 73728, v5
 ds_read_b64_tr_b16 v[144:145], v7 offset:0
 ds_read_b64_tr_b16 v[146:147], v7 offset:768
 ds_read_b64_tr_b16 v[148:149], v7 offset:12288
 ds_read_b64_tr_b16 v[150:151], v7 offset:13056
 ds_read_b64_tr_b16 v[224:225], v7 offset:32
 ds_read_b64_tr_b16 v[226:227], v7 offset:800
 ds_read_b64_tr_b16 v[228:229], v7 offset:12320
 ds_read_b64_tr_b16 v[230:231], v7 offset:13088
 ds_read_b64_tr_b16 v[56:57], v7 offset:64
 ds_read_b64_tr_b16 v[58:59], v7 offset:832
 ds_read_b64_tr_b16 v[60:61], v7 offset:12352
 ds_read_b64_tr_b16 v[62:63], v7 offset:13120
 s_waitcnt lgkmcnt(0)
 s_waitcnt vmcnt(24)
 s_barrier
 s_add_u32 s89, s87, 7077888
 s_add_u32 m0, s88, 73728
 s_nop 0
 buffer_load_dwordx4 v2, s[8:11], s89 offen lds
 s_add_u32 m0, s88, 74752
 s_nop 0
 buffer_load_dwordx4 v3, s[8:11], s89 offen lds
 s_add_u32 m0, s88, 75776
 s_nop 0
 buffer_load_dwordx4 v4, s[8:11], s89 offen lds
 s_add_u32 s89, s87, 7176192
 s_add_u32 m0, s88, 76800
 s_nop 0
 buffer_load_dwordx4 v2, s[8:11], s89 offen lds
 s_add_u32 m0, s88, 77824
 s_nop 0
 buffer_load_dwordx4 v3, s[8:11], s89 offen lds
 s_add_u32 m0, s88, 78848
 s_nop 0
 buffer_load_dwordx4 v4, s[8:11], s89 offen lds
 v_add_u32 v7, 98304, v5
 ds_read_b64_tr_b16 v[120:121], v7 offset:0
 ds_read_b64_tr_b16 v[122:123], v7 offset:768
 ds_read_b64_tr_b16 v[124:125], v7 offset:12288
 ds_read_b64_tr_b16 v[126:127], v7 offset:13056
 ds_read_b64_tr_b16 v[192:193], v7 offset:32
 ds_read_b64_tr_b16 v[194:195], v7 offset:800
 ds_read_b64_tr_b16 v[196:197], v7 offset:12320
 ds_read_b64_tr_b16 v[198:199], v7 offset:13088
 ds_read_b64_tr_b16 a[16:17], v7 offset:64
 ds_read_b64_tr_b16 a[18:19], v7 offset:832
 ds_read_b64_tr_b16 a[20:21], v7 offset:12352
 ds_read_b64_tr_b16 a[22:23], v7 offset:13120
 s_waitcnt lgkmcnt(0)
 s_waitcnt vmcnt(24)
 s_barrier
 s_add_u32 s89, s87, 0
 s_add_u32 m0, s88, 98304
 s_nop 0
 buffer_load_dwordx4 v2, s[12:15], s89 offen lds
 s_add_u32 m0, s88, 99328
 s_nop 0
 buffer_load_dwordx4 v3, s[12:15], s89 offen lds
 s_add_u32 m0, s88, 100352
 s_nop 0
 buffer_load_dwordx4 v4, s[12:15], s89 offen lds
 s_add_u32 s89, s87, 98304
 s_add_u32 m0, s88, 101376
 s_nop 0
 buffer_load_dwordx4 v2, s[12:15], s89 offen lds
 s_add_u32 m0, s88, 102400
 s_nop 0
 buffer_load_dwordx4 v3, s[12:15], s89 offen lds
 s_add_u32 m0, s88, 103424
 s_nop 0
 buffer_load_dwordx4 v4, s[12:15], s89 offen lds
 v_add_u32 v7, 122880, v5
 ds_read_b64_tr_b16 v[152:153], v7 offset:0
 ds_read_b64_tr_b16 v[154:155], v7 offset:768
 ds_read_b64_tr_b16 v[156:157], v7 offset:12288
 ds_read_b64_tr_b16 v[158:159], v7 offset:13056
 ds_read_b64_tr_b16 v[232:233], v7 offset:32
 ds_read_b64_tr_b16 v[234:235], v7 offset:800
 ds_read_b64_tr_b16 v[236:237], v7 offset:12320
 ds_read_b64_tr_b16 v[238:239], v7 offset:13088
 ds_read_b64_tr_b16 v[64:65], v7 offset:64
 ds_read_b64_tr_b16 v[66:67], v7 offset:832
 ds_read_b64_tr_b16 v[68:69], v7 offset:12352
 ds_read_b64_tr_b16 v[70:71], v7 offset:13120
 s_waitcnt lgkmcnt(0)
 s_waitcnt vmcnt(24)
 s_barrier
 s_add_u32 s89, s87, 786432
 s_add_u32 m0, s88, 122880
 s_nop 0
 buffer_load_dwordx4 v2, s[12:15], s89 offen lds
 s_add_u32 m0, s88, 123904
 s_nop 0
 buffer_load_dwordx4 v3, s[12:15], s89 offen lds
 s_add_u32 m0, s88, 124928
 s_nop 0
 buffer_load_dwordx4 v4, s[12:15], s89 offen lds
 s_add_u32 s89, s87, 884736
 s_add_u32 m0, s88, 125952
 s_nop 0
 buffer_load_dwordx4 v2, s[12:15], s89 offen lds
 s_add_u32 m0, s88, 126976
 s_nop 0
 buffer_load_dwordx4 v3, s[12:15], s89 offen lds
 s_add_u32 m0, s88, 128000
 s_nop 0
 buffer_load_dwordx4 v4, s[12:15], s89 offen lds
 v_add_u32 v7, 0, v5
 ds_read_b64_tr_b16 v[160:161], v7 offset:0
 ds_read_b64_tr_b16 v[162:163], v7 offset:768
 ds_read_b64_tr_b16 v[164:165], v7 offset:12288
 ds_read_b64_tr_b16 v[166:167], v7 offset:13056
 ds_read_b64_tr_b16 v[240:241], v7 offset:32
 ds_read_b64_tr_b16 v[242:243], v7 offset:800
 ds_read_b64_tr_b16 v[244:245], v7 offset:12320
 ds_read_b64_tr_b16 v[246:247], v7 offset:13088
 ds_read_b64_tr_b16 v[72:73], v7 offset:64
 ds_read_b64_tr_b16 v[74:75], v7 offset:832
 ds_read_b64_tr_b16 v[76:77], v7 offset:12352
 ds_read_b64_tr_b16 v[78:79], v7 offset:13120
 s_waitcnt lgkmcnt(0)
 s_waitcnt vmcnt(24)
 s_barrier
 s_add_u32 s89, s87, 1572864
 s_add_u32 m0, s88, 0
 s_nop 0
 buffer_load_dwordx4 v2, s[12:15], s89 offen lds
 s_add_u32 m0, s88, 1024
 s_nop 0
 buffer_load_dwordx4 v3, s[12:15], s89 offen lds
 s_add_u32 m0, s88, 2048
 s_nop 0
 buffer_load_dwordx4 v4, s[12:15], s89 offen lds
 s_add_u32 s89, s87, 1671168
 s_add_u32 m0, s88, 3072
 s_nop 0
 buffer_load_dwordx4 v2, s[12:15], s89 offen lds
 s_add_u32 m0, s88, 4096
 s_nop 0
 buffer_load_dwordx4 v3, s[12:15], s89 offen lds
 s_add_u32 m0, s88, 5120
 s_nop 0
 buffer_load_dwordx4 v4, s[12:15], s89 offen lds
 v_add_u32 v7, 24576, v5
 ds_read_b64_tr_b16 v[168:169], v7 offset:0
 ds_read_b64_tr_b16 v[170:171], v7 offset:768
 ds_read_b64_tr_b16 v[172:173], v7 offset:12288
 ds_read_b64_tr_b16 v[174:175], v7 offset:13056
 ds_read_b64_tr_b16 v[248:249], v7 offset:32
 ds_read_b64_tr_b16 v[250:251], v7 offset:800
 ds_read_b64_tr_b16 v[252:253], v7 offset:12320
 ds_read_b64_tr_b16 v[254:255], v7 offset:13088
 ds_read_b64_tr_b16 v[80:81], v7 offset:64
 ds_read_b64_tr_b16 v[82:83], v7 offset:832
 ds_read_b64_tr_b16 v[84:85], v7 offset:12352
 ds_read_b64_tr_b16 v[86:87], v7 offset:13120
 s_waitcnt lgkmcnt(0)
 s_waitcnt vmcnt(24)
 s_barrier
 s_add_u32 s89, s87, 2359296
 s_add_u32 m0, s88, 24576
 s_nop 0
 buffer_load_dwordx4 v2, s[12:15], s89 offen lds
 s_add_u32 m0, s88, 25600
 s_nop 0
 buffer_load_dwordx4 v3, s[12:15], s89 offen lds
 s_add_u32 m0, s88, 26624
 s_nop 0
 buffer_load_dwordx4 v4, s[12:15], s89 offen lds
 s_add_u32 s89, s87, 2457600
 s_add_u32 m0, s88, 27648
 s_nop 0
 buffer_load_dwordx4 v2, s[12:15], s89 offen lds
 s_add_u32 m0, s88, 28672
 s_nop 0
 buffer_load_dwordx4 v3, s[12:15], s89 offen lds
 s_add_u32 m0, s88, 29696
 s_nop 0
 buffer_load_dwordx4 v4, s[12:15], s89 offen lds
 v_add_u32 v7, 49152, v5
 ds_read_b64_tr_b16 v[48:49], v7 offset:0
 ds_read_b64_tr_b16 v[50:51], v7 offset:768
 ds_read_b64_tr_b16 v[52:53], v7 offset:12288
 ds_read_b64_tr_b16 v[54:55], v7 offset:13056
 ds_read_b64_tr_b16 v[200:201], v7 offset:32
 ds_read_b64_tr_b16 v[202:203], v7 offset:800
 ds_read_b64_tr_b16 v[204:205], v7 offset:12320
 ds_read_b64_tr_b16 v[206:207], v7 offset:13088
 ds_read_b64_tr_b16 a[24:25], v7 offset:64
 ds_read_b64_tr_b16 a[26:27], v7 offset:832
 ds_read_b64_tr_b16 a[28:29], v7 offset:12352
 ds_read_b64_tr_b16 a[30:31], v7 offset:13120
 s_waitcnt lgkmcnt(0)
 s_waitcnt vmcnt(24)
 s_barrier
 s_add_u32 s89, s87, 3145728
 s_add_u32 m0, s88, 49152
 s_nop 0
 buffer_load_dwordx4 v2, s[12:15], s89 offen lds
 s_add_u32 m0, s88, 50176
 s_nop 0
 buffer_load_dwordx4 v3, s[12:15], s89 offen lds
 s_add_u32 m0, s88, 51200
 s_nop 0
 buffer_load_dwordx4 v4, s[12:15], s89 offen lds
 s_add_u32 s89, s87, 3244032
 s_add_u32 m0, s88, 52224
 s_nop 0
 buffer_load_dwordx4 v2, s[12:15], s89 offen lds
 s_add_u32 m0, s88, 53248
 s_nop 0
 buffer_load_dwordx4 v3, s[12:15], s89 offen lds
 s_add_u32 m0, s88, 54272
 s_nop 0
 buffer_load_dwordx4 v4, s[12:15], s89 offen lds
 v_add_u32 v7, 73728, v5
 ds_read_b64_tr_b16 v[176:177], v7 offset:0
 ds_read_b64_tr_b16 v[178:179], v7 offset:768
 ds_read_b64_tr_b16 v[180:181], v7 offset:12288
 ds_read_b64_tr_b16 v[182:183], v7 offset:13056
 ds_read_b64_tr_b16 a[0:1], v7 offset:32
 ds_read_b64_tr_b16 a[2:3], v7 offset:800
 ds_read_b64_tr_b16 a[4:5], v7 offset:12320
 ds_read_b64_tr_b16 a[6:7], v7 offset:13088
 ds_read_b64_tr_b16 v[88:89], v7 offset:64
 ds_read_b64_tr_b16 v[90:91], v7 offset:832
 ds_read_b64_tr_b16 v[92:93], v7 offset:12352
 ds_read_b64_tr_b16 v[94:95], v7 offset:13120
 s_waitcnt lgkmcnt(0)
 s_waitcnt vmcnt(24)
 s_barrier
 s_add_u32 s89, s87, 3932160
 s_add_u32 m0, s88, 73728
 s_nop 0
 buffer_load_dwordx4 v2, s[12:15], s89 offen lds
 s_add_u32 m0, s88, 74752
 s_nop 0
 buffer_load_dwordx4 v3, s[12:15], s89 offen lds
 s_add_u32 m0, s88, 75776
 s_nop 0
 buffer_load_dwordx4 v4, s[12:15], s89 offen lds
 s_add_u32 s89, s87, 4030464
 s_add_u32 m0, s88, 76800
 s_nop 0
 buffer_load_dwordx4 v2, s[12:15], s89 offen lds
 s_add_u32 m0, s88, 77824
 s_nop 0
 buffer_load_dwordx4 v3, s[12:15], s89 offen lds
 s_add_u32 m0, s88, 78848
 s_nop 0
 buffer_load_dwordx4 v4, s[12:15], s89 offen lds
 v_add_u32 v7, 98304, v5
 ds_read_b64_tr_b16 a[48:49], v7 offset:0
 ds_read_b64_tr_b16 a[50:51], v7 offset:768
 ds_read_b64_tr_b16 a[52:53], v7 offset:12288
 ds_read_b64_tr_b16 a[54:55], v7 offset:13056
 ds_read_b64_tr_b16 v[16:17], v7 offset:32
 ds_read_b64_tr_b16 v[18:19], v7 offset:800
 ds_read_b64_tr_b16 v[20:21], v7 offset:12320
 ds_read_b64_tr_b16 v[22:23], v7 offset:13088
 ds_read_b64_tr_b16 v[24:25], v7 offset:64
 ds_read_b64_tr_b16 v[26:27], v7 offset:832
 ds_read_b64_tr_b16 v[28:29], v7 offset:12352
 ds_read_b64_tr_b16 v[30:31], v7 offset:13120
 s_waitcnt lgkmcnt(0)
 s_waitcnt vmcnt(24)
 s_barrier
 s_add_u32 s89, s87, 4718592
 s_add_u32 m0, s88, 98304
 s_nop 0
 buffer_load_dwordx4 v2, s[12:15], s89 offen lds
 s_add_u32 m0, s88, 99328
 s_nop 0
 buffer_load_dwordx4 v3, s[12:15], s89 offen lds
 s_add_u32 m0, s88, 100352
 s_nop 0
 buffer_load_dwordx4 v4, s[12:15], s89 offen lds
 s_add_u32 s89, s87, 4816896
 s_add_u32 m0, s88, 101376
 s_nop 0
 buffer_load_dwordx4 v2, s[12:15], s89 offen lds
 s_add_u32 m0, s88, 102400
 s_nop 0
 buffer_load_dwordx4 v3, s[12:15], s89 offen lds
 s_add_u32 m0, s88, 103424
 s_nop 0
 buffer_load_dwordx4 v4, s[12:15], s89 offen lds
 v_add_u32 v7, 122880, v5
 ds_read_b64_tr_b16 a[72:73], v7 offset:0
 ds_read_b64_tr_b16 a[74:75], v7 offset:768
 ds_read_b64_tr_b16 a[76:77], v7 offset:12288
 ds_read_b64_tr_b16 a[78:79], v7 offset:13056
 ds_read_b64_tr_b16 a[136:137], v7 offset:32
 ds_read_b64_tr_b16 a[138:139], v7 offset:800
 ds_read_b64_tr_b16 a[140:141], v7 offset:12320
 ds_read_b64_tr_b16 a[142:143], v7 offset:13088
 ds_read_b64_tr_b16 a[200:201], v7 offset:64
 ds_read_b64_tr_b16 a[202:203], v7 offset:832
 ds_read_b64_tr_b16 a[204:205], v7 offset:12352
 ds_read_b64_tr_b16 a[206:207], v7 offset:13120
 s_waitcnt lgkmcnt(0)
 s_waitcnt vmcnt(24)
 s_barrier
 s_add_u32 s89, s87, 5505024
 s_add_u32 m0, s88, 122880
 s_nop 0
 buffer_load_dwordx4 v2, s[12:15], s89 offen lds
 s_add_u32 m0, s88, 123904
 s_nop 0
 buffer_load_dwordx4 v3, s[12:15], s89 offen lds
 s_add_u32 m0, s88, 124928
 s_nop 0
 buffer_load_dwordx4 v4, s[12:15], s89 offen lds
 s_add_u32 s89, s87, 5603328
 s_add_u32 m0, s88, 125952
 s_nop 0
 buffer_load_dwordx4 v2, s[12:15], s89 offen lds
 s_add_u32 m0, s88, 126976
 s_nop 0
 buffer_load_dwordx4 v3, s[12:15], s89 offen lds
 s_add_u32 m0, s88, 128000
 s_nop 0
 buffer_load_dwordx4 v4, s[12:15], s89 offen lds
 v_add_u32 v7, 0, v5
 ds_read_b64_tr_b16 a[80:81], v7 offset:0
 ds_read_b64_tr_b16 a[82:83], v7 offset:768
 ds_read_b64_tr_b16 a[84:85], v7 offset:12288
 ds_read_b64_tr_b16 a[86:87], v7 offset:13056
 ds_read_b64_tr_b16 a[144:145], v7 offset:32
 ds_read_b64_tr_b16 a[146:147], v7 offset:800
 ds_read_b64_tr_b16 a[148:149], v7 offset:12320
 ds_read_b64_tr_b16 a[150:151], v7 offset:13088
 ds_read_b64_tr_b16 a[208:209], v7 offset:64
 ds_read_b64_tr_b16 a[210:211], v7 offset:832
 ds_read_b64_tr_b16 a[212:213], v7 offset:12352
 ds_read_b64_tr_b16 a[214:215], v7 offset:13120
 s_waitcnt lgkmcnt(0)
 s_waitcnt vmcnt(24)
 s_barrier
 s_add_u32 s89, s87, 6291456
 s_add_u32 m0, s88, 0
 s_nop 0
 buffer_load_dwordx4 v2, s[12:15], s89 offen lds
 s_add_u32 m0, s88, 1024
 s_nop 0
 buffer_load_dwordx4 v3, s[12:15], s89 offen lds
 s_add_u32 m0, s88, 2048
 s_nop 0
 buffer_load_dwordx4 v4, s[12:15], s89 offen lds
 s_add_u32 s89, s87, 6389760
 s_add_u32 m0, s88, 3072
 s_nop 0
 buffer_load_dwordx4 v2, s[12:15], s89 offen lds
 s_add_u32 m0, s88, 4096
 s_nop 0
 buffer_load_dwordx4 v3, s[12:15], s89 offen lds
 s_add_u32 m0, s88, 5120
 s_nop 0
 buffer_load_dwordx4 v4, s[12:15], s89 offen lds
 v_add_u32 v7, 24576, v5
 ds_read_b64_tr_b16 a[88:89], v7 offset:0
 ds_read_b64_tr_b16 a[90:91], v7 offset:768
 ds_read_b64_tr_b16 a[92:93], v7 offset:12288
 ds_read_b64_tr_b16 a[94:95], v7 offset:13056
 ds_read_b64_tr_b16 a[152:153], v7 offset:32
 ds_read_b64_tr_b16 a[154:155], v7 offset:800
 ds_read_b64_tr_b16 a[156:157], v7 offset:12320
 ds_read_b64_tr_b16 a[158:159], v7 offset:13088
 ds_read_b64_tr_b16 a[216:217], v7 offset:64
 ds_read_b64_tr_b16 a[218:219], v7 offset:832
 ds_read_b64_tr_b16 a[220:221], v7 offset:12352
 ds_read_b64_tr_b16 a[222:223], v7 offset:13120
 s_waitcnt lgkmcnt(0)
 s_waitcnt vmcnt(24)
 s_barrier
 s_add_u32 s89, s87, 7077888
 s_add_u32 m0, s88, 24576
 s_nop 0
 buffer_load_dwordx4 v2, s[12:15], s89 offen lds
 s_add_u32 m0, s88, 25600
 s_nop 0
 buffer_load_dwordx4 v3, s[12:15], s89 offen lds
 s_add_u32 m0, s88, 26624
 s_nop 0
 buffer_load_dwordx4 v4, s[12:15], s89 offen lds
 s_add_u32 s89, s87, 7176192
 s_add_u32 m0, s88, 27648
 s_nop 0
 buffer_load_dwordx4 v2, s[12:15], s89 offen lds
 s_add_u32 m0, s88, 28672
 s_nop 0
 buffer_load_dwordx4 v3, s[12:15], s89 offen lds
 s_add_u32 m0, s88, 29696
 s_nop 0
 buffer_load_dwordx4 v4, s[12:15], s89 offen lds
 v_add_u32 v7, 49152, v5
 ds_read_b64_tr_b16 a[56:57], v7 offset:0
 ds_read_b64_tr_b16 a[58:59], v7 offset:768
 ds_read_b64_tr_b16 a[60:61], v7 offset:12288
 ds_read_b64_tr_b16 a[62:63], v7 offset:13056
 ds_read_b64_tr_b16 v[32:33], v7 offset:32
 ds_read_b64_tr_b16 v[34:35], v7 offset:800
 ds_read_b64_tr_b16 v[36:37], v7 offset:12320
 ds_read_b64_tr_b16 v[38:39], v7 offset:13088
 ds_read_b64_tr_b16 v[40:41], v7 offset:64
 ds_read_b64_tr_b16 v[42:43], v7 offset:832
 ds_read_b64_tr_b16 v[44:45], v7 offset:12352
 ds_read_b64_tr_b16 v[46:47], v7 offset:13120
 s_waitcnt lgkmcnt(0)
 s_waitcnt vmcnt(24)
 s_barrier
 v_add_u32 v7, 73728, v5
 ds_read_b64_tr_b16 a[96:97], v7 offset:0
 ds_read_b64_tr_b16 a[98:99], v7 offset:768
 ds_read_b64_tr_b16 a[100:101], v7 offset:12288
 ds_read_b64_tr_b16 a[102:103], v7 offset:13056
 ds_read_b64_tr_b16 a[160:161], v7 offset:32
 ds_read_b64_tr_b16 a[162:163], v7 offset:800
 ds_read_b64_tr_b16 a[164:165], v7 offset:12320
 ds_read_b64_tr_b16 a[166:167], v7 offset:13088
 ds_read_b64_tr_b16 a[224:225], v7 offset:64
 ds_read_b64_tr_b16 a[226:227], v7 offset:832
 ds_read_b64_tr_b16 a[228:229], v7 offset:12352
 ds_read_b64_tr_b16 a[230:231], v7 offset:13120
 s_waitcnt lgkmcnt(0)
 s_waitcnt vmcnt(18)
 s_barrier
 v_add_u32 v7, 98304, v5
 ds_read_b64_tr_b16 a[104:105], v7 offset:0
 ds_read_b64_tr_b16 a[106:107], v7 offset:768
 ds_read_b64_tr_b16 a[108:109], v7 offset:12288
 ds_read_b64_tr_b16 a[110:111], v7 offset:13056
 ds_read_b64_tr_b16 a[168:169], v7 offset:32
 ds_read_b64_tr_b16 a[170:171], v7 offset:800
 ds_read_b64_tr_b16 a[172:173], v7 offset:12320
 ds_read_b64_tr_b16 a[174:175], v7 offset:13088
 ds_read_b64_tr_b16 a[232:233], v7 offset:64
 ds_read_b64_tr_b16 a[234:235], v7 offset:832
 ds_read_b64_tr_b16 a[236:237], v7 offset:12352
 ds_read_b64_tr_b16 a[238:239], v7 offset:13120
 s_waitcnt lgkmcnt(0)
 s_waitcnt vmcnt(12)
 s_barrier
 v_add_u32 v7, 122880, v5
 ds_read_b64_tr_b16 a[112:113], v7 offset:0
 ds_read_b64_tr_b16 a[114:115], v7 offset:768
 ds_read_b64_tr_b16 a[116:117], v7 offset:12288
 ds_read_b64_tr_b16 a[118:119], v7 offset:13056
 ds_read_b64_tr_b16 a[176:177], v7 offset:32
 ds_read_b64_tr_b16 a[178:179], v7 offset:800
 ds_read_b64_tr_b16 a[180:181], v7 offset:12320
 ds_read_b64_tr_b16 a[182:183], v7 offset:13088
 ds_read_b64_tr_b16 a[240:241], v7 offset:64
 ds_read_b64_tr_b16 a[242:243], v7 offset:832
 ds_read_b64_tr_b16 a[244:245], v7 offset:12352
 ds_read_b64_tr_b16 a[246:247], v7 offset:13120
 s_waitcnt lgkmcnt(0)
 s_waitcnt vmcnt(6)
 s_barrier
 v_add_u32 v7, 0, v5
 ds_read_b64_tr_b16 a[64:65], v7 offset:0
 ds_read_b64_tr_b16 a[66:67], v7 offset:768
 ds_read_b64_tr_b16 a[68:69], v7 offset:12288
 ds_read_b64_tr_b16 a[70:71], v7 offset:13056
 ds_read_b64_tr_b16 a[128:129], v7 offset:32
 ds_read_b64_tr_b16 a[130:131], v7 offset:800
 ds_read_b64_tr_b16 a[132:133], v7 offset:12320
 ds_read_b64_tr_b16 a[134:135], v7 offset:13088
 ds_read_b64_tr_b16 a[192:193], v7 offset:64
 ds_read_b64_tr_b16 a[194:195], v7 offset:832
 ds_read_b64_tr_b16 a[196:197], v7 offset:12352
 ds_read_b64_tr_b16 a[198:199], v7 offset:13120
 s_waitcnt lgkmcnt(0)
 s_waitcnt vmcnt(0)
 s_barrier
 v_add_u32 v7, 24576, v5
 ds_read_b64_tr_b16 a[120:121], v7 offset:0
 ds_read_b64_tr_b16 a[122:123], v7 offset:768
 ds_read_b64_tr_b16 a[124:125], v7 offset:12288
 ds_read_b64_tr_b16 a[126:127], v7 offset:13056
 ds_read_b64_tr_b16 a[184:185], v7 offset:32
 ds_read_b64_tr_b16 a[186:187], v7 offset:800
 ds_read_b64_tr_b16 a[188:189], v7 offset:12320
 ds_read_b64_tr_b16 a[190:191], v7 offset:13088
 ds_read_b64_tr_b16 a[248:249], v7 offset:64
 ds_read_b64_tr_b16 a[250:251], v7 offset:832
 ds_read_b64_tr_b16 a[252:253], v7 offset:12352
 ds_read_b64_tr_b16 a[254:255], v7 offset:13120
 s_waitcnt lgkmcnt(0)
 s_barrier
 ds_write_b128 v6, v[16:19] offset:0
 ds_write_b128 v6, v[20:23] offset:1024
 ds_write_b128 v6, v[24:27] offset:2048
 ds_write_b128 v6, v[28:31] offset:3072
 ds_write_b128 v6, v[32:35] offset:4096
 ds_write_b128 v6, v[36:39] offset:5120
 ds_write_b128 v6, v[40:43] offset:6144
 ds_write_b128 v6, v[44:47] offset:7168
 s_waitcnt lgkmcnt(4)
 ds_write_b128 v6, v[48:51] offset:8192
 ds_write_b128 v6, v[52:55] offset:9216
 ds_write_b128 v6, v[56:59] offset:10240
 ds_write_b128 v6, v[60:63] offset:11264
 ds_write_b128 v6, v[64:67] offset:12288
 ds_write_b128 v6, v[68:71] offset:13312
 ds_write_b128 v6, v[72:75] offset:14336
 ds_write_b128 v6, v[76:79] offset:15360
 s_waitcnt lgkmcnt(4)
 ds_write_b128 v6, v[80:83] offset:16384
 ds_write_b128 v6, v[84:87] offset:17408
 ds_write_b128 v6, v[88:91] offset:18432
 ds_write_b128 v6, v[92:95] offset:19456
sagain_2189:
 v_mov_b32 v3, 1572864
 s_mov_b32 s100, 0
pw_2190:
 buffer_load_dword v4, v3, s[4:7], 0 offen sc1
 s_add_u32 s100, s100, 1
 s_cmp_gt_u32 s100, 200000
 s_cbranch_scc1 main_fail
 s_waitcnt vmcnt(0)
 v_cmp_eq_u32 vcc, -1, v4
 s_cbranch_vccnz pw_2190
 v_readfirstlane_b32 s19, v4
 s_nop 1
 s_and_b32 s19, s19, 0x2000
 s_add_u32 s19, s19, s18
 s_add_u32 s36, s19, 0
 s_add_u32 s37, s19, 131072
 s_add_u32 s38, s19, 262144
 s_add_u32 s39, s19, 393216
 s_mov_b32 s31, 0
 s_mul_i32 s25, s20, 12288
 s_add_u32 s25, s25, 53346304
 s_mul_i32 s26, s20, 6144
 s_add_u32 s26, s26, 208535552
 s_lshl_b32 s32, s20, 7
 s_add_u32 s33, s32, 0
 s_add_u32 s33, s33, s3
 s_add_u32 s32, s32, 12288
 s_add_u32 s32, s32, s3
 s_mov_b32 s34, 0
 s_mov_b32 s28, 24576
 v_bfe_u32 v111, v0, 0, 6
 v_lshlrev_b32 v5, 4, v111
 v_bfe_u32 v111, v0, 0, 4
 v_lshlrev_b32 v7, 3, v111
 v_bfe_u32 v111, v0, 4, 1
 s_mov_b32 s101, 1568
 v_mad_u32_u24 v7, v111, s101, v7
 v_bfe_u32 v111, v0, 5, 1
 s_mov_b32 s101, 3200
 v_mad_u32_u24 v7, v111, s101, v7
 v_bfe_u32 v111, v0, 4, 2
 v_lshlrev_b32 v8, 6, v111
 v_bfe_u32 v111, v0, 2, 2
 v_lshl_add_u32 v8, v111, 3, v8
 v_bfe_u32 v111, v0, 0, 1
 s_mov_b32 s101, 1568
 v_mad_u32_u24 v8, v111, s101, v8
 v_bfe_u32 v111, v0, 1, 1
 s_mov_b32 s101, 3200
 v_mad_u32_u24 v8, v111, s101, v8
 v_and_b32 v111, 8, v0
 v_cmp_eq_u32 vcc, 0, v111
 v_mov_b32 v111, 0xeeee
 v_mov_b32 v15, 0x4444
 v_cndmask_b32 v15, v111, v15, vcc
 v_bfe_u32 v111, v0, 4, 2
 v_lshlrev_b32 v9, 9, v111
 v_bfe_u32 v111, v0, 0, 4
 v_lshl_add_u32 v9, v111, 4, v9
 s_lshr_b32 s24, s20, 3
 s_lshl_b32 s24, s24, 14
 s_and_b32 s27, s20, 7
 s_mul_i32 s27, s27, 640
 s_add_u32 s24, s24, s27
 s_add_u32 s24, s24, 32768
 s_add_u32 s27, s24, 128
 v_and_b32 v14, 8, v0
 v_mov_b32 v10, s27
 v_bfe_u32 v111, v0, 3, 1
 v_lshl_add_u32 v10, v111, 8, v10
 v_bfe_u32 v111, v0, 5, 1
 v_lshl_add_u32 v10, v111, 7, v10
 v_bfe_u32 v111, v0, 4, 1
 v_lshl_add_u32 v10, v111, 3, v10
 v_bfe_u32 v111, v0, 0, 3
 v_lshl_add_u32 v10, v111, 4, v10
 v_mov_b32 v12, s24
 v_bfe_u32 v111, v0, 4, 1
 v_lshl_add_u32 v12, v111, 3, v12
 v_bfe_u32 v111, v0, 5, 1
 v_lshl_add_u32 v12, v111, 2, v12
 v_bfe_u32 v111, v0, 0, 3
 v_lshl_add_u32 v12, v111, 4, v12
 v_cmp_eq_u32 vcc, 0, v14
 v_mov_b32 v111, 0x80000000
 s_nop 0
 v_cndmask_b32 v12, v111, v12, vcc
 v_mov_b32 v13, s24
 v_bfe_u32 v111, v0, 0, 6
 v_lshl_add_u32 v13, v111, 4, v13
 v_cmp_gt_u32 vcc, 40, v0
 v_mov_b32 v111, 0x80000000
 s_nop 0
 v_cndmask_b32 v13, v111, v13, vcc
 s_mov_b32 s56, 0x3dd53b95
 s_add_u32 s27, s19, 524288
 s_cmp_eq_u32 s20, 16
 s_cselect_b32 s27, s27, 0x80000000
 v_mov_b32 v3, s27
 v_bfe_u32 v111, v0, 0, 6
 v_lshl_add_u32 v3, v111, 7, v3
 v_add_u32 v4, 16384, v3
 v_and_b32 v14, 63, v0
 v_cmp_gt_u32 vcc, 16, v14
 v_mov_b32 v111, 0x80000000
 s_nop 0
 v_cndmask_b32 v4, v111, v4, vcc
s_2191:
 ds_read_b128 v[40:43], v6 offset:0
 ds_read_b128 v[44:47], v6 offset:1024
 ds_read_b128 v[48:51], v6 offset:2048
 ds_read_b128 v[52:55], v6 offset:3072
 ds_read_b128 v[56:59], v6 offset:4096
 ds_read_b128 v[60:63], v6 offset:5120
 ds_read_b128 v[64:67], v6 offset:6144
 ds_read_b128 v[68:71], v6 offset:7168
 ds_read_b128 v[72:75], v6 offset:8192
 ds_read_b128 v[76:79], v6 offset:9216
 s_add_u32 s51, s36, 0
 s_add_u32 s57, s36, 4096
 s_add_u32 s58, s36, 16384
 v_add_u32 v11, s28, v9
 s_cmp_eq_u32 s31, 63
 s_cselect_b32 s55, 0x20000000, s36
 s_mov_b32 s99, 0
 s_waitcnt lgkmcnt(0)
 s_add_u32 s25, s25, 393216
 s_cmp_ge_u32 s31, 62
 s_cselect_b32 s25, 0x20000000, s25
 s_xor_b32 s35, s28, 61440
 s_add_u32 m0, s35, 0
 s_add_u32 s89, s25, 0
 s_add_u32 s29, s31, 1
 v_mov_b32 v14, s29
 s_mov_b32 s97, 0
 s_barrier
 buffer_load_dwordx4 v[80:83], v5, s[4:7], s51 offen offset:0 sc1
 v_mov_b32 v16, 0
 v_mov_b32 v17, 0
 v_mov_b32 v18, 0
 v_mov_b32 v19, 0
 v_mov_b32 v20, 0
 v_mov_b32 v21, 0
 v_mov_b32 v22, 0
 v_mov_b32 v23, 0
 buffer_load_dwordx4 v[84:87], v5, s[4:7], s57 offen offset:0 sc1
 v_mov_b32 v24, 0
 v_mov_b32 v25, 0
 v_mov_b32 v26, 0
 v_mov_b32 v27, 0
 v_mov_b32 v28, 0
 v_mov_b32 v29, 0
 v_mov_b32 v30, 0
 v_mov_b32 v31, 0
 buffer_load_dwordx4 v[88:91], v5, s[4:7], s58 offen offset:0 sc1
 v_mov_b32 v32, 0
 v_mov_b32 v33, 0
 v_mov_b32 v34, 0
 v_mov_b32 v35, 0
 v_mov_b32 v36, 0
 v_mov_b32 v37, 0
 v_mov_b32 v38, 0
 v_mov_b32 v39, 0
 s_waitcnt vmcnt(2)
 v_max3_u32 v108, v80, v81, v82
 v_max_u32 v108, v108, v83
 v_cmp_eq_u32 vcc, -1, v108
 s_cbranch_vccnz spl_2195
sst_2193:
 s_waitcnt vmcnt(2)
 v_smfmac_f32_16x16x64_bf16 v[16:19], v[80:83], v[112:119], v15
 ds_write_b128 v5, v[80:83] offset:0
 v_smfmac_f32_16x16x64_bf16 v[20:23], v[80:83], v[184:191], v15
 v_max3_u32 v108, v80, v81, v82
 v_smfmac_f32_16x16x64_bf16 v[24:27], v[80:83], a[8:15], v15
 v_smfmac_f32_16x16x64_bf16 v[28:31], v[80:83], a[48:55], v15
 s_waitcnt vmcnt(1)
 ds_write_b128 v5, v[84:87] offset:4096
 v_smfmac_f32_16x16x64_bf16 v[32:35], v[80:83], v[40:47], v15
 v_max3_u32 v108, v108, v83, v84
 v_smfmac_f32_16x16x64_bf16 v[36:39], v[80:83], v[48:55], v15
 v_max3_u32 v108, v108, v85, v86
 v_smfmac_f32_16x16x64_bf16 v[16:19], v[84:87], v[120:127], v15
 v_smfmac_f32_16x16x64_bf16 v[20:23], v[84:87], v[192:199], v15
 s_waitcnt vmcnt(0)
 ds_write_b128 v5, v[88:91] offset:8192
 v_smfmac_f32_16x16x64_bf16 v[24:27], v[84:87], a[16:23], v15
 v_max3_u32 v108, v108, v87, v88
 v_max3_u32 v108, v108, v89, v90
 v_smfmac_f32_16x16x64_bf16 v[28:31], v[84:87], a[56:63], v15
 v_max_u32 v108, v108, v91
 v_cmp_eq_u32 vcc, -1, v108
 v_smfmac_f32_16x16x64_bf16 v[32:35], v[84:87], v[56:63], v15
 s_cbranch_vccnz srt_2194
 s_waitcnt lgkmcnt(0)
 s_barrier
 ds_read_b128 v[92:95], v5 offset:1024
 v_smfmac_f32_16x16x64_bf16 v[36:39], v[84:87], v[64:71], v15
 ds_read_b128 v[96:99], v5 offset:2048
 v_smfmac_f32_16x16x64_bf16 v[16:19], v[88:91], v[72:79], v15
 ds_read_b128 v[100:103], v5 offset:3072
 v_smfmac_f32_16x16x64_bf16 v[20:23], v[88:91], v[200:207], v15
 ds_read_b128 v[104:107], v5 offset:5120
 v_smfmac_f32_16x16x64_bf16 v[24:27], v[88:91], a[24:31], v15
 ds_read_b128 v[80:83], v5 offset:6144
 v_smfmac_f32_16x16x64_bf16 v[28:31], v[88:91], a[64:71], v15
 ds_read_b128 v[84:87], v5 offset:7168
 v_smfmac_f32_16x16x64_bf16 v[32:35], v[88:91], a[128:135], v15
 v_smfmac_f32_16x16x64_bf16 v[36:39], v[88:91], a[192:199], v15
 ds_read_b128 v[88:91], v5 offset:9216
 s_waitcnt lgkmcnt(6)
 v_smfmac_f32_16x16x64_bf16 v[16:19], v[92:95], v[128:135], v15
 ds_read_b128 v[40:43], v6 offset:10240
 s_waitcnt lgkmcnt(6)
 v_smfmac_f32_16x16x64_bf16 v[16:19], v[96:99], v[136:143], v15
 ds_read_b128 v[44:47], v6 offset:11264
 s_waitcnt lgkmcnt(6)
 v_smfmac_f32_16x16x64_bf16 v[16:19], v[100:103], v[144:151], v15
 ds_read_b128 v[48:51], v6 offset:12288
 s_waitcnt lgkmcnt(6)
 v_smfmac_f32_16x16x64_bf16 v[16:19], v[104:107], v[152:159], v15
 ds_read_b128 v[52:55], v6 offset:13312
 s_waitcnt lgkmcnt(6)
 v_smfmac_f32_16x16x64_bf16 v[16:19], v[80:83], v[160:167], v15
 ds_read_b128 v[56:59], v6 offset:14336
 s_waitcnt lgkmcnt(6)
 v_smfmac_f32_16x16x64_bf16 v[16:19], v[84:87], v[168:175], v15
 ds_read_b128 v[60:63], v6 offset:15360
 s_waitcnt lgkmcnt(6)
 v_smfmac_f32_16x16x64_bf16 v[16:19], v[88:91], v[176:183], v15
 ds_read_b128 v[64:67], v6 offset:16384
 v_smfmac_f32_16x16x64_bf16 v[20:23], v[92:95], v[208:215], v15
 ds_read_b128 v[68:71], v6 offset:17408
 v_smfmac_f32_16x16x64_bf16 v[20:23], v[96:99], v[216:223], v15
 ds_read_b128 v[72:75], v6 offset:18432
 v_smfmac_f32_16x16x64_bf16 v[20:23], v[100:103], v[224:231], v15
 ds_read_b128 v[76:79], v6 offset:19456
 s_nop 0
 v_mul_f32 v16, s56, v16
 v_smfmac_f32_16x16x64_bf16 v[20:23], v[104:107], v[232:239], v15
 v_mul_f32 v17, s56, v17
 v_smfmac_f32_16x16x64_bf16 v[20:23], v[80:83], v[240:247], v15
 v_mul_f32 v18, s56, v18
 v_smfmac_f32_16x16x64_bf16 v[20:23], v[84:87], v[248:255], v15
 v_mul_f32 v19, s56, v19
 v_smfmac_f32_16x16x64_bf16 v[20:23], v[88:91], a[0:7], v15
 v_cvt_pk_bf16_f32 v16, v16, v17
 v_smfmac_f32_16x16x64_bf16 v[24:27], v[92:95], a[32:39], v15
 v_cvt_pk_bf16_f32 v17, v18, v19
 v_smfmac_f32_16x16x64_bf16 v[24:27], v[96:99], a[40:47], v15
 ds_write_b64 v7, v[16:17] offset:10240
 s_waitcnt lgkmcnt(1)
 v_smfmac_f32_16x16x64_bf16 v[24:27], v[100:103], v[40:47], v15
 ds_read_b128 v[108:111], v11 offset:10496
 s_nop 0
 v_mul_f32 v20, s56, v20
 v_smfmac_f32_16x16x64_bf16 v[24:27], v[104:107], v[48:55], v15
 ds_read_b128 v[40:43], v11 offset:0
 v_mul_f32 v21, s56, v21
 v_smfmac_f32_16x16x64_bf16 v[24:27], v[80:83], v[56:63], v15
 ds_read_b128 v[44:47], v11 offset:256
 v_mul_f32 v22, s56, v22
 v_smfmac_f32_16x16x64_bf16 v[24:27], v[84:87], v[64:71], v15
 ds_read_b128 v[48:51], v11 offset:2048
 v_mul_f32 v23, s56, v23
 v_smfmac_f32_16x16x64_bf16 v[24:27], v[88:91], v[72:79], v15
 ds_read_b128 v[52:55], v11 offset:2304
 v_cvt_pk_bf16_f32 v20, v20, v21
 v_smfmac_f32_16x16x64_bf16 v[28:31], v[92:95], a[72:79], v15
 v_cvt_pk_bf16_f32 v21, v22, v23
 v_smfmac_f32_16x16x64_bf16 v[28:31], v[96:99], a[80:87], v15
 ds_write_b64 v7, v[20:21] offset:10368
 v_smfmac_f32_16x16x64_bf16 v[28:31], v[100:103], a[88:95], v15
 s_nop 0
 v_mul_f32 v24, s56, v24
 v_smfmac_f32_16x16x64_bf16 v[28:31], v[104:107], a[96:103], v15
 buffer_load_dwordx4 v5, s[4:7], s89 offen offset:0 sc1 lds
 v_mul_f32 v25, s56, v25
 v_smfmac_f32_16x16x64_bf16 v[28:31], v[80:83], a[104:111], v15
 buffer_load_dwordx4 v5, s[4:7], s89 offen offset:1024 sc1 lds
 v_mul_f32 v26, s56, v26
 v_smfmac_f32_16x16x64_bf16 v[28:31], v[84:87], a[112:119], v15
 buffer_load_dwordx4 v5, s[4:7], s89 offen offset:2048 sc1 lds
 v_mul_f32 v27, s56, v27
 v_smfmac_f32_16x16x64_bf16 v[28:31], v[88:91], a[120:127], v15
 v_cvt_pk_bf16_f32 v24, v24, v25
 v_smfmac_f32_16x16x64_bf16 v[32:35], v[92:95], a[136:143], v15
 v_cvt_pk_bf16_f32 v25, v26, v27
 v_smfmac_f32_16x16x64_bf16 v[32:35], v[96:99], a[144:151], v15
 ds_write_b64 v7, v[24:25] offset:10496
 v_smfmac_f32_16x16x64_bf16 v[32:35], v[100:103], a[152:159], v15
 s_nop 1
 v_cvt_pk_bf16_f32 v28, v28, v29
 v_smfmac_f32_16x16x64_bf16 v[32:35], v[104:107], a[160:167], v15
 v_cvt_pk_bf16_f32 v29, v30, v31
 v_smfmac_f32_16x16x64_bf16 v[32:35], v[80:83], a[168:175], v15
 ds_write_b64 v7, v[28:29] offset:16640
 v_smfmac_f32_16x16x64_bf16 v[32:35], v[84:87], a[176:183], v15
 s_waitcnt lgkmcnt(1)
 s_barrier
 v_smfmac_f32_16x16x64_bf16 v[32:35], v[88:91], a[184:191], v15
 ds_read_b64_tr_b16 v[56:57], v8 offset:10240
 ds_read_b64_tr_b16 v[58:59], v8 offset:10272
 v_smfmac_f32_16x16x64_bf16 v[36:39], v[92:95], a[200:207], v15
 ds_read_b128 v[92:95], v11 offset:4096
 ds_read_b64_tr_b16 v[60:61], v8 offset:10496
 v_smfmac_f32_16x16x64_bf16 v[36:39], v[96:99], a[208:215], v15
 ds_read_b128 v[96:99], v11 offset:4352
 ds_read_b64_tr_b16 v[62:63], v8 offset:10528
 v_smfmac_f32_16x16x64_bf16 v[36:39], v[100:103], a[216:223], v15
 ds_read_b128 v[100:103], v11 offset:6144
 ds_read_b64_tr_b16 v[64:65], v8 offset:10752
 v_cvt_pk_bf16_f32 v32, v32, v33
 v_smfmac_f32_16x16x64_bf16 v[36:39], v[104:107], a[224:231], v15
 ds_read_b128 v[104:107], v11 offset:6400
 ds_read_b64_tr_b16 v[66:67], v8 offset:10784
 v_cvt_pk_bf16_f32 v33, v34, v35
 v_smfmac_f32_16x16x64_bf16 v[36:39], v[80:83], a[232:239], v15
 ds_write_b64 v7, v[32:33] offset:16768
 v_smfmac_f32_16x16x64_bf16 v[36:39], v[84:87], a[240:247], v15
 ds_read_b128 v[80:83], v11 offset:8192
 ds_read_b64_tr_b16 v[68:69], v8 offset:11008
 v_smfmac_f32_16x16x64_bf16 v[36:39], v[88:91], a[248:255], v15
 ds_read_b128 v[84:87], v11 offset:8448
 ds_read_b128 v[88:91], v11 offset:10240
 s_waitcnt lgkmcnt(13)
 v_mfma_f32_16x16x32_bf16 v[16:19], v[40:43], v[56:59], 0
 ds_read_b64_tr_b16 v[70:71], v8 offset:11040
 ds_read_b64_tr_b16 v[72:73], v8 offset:11264
 v_mfma_f32_16x16x32_bf16 v[20:23], v[44:47], v[56:59], 0
 ds_read_b64_tr_b16 v[74:75], v8 offset:11296
 s_waitcnt lgkmcnt(12)
 v_cvt_pk_bf16_f32 v36, v36, v37
 v_cvt_pk_bf16_f32 v37, v38, v39
 v_mfma_f32_16x16x32_bf16 v[16:19], v[48:51], v[60:63], v[16:19]
 ds_write_b64 v7, v[36:37] offset:16896
 v_mfma_f32_16x16x32_bf16 v[20:23], v[52:55], v[60:63], v[20:23]
 ds_read_b64_tr_b16 v[76:77], v8 offset:11520
 ds_read_b64_tr_b16 v[78:79], v8 offset:11552
 s_waitcnt lgkmcnt(11)
 v_mfma_f32_16x16x32_bf16 v[16:19], v[92:95], v[64:67], v[16:19]
 v_mfma_f32_16x16x32_bf16 v[20:23], v[96:99], v[64:67], v[20:23]
 s_waitcnt lgkmcnt(2)
 s_barrier
 v_mfma_f32_16x16x32_bf16 v[16:19], v[100:103], v[68:71], v[16:19]
 ds_read_b64_tr_b16 v[40:41], v8 offset:16640
 ds_read_b64_tr_b16 v[42:43], v8 offset:16672
 v_mfma_f32_16x16x32_bf16 v[20:23], v[104:107], v[68:71], v[20:23]
 ds_read_b64_tr_b16 v[44:45], v8 offset:16896
 ds_read_b64_tr_b16 v[46:47], v8 offset:16928
 v_mfma_f32_16x16x32_bf16 v[16:19], v[80:83], v[72:75], v[16:19]
 ds_read_b64_tr_b16 v[48:49], v8 offset:17152
 ds_read_b64_tr_b16 v[50:51], v8 offset:17184
 v_mfma_f32_16x16x32_bf16 v[20:23], v[84:87], v[72:75], v[20:23]
 ds_read_b64_tr_b16 v[52:53], v8 offset:17408
 ds_read_b64_tr_b16 v[54:55], v8 offset:17440
 s_waitcnt lgkmcnt(8)
 v_mfma_f32_16x16x32_bf16 v[16:19], v[88:91], v[76:79], v[16:19]
 ds_read_b64_tr_b16 v[92:93], v8 offset:17664
 ds_read_b64_tr_b16 v[94:95], v8 offset:17696
 v_mfma_f32_16x16x32_bf16 v[20:23], v[108:111], v[76:79], v[20:23]
 ds_read_b64_tr_b16 v[96:97], v8 offset:17920
 ds_read_b64_tr_b16 v[98:99], v8 offset:17952
 s_waitcnt lgkmcnt(10)
 v_mfma_f32_16x16x32_bf16 v[24:27], v[40:43], v[56:59], 0
 s_waitcnt lgkmcnt(8)
 v_mfma_f32_16x16x32_bf16 v[24:27], v[44:47], v[60:63], v[24:27]
 s_waitcnt lgkmcnt(6)
 v_add_f32_dpp v32, v16, v16 row_ror:8 row_mask:0xf bank_mask:0x3
 v_add_f32_dpp v33, v17, v17 row_ror:8 row_mask:0xf bank_mask:0x3
 v_mfma_f32_16x16x32_bf16 v[24:27], v[48:51], v[64:67], v[24:27]
 s_waitcnt lgkmcnt(4)
 v_add_f32_dpp v34, v18, v18 row_ror:8 row_mask:0xf bank_mask:0x3
 v_add_f32_dpp v35, v19, v19 row_ror:8 row_mask:0xf bank_mask:0x3
 v_mfma_f32_16x16x32_bf16 v[24:27], v[52:55], v[68:71], v[24:27]
 s_waitcnt lgkmcnt(2)
 v_add_f32_dpp v32, v20, v20 row_ror:8 row_mask:0xf bank_mask:0xc
 v_add_f32_dpp v33, v21, v21 row_ror:8 row_mask:0xf bank_mask:0xc
 v_mfma_f32_16x16x32_bf16 v[24:27], v[92:95], v[72:75], v[24:27]
 s_waitcnt lgkmcnt(0)
 v_add_f32_dpp v34, v22, v22 row_ror:8 row_mask:0xf bank_mask:0xc
 v_add_f32_dpp v35, v23, v23 row_ror:8 row_mask:0xf bank_mask:0xc
 v_mfma_f32_16x16x32_bf16 v[24:27], v[96:99], v[76:79], v[24:27]
 v_max3_f32 v28, v32, v33, v34
 v_max_f32 v28, v28, v35
 s_nop 1
 v_max_f32_dpp v28, v28, v28 row_ror:8 row_mask:0xf bank_mask:0xf
 s_nop 2
 v_permlane32_swap_b32 v24, v26
 v_permlane32_swap_b32 v25, v27
 v_pk_add_f32 v[24:25], v[24:25], v[26:27]
 s_nop 1
 v_add_f32_dpp v36, v24, v24 row_ror:8 row_mask:0xf bank_mask:0xf
 v_add_f32_dpp v37, v25, v25 row_ror:8 row_mask:0xf bank_mask:0xf
 v_max3_f32 v29, v28, v36, v37
 v_max3_f32 v28, v28, v36, v37
 s_nop 1
 v_permlane16_swap_b32 v29, v28
 v_max_f32 v30, v28, v29
 v_max_f32 v28, v28, v29
 s_nop 1
 v_permlane32_swap_b32 v30, v28
 v_max_f32 v28, v28, v30
 v_pk_add_f32 v[36:37], v[36:37], v[28:29] op_sel_hi:[1,0] neg_lo:[0,1] neg_hi:[0,1]
 v_pk_add_f32 v[32:33], v[32:33], v[28:29] op_sel_hi:[1,0] neg_lo:[0,1] neg_hi:[0,1]
 v_pk_add_f32 v[34:35], v[34:35], v[28:29] op_sel_hi:[1,0] neg_lo:[0,1] neg_hi:[0,1]
 v_exp_f32 v36, v36
 v_exp_f32 v37, v37
 v_exp_f32 v32, v32
 v_exp_f32 v33, v33
 v_exp_f32 v34, v34
 v_exp_f32 v35, v35
 v_pk_fma_f32 v[28:29], v[36:37], 0.5, v[32:33] op_sel_hi:[1,0,1]
 v_pk_add_f32 v[28:29], v[28:29], v[34:35]
 v_add_f32 v28, v28, v29
 s_nop 1
 v_add_f32_dpp v29, v28, v28 row_ror:8 row_mask:0xf bank_mask:0xf
 v_add_f32_dpp v30, v28, v28 row_ror:8 row_mask:0xf bank_mask:0xf
 s_nop 1
 v_permlane16_swap_b32 v29, v30
 v_add_f32 v28, v29, v30
 v_add_f32 v29, v29, v30
 s_nop 1
 v_permlane32_swap_b32 v28, v29
 v_add_f32 v28, v28, v29
 v_rcp_f32 v28, v28
 s_nop 0
 v_pk_mul_f32 v[32:33], v[32:33], v[28:29] op_sel_hi:[1,0] clamp
 v_cvt_pk_bf16_f32 v16, v32, v33
 v_pk_mul_f32 v[34:35], v[34:35], v[28:29] op_sel_hi:[1,0] clamp
 v_cvt_pk_bf16_f32 v17, v34, v35
 buffer_store_dwordx2 v[16:17], v10, s[4:7], s55 offen sc1
 v_pk_mul_f32 v[36:37], v[36:37], v[28:29] op_sel_hi:[1,0] clamp
 v_cvt_pk_bf16_f32 v18, v36, v37
 buffer_store_dword v18, v12, s[4:7], s55 offen sc1
 buffer_store_dword v14, v4, s[4:7], 0 offen sc1
 buffer_store_dword v14, v3, s[4:7], 0 offen sc1
 s_barrier
 v_mov_b32 v108, -1
 v_mov_b32 v109, -1
 v_mov_b32 v110, -1
 v_mov_b32 v111, -1
 buffer_store_dwordx4 v[108:111], v13, s[4:7], s38 offen sc1
 s_xor_b32 s28, s28, 61440
 s_mov_b32 s30, s36
 s_mov_b32 s36, s37
 s_mov_b32 s37, s38
 s_mov_b32 s38, s39
 s_mov_b32 s39, s30
 s_add_u32 s31, s31, 1
 s_cmp_lt_u32 s31, 64
 s_cbranch_scc1 s_2191
sdone_2192:
 s_cmp_lg_u32 s98, 0
 s_cbranch_scc1 g2_task
 s_mov_b32 s98, 1
 s_add_u32 s3, s3, 655360
 s_add_u32 s18, s18, 655360
 s_waitcnt vmcnt(0) lgkmcnt(0)
 s_barrier
 s_branch sagain_2189
srt_2194:
 s_waitcnt lgkmcnt(0)
mr_2196:
 buffer_load_dwordx4 v[80:83], v5, s[4:7], s51 offen offset:0 sc1
 buffer_load_dwordx4 v[84:87], v5, s[4:7], s57 offen offset:0 sc1
 buffer_load_dwordx4 v[88:91], v5, s[4:7], s58 offen offset:0 sc1
 s_add_u32 s99, s99, 1
 s_cmp_gt_u32 s99, 200000
 s_cbranch_scc1 main_fail
 s_waitcnt vmcnt(0)
 v_max3_u32 v108, v80, v81, v82
 v_max3_u32 v108, v108, v83, v84
 v_max3_u32 v108, v108, v85, v86
 v_max3_u32 v108, v108, v87, v88
 v_max3_u32 v108, v108, v89, v90
 v_max_u32 v108, v108, v91
 v_cmp_eq_u32 vcc, -1, v108
 s_cbranch_vccnz mr_2196
 v_mov_b32 v16, 0
 v_mov_b32 v17, 0
 v_mov_b32 v18, 0
 v_mov_b32 v19, 0
 v_mov_b32 v20, 0
 v_mov_b32 v21, 0
 v_mov_b32 v22, 0
 v_mov_b32 v23, 0
 v_mov_b32 v24, 0
 v_mov_b32 v25, 0
 v_mov_b32 v26, 0
 v_mov_b32 v27, 0
 v_mov_b32 v28, 0
 v_mov_b32 v29, 0
 v_mov_b32 v30, 0
 v_mov_b32 v31, 0
 v_mov_b32 v32, 0
 v_mov_b32 v33, 0
 v_mov_b32 v34, 0
 v_mov_b32 v35, 0
 v_mov_b32 v36, 0
 v_mov_b32 v37, 0
 v_mov_b32 v38, 0
 v_mov_b32 v39, 0
 s_branch sst_2193
spl_2195:
mp_2197:
 buffer_load_dwordx4 v[80:83], v5, s[4:7], s51 offen offset:0 sc1
 s_waitcnt vmcnt(2)
 buffer_load_dwordx4 v[84:87], v5, s[4:7], s57 offen offset:0 sc1
 s_waitcnt vmcnt(2)
 buffer_load_dwordx4 v[88:91], v5, s[4:7], s58 offen offset:0 sc1
 s_add_u32 s99, s99, 1
 s_cmp_gt_u32 s99, 200000
 s_cbranch_scc1 main_fail
 s_waitcnt vmcnt(2)
 v_max3_u32 v108, v80, v81, v82
 v_max_u32 v108, v108, v83
 v_cmp_eq_u32 vcc, -1, v108
 s_cbranch_vccnz mp_2197
 s_branch sst_2193
sw_2186:
 s_add_u32 s89, s87, 0
 s_add_u32 m0, s88, 0
 s_nop 0
 buffer_load_dwordx4 v2, s[8:11], s89 offen lds
 s_add_u32 m0, s88, 1024
 s_nop 0
 buffer_load_dwordx4 v3, s[8:11], s89 offen lds
 s_add_u32 m0, s88, 2048
 s_nop 0
 buffer_load_dwordx4 v4, s[8:11], s89 offen lds
 s_add_u32 s89, s87, 98304
 s_add_u32 m0, s88, 3072
 s_nop 0
 buffer_load_dwordx4 v2, s[8:11], s89 offen lds
 s_add_u32 m0, s88, 4096
 s_nop 0
 buffer_load_dwordx4 v3, s[8:11], s89 offen lds
 s_add_u32 m0, s88, 5120
 s_nop 0
 buffer_load_dwordx4 v4, s[8:11], s89 offen lds
 s_add_u32 s89, s87, 786432
 s_add_u32 m0, s88, 24576
 s_nop 0
 buffer_load_dwordx4 v2, s[8:11], s89 offen lds
 s_add_u32 m0, s88, 25600
 s_nop 0
 buffer_load_dwordx4 v3, s[8:11], s89 offen lds
 s_add_u32 m0, s88, 26624
 s_nop 0
 buffer_load_dwordx4 v4, s[8:11], s89 offen lds
 s_add_u32 s89, s87, 884736
 s_add_u32 m0, s88, 27648
 s_nop 0
 buffer_load_dwordx4 v2, s[8:11], s89 offen lds
 s_add_u32 m0, s88, 28672
 s_nop 0
 buffer_load_dwordx4 v3, s[8:11], s89 offen lds
 s_add_u32 m0, s88, 29696
 s_nop 0
 buffer_load_dwordx4 v4, s[8:11], s89 offen lds
 s_add_u32 s89, s87, 1572864
 s_add_u32 m0, s88, 49152
 s_nop 0
 buffer_load_dwordx4 v2, s[8:11], s89 offen lds
 s_add_u32 m0, s88, 50176
 s_nop 0
 buffer_load_dwordx4 v3, s[8:11], s89 offen lds
 s_add_u32 m0, s88, 51200
 s_nop 0
 buffer_load_dwordx4 v4, s[8:11], s89 offen lds
 s_add_u32 s89, s87, 1671168
 s_add_u32 m0, s88, 52224
 s_nop 0
 buffer_load_dwordx4 v2, s[8:11], s89 offen lds
 s_add_u32 m0, s88, 53248
 s_nop 0
 buffer_load_dwordx4 v3, s[8:11], s89 offen lds
 s_add_u32 m0, s88, 54272
 s_nop 0
 buffer_load_dwordx4 v4, s[8:11], s89 offen lds
 s_add_u32 s89, s87, 2359296
 s_add_u32 m0, s88, 73728
 s_nop 0
 buffer_load_dwordx4 v2, s[8:11], s89 offen lds
 s_add_u32 m0, s88, 74752
 s_nop 0
 buffer_load_dwordx4 v3, s[8:11], s89 offen lds
 s_add_u32 m0, s88, 75776
 s_nop 0
 buffer_load_dwordx4 v4, s[8:11], s89 offen lds
 s_add_u32 s89, s87, 2457600
 s_add_u32 m0, s88, 76800
 s_nop 0
 buffer_load_dwordx4 v2, s[8:11], s89 offen lds
 s_add_u32 m0, s88, 77824
 s_nop 0
 buffer_load_dwordx4 v3, s[8:11], s89 offen lds
 s_add_u32 m0, s88, 78848
 s_nop 0
 buffer_load_dwordx4 v4, s[8:11], s89 offen lds
 s_add_u32 s89, s87, 3145728
 s_add_u32 m0, s88, 98304
 s_nop 0
 buffer_load_dwordx4 v2, s[8:11], s89 offen lds
 s_add_u32 m0, s88, 99328
 s_nop 0
 buffer_load_dwordx4 v3, s[8:11], s89 offen lds
 s_add_u32 m0, s88, 100352
 s_nop 0
 buffer_load_dwordx4 v4, s[8:11], s89 offen lds
 s_add_u32 s89, s87, 3244032
 s_add_u32 m0, s88, 101376
 s_nop 0
 buffer_load_dwordx4 v2, s[8:11], s89 offen lds
 s_add_u32 m0, s88, 102400
 s_nop 0
 buffer_load_dwordx4 v3, s[8:11], s89 offen lds
 s_add_u32 m0, s88, 103424
 s_nop 0
 buffer_load_dwordx4 v4, s[8:11], s89 offen lds
 s_waitcnt vmcnt(24)
 s_barrier
 s_add_u32 s89, s87, 3932160
 s_add_u32 m0, s88, 122880
 s_nop 0
 buffer_load_dwordx4 v2, s[8:11], s89 offen lds
 s_add_u32 m0, s88, 123904
 s_nop 0
 buffer_load_dwordx4 v3, s[8:11], s89 offen lds
 s_add_u32 m0, s88, 124928
 s_nop 0
 buffer_load_dwordx4 v4, s[8:11], s89 offen lds
 s_add_u32 s89, s87, 4030464
 s_add_u32 m0, s88, 125952
 s_nop 0
 buffer_load_dwordx4 v2, s[8:11], s89 offen lds
 s_add_u32 m0, s88, 126976
 s_nop 0
 buffer_load_dwordx4 v3, s[8:11], s89 offen lds
 s_add_u32 m0, s88, 128000
 s_nop 0
 buffer_load_dwordx4 v4, s[8:11], s89 offen lds
 v_add_u32 v7, 0, v5
 ds_read_b64_tr_b16 v[128:129], v7 offset:0
 ds_read_b64_tr_b16 v[130:131], v7 offset:768
 ds_read_b64_tr_b16 v[132:133], v7 offset:12288
 ds_read_b64_tr_b16 v[134:135], v7 offset:13056
 ds_read_b64_tr_b16 v[208:209], v7 offset:32
 ds_read_b64_tr_b16 v[210:211], v7 offset:800
 ds_read_b64_tr_b16 v[212:213], v7 offset:12320
 ds_read_b64_tr_b16 v[214:215], v7 offset:13088
 ds_read_b64_tr_b16 a[32:33], v7 offset:64
 ds_read_b64_tr_b16 a[34:35], v7 offset:832
 ds_read_b64_tr_b16 a[36:37], v7 offset:12352
 ds_read_b64_tr_b16 a[38:39], v7 offset:13120
 s_waitcnt lgkmcnt(0)
 s_waitcnt vmcnt(24)
 s_barrier
 s_add_u32 s89, s87, 4718592
 s_add_u32 m0, s88, 0
 s_nop 0
 buffer_load_dwordx4 v2, s[8:11], s89 offen lds
 s_add_u32 m0, s88, 1024
 s_nop 0
 buffer_load_dwordx4 v3, s[8:11], s89 offen lds
 s_add_u32 m0, s88, 2048
 s_nop 0
 buffer_load_dwordx4 v4, s[8:11], s89 offen lds
 s_add_u32 s89, s87, 4816896
 s_add_u32 m0, s88, 3072
 s_nop 0
 buffer_load_dwordx4 v2, s[8:11], s89 offen lds
 s_add_u32 m0, s88, 4096
 s_nop 0
 buffer_load_dwordx4 v3, s[8:11], s89 offen lds
 s_add_u32 m0, s88, 5120
 s_nop 0
 buffer_load_dwordx4 v4, s[8:11], s89 offen lds
 v_add_u32 v7, 24576, v5
 ds_read_b64_tr_b16 v[112:113], v7 offset:0
 ds_read_b64_tr_b16 v[114:115], v7 offset:768
 ds_read_b64_tr_b16 v[116:117], v7 offset:12288
 ds_read_b64_tr_b16 v[118:119], v7 offset:13056
 ds_read_b64_tr_b16 v[184:185], v7 offset:32
 ds_read_b64_tr_b16 v[186:187], v7 offset:800
 ds_read_b64_tr_b16 v[188:189], v7 offset:12320
 ds_read_b64_tr_b16 v[190:191], v7 offset:13088
 ds_read_b64_tr_b16 a[8:9], v7 offset:64
 ds_read_b64_tr_b16 a[10:11], v7 offset:832
 ds_read_b64_tr_b16 a[12:13], v7 offset:12352
 ds_read_b64_tr_b16 a[14:15], v7 offset:13120
 s_waitcnt lgkmcnt(0)
 s_waitcnt vmcnt(24)
 s_barrier
 s_add_u32 s89, s87, 5505024
 s_add_u32 m0, s88, 24576
 s_nop 0
 buffer_load_dwordx4 v2, s[8:11], s89 offen lds
 s_add_u32 m0, s88, 25600
 s_nop 0
 buffer_load_dwordx4 v3, s[8:11], s89 offen lds
 s_add_u32 m0, s88, 26624
 s_nop 0
 buffer_load_dwordx4 v4, s[8:11], s89 offen lds
 s_add_u32 s89, s87, 5603328
 s_add_u32 m0, s88, 27648
 s_nop 0
 buffer_load_dwordx4 v2, s[8:11], s89 offen lds
 s_add_u32 m0, s88, 28672
 s_nop 0
 buffer_load_dwordx4 v3, s[8:11], s89 offen lds
 s_add_u32 m0, s88, 29696
 s_nop 0
 buffer_load_dwordx4 v4, s[8:11], s89 offen lds
 v_add_u32 v7, 49152, v5
 ds_read_b64_tr_b16 v[136:137], v7 offset:0
 ds_read_b64_tr_b16 v[138:139], v7 offset:768
 ds_read_b64_tr_b16 v[140:141], v7 offset:12288
 ds_read_b64_tr_b16 v[142:143], v7 offset:13056
 ds_read_b64_tr_b16 v[216:217], v7 offset:32
 ds_read_b64_tr_b16 v[218:219], v7 offset:800
 ds_read_b64_tr_b16 v[220:221], v7 offset:12320
 ds_read_b64_tr_b16 v[222:223], v7 offset:13088
 ds_read_b64_tr_b16 a[40:41], v7 offset:64
 ds_read_b64_tr_b16 a[42:43], v7 offset:832
 ds_read_b64_tr_b16 a[44:45], v7 offset:12352
 ds_read_b64_tr_b16 a[46:47], v7 offset:13120
 s_waitcnt lgkmcnt(0)
 s_waitcnt vmcnt(24)
 s_barrier
 s_add_u32 s89, s87, 6291456
 s_add_u32 m0, s88, 49152
 s_nop 0
 buffer_load_dwordx4 v2, s[8:11], s89 offen lds
 s_add_u32 m0, s88, 50176
 s_nop 0
 buffer_load_dwordx4 v3, s[8:11], s89 offen lds
 s_add_u32 m0, s88, 51200
 s_nop 0
 buffer_load_dwordx4 v4, s[8:11], s89 offen lds
 s_add_u32 s89, s87, 6389760
 s_add_u32 m0, s88, 52224
 s_nop 0
 buffer_load_dwordx4 v2, s[8:11], s89 offen lds
 s_add_u32 m0, s88, 53248
 s_nop 0
 buffer_load_dwordx4 v3, s[8:11], s89 offen lds
 s_add_u32 m0, s88, 54272
 s_nop 0
 buffer_load_dwordx4 v4, s[8:11], s89 offen lds
 v_add_u32 v7, 73728, v5
 ds_read_b64_tr_b16 v[144:145], v7 offset:0
 ds_read_b64_tr_b16 v[146:147], v7 offset:768
 ds_read_b64_tr_b16 v[148:149], v7 offset:12288
 ds_read_b64_tr_b16 v[150:151], v7 offset:13056
 ds_read_b64_tr_b16 v[224:225], v7 offset:32
 ds_read_b64_tr_b16 v[226:227], v7 offset:800
 ds_read_b64_tr_b16 v[228:229], v7 offset:12320
 ds_read_b64_tr_b16 v[230:231], v7 offset:13088
 ds_read_b64_tr_b16 v[56:57], v7 offset:64
 ds_read_b64_tr_b16 v[58:59], v7 offset:832
 ds_read_b64_tr_b16 v[60:61], v7 offset:12352
 ds_read_b64_tr_b16 v[62:63], v7 offset:13120
 s_waitcnt lgkmcnt(0)
 s_waitcnt vmcnt(24)
 s_barrier
 s_add_u32 s89, s87, 7077888
 s_add_u32 m0, s88, 73728
 s_nop 0
 buffer_load_dwordx4 v2, s[8:11], s89 offen lds
 s_add_u32 m0, s88, 74752
 s_nop 0
 buffer_load_dwordx4 v3, s[8:11], s89 offen lds
 s_add_u32 m0, s88, 75776
 s_nop 0
 buffer_load_dwordx4 v4, s[8:11], s89 offen lds
 s_add_u32 s89, s87, 7176192
 s_add_u32 m0, s88, 76800
 s_nop 0
 buffer_load_dwordx4 v2, s[8:11], s89 offen lds
 s_add_u32 m0, s88, 77824
 s_nop 0
 buffer_load_dwordx4 v3, s[8:11], s89 offen lds
 s_add_u32 m0, s88, 78848
 s_nop 0
 buffer_load_dwordx4 v4, s[8:11], s89 offen lds
 v_add_u32 v7, 98304, v5
 ds_read_b64_tr_b16 v[152:153], v7 offset:0
 ds_read_b64_tr_b16 v[154:155], v7 offset:768
 ds_read_b64_tr_b16 v[156:157], v7 offset:12288
 ds_read_b64_tr_b16 v[158:159], v7 offset:13056
 ds_read_b64_tr_b16 v[232:233], v7 offset:32
 ds_read_b64_tr_b16 v[234:235], v7 offset:800
 ds_read_b64_tr_b16 v[236:237], v7 offset:12320
 ds_read_b64_tr_b16 v[238:239], v7 offset:13088
 ds_read_b64_tr_b16 v[64:65], v7 offset:64
 ds_read_b64_tr_b16 v[66:67], v7 offset:832
 ds_read_b64_tr_b16 v[68:69], v7 offset:12352
 ds_read_b64_tr_b16 v[70:71], v7 offset:13120
 s_waitcnt lgkmcnt(0)
 s_waitcnt vmcnt(24)
 s_barrier
 s_add_u32 s89, s87, 0
 s_add_u32 m0, s88, 98304
 s_nop 0
 buffer_load_dwordx4 v2, s[12:15], s89 offen lds
 s_add_u32 m0, s88, 99328
 s_nop 0
 buffer_load_dwordx4 v3, s[12:15], s89 offen lds
 s_add_u32 m0, s88, 100352
 s_nop 0
 buffer_load_dwordx4 v4, s[12:15], s89 offen lds
 s_add_u32 s89, s87, 98304
 s_add_u32 m0, s88, 101376
 s_nop 0
 buffer_load_dwordx4 v2, s[12:15], s89 offen lds
 s_add_u32 m0, s88, 102400
 s_nop 0
 buffer_load_dwordx4 v3, s[12:15], s89 offen lds
 s_add_u32 m0, s88, 103424
 s_nop 0
 buffer_load_dwordx4 v4, s[12:15], s89 offen lds
 v_add_u32 v7, 122880, v5
 ds_read_b64_tr_b16 v[120:121], v7 offset:0
 ds_read_b64_tr_b16 v[122:123], v7 offset:768
 ds_read_b64_tr_b16 v[124:125], v7 offset:12288
 ds_read_b64_tr_b16 v[126:127], v7 offset:13056
 ds_read_b64_tr_b16 v[192:193], v7 offset:32
 ds_read_b64_tr_b16 v[194:195], v7 offset:800
 ds_read_b64_tr_b16 v[196:197], v7 offset:12320
 ds_read_b64_tr_b16 v[198:199], v7 offset:13088
 ds_read_b64_tr_b16 a[16:17], v7 offset:64
 ds_read_b64_tr_b16 a[18:19], v7 offset:832
 ds_read_b64_tr_b16 a[20:21], v7 offset:12352
 ds_read_b64_tr_b16 a[22:23], v7 offset:13120
 s_waitcnt lgkmcnt(0)
 s_waitcnt vmcnt(24)
 s_barrier
 s_add_u32 s89, s87, 786432
 s_add_u32 m0, s88, 122880
 s_nop 0
 buffer_load_dwordx4 v2, s[12:15], s89 offen lds
 s_add_u32 m0, s88, 123904
 s_nop 0
 buffer_load_dwordx4 v3, s[12:15], s89 offen lds
 s_add_u32 m0, s88, 124928
 s_nop 0
 buffer_load_dwordx4 v4, s[12:15], s89 offen lds
 s_add_u32 s89, s87, 884736
 s_add_u32 m0, s88, 125952
 s_nop 0
 buffer_load_dwordx4 v2, s[12:15], s89 offen lds
 s_add_u32 m0, s88, 126976
 s_nop 0
 buffer_load_dwordx4 v3, s[12:15], s89 offen lds
 s_add_u32 m0, s88, 128000
 s_nop 0
 buffer_load_dwordx4 v4, s[12:15], s89 offen lds
 v_add_u32 v7, 0, v5
 ds_read_b64_tr_b16 v[160:161], v7 offset:0
 ds_read_b64_tr_b16 v[162:163], v7 offset:768
 ds_read_b64_tr_b16 v[164:165], v7 offset:12288
 ds_read_b64_tr_b16 v[166:167], v7 offset:13056
 ds_read_b64_tr_b16 v[240:241], v7 offset:32
 ds_read_b64_tr_b16 v[242:243], v7 offset:800
 ds_read_b64_tr_b16 v[244:245], v7 offset:12320
 ds_read_b64_tr_b16 v[246:247], v7 offset:13088
 ds_read_b64_tr_b16 v[72:73], v7 offset:64
 ds_read_b64_tr_b16 v[74:75], v7 offset:832
 ds_read_b64_tr_b16 v[76:77], v7 offset:12352
 ds_read_b64_tr_b16 v[78:79], v7 offset:13120
 s_waitcnt lgkmcnt(0)
 s_waitcnt vmcnt(24)
 s_barrier
 s_add_u32 s89, s87, 1572864
 s_add_u32 m0, s88, 0
 s_nop 0
 buffer_load_dwordx4 v2, s[12:15], s89 offen lds
 s_add_u32 m0, s88, 1024
 s_nop 0
 buffer_load_dwordx4 v3, s[12:15], s89 offen lds
 s_add_u32 m0, s88, 2048
 s_nop 0
 buffer_load_dwordx4 v4, s[12:15], s89 offen lds
 s_add_u32 s89, s87, 1671168
 s_add_u32 m0, s88, 3072
 s_nop 0
 buffer_load_dwordx4 v2, s[12:15], s89 offen lds
 s_add_u32 m0, s88, 4096
 s_nop 0
 buffer_load_dwordx4 v3, s[12:15], s89 offen lds
 s_add_u32 m0, s88, 5120
 s_nop 0
 buffer_load_dwordx4 v4, s[12:15], s89 offen lds
 v_add_u32 v7, 24576, v5
 ds_read_b64_tr_b16 v[168:169], v7 offset:0
 ds_read_b64_tr_b16 v[170:171], v7 offset:768
 ds_read_b64_tr_b16 v[172:173], v7 offset:12288
 ds_read_b64_tr_b16 v[174:175], v7 offset:13056
 ds_read_b64_tr_b16 v[248:249], v7 offset:32
 ds_read_b64_tr_b16 v[250:251], v7 offset:800
 ds_read_b64_tr_b16 v[252:253], v7 offset:12320
 ds_read_b64_tr_b16 v[254:255], v7 offset:13088
 ds_read_b64_tr_b16 v[80:81], v7 offset:64
 ds_read_b64_tr_b16 v[82:83], v7 offset:832
 ds_read_b64_tr_b16 v[84:85], v7 offset:12352
 ds_read_b64_tr_b16 v[86:87], v7 offset:13120
 s_waitcnt lgkmcnt(0)
 s_waitcnt vmcnt(24)
 s_barrier
 s_add_u32 s89, s87, 2359296
 s_add_u32 m0, s88, 24576
 s_nop 0
 buffer_load_dwordx4 v2, s[12:15], s89 offen lds
 s_add_u32 m0, s88, 25600
 s_nop 0
 buffer_load_dwordx4 v3, s[12:15], s89 offen lds
 s_add_u32 m0, s88, 26624
 s_nop 0
 buffer_load_dwordx4 v4, s[12:15], s89 offen lds
 s_add_u32 s89, s87, 2457600
 s_add_u32 m0, s88, 27648
 s_nop 0
 buffer_load_dwordx4 v2, s[12:15], s89 offen lds
 s_add_u32 m0, s88, 28672
 s_nop 0
 buffer_load_dwordx4 v3, s[12:15], s89 offen lds
 s_add_u32 m0, s88, 29696
 s_nop 0
 buffer_load_dwordx4 v4, s[12:15], s89 offen lds
 v_add_u32 v7, 49152, v5
 ds_read_b64_tr_b16 v[176:177], v7 offset:0
 ds_read_b64_tr_b16 v[178:179], v7 offset:768
 ds_read_b64_tr_b16 v[180:181], v7 offset:12288
 ds_read_b64_tr_b16 v[182:183], v7 offset:13056
 ds_read_b64_tr_b16 a[0:1], v7 offset:32
 ds_read_b64_tr_b16 a[2:3], v7 offset:800
 ds_read_b64_tr_b16 a[4:5], v7 offset:12320
 ds_read_b64_tr_b16 a[6:7], v7 offset:13088
 ds_read_b64_tr_b16 v[88:89], v7 offset:64
 ds_read_b64_tr_b16 v[90:91], v7 offset:832
 ds_read_b64_tr_b16 v[92:93], v7 offset:12352
 ds_read_b64_tr_b16 v[94:95], v7 offset:13120
 s_waitcnt lgkmcnt(0)
 s_waitcnt vmcnt(24)
 s_barrier
 s_add_u32 s89, s87, 3145728
 s_add_u32 m0, s88, 49152
 s_nop 0
 buffer_load_dwordx4 v2, s[12:15], s89 offen lds
 s_add_u32 m0, s88, 50176
 s_nop 0
 buffer_load_dwordx4 v3, s[12:15], s89 offen lds
 s_add_u32 m0, s88, 51200
 s_nop 0
 buffer_load_dwordx4 v4, s[12:15], s89 offen lds
 s_add_u32 s89, s87, 3244032
 s_add_u32 m0, s88, 52224
 s_nop 0
 buffer_load_dwordx4 v2, s[12:15], s89 offen lds
 s_add_u32 m0, s88, 53248
 s_nop 0
 buffer_load_dwordx4 v3, s[12:15], s89 offen lds
 s_add_u32 m0, s88, 54272
 s_nop 0
 buffer_load_dwordx4 v4, s[12:15], s89 offen lds
 v_add_u32 v7, 73728, v5
 ds_read_b64_tr_b16 v[48:49], v7 offset:0
 ds_read_b64_tr_b16 v[50:51], v7 offset:768
 ds_read_b64_tr_b16 v[52:53], v7 offset:12288
 ds_read_b64_tr_b16 v[54:55], v7 offset:13056
 ds_read_b64_tr_b16 v[200:201], v7 offset:32
 ds_read_b64_tr_b16 v[202:203], v7 offset:800
 ds_read_b64_tr_b16 v[204:205], v7 offset:12320
 ds_read_b64_tr_b16 v[206:207], v7 offset:13088
 ds_read_b64_tr_b16 a[24:25], v7 offset:64
 ds_read_b64_tr_b16 a[26:27], v7 offset:832
 ds_read_b64_tr_b16 a[28:29], v7 offset:12352
 ds_read_b64_tr_b16 a[30:31], v7 offset:13120
 s_waitcnt lgkmcnt(0)
 s_waitcnt vmcnt(24)
 s_barrier
 s_add_u32 s89, s87, 3932160
 s_add_u32 m0, s88, 73728
 s_nop 0
 buffer_load_dwordx4 v2, s[12:15], s89 offen lds
 s_add_u32 m0, s88, 74752
 s_nop 0
 buffer_load_dwordx4 v3, s[12:15], s89 offen lds
 s_add_u32 m0, s88, 75776
 s_nop 0
 buffer_load_dwordx4 v4, s[12:15], s89 offen lds
 s_add_u32 s89, s87, 4030464
 s_add_u32 m0, s88, 76800
 s_nop 0
 buffer_load_dwordx4 v2, s[12:15], s89 offen lds
 s_add_u32 m0, s88, 77824
 s_nop 0
 buffer_load_dwordx4 v3, s[12:15], s89 offen lds
 s_add_u32 m0, s88, 78848
 s_nop 0
 buffer_load_dwordx4 v4, s[12:15], s89 offen lds
 v_add_u32 v7, 98304, v5
 ds_read_b64_tr_b16 a[72:73], v7 offset:0
 ds_read_b64_tr_b16 a[74:75], v7 offset:768
 ds_read_b64_tr_b16 a[76:77], v7 offset:12288
 ds_read_b64_tr_b16 a[78:79], v7 offset:13056
 ds_read_b64_tr_b16 a[136:137], v7 offset:32
 ds_read_b64_tr_b16 a[138:139], v7 offset:800
 ds_read_b64_tr_b16 a[140:141], v7 offset:12320
 ds_read_b64_tr_b16 a[142:143], v7 offset:13088
 ds_read_b64_tr_b16 a[200:201], v7 offset:64
 ds_read_b64_tr_b16 a[202:203], v7 offset:832
 ds_read_b64_tr_b16 a[204:205], v7 offset:12352
 ds_read_b64_tr_b16 a[206:207], v7 offset:13120
 s_waitcnt lgkmcnt(0)
 s_waitcnt vmcnt(24)
 s_barrier
 s_add_u32 s89, s87, 4718592
 s_add_u32 m0, s88, 98304
 s_nop 0
 buffer_load_dwordx4 v2, s[12:15], s89 offen lds
 s_add_u32 m0, s88, 99328
 s_nop 0
 buffer_load_dwordx4 v3, s[12:15], s89 offen lds
 s_add_u32 m0, s88, 100352
 s_nop 0
 buffer_load_dwordx4 v4, s[12:15], s89 offen lds
 s_add_u32 s89, s87, 4816896
 s_add_u32 m0, s88, 101376
 s_nop 0
 buffer_load_dwordx4 v2, s[12:15], s89 offen lds
 s_add_u32 m0, s88, 102400
 s_nop 0
 buffer_load_dwordx4 v3, s[12:15], s89 offen lds
 s_add_u32 m0, s88, 103424
 s_nop 0
 buffer_load_dwordx4 v4, s[12:15], s89 offen lds
 v_add_u32 v7, 122880, v5
 ds_read_b64_tr_b16 a[48:49], v7 offset:0
 ds_read_b64_tr_b16 a[50:51], v7 offset:768
 ds_read_b64_tr_b16 a[52:53], v7 offset:12288
 ds_read_b64_tr_b16 a[54:55], v7 offset:13056
 ds_read_b64_tr_b16 v[16:17], v7 offset:32
 ds_read_b64_tr_b16 v[18:19], v7 offset:800
 ds_read_b64_tr_b16 v[20:21], v7 offset:12320
 ds_read_b64_tr_b16 v[22:23], v7 offset:13088
 ds_read_b64_tr_b16 v[24:25], v7 offset:64
 ds_read_b64_tr_b16 v[26:27], v7 offset:832
 ds_read_b64_tr_b16 v[28:29], v7 offset:12352
 ds_read_b64_tr_b16 v[30:31], v7 offset:13120
 s_waitcnt lgkmcnt(0)
 s_waitcnt vmcnt(24)
 s_barrier
 s_add_u32 s89, s87, 5505024
 s_add_u32 m0, s88, 122880
 s_nop 0
 buffer_load_dwordx4 v2, s[12:15], s89 offen lds
 s_add_u32 m0, s88, 123904
 s_nop 0
 buffer_load_dwordx4 v3, s[12:15], s89 offen lds
 s_add_u32 m0, s88, 124928
 s_nop 0
 buffer_load_dwordx4 v4, s[12:15], s89 offen lds
 s_add_u32 s89, s87, 5603328
 s_add_u32 m0, s88, 125952
 s_nop 0
 buffer_load_dwordx4 v2, s[12:15], s89 offen lds
 s_add_u32 m0, s88, 126976
 s_nop 0
 buffer_load_dwordx4 v3, s[12:15], s89 offen lds
 s_add_u32 m0, s88, 128000
 s_nop 0
 buffer_load_dwordx4 v4, s[12:15], s89 offen lds
 v_add_u32 v7, 0, v5
 ds_read_b64_tr_b16 a[80:81], v7 offset:0
 ds_read_b64_tr_b16 a[82:83], v7 offset:768
 ds_read_b64_tr_b16 a[84:85], v7 offset:12288
 ds_read_b64_tr_b16 a[86:87], v7 offset:13056
 ds_read_b64_tr_b16 a[144:145], v7 offset:32
 ds_read_b64_tr_b16 a[146:147], v7 offset:800
 ds_read_b64_tr_b16 a[148:149], v7 offset:12320
 ds_read_b64_tr_b16 a[150:151], v7 offset:13088
 ds_read_b64_tr_b16 a[208:209], v7 offset:64
 ds_read_b64_tr_b16 a[210:211], v7 offset:832
 ds_read_b64_tr_b16 a[212:213], v7 offset:12352
 ds_read_b64_tr_b16 a[214:215], v7 offset:13120
 s_waitcnt lgkmcnt(0)
 s_waitcnt vmcnt(24)
 s_barrier
 s_add_u32 s89, s87, 6291456
 s_add_u32 m0, s88, 0
 s_nop 0
 buffer_load_dwordx4 v2, s[12:15], s89 offen lds
 s_add_u32 m0, s88, 1024
 s_nop 0
 buffer_load_dwordx4 v3, s[12:15], s89 offen lds
 s_add_u32 m0, s88, 2048
 s_nop 0
 buffer_load_dwordx4 v4, s[12:15], s89 offen lds
 s_add_u32 s89, s87, 6389760
 s_add_u32 m0, s88, 3072
 s_nop 0
 buffer_load_dwordx4 v2, s[12:15], s89 offen lds
 s_add_u32 m0, s88, 4096
 s_nop 0
 buffer_load_dwordx4 v3, s[12:15], s89 offen lds
 s_add_u32 m0, s88, 5120
 s_nop 0
 buffer_load_dwordx4 v4, s[12:15], s89 offen lds
 v_add_u32 v7, 24576, v5
 ds_read_b64_tr_b16 a[88:89], v7 offset:0
 ds_read_b64_tr_b16 a[90:91], v7 offset:768
 ds_read_b64_tr_b16 a[92:93], v7 offset:12288
 ds_read_b64_tr_b16 a[94:95], v7 offset:13056
 ds_read_b64_tr_b16 a[152:153], v7 offset:32
 ds_read_b64_tr_b16 a[154:155], v7 offset:800
 ds_read_b64_tr_b16 a[156:157], v7 offset:12320
 ds_read_b64_tr_b16 a[158:159], v7 offset:13088
 ds_read_b64_tr_b16 a[216:217], v7 offset:64
 ds_read_b64_tr_b16 a[218:219], v7 offset:832
 ds_read_b64_tr_b16 a[220:221], v7 offset:12352
 ds_read_b64_tr_b16 a[222:223], v7 offset:13120
 s_waitcnt lgkmcnt(0)
 s_waitcnt vmcnt(24)
 s_barrier
 s_add_u32 s89, s87, 7077888
 s_add_u32 m0, s88, 24576
 s_nop 0
 buffer_load_dwordx4 v2, s[12:15], s89 offen lds
 s_add_u32 m0, s88, 25600
 s_nop 0
 buffer_load_dwordx4 v3, s[12:15], s89 offen lds
 s_add_u32 m0, s88, 26624
 s_nop 0
 buffer_load_dwordx4 v4, s[12:15], s89 offen lds
 s_add_u32 s89, s87, 7176192
 s_add_u32 m0, s88, 27648
 s_nop 0
 buffer_load_dwordx4 v2, s[12:15], s89 offen lds
 s_add_u32 m0, s88, 28672
 s_nop 0
 buffer_load_dwordx4 v3, s[12:15], s89 offen lds
 s_add_u32 m0, s88, 29696
 s_nop 0
 buffer_load_dwordx4 v4, s[12:15], s89 offen lds
 v_add_u32 v7, 49152, v5
 ds_read_b64_tr_b16 a[96:97], v7 offset:0
 ds_read_b64_tr_b16 a[98:99], v7 offset:768
 ds_read_b64_tr_b16 a[100:101], v7 offset:12288
 ds_read_b64_tr_b16 a[102:103], v7 offset:13056
 ds_read_b64_tr_b16 a[160:161], v7 offset:32
 ds_read_b64_tr_b16 a[162:163], v7 offset:800
 ds_read_b64_tr_b16 a[164:165], v7 offset:12320
 ds_read_b64_tr_b16 a[166:167], v7 offset:13088
 ds_read_b64_tr_b16 a[224:225], v7 offset:64
 ds_read_b64_tr_b16 a[226:227], v7 offset:832
 ds_read_b64_tr_b16 a[228:229], v7 offset:12352
 ds_read_b64_tr_b16 a[230:231], v7 offset:13120
 s_waitcnt lgkmcnt(0)
 s_waitcnt vmcnt(24)
 s_barrier
 v_add_u32 v7, 73728, v5
 ds_read_b64_tr_b16 a[56:57], v7 offset:0
 ds_read_b64_tr_b16 a[58:59], v7 offset:768
 ds_read_b64_tr_b16 a[60:61], v7 offset:12288
 ds_read_b64_tr_b16 a[62:63], v7 offset:13056
 ds_read_b64_tr_b16 v[32:33], v7 offset:32
 ds_read_b64_tr_b16 v[34:35], v7 offset:800
 ds_read_b64_tr_b16 v[36:37], v7 offset:12320
 ds_read_b64_tr_b16 v[38:39], v7 offset:13088
 ds_read_b64_tr_b16 v[40:41], v7 offset:64
 ds_read_b64_tr_b16 v[42:43], v7 offset:832
 ds_read_b64_tr_b16 v[44:45], v7 offset:12352
 ds_read_b64_tr_b16 v[46:47], v7 offset:13120
 s_waitcnt lgkmcnt(0)
 s_waitcnt vmcnt(18)
 s_barrier
 v_add_u32 v7, 98304, v5
 ds_read_b64_tr_b16 a[104:105], v7 offset:0
 ds_read_b64_tr_b16 a[106:107], v7 offset:768
 ds_read_b64_tr_b16 a[108:109], v7 offset:12288
 ds_read_b64_tr_b16 a[110:111], v7 offset:13056
 ds_read_b64_tr_b16 a[168:169], v7 offset:32
 ds_read_b64_tr_b16 a[170:171], v7 offset:800
 ds_read_b64_tr_b16 a[172:173], v7 offset:12320
 ds_read_b64_tr_b16 a[174:175], v7 offset:13088
 ds_read_b64_tr_b16 a[232:233], v7 offset:64
 ds_read_b64_tr_b16 a[234:235], v7 offset:832
 ds_read_b64_tr_b16 a[236:237], v7 offset:12352
 ds_read_b64_tr_b16 a[238:239], v7 offset:13120
 s_waitcnt lgkmcnt(0)
 s_waitcnt vmcnt(12)
 s_barrier
 v_add_u32 v7, 122880, v5
 ds_read_b64_tr_b16 a[112:113], v7 offset:0
 ds_read_b64_tr_b16 a[114:115], v7 offset:768
 ds_read_b64_tr_b16 a[116:117], v7 offset:12288
 ds_read_b64_tr_b16 a[118:119], v7 offset:13056
 ds_read_b64_tr_b16 a[176:177], v7 offset:32
 ds_read_b64_tr_b16 a[178:179], v7 offset:800
 ds_read_b64_tr_b16 a[180:181], v7 offset:12320
 ds_read_b64_tr_b16 a[182:183], v7 offset:13088
 ds_read_b64_tr_b16 a[240:241], v7 offset:64
 ds_read_b64_tr_b16 a[242:243], v7 offset:832
 ds_read_b64_tr_b16 a[244:245], v7 offset:12352
 ds_read_b64_tr_b16 a[246:247], v7 offset:13120
 s_waitcnt lgkmcnt(0)
 s_waitcnt vmcnt(6)
 s_barrier
 v_add_u32 v7, 0, v5
 ds_read_b64_tr_b16 a[120:121], v7 offset:0
 ds_read_b64_tr_b16 a[122:123], v7 offset:768
 ds_read_b64_tr_b16 a[124:125], v7 offset:12288
 ds_read_b64_tr_b16 a[126:127], v7 offset:13056
 ds_read_b64_tr_b16 a[184:185], v7 offset:32
 ds_read_b64_tr_b16 a[186:187], v7 offset:800
 ds_read_b64_tr_b16 a[188:189], v7 offset:12320
 ds_read_b64_tr_b16 a[190:191], v7 offset:13088
 ds_read_b64_tr_b16 a[248:249], v7 offset:64
 ds_read_b64_tr_b16 a[250:251], v7 offset:832
 ds_read_b64_tr_b16 a[252:253], v7 offset:12352
 ds_read_b64_tr_b16 a[254:255], v7 offset:13120
 s_waitcnt lgkmcnt(0)
 s_waitcnt vmcnt(0)
 s_barrier
 v_add_u32 v7, 24576, v5
 ds_read_b64_tr_b16 a[64:65], v7 offset:0
 ds_read_b64_tr_b16 a[66:67], v7 offset:768
 ds_read_b64_tr_b16 a[68:69], v7 offset:12288
 ds_read_b64_tr_b16 a[70:71], v7 offset:13056
 ds_read_b64_tr_b16 a[128:129], v7 offset:32
 ds_read_b64_tr_b16 a[130:131], v7 offset:800
 ds_read_b64_tr_b16 a[132:133], v7 offset:12320
 ds_read_b64_tr_b16 a[134:135], v7 offset:13088
 ds_read_b64_tr_b16 a[192:193], v7 offset:64
 ds_read_b64_tr_b16 a[194:195], v7 offset:832
 ds_read_b64_tr_b16 a[196:197], v7 offset:12352
 ds_read_b64_tr_b16 a[198:199], v7 offset:13120
 s_waitcnt lgkmcnt(0)
 s_barrier
 ds_write_b128 v6, v[16:19] offset:0
 ds_write_b128 v6, v[20:23] offset:1024
 ds_write_b128 v6, v[24:27] offset:2048
 ds_write_b128 v6, v[28:31] offset:3072
 ds_write_b128 v6, v[32:35] offset:4096
 ds_write_b128 v6, v[36:39] offset:5120
 ds_write_b128 v6, v[40:43] offset:6144
 ds_write_b128 v6, v[44:47] offset:7168
 s_waitcnt lgkmcnt(4)
 ds_write_b128 v6, v[48:51] offset:8192
 ds_write_b128 v6, v[52:55] offset:9216
 ds_write_b128 v6, v[56:59] offset:10240
 ds_write_b128 v6, v[60:63] offset:11264
 ds_write_b128 v6, v[64:67] offset:12288
 ds_write_b128 v6, v[68:71] offset:13312
 ds_write_b128 v6, v[72:75] offset:14336
 ds_write_b128 v6, v[76:79] offset:15360
 s_waitcnt lgkmcnt(4)
 ds_write_b128 v6, v[80:83] offset:16384
 ds_write_b128 v6, v[84:87] offset:17408
 ds_write_b128 v6, v[88:91] offset:18432
 ds_write_b128 v6, v[92:95] offset:19456
sagain_2198:
 v_mov_b32 v3, 1572864
 s_mov_b32 s100, 0
pw_2199:
 buffer_load_dword v4, v3, s[4:7], 0 offen sc1
 s_add_u32 s100, s100, 1
 s_cmp_gt_u32 s100, 200000
 s_cbranch_scc1 main_fail
 s_waitcnt vmcnt(0)
 v_cmp_eq_u32 vcc, -1, v4
 s_cbranch_vccnz pw_2199
 v_readfirstlane_b32 s19, v4
 s_nop 1
 s_and_b32 s19, s19, 0x2000
 s_add_u32 s19, s19, s18
 s_add_u32 s36, s19, 0
 s_add_u32 s37, s19, 131072
 s_add_u32 s38, s19, 262144
 s_add_u32 s39, s19, 393216
 s_mov_b32 s31, 0
 s_mul_i32 s25, s20, 12288
 s_add_u32 s25, s25, 53346304
 s_mul_i32 s26, s20, 6144
 s_add_u32 s26, s26, 208535552
 s_lshl_b32 s32, s20, 7
 s_add_u32 s33, s32, 0
 s_add_u32 s33, s33, s3
 s_add_u32 s32, s32, 12288
 s_add_u32 s32, s32, s3
 s_mov_b32 s34, 0
 s_mov_b32 s28, 24576
 v_bfe_u32 v111, v0, 0, 6
 v_lshlrev_b32 v5, 4, v111
 v_mov_b32 v7, 384
 v_bfe_u32 v111, v0, 0, 4
 v_lshl_add_u32 v7, v111, 3, v7
 v_bfe_u32 v111, v0, 4, 1
 s_mov_b32 s101, 1568
 v_mad_u32_u24 v7, v111, s101, v7
 v_bfe_u32 v111, v0, 5, 1
 s_mov_b32 s101, 3200
 v_mad_u32_u24 v7, v111, s101, v7
 v_bfe_u32 v111, v0, 4, 2
 v_lshlrev_b32 v8, 6, v111
 v_bfe_u32 v111, v0, 2, 2
 v_lshl_add_u32 v8, v111, 3, v8
 v_bfe_u32 v111, v0, 0, 1
 s_mov_b32 s101, 1568
 v_mad_u32_u24 v8, v111, s101, v8
 v_bfe_u32 v111, v0, 1, 1
 s_mov_b32 s101, 3200
 v_mad_u32_u24 v8, v111, s101, v8
 v_and_b32 v111, 8, v0
 v_cmp_eq_u32 vcc, 0, v111
 v_mov_b32 v111, 0xeeee
 v_mov_b32 v15, 0x4444
 v_cndmask_b32 v15, v111, v15, vcc
 s_mov_b32 s56, 0x3dd53b95
 v_mov_b32 v9, s32
 v_cmp_eq_u32 vcc, 64, v0
 v_mov_b32 v111, 0x80000000
 s_nop 0
 v_cndmask_b32 v9, v111, v9, vcc
s_2200:
 ds_read_b128 v[40:43], v6 offset:0
 ds_read_b128 v[44:47], v6 offset:1024
 ds_read_b128 v[48:51], v6 offset:2048
 ds_read_b128 v[52:55], v6 offset:3072
 ds_read_b128 v[56:59], v6 offset:4096
 ds_read_b128 v[60:63], v6 offset:5120
 ds_read_b128 v[64:67], v6 offset:6144
 ds_read_b128 v[68:71], v6 offset:7168
 ds_read_b128 v[72:75], v6 offset:8192
 ds_read_b128 v[76:79], v6 offset:9216
 s_add_u32 s51, s36, 0
 s_add_u32 s57, s36, 4096
 s_add_u32 s58, s36, 16384
 s_mov_b32 s99, 0
 s_waitcnt lgkmcnt(0)
 s_add_u32 s25, s25, 393216
 s_cmp_ge_u32 s31, 62
 s_cselect_b32 s25, 0x20000000, s25
 s_xor_b32 s35, s28, 61440
 s_add_u32 m0, s35, 3072
 s_add_u32 s89, s25, 3072
 s_barrier
 buffer_load_dwordx4 v[80:83], v5, s[4:7], s51 offen offset:1024 sc1
 v_mov_b32 v16, 0
 v_mov_b32 v17, 0
 v_mov_b32 v18, 0
 v_mov_b32 v19, 0
 v_mov_b32 v20, 0
 v_mov_b32 v21, 0
 v_mov_b32 v22, 0
 v_mov_b32 v23, 0
 buffer_load_dwordx4 v[84:87], v5, s[4:7], s57 offen offset:1024 sc1
 v_mov_b32 v24, 0
 v_mov_b32 v25, 0
 v_mov_b32 v26, 0
 v_mov_b32 v27, 0
 v_mov_b32 v28, 0
 v_mov_b32 v29, 0
 v_mov_b32 v30, 0
 v_mov_b32 v31, 0
 buffer_load_dwordx4 v[88:91], v5, s[4:7], s58 offen offset:1024 sc1
 v_mov_b32 v32, 0
 v_mov_b32 v33, 0
 v_mov_b32 v34, 0
 v_mov_b32 v35, 0
 v_mov_b32 v36, 0
 v_mov_b32 v37, 0
 v_mov_b32 v38, 0
 v_mov_b32 v39, 0
 s_waitcnt vmcnt(2)
 v_max3_u32 v108, v80, v81, v82
 v_max_u32 v108, v108, v83
 v_cmp_eq_u32 vcc, -1, v108
 s_cbranch_vccnz spl_2204
sst_2202:
 s_waitcnt vmcnt(2)
 v_smfmac_f32_16x16x64_bf16 v[16:19], v[80:83], v[112:119], v15
 ds_write_b128 v5, v[80:83] offset:1024
 v_smfmac_f32_16x16x64_bf16 v[20:23], v[80:83], v[184:191], v15
 v_max3_u32 v108, v80, v81, v82
 v_smfmac_f32_16x16x64_bf16 v[24:27], v[80:83], a[8:15], v15
 v_smfmac_f32_16x16x64_bf16 v[28:31], v[80:83], a[48:55], v15
 s_waitcnt vmcnt(1)
 ds_write_b128 v5, v[84:87] offset:5120
 v_smfmac_f32_16x16x64_bf16 v[32:35], v[80:83], v[40:47], v15
 v_max3_u32 v108, v108, v83, v84
 v_smfmac_f32_16x16x64_bf16 v[36:39], v[80:83], v[48:55], v15
 v_max3_u32 v108, v108, v85, v86
 v_smfmac_f32_16x16x64_bf16 v[16:19], v[84:87], v[120:127], v15
 v_smfmac_f32_16x16x64_bf16 v[20:23], v[84:87], v[192:199], v15
 s_waitcnt vmcnt(0)
 ds_write_b128 v5, v[88:91] offset:9216
 v_smfmac_f32_16x16x64_bf16 v[24:27], v[84:87], a[16:23], v15
 v_max3_u32 v108, v108, v87, v88
 v_max3_u32 v108, v108, v89, v90
 v_smfmac_f32_16x16x64_bf16 v[28:31], v[84:87], a[56:63], v15
 v_max_u32 v108, v108, v91
 v_cmp_eq_u32 vcc, -1, v108
 v_smfmac_f32_16x16x64_bf16 v[32:35], v[84:87], v[56:63], v15
 s_cbranch_vccnz srt_2203
 s_waitcnt lgkmcnt(0)
 s_barrier
 ds_read_b128 v[92:95], v5 offset:0
 v_smfmac_f32_16x16x64_bf16 v[36:39], v[84:87], v[64:71], v15
 ds_read_b128 v[96:99], v5 offset:2048
 v_smfmac_f32_16x16x64_bf16 v[16:19], v[88:91], v[72:79], v15
 ds_read_b128 v[100:103], v5 offset:3072
 v_smfmac_f32_16x16x64_bf16 v[20:23], v[88:91], v[200:207], v15
 ds_read_b128 v[104:107], v5 offset:4096
 v_smfmac_f32_16x16x64_bf16 v[24:27], v[88:91], a[24:31], v15
 ds_read_b128 v[80:83], v5 offset:6144
 v_smfmac_f32_16x16x64_bf16 v[28:31], v[88:91], a[64:71], v15
 ds_read_b128 v[84:87], v5 offset:7168
 v_smfmac_f32_16x16x64_bf16 v[32:35], v[88:91], a[128:135], v15
 v_smfmac_f32_16x16x64_bf16 v[36:39], v[88:91], a[192:199], v15
 ds_read_b128 v[88:91], v5 offset:8192
 s_waitcnt lgkmcnt(6)
 v_smfmac_f32_16x16x64_bf16 v[16:19], v[92:95], v[128:135], v15
 ds_read_b128 v[40:43], v6 offset:10240
 s_waitcnt lgkmcnt(6)
 v_smfmac_f32_16x16x64_bf16 v[16:19], v[96:99], v[136:143], v15
 ds_read_b128 v[44:47], v6 offset:11264
 s_waitcnt lgkmcnt(6)
 v_smfmac_f32_16x16x64_bf16 v[16:19], v[100:103], v[144:151], v15
 ds_read_b128 v[48:51], v6 offset:12288
 s_waitcnt lgkmcnt(6)
 v_smfmac_f32_16x16x64_bf16 v[16:19], v[104:107], v[152:159], v15
 ds_read_b128 v[52:55], v6 offset:13312
 s_waitcnt lgkmcnt(6)
 v_smfmac_f32_16x16x64_bf16 v[16:19], v[80:83], v[160:167], v15
 ds_read_b128 v[56:59], v6 offset:14336
 s_waitcnt lgkmcnt(6)
 v_smfmac_f32_16x16x64_bf16 v[16:19], v[84:87], v[168:175], v15
 ds_read_b128 v[60:63], v6 offset:15360
 s_waitcnt lgkmcnt(6)
 v_smfmac_f32_16x16x64_bf16 v[16:19], v[88:91], v[176:183], v15
 ds_read_b128 v[64:67], v6 offset:16384
 v_smfmac_f32_16x16x64_bf16 v[20:23], v[92:95], v[208:215], v15
 ds_read_b128 v[68:71], v6 offset:17408
 v_smfmac_f32_16x16x64_bf16 v[20:23], v[96:99], v[216:223], v15
 ds_read_b128 v[72:75], v6 offset:18432
 v_smfmac_f32_16x16x64_bf16 v[20:23], v[100:103], v[224:231], v15
 ds_read_b128 v[76:79], v6 offset:19456
 s_nop 0
 v_mul_f32 v16, s56, v16
 v_smfmac_f32_16x16x64_bf16 v[20:23], v[104:107], v[232:239], v15
 v_mul_f32 v17, s56, v17
 v_smfmac_f32_16x16x64_bf16 v[20:23], v[80:83], v[240:247], v15
 v_mul_f32 v18, s56, v18
 v_smfmac_f32_16x16x64_bf16 v[20:23], v[84:87], v[248:255], v15
 v_mul_f32 v19, s56, v19
 v_smfmac_f32_16x16x64_bf16 v[20:23], v[88:91], a[0:7], v15
 v_cvt_pk_bf16_f32 v16, v16, v17
 v_smfmac_f32_16x16x64_bf16 v[24:27], v[92:95], a[32:39], v15
 v_cvt_pk_bf16_f32 v17, v18, v19
 v_smfmac_f32_16x16x64_bf16 v[24:27], v[96:99], a[40:47], v15
 ds_write_b64 v7, v[16:17] offset:10240
 s_waitcnt lgkmcnt(1)
 v_smfmac_f32_16x16x64_bf16 v[24:27], v[100:103], v[40:47], v15
 s_nop 1
 v_mul_f32 v20, s56, v20
 v_smfmac_f32_16x16x64_bf16 v[24:27], v[104:107], v[48:55], v15
 v_mul_f32 v21, s56, v21
 v_smfmac_f32_16x16x64_bf16 v[24:27], v[80:83], v[56:63], v15
 v_mul_f32 v22, s56, v22
 v_smfmac_f32_16x16x64_bf16 v[24:27], v[84:87], v[64:71], v15
 v_mul_f32 v23, s56, v23
 v_smfmac_f32_16x16x64_bf16 v[24:27], v[88:91], v[72:79], v15
 v_cvt_pk_bf16_f32 v20, v20, v21
 v_smfmac_f32_16x16x64_bf16 v[28:31], v[92:95], a[72:79], v15
 v_cvt_pk_bf16_f32 v21, v22, v23
 v_smfmac_f32_16x16x64_bf16 v[28:31], v[96:99], a[80:87], v15
 ds_write_b64 v7, v[20:21] offset:10368
 v_smfmac_f32_16x16x64_bf16 v[28:31], v[100:103], a[88:95], v15
 s_nop 1
 v_mul_f32 v24, s56, v24
 v_smfmac_f32_16x16x64_bf16 v[28:31], v[104:107], a[96:103], v15
 buffer_load_dwordx4 v5, s[4:7], s89 offen offset:0 sc1 lds
 v_mul_f32 v25, s56, v25
 v_smfmac_f32_16x16x64_bf16 v[28:31], v[80:83], a[104:111], v15
 buffer_load_dwordx4 v5, s[4:7], s89 offen offset:1024 sc1 lds
 v_mul_f32 v26, s56, v26
 v_smfmac_f32_16x16x64_bf16 v[28:31], v[84:87], a[112:119], v15
 buffer_load_dwordx4 v5, s[4:7], s89 offen offset:2048 sc1 lds
 v_mul_f32 v27, s56, v27
 v_smfmac_f32_16x16x64_bf16 v[28:31], v[88:91], a[120:127], v15
 v_cvt_pk_bf16_f32 v24, v24, v25
 v_smfmac_f32_16x16x64_bf16 v[32:35], v[92:95], a[136:143], v15
 v_cvt_pk_bf16_f32 v25, v26, v27
 v_smfmac_f32_16x16x64_bf16 v[32:35], v[96:99], a[144:151], v15
 ds_write_b64 v7, v[24:25] offset:10496
 v_smfmac_f32_16x16x64_bf16 v[32:35], v[100:103], a[152:159], v15
 s_nop 1
 v_cvt_pk_bf16_f32 v28, v28, v29
 v_smfmac_f32_16x16x64_bf16 v[32:35], v[104:107], a[160:167], v15
 v_cvt_pk_bf16_f32 v29, v30, v31
 v_smfmac_f32_16x16x64_bf16 v[32:35], v[80:83], a[168:175], v15
 ds_write_b64 v7, v[28:29] offset:16640
 v_smfmac_f32_16x16x64_bf16 v[32:35], v[84:87], a[176:183], v15
 s_waitcnt lgkmcnt(1)
 s_barrier
 v_smfmac_f32_16x16x64_bf16 v[32:35], v[88:91], a[184:191], v15
 v_smfmac_f32_16x16x64_bf16 v[36:39], v[92:95], a[200:207], v15
 s_nop 2
 v_smfmac_f32_16x16x64_bf16 v[36:39], v[96:99], a[208:215], v15
 v_smfmac_f32_16x16x64_bf16 v[36:39], v[100:103], a[216:223], v15
 s_nop 1
 v_cvt_pk_bf16_f32 v32, v32, v33
 v_smfmac_f32_16x16x64_bf16 v[36:39], v[104:107], a[224:231], v15
 v_cvt_pk_bf16_f32 v33, v34, v35
 v_smfmac_f32_16x16x64_bf16 v[36:39], v[80:83], a[232:239], v15
 ds_write_b64 v7, v[32:33] offset:16768
 v_smfmac_f32_16x16x64_bf16 v[36:39], v[84:87], a[240:247], v15
 v_smfmac_f32_16x16x64_bf16 v[36:39], v[88:91], a[248:255], v15
 s_nop 7
 v_cvt_pk_bf16_f32 v36, v36, v37
 v_cvt_pk_bf16_f32 v37, v38, v39
 ds_write_b64 v7, v[36:37] offset:16896
 s_waitcnt lgkmcnt(0)
 s_barrier
 ds_read_b64_tr_b16 v[56:57], v8 offset:16640
 ds_read_b64_tr_b16 v[58:59], v8 offset:16672
 ds_read_b64_tr_b16 v[60:61], v8 offset:16896
 ds_read_b64_tr_b16 v[62:63], v8 offset:16928
 ds_read_b64_tr_b16 v[64:65], v8 offset:17152
 ds_read_b64_tr_b16 v[66:67], v8 offset:17184
 ds_read_b64_tr_b16 v[68:69], v8 offset:17408
 ds_read_b64_tr_b16 v[70:71], v8 offset:17440
 ds_read_b64_tr_b16 v[72:73], v8 offset:17664
 ds_read_b64_tr_b16 v[74:75], v8 offset:17696
 ds_read_b64_tr_b16 v[76:77], v8 offset:17920
 ds_read_b64_tr_b16 v[78:79], v8 offset:17952
 s_add_u32 s29, s31, 1
 v_mov_b32 v10, s29
 s_add_u32 s30, s26, 4096
 s_waitcnt lgkmcnt(0)
 s_barrier
 buffer_store_dwordx4 v[56:59], v5, s[4:7], s26 offen offset:0 sc1
 buffer_store_dwordx4 v[60:63], v5, s[4:7], s26 offen offset:1024 sc1
 buffer_store_dwordx4 v[64:67], v5, s[4:7], s26 offen offset:2048 sc1
 buffer_store_dwordx4 v[68:71], v5, s[4:7], s26 offen offset:3072 sc1
 buffer_store_dwordx4 v[72:75], v5, s[4:7], s30 offen offset:0 sc1
 buffer_store_dwordx4 v[76:79], v5, s[4:7], s30 offen offset:1024 sc1
 s_add_u32 s26, s26, 196608
 s_waitcnt vmcnt(0)
 buffer_store_dword v10, v9, s[4:7], 0 offen sc1
 s_xor_b32 s28, s28, 61440
 s_mov_b32 s30, s36
 s_mov_b32 s36, s37
 s_mov_b32 s37, s38
 s_mov_b32 s38, s39
 s_mov_b32 s39, s30
 s_add_u32 s31, s31, 1
 s_cmp_lt_u32 s31, 64
 s_cbranch_scc1 s_2200
sdone_2201:
 s_cmp_lg_u32 s98, 0
 s_cbranch_scc1 g2_task
 s_mov_b32 s98, 1
 s_add_u32 s3, s3, 655360
 s_add_u32 s18, s18, 655360
 s_waitcnt vmcnt(0) lgkmcnt(0)
 s_barrier
 s_branch sagain_2198
srt_2203:
 s_waitcnt lgkmcnt(0)
mr_2205:
 buffer_load_dwordx4 v[80:83], v5, s[4:7], s51 offen offset:1024 sc1
 buffer_load_dwordx4 v[84:87], v5, s[4:7], s57 offen offset:1024 sc1
 buffer_load_dwordx4 v[88:91], v5, s[4:7], s58 offen offset:1024 sc1
 s_add_u32 s99, s99, 1
 s_cmp_gt_u32 s99, 200000
 s_cbranch_scc1 main_fail
 s_waitcnt vmcnt(0)
 v_max3_u32 v108, v80, v81, v82
 v_max3_u32 v108, v108, v83, v84
 v_max3_u32 v108, v108, v85, v86
 v_max3_u32 v108, v108, v87, v88
 v_max3_u32 v108, v108, v89, v90
 v_max_u32 v108, v108, v91
 v_cmp_eq_u32 vcc, -1, v108
 s_cbranch_vccnz mr_2205
 v_mov_b32 v16, 0
 v_mov_b32 v17, 0
 v_mov_b32 v18, 0
 v_mov_b32 v19, 0
 v_mov_b32 v20, 0
 v_mov_b32 v21, 0
 v_mov_b32 v22, 0
 v_mov_b32 v23, 0
 v_mov_b32 v24, 0
 v_mov_b32 v25, 0
 v_mov_b32 v26, 0
 v_mov_b32 v27, 0
 v_mov_b32 v28, 0
 v_mov_b32 v29, 0
 v_mov_b32 v30, 0
 v_mov_b32 v31, 0
 v_mov_b32 v32, 0
 v_mov_b32 v33, 0
 v_mov_b32 v34, 0
 v_mov_b32 v35, 0
 v_mov_b32 v36, 0
 v_mov_b32 v37, 0
 v_mov_b32 v38, 0
 v_mov_b32 v39, 0
 s_branch sst_2202
spl_2204:
mp_2206:
 buffer_load_dwordx4 v[80:83], v5, s[4:7], s51 offen offset:1024 sc1
 s_waitcnt vmcnt(2)
 buffer_load_dwordx4 v[84:87], v5, s[4:7], s57 offen offset:1024 sc1
 s_waitcnt vmcnt(2)
 buffer_load_dwordx4 v[88:91], v5, s[4:7], s58 offen offset:1024 sc1
 s_add_u32 s99, s99, 1
 s_cmp_gt_u32 s99, 200000
 s_cbranch_scc1 main_fail
 s_waitcnt vmcnt(2)
 v_max3_u32 v108, v80, v81, v82
 v_max_u32 v108, v108, v83
 v_cmp_eq_u32 vcc, -1, v108
 s_cbranch_vccnz mp_2206
 s_branch sst_2202
sw_2187:
 s_add_u32 s89, s87, 0
 s_add_u32 m0, s88, 0
 s_nop 0
 buffer_load_dwordx4 v2, s[8:11], s89 offen lds
 s_add_u32 m0, s88, 1024
 s_nop 0
 buffer_load_dwordx4 v3, s[8:11], s89 offen lds
 s_add_u32 m0, s88, 2048
 s_nop 0
 buffer_load_dwordx4 v4, s[8:11], s89 offen lds
 s_add_u32 s89, s87, 98304
 s_add_u32 m0, s88, 3072
 s_nop 0
 buffer_load_dwordx4 v2, s[8:11], s89 offen lds
 s_add_u32 m0, s88, 4096
 s_nop 0
 buffer_load_dwordx4 v3, s[8:11], s89 offen lds
 s_add_u32 m0, s88, 5120
 s_nop 0
 buffer_load_dwordx4 v4, s[8:11], s89 offen lds
 s_add_u32 s89, s87, 786432
 s_add_u32 m0, s88, 24576
 s_nop 0
 buffer_load_dwordx4 v2, s[8:11], s89 offen lds
 s_add_u32 m0, s88, 25600
 s_nop 0
 buffer_load_dwordx4 v3, s[8:11], s89 offen lds
 s_add_u32 m0, s88, 26624
 s_nop 0
 buffer_load_dwordx4 v4, s[8:11], s89 offen lds
 s_add_u32 s89, s87, 884736
 s_add_u32 m0, s88, 27648
 s_nop 0
 buffer_load_dwordx4 v2, s[8:11], s89 offen lds
 s_add_u32 m0, s88, 28672
 s_nop 0
 buffer_load_dwordx4 v3, s[8:11], s89 offen lds
 s_add_u32 m0, s88, 29696
 s_nop 0
 buffer_load_dwordx4 v4, s[8:11], s89 offen lds
 s_add_u32 s89, s87, 1572864
 s_add_u32 m0, s88, 49152
 s_nop 0
 buffer_load_dwordx4 v2, s[8:11], s89 offen lds
 s_add_u32 m0, s88, 50176
 s_nop 0
 buffer_load_dwordx4 v3, s[8:11], s89 offen lds
 s_add_u32 m0, s88, 51200
 s_nop 0
 buffer_load_dwordx4 v4, s[8:11], s89 offen lds
 s_add_u32 s89, s87, 1671168
 s_add_u32 m0, s88, 52224
 s_nop 0
 buffer_load_dwordx4 v2, s[8:11], s89 offen lds
 s_add_u32 m0, s88, 53248
 s_nop 0
 buffer_load_dwordx4 v3, s[8:11], s89 offen lds
 s_add_u32 m0, s88, 54272
 s_nop 0
 buffer_load_dwordx4 v4, s[8:11], s89 offen lds
 s_add_u32 s89, s87, 2359296
 s_add_u32 m0, s88, 73728
 s_nop 0
 buffer_load_dwordx4 v2, s[8:11], s89 offen lds
 s_add_u32 m0, s88, 74752
 s_nop 0
 buffer_load_dwordx4 v3, s[8:11], s89 offen lds
 s_add_u32 m0, s88, 75776
 s_nop 0
 buffer_load_dwordx4 v4, s[8:11], s89 offen lds
 s_add_u32 s89, s87, 2457600
 s_add_u32 m0, s88, 76800
 s_nop 0
 buffer_load_dwordx4 v2, s[8:11], s89 offen lds
 s_add_u32 m0, s88, 77824
 s_nop 0
 buffer_load_dwordx4 v3, s[8:11], s89 offen lds
 s_add_u32 m0, s88, 78848
 s_nop 0
 buffer_load_dwordx4 v4, s[8:11], s89 offen lds
 s_add_u32 s89, s87, 3145728
 s_add_u32 m0, s88, 98304
 s_nop 0
 buffer_load_dwordx4 v2, s[8:11], s89 offen lds
 s_add_u32 m0, s88, 99328
 s_nop 0
 buffer_load_dwordx4 v3, s[8:11], s89 offen lds
 s_add_u32 m0, s88, 100352
 s_nop 0
 buffer_load_dwordx4 v4, s[8:11], s89 offen lds
 s_add_u32 s89, s87, 3244032
 s_add_u32 m0, s88, 101376
 s_nop 0
 buffer_load_dwordx4 v2, s[8:11], s89 offen lds
 s_add_u32 m0, s88, 102400
 s_nop 0
 buffer_load_dwordx4 v3, s[8:11], s89 offen lds
 s_add_u32 m0, s88, 103424
 s_nop 0
 buffer_load_dwordx4 v4, s[8:11], s89 offen lds
 s_waitcnt vmcnt(24)
 s_barrier
 s_add_u32 s89, s87, 3932160
 s_add_u32 m0, s88, 122880
 s_nop 0
 buffer_load_dwordx4 v2, s[8:11], s89 offen lds
 s_add_u32 m0, s88, 123904
 s_nop 0
 buffer_load_dwordx4 v3, s[8:11], s89 offen lds
 s_add_u32 m0, s88, 124928
 s_nop 0
 buffer_load_dwordx4 v4, s[8:11], s89 offen lds
 s_add_u32 s89, s87, 4030464
 s_add_u32 m0, s88, 125952
 s_nop 0
 buffer_load_dwordx4 v2, s[8:11], s89 offen lds
 s_add_u32 m0, s88, 126976
 s_nop 0
 buffer_load_dwordx4 v3, s[8:11], s89 offen lds
 s_add_u32 m0, s88, 128000
 s_nop 0
 buffer_load_dwordx4 v4, s[8:11], s89 offen lds
 v_add_u32 v7, 0, v5
 ds_read_b64_tr_b16 v[128:129], v7 offset:0
 ds_read_b64_tr_b16 v[130:131], v7 offset:768
 ds_read_b64_tr_b16 v[132:133], v7 offset:12288
 ds_read_b64_tr_b16 v[134:135], v7 offset:13056
 ds_read_b64_tr_b16 v[208:209], v7 offset:32
 ds_read_b64_tr_b16 v[210:211], v7 offset:800
 ds_read_b64_tr_b16 v[212:213], v7 offset:12320
 ds_read_b64_tr_b16 v[214:215], v7 offset:13088
 ds_read_b64_tr_b16 a[32:33], v7 offset:64
 ds_read_b64_tr_b16 a[34:35], v7 offset:832
 ds_read_b64_tr_b16 a[36:37], v7 offset:12352
 ds_read_b64_tr_b16 a[38:39], v7 offset:13120
 s_waitcnt lgkmcnt(0)
 s_waitcnt vmcnt(24)
 s_barrier
 s_add_u32 s89, s87, 4718592
 s_add_u32 m0, s88, 0
 s_nop 0
 buffer_load_dwordx4 v2, s[8:11], s89 offen lds
 s_add_u32 m0, s88, 1024
 s_nop 0
 buffer_load_dwordx4 v3, s[8:11], s89 offen lds
 s_add_u32 m0, s88, 2048
 s_nop 0
 buffer_load_dwordx4 v4, s[8:11], s89 offen lds
 s_add_u32 s89, s87, 4816896
 s_add_u32 m0, s88, 3072
 s_nop 0
 buffer_load_dwordx4 v2, s[8:11], s89 offen lds
 s_add_u32 m0, s88, 4096
 s_nop 0
 buffer_load_dwordx4 v3, s[8:11], s89 offen lds
 s_add_u32 m0, s88, 5120
 s_nop 0
 buffer_load_dwordx4 v4, s[8:11], s89 offen lds
 v_add_u32 v7, 24576, v5
 ds_read_b64_tr_b16 v[136:137], v7 offset:0
 ds_read_b64_tr_b16 v[138:139], v7 offset:768
 ds_read_b64_tr_b16 v[140:141], v7 offset:12288
 ds_read_b64_tr_b16 v[142:143], v7 offset:13056
 ds_read_b64_tr_b16 v[216:217], v7 offset:32
 ds_read_b64_tr_b16 v[218:219], v7 offset:800
 ds_read_b64_tr_b16 v[220:221], v7 offset:12320
 ds_read_b64_tr_b16 v[222:223], v7 offset:13088
 ds_read_b64_tr_b16 a[40:41], v7 offset:64
 ds_read_b64_tr_b16 a[42:43], v7 offset:832
 ds_read_b64_tr_b16 a[44:45], v7 offset:12352
 ds_read_b64_tr_b16 a[46:47], v7 offset:13120
 s_waitcnt lgkmcnt(0)
 s_waitcnt vmcnt(24)
 s_barrier
 s_add_u32 s89, s87, 5505024
 s_add_u32 m0, s88, 24576
 s_nop 0
 buffer_load_dwordx4 v2, s[8:11], s89 offen lds
 s_add_u32 m0, s88, 25600
 s_nop 0
 buffer_load_dwordx4 v3, s[8:11], s89 offen lds
 s_add_u32 m0, s88, 26624
 s_nop 0
 buffer_load_dwordx4 v4, s[8:11], s89 offen lds
 s_add_u32 s89, s87, 5603328
 s_add_u32 m0, s88, 27648
 s_nop 0
 buffer_load_dwordx4 v2, s[8:11], s89 offen lds
 s_add_u32 m0, s88, 28672
 s_nop 0
 buffer_load_dwordx4 v3, s[8:11], s89 offen lds
 s_add_u32 m0, s88, 29696
 s_nop 0
 buffer_load_dwordx4 v4, s[8:11], s89 offen lds
 v_add_u32 v7, 49152, v5
 ds_read_b64_tr_b16 v[112:113], v7 offset:0
 ds_read_b64_tr_b16 v[114:115], v7 offset:768
 ds_read_b64_tr_b16 v[116:117], v7 offset:12288
 ds_read_b64_tr_b16 v[118:119], v7 offset:13056
 ds_read_b64_tr_b16 v[184:185], v7 offset:32
 ds_read_b64_tr_b16 v[186:187], v7 offset:800
 ds_read_b64_tr_b16 v[188:189], v7 offset:12320
 ds_read_b64_tr_b16 v[190:191], v7 offset:13088
 ds_read_b64_tr_b16 a[8:9], v7 offset:64
 ds_read_b64_tr_b16 a[10:11], v7 offset:832
 ds_read_b64_tr_b16 a[12:13], v7 offset:12352
 ds_read_b64_tr_b16 a[14:15], v7 offset:13120
 s_waitcnt lgkmcnt(0)
 s_waitcnt vmcnt(24)
 s_barrier
 s_add_u32 s89, s87, 6291456
 s_add_u32 m0, s88, 49152
 s_nop 0
 buffer_load_dwordx4 v2, s[8:11], s89 offen lds
 s_add_u32 m0, s88, 50176
 s_nop 0
 buffer_load_dwordx4 v3, s[8:11], s89 offen lds
 s_add_u32 m0, s88, 51200
 s_nop 0
 buffer_load_dwordx4 v4, s[8:11], s89 offen lds
 s_add_u32 s89, s87, 6389760
 s_add_u32 m0, s88, 52224
 s_nop 0
 buffer_load_dwordx4 v2, s[8:11], s89 offen lds
 s_add_u32 m0, s88, 53248
 s_nop 0
 buffer_load_dwordx4 v3, s[8:11], s89 offen lds
 s_add_u32 m0, s88, 54272
 s_nop 0
 buffer_load_dwordx4 v4, s[8:11], s89 offen lds
 v_add_u32 v7, 73728, v5
 ds_read_b64_tr_b16 v[144:145], v7 offset:0
 ds_read_b64_tr_b16 v[146:147], v7 offset:768
 ds_read_b64_tr_b16 v[148:149], v7 offset:12288
 ds_read_b64_tr_b16 v[150:151], v7 offset:13056
 ds_read_b64_tr_b16 v[224:225], v7 offset:32
 ds_read_b64_tr_b16 v[226:227], v7 offset:800
 ds_read_b64_tr_b16 v[228:229], v7 offset:12320
 ds_read_b64_tr_b16 v[230:231], v7 offset:13088
 ds_read_b64_tr_b16 v[56:57], v7 offset:64
 ds_read_b64_tr_b16 v[58:59], v7 offset:832
 ds_read_b64_tr_b16 v[60:61], v7 offset:12352
 ds_read_b64_tr_b16 v[62:63], v7 offset:13120
 s_waitcnt lgkmcnt(0)
 s_waitcnt vmcnt(24)
 s_barrier
 s_add_u32 s89, s87, 7077888
 s_add_u32 m0, s88, 73728
 s_nop 0
 buffer_load_dwordx4 v2, s[8:11], s89 offen lds
 s_add_u32 m0, s88, 74752
 s_nop 0
 buffer_load_dwordx4 v3, s[8:11], s89 offen lds
 s_add_u32 m0, s88, 75776
 s_nop 0
 buffer_load_dwordx4 v4, s[8:11], s89 offen lds
 s_add_u32 s89, s87, 7176192
 s_add_u32 m0, s88, 76800
 s_nop 0
 buffer_load_dwordx4 v2, s[8:11], s89 offen lds
 s_add_u32 m0, s88, 77824
 s_nop 0
 buffer_load_dwordx4 v3, s[8:11], s89 offen lds
 s_add_u32 m0, s88, 78848
 s_nop 0
 buffer_load_dwordx4 v4, s[8:11], s89 offen lds
 v_add_u32 v7, 98304, v5
 ds_read_b64_tr_b16 v[152:153], v7 offset:0
 ds_read_b64_tr_b16 v[154:155], v7 offset:768
 ds_read_b64_tr_b16 v[156:157], v7 offset:12288
 ds_read_b64_tr_b16 v[158:159], v7 offset:13056
 ds_read_b64_tr_b16 v[232:233], v7 offset:32
 ds_read_b64_tr_b16 v[234:235], v7 offset:800
 ds_read_b64_tr_b16 v[236:237], v7 offset:12320
 ds_read_b64_tr_b16 v[238:239], v7 offset:13088
 ds_read_b64_tr_b16 v[64:65], v7 offset:64
 ds_read_b64_tr_b16 v[66:67], v7 offset:832
 ds_read_b64_tr_b16 v[68:69], v7 offset:12352
 ds_read_b64_tr_b16 v[70:71], v7 offset:13120
 s_waitcnt lgkmcnt(0)
 s_waitcnt vmcnt(24)
 s_barrier
 s_add_u32 s89, s87, 0
 s_add_u32 m0, s88, 98304
 s_nop 0
 buffer_load_dwordx4 v2, s[12:15], s89 offen lds
 s_add_u32 m0, s88, 99328
 s_nop 0
 buffer_load_dwordx4 v3, s[12:15], s89 offen lds
 s_add_u32 m0, s88, 100352
 s_nop 0
 buffer_load_dwordx4 v4, s[12:15], s89 offen lds
 s_add_u32 s89, s87, 98304
 s_add_u32 m0, s88, 101376
 s_nop 0
 buffer_load_dwordx4 v2, s[12:15], s89 offen lds
 s_add_u32 m0, s88, 102400
 s_nop 0
 buffer_load_dwordx4 v3, s[12:15], s89 offen lds
 s_add_u32 m0, s88, 103424
 s_nop 0
 buffer_load_dwordx4 v4, s[12:15], s89 offen lds
 v_add_u32 v7, 122880, v5
 ds_read_b64_tr_b16 v[160:161], v7 offset:0
 ds_read_b64_tr_b16 v[162:163], v7 offset:768
 ds_read_b64_tr_b16 v[164:165], v7 offset:12288
 ds_read_b64_tr_b16 v[166:167], v7 offset:13056
 ds_read_b64_tr_b16 v[240:241], v7 offset:32
 ds_read_b64_tr_b16 v[242:243], v7 offset:800
 ds_read_b64_tr_b16 v[244:245], v7 offset:12320
 ds_read_b64_tr_b16 v[246:247], v7 offset:13088
 ds_read_b64_tr_b16 v[72:73], v7 offset:64
 ds_read_b64_tr_b16 v[74:75], v7 offset:832
 ds_read_b64_tr_b16 v[76:77], v7 offset:12352
 ds_read_b64_tr_b16 v[78:79], v7 offset:13120
 s_waitcnt lgkmcnt(0)
 s_waitcnt vmcnt(24)
 s_barrier
 s_add_u32 s89, s87, 786432
 s_add_u32 m0, s88, 122880
 s_nop 0
 buffer_load_dwordx4 v2, s[12:15], s89 offen lds
 s_add_u32 m0, s88, 123904
 s_nop 0
 buffer_load_dwordx4 v3, s[12:15], s89 offen lds
 s_add_u32 m0, s88, 124928
 s_nop 0
 buffer_load_dwordx4 v4, s[12:15], s89 offen lds
 s_add_u32 s89, s87, 884736
 s_add_u32 m0, s88, 125952
 s_nop 0
 buffer_load_dwordx4 v2, s[12:15], s89 offen lds
 s_add_u32 m0, s88, 126976
 s_nop 0
 buffer_load_dwordx4 v3, s[12:15], s89 offen lds
 s_add_u32 m0, s88, 128000
 s_nop 0
 buffer_load_dwordx4 v4, s[12:15], s89 offen lds
 v_add_u32 v7, 0, v5
 ds_read_b64_tr_b16 v[120:121], v7 offset:0
 ds_read_b64_tr_b16 v[122:123], v7 offset:768
 ds_read_b64_tr_b16 v[124:125], v7 offset:12288
 ds_read_b64_tr_b16 v[126:127], v7 offset:13056
 ds_read_b64_tr_b16 v[192:193], v7 offset:32
 ds_read_b64_tr_b16 v[194:195], v7 offset:800
 ds_read_b64_tr_b16 v[196:197], v7 offset:12320
 ds_read_b64_tr_b16 v[198:199], v7 offset:13088
 ds_read_b64_tr_b16 a[16:17], v7 offset:64
 ds_read_b64_tr_b16 a[18:19], v7 offset:832
 ds_read_b64_tr_b16 a[20:21], v7 offset:12352
 ds_read_b64_tr_b16 a[22:23], v7 offset:13120
 s_waitcnt lgkmcnt(0)
 s_waitcnt vmcnt(24)
 s_barrier
 s_add_u32 s89, s87, 1572864
 s_add_u32 m0, s88, 0
 s_nop 0
 buffer_load_dwordx4 v2, s[12:15], s89 offen lds
 s_add_u32 m0, s88, 1024
 s_nop 0
 buffer_load_dwordx4 v3, s[12:15], s89 offen lds
 s_add_u32 m0, s88, 2048
 s_nop 0
 buffer_load_dwordx4 v4, s[12:15], s89 offen lds
 s_add_u32 s89, s87, 1671168
 s_add_u32 m0, s88, 3072
 s_nop 0
 buffer_load_dwordx4 v2, s[12:15], s89 offen lds
 s_add_u32 m0, s88, 4096
 s_nop 0
 buffer_load_dwordx4 v3, s[12:15], s89 offen lds
 s_add_u32 m0, s88, 5120
 s_nop 0
 buffer_load_dwordx4 v4, s[12:15], s89 offen lds
 v_add_u32 v7, 24576, v5
 ds_read_b64_tr_b16 v[168:169], v7 offset:0
 ds_read_b64_tr_b16 v[170:171], v7 offset:768
 ds_read_b64_tr_b16 v[172:173], v7 offset:12288
 ds_read_b64_tr_b16 v[174:175], v7 offset:13056
 ds_read_b64_tr_b16 v[248:249], v7 offset:32
 ds_read_b64_tr_b16 v[250:251], v7 offset:800
 ds_read_b64_tr_b16 v[252:253], v7 offset:12320
 ds_read_b64_tr_b16 v[254:255], v7 offset:13088
 ds_read_b64_tr_b16 v[80:81], v7 offset:64
 ds_read_b64_tr_b16 v[82:83], v7 offset:832
 ds_read_b64_tr_b16 v[84:85], v7 offset:12352
 ds_read_b64_tr_b16 v[86:87], v7 offset:13120
 s_waitcnt lgkmcnt(0)
 s_waitcnt vmcnt(24)
 s_barrier
 s_add_u32 s89, s87, 2359296
 s_add_u32 m0, s88, 24576
 s_nop 0
 buffer_load_dwordx4 v2, s[12:15], s89 offen lds
 s_add_u32 m0, s88, 25600
 s_nop 0
 buffer_load_dwordx4 v3, s[12:15], s89 offen lds
 s_add_u32 m0, s88, 26624
 s_nop 0
 buffer_load_dwordx4 v4, s[12:15], s89 offen lds
 s_add_u32 s89, s87, 2457600
 s_add_u32 m0, s88, 27648
 s_nop 0
 buffer_load_dwordx4 v2, s[12:15], s89 offen lds
 s_add_u32 m0, s88, 28672
 s_nop 0
 buffer_load_dwordx4 v3, s[12:15], s89 offen lds
 s_add_u32 m0, s88, 29696
 s_nop 0
 buffer_load_dwordx4 v4, s[12:15], s89 offen lds
 v_add_u32 v7, 49152, v5
 ds_read_b64_tr_b16 v[48:49], v7 offset:0
 ds_read_b64_tr_b16 v[50:51], v7 offset:768
 ds_read_b64_tr_b16 v[52:53], v7 offset:12288
 ds_read_b64_tr_b16 v[54:55], v7 offset:13056
 ds_read_b64_tr_b16 v[200:201], v7 offset:32
 ds_read_b64_tr_b16 v[202:203], v7 offset:800
 ds_read_b64_tr_b16 v[204:205], v7 offset:12320
 ds_read_b64_tr_b16 v[206:207], v7 offset:13088
 ds_read_b64_tr_b16 a[24:25], v7 offset:64
 ds_read_b64_tr_b16 a[26:27], v7 offset:832
 ds_read_b64_tr_b16 a[28:29], v7 offset:12352
 ds_read_b64_tr_b16 a[30:31], v7 offset:13120
 s_waitcnt lgkmcnt(0)
 s_waitcnt vmcnt(24)
 s_barrier
 s_add_u32 s89, s87, 3145728
 s_add_u32 m0, s88, 49152
 s_nop 0
 buffer_load_dwordx4 v2, s[12:15], s89 offen lds
 s_add_u32 m0, s88, 50176
 s_nop 0
 buffer_load_dwordx4 v3, s[12:15], s89 offen lds
 s_add_u32 m0, s88, 51200
 s_nop 0
 buffer_load_dwordx4 v4, s[12:15], s89 offen lds
 s_add_u32 s89, s87, 3244032
 s_add_u32 m0, s88, 52224
 s_nop 0
 buffer_load_dwordx4 v2, s[12:15], s89 offen lds
 s_add_u32 m0, s88, 53248
 s_nop 0
 buffer_load_dwordx4 v3, s[12:15], s89 offen lds
 s_add_u32 m0, s88, 54272
 s_nop 0
 buffer_load_dwordx4 v4, s[12:15], s89 offen lds
 v_add_u32 v7, 73728, v5
 ds_read_b64_tr_b16 v[176:177], v7 offset:0
 ds_read_b64_tr_b16 v[178:179], v7 offset:768
 ds_read_b64_tr_b16 v[180:181], v7 offset:12288
 ds_read_b64_tr_b16 v[182:183], v7 offset:13056
 ds_read_b64_tr_b16 a[0:1], v7 offset:32
 ds_read_b64_tr_b16 a[2:3], v7 offset:800
 ds_read_b64_tr_b16 a[4:5], v7 offset:12320
 ds_read_b64_tr_b16 a[6:7], v7 offset:13088
 ds_read_b64_tr_b16 v[88:89], v7 offset:64
 ds_read_b64_tr_b16 v[90:91], v7 offset:832
 ds_read_b64_tr_b16 v[92:93], v7 offset:12352
 ds_read_b64_tr_b16 v[94:95], v7 offset:13120
 s_waitcnt lgkmcnt(0)
 s_waitcnt vmcnt(24)
 s_barrier
 s_add_u32 s89, s87, 3932160
 s_add_u32 m0, s88, 73728
 s_nop 0
 buffer_load_dwordx4 v2, s[12:15], s89 offen lds
 s_add_u32 m0, s88, 74752
 s_nop 0
 buffer_load_dwordx4 v3, s[12:15], s89 offen lds
 s_add_u32 m0, s88, 75776
 s_nop 0
 buffer_load_dwordx4 v4, s[12:15], s89 offen lds
 s_add_u32 s89, s87, 4030464
 s_add_u32 m0, s88, 76800
 s_nop 0
 buffer_load_dwordx4 v2, s[12:15], s89 offen lds
 s_add_u32 m0, s88, 77824
 s_nop 0
 buffer_load_dwordx4 v3, s[12:15], s89 offen lds
 s_add_u32 m0, s88, 78848
 s_nop 0
 buffer_load_dwordx4 v4, s[12:15], s89 offen lds
 v_add_u32 v7, 98304, v5
 ds_read_b64_tr_b16 a[72:73], v7 offset:0
 ds_read_b64_tr_b16 a[74:75], v7 offset:768
 ds_read_b64_tr_b16 a[76:77], v7 offset:12288
 ds_read_b64_tr_b16 a[78:79], v7 offset:13056
 ds_read_b64_tr_b16 a[136:137], v7 offset:32
 ds_read_b64_tr_b16 a[138:139], v7 offset:800
 ds_read_b64_tr_b16 a[140:141], v7 offset:12320
 ds_read_b64_tr_b16 a[142:143], v7 offset:13088
 ds_read_b64_tr_b16 a[200:201], v7 offset:64
 ds_read_b64_tr_b16 a[202:203], v7 offset:832
 ds_read_b64_tr_b16 a[204:205], v7 offset:12352
 ds_read_b64_tr_b16 a[206:207], v7 offset:13120
 s_waitcnt lgkmcnt(0)
 s_waitcnt vmcnt(24)
 s_barrier
 s_add_u32 s89, s87, 4718592
 s_add_u32 m0, s88, 98304
 s_nop 0
 buffer_load_dwordx4 v2, s[12:15], s89 offen lds
 s_add_u32 m0, s88, 99328
 s_nop 0
 buffer_load_dwordx4 v3, s[12:15], s89 offen lds
 s_add_u32 m0, s88, 100352
 s_nop 0
 buffer_load_dwordx4 v4, s[12:15], s89 offen lds
 s_add_u32 s89, s87, 4816896
 s_add_u32 m0, s88, 101376
 s_nop 0
 buffer_load_dwordx4 v2, s[12:15], s89 offen lds
 s_add_u32 m0, s88, 102400
 s_nop 0
 buffer_load_dwordx4 v3, s[12:15], s89 offen lds
 s_add_u32 m0, s88, 103424
 s_nop 0
 buffer_load_dwordx4 v4, s[12:15], s89 offen lds
 v_add_u32 v7, 122880, v5
 ds_read_b64_tr_b16 a[80:81], v7 offset:0
 ds_read_b64_tr_b16 a[82:83], v7 offset:768
 ds_read_b64_tr_b16 a[84:85], v7 offset:12288
 ds_read_b64_tr_b16 a[86:87], v7 offset:13056
 ds_read_b64_tr_b16 a[144:145], v7 offset:32
 ds_read_b64_tr_b16 a[146:147], v7 offset:800
 ds_read_b64_tr_b16 a[148:149], v7 offset:12320
 ds_read_b64_tr_b16 a[150:151], v7 offset:13088
 ds_read_b64_tr_b16 a[208:209], v7 offset:64
 ds_read_b64_tr_b16 a[210:211], v7 offset:832
 ds_read_b64_tr_b16 a[212:213], v7 offset:12352
 ds_read_b64_tr_b16 a[214:215], v7 offset:13120
 s_waitcnt lgkmcnt(0)
 s_waitcnt vmcnt(24)
 s_barrier
 s_add_u32 s89, s87, 5505024
 s_add_u32 m0, s88, 122880
 s_nop 0
 buffer_load_dwordx4 v2, s[12:15], s89 offen lds
 s_add_u32 m0, s88, 123904
 s_nop 0
 buffer_load_dwordx4 v3, s[12:15], s89 offen lds
 s_add_u32 m0, s88, 124928
 s_nop 0
 buffer_load_dwordx4 v4, s[12:15], s89 offen lds
 s_add_u32 s89, s87, 5603328
 s_add_u32 m0, s88, 125952
 s_nop 0
 buffer_load_dwordx4 v2, s[12:15], s89 offen lds
 s_add_u32 m0, s88, 126976
 s_nop 0
 buffer_load_dwordx4 v3, s[12:15], s89 offen lds
 s_add_u32 m0, s88, 128000
 s_nop 0
 buffer_load_dwordx4 v4, s[12:15], s89 offen lds
 v_add_u32 v7, 0, v5
 ds_read_b64_tr_b16 a[48:49], v7 offset:0
 ds_read_b64_tr_b16 a[50:51], v7 offset:768
 ds_read_b64_tr_b16 a[52:53], v7 offset:12288
 ds_read_b64_tr_b16 a[54:55], v7 offset:13056
 ds_read_b64_tr_b16 v[16:17], v7 offset:32
 ds_read_b64_tr_b16 v[18:19], v7 offset:800
 ds_read_b64_tr_b16 v[20:21], v7 offset:12320
 ds_read_b64_tr_b16 v[22:23], v7 offset:13088
 ds_read_b64_tr_b16 v[24:25], v7 offset:64
 ds_read_b64_tr_b16 v[26:27], v7 offset:832
 ds_read_b64_tr_b16 v[28:29], v7 offset:12352
 ds_read_b64_tr_b16 v[30:31], v7 offset:13120
 s_waitcnt lgkmcnt(0)
 s_waitcnt vmcnt(24)
 s_barrier
 s_add_u32 s89, s87, 6291456
 s_add_u32 m0, s88, 0
 s_nop 0
 buffer_load_dwordx4 v2, s[12:15], s89 offen lds
 s_add_u32 m0, s88, 1024
 s_nop 0
 buffer_load_dwordx4 v3, s[12:15], s89 offen lds
 s_add_u32 m0, s88, 2048
 s_nop 0
 buffer_load_dwordx4 v4, s[12:15], s89 offen lds
 s_add_u32 s89, s87, 6389760
 s_add_u32 m0, s88, 3072
 s_nop 0
 buffer_load_dwordx4 v2, s[12:15], s89 offen lds
 s_add_u32 m0, s88, 4096
 s_nop 0
 buffer_load_dwordx4 v3, s[12:15], s89 offen lds
 s_add_u32 m0, s88, 5120
 s_nop 0
 buffer_load_dwordx4 v4, s[12:15], s89 offen lds
 v_add_u32 v7, 24576, v5
 ds_read_b64_tr_b16 a[88:89], v7 offset:0
 ds_read_b64_tr_b16 a[90:91], v7 offset:768
 ds_read_b64_tr_b16 a[92:93], v7 offset:12288
 ds_read_b64_tr_b16 a[94:95], v7 offset:13056
 ds_read_b64_tr_b16 a[152:153], v7 offset:32
 ds_read_b64_tr_b16 a[154:155], v7 offset:800
 ds_read_b64_tr_b16 a[156:157], v7 offset:12320
 ds_read_b64_tr_b16 a[158:159], v7 offset:13088
 ds_read_b64_tr_b16 a[216:217], v7 offset:64
 ds_read_b64_tr_b16 a[218:219], v7 offset:832
 ds_read_b64_tr_b16 a[220:221], v7 offset:12352
 ds_read_b64_tr_b16 a[222:223], v7 offset:13120
 s_waitcnt lgkmcnt(0)
 s_waitcnt vmcnt(24)
 s_barrier
 s_add_u32 s89, s87, 7077888
 s_add_u32 m0, s88, 24576
 s_nop 0
 buffer_load_dwordx4 v2, s[12:15], s89 offen lds
 s_add_u32 m0, s88, 25600
 s_nop 0
 buffer_load_dwordx4 v3, s[12:15], s89 offen lds
 s_add_u32 m0, s88, 26624
 s_nop 0
 buffer_load_dwordx4 v4, s[12:15], s89 offen lds
 s_add_u32 s89, s87, 7176192
 s_add_u32 m0, s88, 27648
 s_nop 0
 buffer_load_dwordx4 v2, s[12:15], s89 offen lds
 s_add_u32 m0, s88, 28672
 s_nop 0
 buffer_load_dwordx4 v3, s[12:15], s89 offen lds
 s_add_u32 m0, s88, 29696
 s_nop 0
 buffer_load_dwordx4 v4, s[12:15], s89 offen lds
 v_add_u32 v7, 49152, v5
 ds_read_b64_tr_b16 a[96:97], v7 offset:0
 ds_read_b64_tr_b16 a[98:99], v7 offset:768
 ds_read_b64_tr_b16 a[100:101], v7 offset:12288
 ds_read_b64_tr_b16 a[102:103], v7 offset:13056
 ds_read_b64_tr_b16 a[160:161], v7 offset:32
 ds_read_b64_tr_b16 a[162:163], v7 offset:800
 ds_read_b64_tr_b16 a[164:165], v7 offset:12320
 ds_read_b64_tr_b16 a[166:167], v7 offset:13088
 ds_read_b64_tr_b16 a[224:225], v7 offset:64
 ds_read_b64_tr_b16 a[226:227], v7 offset:832
 ds_read_b64_tr_b16 a[228:229], v7 offset:12352
 ds_read_b64_tr_b16 a[230:231], v7 offset:13120
 s_waitcnt lgkmcnt(0)
 s_waitcnt vmcnt(24)
 s_barrier
 v_add_u32 v7, 73728, v5
 ds_read_b64_tr_b16 a[104:105], v7 offset:0
 ds_read_b64_tr_b16 a[106:107], v7 offset:768
 ds_read_b64_tr_b16 a[108:109], v7 offset:12288
 ds_read_b64_tr_b16 a[110:111], v7 offset:13056
 ds_read_b64_tr_b16 a[168:169], v7 offset:32
 ds_read_b64_tr_b16 a[170:171], v7 offset:800
 ds_read_b64_tr_b16 a[172:173], v7 offset:12320
 ds_read_b64_tr_b16 a[174:175], v7 offset:13088
 ds_read_b64_tr_b16 a[232:233], v7 offset:64
 ds_read_b64_tr_b16 a[234:235], v7 offset:832
 ds_read_b64_tr_b16 a[236:237], v7 offset:12352
 ds_read_b64_tr_b16 a[238:239], v7 offset:13120
 s_waitcnt lgkmcnt(0)
 s_waitcnt vmcnt(18)
 s_barrier
 v_add_u32 v7, 98304, v5
 ds_read_b64_tr_b16 a[56:57], v7 offset:0
 ds_read_b64_tr_b16 a[58:59], v7 offset:768
 ds_read_b64_tr_b16 a[60:61], v7 offset:12288
 ds_read_b64_tr_b16 a[62:63], v7 offset:13056
 ds_read_b64_tr_b16 v[32:33], v7 offset:32
 ds_read_b64_tr_b16 v[34:35], v7 offset:800
 ds_read_b64_tr_b16 v[36:37], v7 offset:12320
 ds_read_b64_tr_b16 v[38:39], v7 offset:13088
 ds_read_b64_tr_b16 v[40:41], v7 offset:64
 ds_read_b64_tr_b16 v[42:43], v7 offset:832
 ds_read_b64_tr_b16 v[44:45], v7 offset:12352
 ds_read_b64_tr_b16 v[46:47], v7 offset:13120
 s_waitcnt lgkmcnt(0)
 s_waitcnt vmcnt(12)
 s_barrier
 v_add_u32 v7, 122880, v5
 ds_read_b64_tr_b16 a[112:113], v7 offset:0
 ds_read_b64_tr_b16 a[114:115], v7 offset:768
 ds_read_b64_tr_b16 a[116:117], v7 offset:12288
 ds_read_b64_tr_b16 a[118:119], v7 offset:13056
 ds_read_b64_tr_b16 a[176:177], v7 offset:32
 ds_read_b64_tr_b16 a[178:179], v7 offset:800
 ds_read_b64_tr_b16 a[180:181], v7 offset:12320
 ds_read_b64_tr_b16 a[182:183], v7 offset:13088
 ds_read_b64_tr_b16 a[240:241], v7 offset:64
 ds_read_b64_tr_b16 a[242:243], v7 offset:832
 ds_read_b64_tr_b16 a[244:245], v7 offset:12352
 ds_read_b64_tr_b16 a[246:247], v7 offset:13120
 s_waitcnt lgkmcnt(0)
 s_waitcnt vmcnt(6)
 s_barrier
 v_add_u32 v7, 0, v5
 ds_read_b64_tr_b16 a[64:65], v7 offset:0
 ds_read_b64_tr_b16 a[66:67], v7 offset:768
 ds_read_b64_tr_b16 a[68:69], v7 offset:12288
 ds_read_b64_tr_b16 a[70:71], v7 offset:13056
 ds_read_b64_tr_b16 a[128:129], v7 offset:32
 ds_read_b64_tr_b16 a[130:131], v7 offset:800
 ds_read_b64_tr_b16 a[132:133], v7 offset:12320
 ds_read_b64_tr_b16 a[134:135], v7 offset:13088
 ds_read_b64_tr_b16 a[192:193], v7 offset:64
 ds_read_b64_tr_b16 a[194:195], v7 offset:832
 ds_read_b64_tr_b16 a[196:197], v7 offset:12352
 ds_read_b64_tr_b16 a[198:199], v7 offset:13120
 s_waitcnt lgkmcnt(0)
 s_waitcnt vmcnt(0)
 s_barrier
 v_add_u32 v7, 24576, v5
 ds_read_b64_tr_b16 a[120:121], v7 offset:0
 ds_read_b64_tr_b16 a[122:123], v7 offset:768
 ds_read_b64_tr_b16 a[124:125], v7 offset:12288
 ds_read_b64_tr_b16 a[126:127], v7 offset:13056
 ds_read_b64_tr_b16 a[184:185], v7 offset:32
 ds_read_b64_tr_b16 a[186:187], v7 offset:800
 ds_read_b64_tr_b16 a[188:189], v7 offset:12320
 ds_read_b64_tr_b16 a[190:191], v7 offset:13088
 ds_read_b64_tr_b16 a[248:249], v7 offset:64
 ds_read_b64_tr_b16 a[250:251], v7 offset:832
 ds_read_b64_tr_b16 a[252:253], v7 offset:12352
 ds_read_b64_tr_b16 a[254:255], v7 offset:13120
 s_waitcnt lgkmcnt(0)
 s_barrier
 ds_write_b128 v6, v[16:19] offset:0
 ds_write_b128 v6, v[20:23] offset:1024
 ds_write_b128 v6, v[24:27] offset:2048
 ds_write_b128 v6, v[28:31] offset:3072
 ds_write_b128 v6, v[32:35] offset:4096
 ds_write_b128 v6, v[36:39] offset:5120
 ds_write_b128 v6, v[40:43] offset:6144
 ds_write_b128 v6, v[44:47] offset:7168
 s_waitcnt lgkmcnt(4)
 ds_write_b128 v6, v[48:51] offset:8192
 ds_write_b128 v6, v[52:55] offset:9216
 ds_write_b128 v6, v[56:59] offset:10240
 ds_write_b128 v6, v[60:63] offset:11264
 ds_write_b128 v6, v[64:67] offset:12288
 ds_write_b128 v6, v[68:71] offset:13312
 ds_write_b128 v6, v[72:75] offset:14336
 ds_write_b128 v6, v[76:79] offset:15360
 s_waitcnt lgkmcnt(4)
 ds_write_b128 v6, v[80:83] offset:16384
 ds_write_b128 v6, v[84:87] offset:17408
 ds_write_b128 v6, v[88:91] offset:18432
 ds_write_b128 v6, v[92:95] offset:19456
sagain_2207:
 v_mov_b32 v3, 1572864
 s_mov_b32 s100, 0
pw_2208:
 buffer_load_dword v4, v3, s[4:7], 0 offen sc1
 s_add_u32 s100, s100, 1
 s_cmp_gt_u32 s100, 200000
 s_cbranch_scc1 main_fail
 s_waitcnt vmcnt(0)
 v_cmp_eq_u32 vcc, -1, v4
 s_cbranch_vccnz pw_2208
 v_readfirstlane_b32 s19, v4
 s_nop 1
 s_and_b32 s19, s19, 0x2000
 s_add_u32 s19, s19, s18
 s_add_u32 s36, s19, 0
 s_add_u32 s37, s19, 131072
 s_add_u32 s38, s19, 262144
 s_add_u32 s39, s19, 393216
 s_mov_b32 s31, 0
 s_mul_i32 s25, s20, 12288
 s_add_u32 s25, s25, 53346304
 s_mul_i32 s26, s20, 6144
 s_add_u32 s26, s26, 208535552
 s_lshl_b32 s32, s20, 7
 s_add_u32 s33, s32, 0
 s_add_u32 s33, s33, s3
 s_add_u32 s32, s32, 12288
 s_add_u32 s32, s32, s3
 s_mov_b32 s34, 0
 s_mov_b32 s28, 24576
 v_bfe_u32 v111, v0, 0, 6
 v_lshlrev_b32 v5, 4, v111
 v_mov_b32 v7, 768
 v_bfe_u32 v111, v0, 0, 4
 v_lshl_add_u32 v7, v111, 3, v7
 v_bfe_u32 v111, v0, 4, 1
 s_mov_b32 s101, 1568
 v_mad_u32_u24 v7, v111, s101, v7
 v_bfe_u32 v111, v0, 5, 1
 s_mov_b32 s101, 3200
 v_mad_u32_u24 v7, v111, s101, v7
 v_bfe_u32 v111, v0, 4, 2
 v_lshlrev_b32 v8, 6, v111
 v_bfe_u32 v111, v0, 2, 2
 v_lshl_add_u32 v8, v111, 3, v8
 v_bfe_u32 v111, v0, 0, 1
 s_mov_b32 s101, 1568
 v_mad_u32_u24 v8, v111, s101, v8
 v_bfe_u32 v111, v0, 1, 1
 s_mov_b32 s101, 3200
 v_mad_u32_u24 v8, v111, s101, v8
 v_and_b32 v111, 8, v0
 v_cmp_eq_u32 vcc, 0, v111
 v_mov_b32 v111, 0xeeee
 v_mov_b32 v15, 0x4444
 v_cndmask_b32 v15, v111, v15, vcc
 s_mov_b32 s56, 0x3dd53b95
 s_cmp_gt_u32 s34, 0
 s_cbranch_scc1 fw_done_2209
 s_mov_b32 s100, 0
fw_2210:
 s_load_dword s34, s[4:5], s33 glc
 s_add_u32 s100, s100, 1
 s_cmp_gt_u32 s100, 200000
 s_cbranch_scc1 main_fail
 s_waitcnt lgkmcnt(0)
 s_cmp_gt_u32 s34, 0
 s_cbranch_scc0 fw_2210
fw_done_2209:
 s_add_u32 m0, s28, 0
 s_add_u32 s89, s25, 0
 buffer_load_dwordx4 v5, s[4:7], s89 offen offset:0 sc1 lds
 buffer_load_dwordx4 v5, s[4:7], s89 offen offset:1024 sc1 lds
 buffer_load_dwordx4 v5, s[4:7], s89 offen offset:2048 sc1 lds
 buffer_load_dwordx4 v5, s[4:7], s89 offen offset:3072 sc1 lds
 s_add_u32 m0, s28, 4096
 s_add_u32 s89, s25, 4096
 buffer_load_dwordx4 v5, s[4:7], s89 offen offset:0 sc1 lds
 buffer_load_dwordx4 v5, s[4:7], s89 offen offset:1024 sc1 lds
 buffer_load_dwordx4 v5, s[4:7], s89 offen offset:2048 sc1 lds
 buffer_load_dwordx4 v5, s[4:7], s89 offen offset:3072 sc1 lds
 s_add_u32 m0, s28, 8192
 s_add_u32 s89, s25, 8192
 buffer_load_dwordx4 v5, s[4:7], s89 offen offset:0 sc1 lds
 buffer_load_dwordx4 v5, s[4:7], s89 offen offset:1024 sc1 lds
 buffer_load_dwordx4 v5, s[4:7], s89 offen offset:2048 sc1 lds
 buffer_load_dwordx4 v5, s[4:7], s89 offen offset:3072 sc1 lds
s_2211:
 ds_read_b128 v[40:43], v6 offset:0
 ds_read_b128 v[44:47], v6 offset:1024
 ds_read_b128 v[48:51], v6 offset:2048
 ds_read_b128 v[52:55], v6 offset:3072
 ds_read_b128 v[56:59], v6 offset:4096
 ds_read_b128 v[60:63], v6 offset:5120
 ds_read_b128 v[64:67], v6 offset:6144
 ds_read_b128 v[68:71], v6 offset:7168
 ds_read_b128 v[72:75], v6 offset:8192
 ds_read_b128 v[76:79], v6 offset:9216
 s_add_u32 s51, s36, 0
 s_add_u32 s57, s36, 4096
 s_add_u32 s58, s36, 16384
 s_mov_b32 s99, 0
 s_waitcnt lgkmcnt(0)
 s_add_u32 s29, s31, 1
 s_min_u32 s29, s29, 62
 s_cmp_gt_u32 s34, s29
 s_cbranch_scc1 fw_done_2215
 s_mov_b32 s100, 0
fw_2216:
 s_load_dword s34, s[4:5], s33 glc
 s_add_u32 s100, s100, 1
 s_cmp_gt_u32 s100, 200000
 s_cbranch_scc1 main_fail
 s_waitcnt lgkmcnt(0)
 s_cmp_gt_u32 s34, s29
 s_cbranch_scc0 fw_2216
fw_done_2215:
 s_add_u32 s25, s25, 393216
 s_cmp_ge_u32 s31, 62
 s_cselect_b32 s25, 0x20000000, s25
 s_xor_b32 s35, s28, 61440
 s_add_u32 m0, s35, 6144
 s_add_u32 s89, s25, 6144
 s_barrier
 buffer_load_dwordx4 v[80:83], v5, s[4:7], s51 offen offset:2048 sc1
 v_mov_b32 v16, 0
 v_mov_b32 v17, 0
 v_mov_b32 v18, 0
 v_mov_b32 v19, 0
 v_mov_b32 v20, 0
 v_mov_b32 v21, 0
 v_mov_b32 v22, 0
 v_mov_b32 v23, 0
 buffer_load_dwordx4 v[84:87], v5, s[4:7], s57 offen offset:2048 sc1
 v_mov_b32 v24, 0
 v_mov_b32 v25, 0
 v_mov_b32 v26, 0
 v_mov_b32 v27, 0
 v_mov_b32 v28, 0
 v_mov_b32 v29, 0
 v_mov_b32 v30, 0
 v_mov_b32 v31, 0
 buffer_load_dwordx4 v[88:91], v5, s[4:7], s58 offen offset:0 sc1
 v_mov_b32 v32, 0
 v_mov_b32 v33, 0
 v_mov_b32 v34, 0
 v_mov_b32 v35, 0
 v_mov_b32 v36, 0
 v_mov_b32 v37, 0
 v_mov_b32 v38, 0
 v_mov_b32 v39, 0
 s_waitcnt vmcnt(2)
 v_max3_u32 v108, v80, v81, v82
 v_max_u32 v108, v108, v83
 v_cmp_eq_u32 vcc, -1, v108
 s_cbranch_vccnz spl_2217
sst_2213:
 s_waitcnt vmcnt(2)
 v_smfmac_f32_16x16x64_bf16 v[16:19], v[80:83], v[112:119], v15
 ds_write_b128 v5, v[80:83] offset:2048
 v_smfmac_f32_16x16x64_bf16 v[20:23], v[80:83], v[184:191], v15
 v_max3_u32 v108, v80, v81, v82
 v_smfmac_f32_16x16x64_bf16 v[24:27], v[80:83], a[8:15], v15
 v_smfmac_f32_16x16x64_bf16 v[28:31], v[80:83], a[48:55], v15
 s_waitcnt vmcnt(1)
 ds_write_b128 v5, v[84:87] offset:6144
 v_smfmac_f32_16x16x64_bf16 v[32:35], v[80:83], v[40:47], v15
 v_max3_u32 v108, v108, v83, v84
 v_smfmac_f32_16x16x64_bf16 v[36:39], v[80:83], v[48:55], v15
 v_max3_u32 v108, v108, v85, v86
 v_smfmac_f32_16x16x64_bf16 v[16:19], v[84:87], v[120:127], v15
 v_smfmac_f32_16x16x64_bf16 v[20:23], v[84:87], v[192:199], v15
 s_waitcnt vmcnt(0)
 v_smfmac_f32_16x16x64_bf16 v[24:27], v[84:87], a[16:23], v15
 v_max3_u32 v108, v108, v87, v88
 v_max3_u32 v108, v108, v89, v90
 v_smfmac_f32_16x16x64_bf16 v[28:31], v[84:87], a[56:63], v15
 v_max_u32 v108, v108, v91
 v_cmp_eq_u32 vcc, -1, v108
 v_smfmac_f32_16x16x64_bf16 v[32:35], v[84:87], v[56:63], v15
 s_cbranch_vccnz srt_2214
 s_waitcnt lgkmcnt(0)
 s_barrier
 ds_read_b128 v[92:95], v5 offset:0
 v_smfmac_f32_16x16x64_bf16 v[36:39], v[84:87], v[64:71], v15
 ds_read_b128 v[96:99], v5 offset:1024
 v_smfmac_f32_16x16x64_bf16 v[16:19], v[88:91], v[72:79], v15
 ds_read_b128 v[100:103], v5 offset:3072
 v_smfmac_f32_16x16x64_bf16 v[20:23], v[88:91], v[200:207], v15
 ds_read_b128 v[104:107], v5 offset:4096
 v_smfmac_f32_16x16x64_bf16 v[24:27], v[88:91], a[24:31], v15
 ds_read_b128 v[80:83], v5 offset:5120
 v_smfmac_f32_16x16x64_bf16 v[28:31], v[88:91], a[64:71], v15
 ds_read_b128 v[84:87], v5 offset:7168
 v_smfmac_f32_16x16x64_bf16 v[32:35], v[88:91], a[128:135], v15
 v_smfmac_f32_16x16x64_bf16 v[36:39], v[88:91], a[192:199], v15
 ds_read_b128 v[88:91], v5 offset:9216
 s_waitcnt lgkmcnt(6)
 v_smfmac_f32_16x16x64_bf16 v[16:19], v[92:95], v[128:135], v15
 ds_read_b128 v[40:43], v6 offset:10240
 s_waitcnt lgkmcnt(6)
 v_smfmac_f32_16x16x64_bf16 v[16:19], v[96:99], v[136:143], v15
 ds_read_b128 v[44:47], v6 offset:11264
 s_waitcnt lgkmcnt(6)
 v_smfmac_f32_16x16x64_bf16 v[16:19], v[100:103], v[144:151], v15
 ds_read_b128 v[48:51], v6 offset:12288
 s_waitcnt lgkmcnt(6)
 v_smfmac_f32_16x16x64_bf16 v[16:19], v[104:107], v[152:159], v15
 ds_read_b128 v[52:55], v6 offset:13312
 s_waitcnt lgkmcnt(6)
 v_smfmac_f32_16x16x64_bf16 v[16:19], v[80:83], v[160:167], v15
 ds_read_b128 v[56:59], v6 offset:14336
 s_waitcnt lgkmcnt(6)
 v_smfmac_f32_16x16x64_bf16 v[16:19], v[84:87], v[168:175], v15
 ds_read_b128 v[60:63], v6 offset:15360
 s_waitcnt lgkmcnt(6)
 v_smfmac_f32_16x16x64_bf16 v[16:19], v[88:91], v[176:183], v15
 ds_read_b128 v[64:67], v6 offset:16384
 v_smfmac_f32_16x16x64_bf16 v[20:23], v[92:95], v[208:215], v15
 ds_read_b128 v[68:71], v6 offset:17408
 v_smfmac_f32_16x16x64_bf16 v[20:23], v[96:99], v[216:223], v15
 ds_read_b128 v[72:75], v6 offset:18432
 v_smfmac_f32_16x16x64_bf16 v[20:23], v[100:103], v[224:231], v15
 ds_read_b128 v[76:79], v6 offset:19456
 s_nop 0
 v_mul_f32 v16, s56, v16
 v_smfmac_f32_16x16x64_bf16 v[20:23], v[104:107], v[232:239], v15
 v_mul_f32 v17, s56, v17
 v_smfmac_f32_16x16x64_bf16 v[20:23], v[80:83], v[240:247], v15
 v_mul_f32 v18, s56, v18
 v_smfmac_f32_16x16x64_bf16 v[20:23], v[84:87], v[248:255], v15
 v_mul_f32 v19, s56, v19
 v_smfmac_f32_16x16x64_bf16 v[20:23], v[88:91], a[0:7], v15
 v_cvt_pk_bf16_f32 v16, v16, v17
 v_smfmac_f32_16x16x64_bf16 v[24:27], v[92:95], a[32:39], v15
 v_cvt_pk_bf16_f32 v17, v18, v19
 v_smfmac_f32_16x16x64_bf16 v[24:27], v[96:99], a[40:47], v15
 ds_write_b64 v7, v[16:17] offset:10240
 s_waitcnt lgkmcnt(1)
 v_smfmac_f32_16x16x64_bf16 v[24:27], v[100:103], v[40:47], v15
 s_nop 1
 v_mul_f32 v20, s56, v20
 v_smfmac_f32_16x16x64_bf16 v[24:27], v[104:107], v[48:55], v15
 v_mul_f32 v21, s56, v21
 v_smfmac_f32_16x16x64_bf16 v[24:27], v[80:83], v[56:63], v15
 v_mul_f32 v22, s56, v22
 v_smfmac_f32_16x16x64_bf16 v[24:27], v[84:87], v[64:71], v15
 v_mul_f32 v23, s56, v23
 v_smfmac_f32_16x16x64_bf16 v[24:27], v[88:91], v[72:79], v15
 v_cvt_pk_bf16_f32 v20, v20, v21
 v_smfmac_f32_16x16x64_bf16 v[28:31], v[92:95], a[72:79], v15
 v_cvt_pk_bf16_f32 v21, v22, v23
 v_smfmac_f32_16x16x64_bf16 v[28:31], v[96:99], a[80:87], v15
 ds_write_b64 v7, v[20:21] offset:10368
 v_smfmac_f32_16x16x64_bf16 v[28:31], v[100:103], a[88:95], v15
 s_nop 1
 v_mul_f32 v24, s56, v24
 v_smfmac_f32_16x16x64_bf16 v[28:31], v[104:107], a[96:103], v15
 buffer_load_dwordx4 v5, s[4:7], s89 offen offset:0 sc1 lds
 v_mul_f32 v25, s56, v25
 v_smfmac_f32_16x16x64_bf16 v[28:31], v[80:83], a[104:111], v15
 buffer_load_dwordx4 v5, s[4:7], s89 offen offset:1024 sc1 lds
 v_mul_f32 v26, s56, v26
 v_smfmac_f32_16x16x64_bf16 v[28:31], v[84:87], a[112:119], v15
 buffer_load_dwordx4 v5, s[4:7], s89 offen offset:2048 sc1 lds
 v_mul_f32 v27, s56, v27
 v_smfmac_f32_16x16x64_bf16 v[28:31], v[88:91], a[120:127], v15
 v_cvt_pk_bf16_f32 v24, v24, v25
 v_smfmac_f32_16x16x64_bf16 v[32:35], v[92:95], a[136:143], v15
 v_cvt_pk_bf16_f32 v25, v26, v27
 v_smfmac_f32_16x16x64_bf16 v[32:35], v[96:99], a[144:151], v15
 ds_write_b64 v7, v[24:25] offset:10496
 v_smfmac_f32_16x16x64_bf16 v[32:35], v[100:103], a[152:159], v15
 s_nop 1
 v_cvt_pk_bf16_f32 v28, v28, v29
 v_smfmac_f32_16x16x64_bf16 v[32:35], v[104:107], a[160:167], v15
 v_cvt_pk_bf16_f32 v29, v30, v31
 v_smfmac_f32_16x16x64_bf16 v[32:35], v[80:83], a[168:175], v15
 ds_write_b64 v7, v[28:29] offset:16640
 v_smfmac_f32_16x16x64_bf16 v[32:35], v[84:87], a[176:183], v15
 s_waitcnt lgkmcnt(1)
 s_barrier
 v_smfmac_f32_16x16x64_bf16 v[32:35], v[88:91], a[184:191], v15
 v_smfmac_f32_16x16x64_bf16 v[36:39], v[92:95], a[200:207], v15
 s_nop 2
 v_smfmac_f32_16x16x64_bf16 v[36:39], v[96:99], a[208:215], v15
 v_smfmac_f32_16x16x64_bf16 v[36:39], v[100:103], a[216:223], v15
 s_nop 1
 v_cvt_pk_bf16_f32 v32, v32, v33
 v_smfmac_f32_16x16x64_bf16 v[36:39], v[104:107], a[224:231], v15
 v_cvt_pk_bf16_f32 v33, v34, v35
 v_smfmac_f32_16x16x64_bf16 v[36:39], v[80:83], a[232:239], v15
 ds_write_b64 v7, v[32:33] offset:16768
 v_smfmac_f32_16x16x64_bf16 v[36:39], v[84:87], a[240:247], v15
 v_smfmac_f32_16x16x64_bf16 v[36:39], v[88:91], a[248:255], v15
 s_nop 7
 v_cvt_pk_bf16_f32 v36, v36, v37
 v_cvt_pk_bf16_f32 v37, v38, v39
 ds_write_b64 v7, v[36:37] offset:16896
 s_waitcnt lgkmcnt(0)
 s_barrier
 s_barrier
 s_xor_b32 s28, s28, 61440
 s_mov_b32 s30, s36
 s_mov_b32 s36, s37
 s_mov_b32 s37, s38
 s_mov_b32 s38, s39
 s_mov_b32 s39, s30
 s_add_u32 s31, s31, 1
 s_cmp_lt_u32 s31, 64
 s_cbranch_scc1 s_2211
sdone_2212:
 s_cmp_lg_u32 s98, 0
 s_cbranch_scc1 g2_task
 s_mov_b32 s98, 1
 s_add_u32 s3, s3, 655360
 s_add_u32 s18, s18, 655360
 s_waitcnt vmcnt(0) lgkmcnt(0)
 s_barrier
 s_branch sagain_2207
srt_2214:
 s_waitcnt lgkmcnt(0)
mr_2218:
 buffer_load_dwordx4 v[80:83], v5, s[4:7], s51 offen offset:2048 sc1
 buffer_load_dwordx4 v[84:87], v5, s[4:7], s57 offen offset:2048 sc1
 buffer_load_dwordx4 v[88:91], v5, s[4:7], s58 offen offset:0 sc1
 s_add_u32 s99, s99, 1
 s_cmp_gt_u32 s99, 200000
 s_cbranch_scc1 main_fail
 s_waitcnt vmcnt(0)
 v_max3_u32 v108, v80, v81, v82
 v_max3_u32 v108, v108, v83, v84
 v_max3_u32 v108, v108, v85, v86
 v_max3_u32 v108, v108, v87, v88
 v_max3_u32 v108, v108, v89, v90
 v_max_u32 v108, v108, v91
 v_cmp_eq_u32 vcc, -1, v108
 s_cbranch_vccnz mr_2218
 v_mov_b32 v16, 0
 v_mov_b32 v17, 0
 v_mov_b32 v18, 0
 v_mov_b32 v19, 0
 v_mov_b32 v20, 0
 v_mov_b32 v21, 0
 v_mov_b32 v22, 0
 v_mov_b32 v23, 0
 v_mov_b32 v24, 0
 v_mov_b32 v25, 0
 v_mov_b32 v26, 0
 v_mov_b32 v27, 0
 v_mov_b32 v28, 0
 v_mov_b32 v29, 0
 v_mov_b32 v30, 0
 v_mov_b32 v31, 0
 v_mov_b32 v32, 0
 v_mov_b32 v33, 0
 v_mov_b32 v34, 0
 v_mov_b32 v35, 0
 v_mov_b32 v36, 0
 v_mov_b32 v37, 0
 v_mov_b32 v38, 0
 v_mov_b32 v39, 0
 s_branch sst_2213
spl_2217:
mp_2219:
 buffer_load_dwordx4 v[80:83], v5, s[4:7], s51 offen offset:2048 sc1
 s_waitcnt vmcnt(2)
 buffer_load_dwordx4 v[84:87], v5, s[4:7], s57 offen offset:2048 sc1
 s_waitcnt vmcnt(2)
 buffer_load_dwordx4 v[88:91], v5, s[4:7], s58 offen offset:0 sc1
 s_add_u32 s99, s99, 1
 s_cmp_gt_u32 s99, 200000
 s_cbranch_scc1 main_fail
 s_waitcnt vmcnt(2)
 v_max3_u32 v108, v80, v81, v82
 v_max_u32 v108, v108, v83
 v_cmp_eq_u32 vcc, -1, v108
 s_cbranch_vccnz mp_2219
 s_branch sst_2213
sw_2188:
 s_add_u32 s89, s87, 0
 s_add_u32 m0, s88, 0
 s_nop 0
 buffer_load_dwordx4 v2, s[8:11], s89 offen lds
 s_add_u32 m0, s88, 1024
 s_nop 0
 buffer_load_dwordx4 v3, s[8:11], s89 offen lds
 s_add_u32 m0, s88, 2048
 s_nop 0
 buffer_load_dwordx4 v4, s[8:11], s89 offen lds
 s_add_u32 s89, s87, 98304
 s_add_u32 m0, s88, 3072
 s_nop 0
 buffer_load_dwordx4 v2, s[8:11], s89 offen lds
 s_add_u32 m0, s88, 4096
 s_nop 0
 buffer_load_dwordx4 v3, s[8:11], s89 offen lds
 s_add_u32 m0, s88, 5120
 s_nop 0
 buffer_load_dwordx4 v4, s[8:11], s89 offen lds
 s_add_u32 s89, s87, 786432
 s_add_u32 m0, s88, 24576
 s_nop 0
 buffer_load_dwordx4 v2, s[8:11], s89 offen lds
 s_add_u32 m0, s88, 25600
 s_nop 0
 buffer_load_dwordx4 v3, s[8:11], s89 offen lds
 s_add_u32 m0, s88, 26624
 s_nop 0
 buffer_load_dwordx4 v4, s[8:11], s89 offen lds
 s_add_u32 s89, s87, 884736
 s_add_u32 m0, s88, 27648
 s_nop 0
 buffer_load_dwordx4 v2, s[8:11], s89 offen lds
 s_add_u32 m0, s88, 28672
 s_nop 0
 buffer_load_dwordx4 v3, s[8:11], s89 offen lds
 s_add_u32 m0, s88, 29696
 s_nop 0
 buffer_load_dwordx4 v4, s[8:11], s89 offen lds
 s_add_u32 s89, s87, 1572864
 s_add_u32 m0, s88, 49152
 s_nop 0
 buffer_load_dwordx4 v2, s[8:11], s89 offen lds
 s_add_u32 m0, s88, 50176
 s_nop 0
 buffer_load_dwordx4 v3, s[8:11], s89 offen lds
 s_add_u32 m0, s88, 51200
 s_nop 0
 buffer_load_dwordx4 v4, s[8:11], s89 offen lds
 s_add_u32 s89, s87, 1671168
 s_add_u32 m0, s88, 52224
 s_nop 0
 buffer_load_dwordx4 v2, s[8:11], s89 offen lds
 s_add_u32 m0, s88, 53248
 s_nop 0
 buffer_load_dwordx4 v3, s[8:11], s89 offen lds
 s_add_u32 m0, s88, 54272
 s_nop 0
 buffer_load_dwordx4 v4, s[8:11], s89 offen lds
 s_add_u32 s89, s87, 2359296
 s_add_u32 m0, s88, 73728
 s_nop 0
 buffer_load_dwordx4 v2, s[8:11], s89 offen lds
 s_add_u32 m0, s88, 74752
 s_nop 0
 buffer_load_dwordx4 v3, s[8:11], s89 offen lds
 s_add_u32 m0, s88, 75776
 s_nop 0
 buffer_load_dwordx4 v4, s[8:11], s89 offen lds
 s_add_u32 s89, s87, 2457600
 s_add_u32 m0, s88, 76800
 s_nop 0
 buffer_load_dwordx4 v2, s[8:11], s89 offen lds
 s_add_u32 m0, s88, 77824
 s_nop 0
 buffer_load_dwordx4 v3, s[8:11], s89 offen lds
 s_add_u32 m0, s88, 78848
 s_nop 0
 buffer_load_dwordx4 v4, s[8:11], s89 offen lds
 s_add_u32 s89, s87, 3145728
 s_add_u32 m0, s88, 98304
 s_nop 0
 buffer_load_dwordx4 v2, s[8:11], s89 offen lds
 s_add_u32 m0, s88, 99328
 s_nop 0
 buffer_load_dwordx4 v3, s[8:11], s89 offen lds
 s_add_u32 m0, s88, 100352
 s_nop 0
 buffer_load_dwordx4 v4, s[8:11], s89 offen lds
 s_add_u32 s89, s87, 3244032
 s_add_u32 m0, s88, 101376
 s_nop 0
 buffer_load_dwordx4 v2, s[8:11], s89 offen lds
 s_add_u32 m0, s88, 102400
 s_nop 0
 buffer_load_dwordx4 v3, s[8:11], s89 offen lds
 s_add_u32 m0, s88, 103424
 s_nop 0
 buffer_load_dwordx4 v4, s[8:11], s89 offen lds
 s_waitcnt vmcnt(24)
 s_barrier
 s_add_u32 s89, s87, 3932160
 s_add_u32 m0, s88, 122880
 s_nop 0
 buffer_load_dwordx4 v2, s[8:11], s89 offen lds
 s_add_u32 m0, s88, 123904
 s_nop 0
 buffer_load_dwordx4 v3, s[8:11], s89 offen lds
 s_add_u32 m0, s88, 124928
 s_nop 0
 buffer_load_dwordx4 v4, s[8:11], s89 offen lds
 s_add_u32 s89, s87, 4030464
 s_add_u32 m0, s88, 125952
 s_nop 0
 buffer_load_dwordx4 v2, s[8:11], s89 offen lds
 s_add_u32 m0, s88, 126976
 s_nop 0
 buffer_load_dwordx4 v3, s[8:11], s89 offen lds
 s_add_u32 m0, s88, 128000
 s_nop 0
 buffer_load_dwordx4 v4, s[8:11], s89 offen lds
 v_add_u32 v7, 0, v5
 ds_read_b64_tr_b16 v[128:129], v7 offset:0
 ds_read_b64_tr_b16 v[130:131], v7 offset:768
 ds_read_b64_tr_b16 v[132:133], v7 offset:12288
 ds_read_b64_tr_b16 v[134:135], v7 offset:13056
 ds_read_b64_tr_b16 v[208:209], v7 offset:32
 ds_read_b64_tr_b16 v[210:211], v7 offset:800
 ds_read_b64_tr_b16 v[212:213], v7 offset:12320
 ds_read_b64_tr_b16 v[214:215], v7 offset:13088
 ds_read_b64_tr_b16 a[32:33], v7 offset:64
 ds_read_b64_tr_b16 a[34:35], v7 offset:832
 ds_read_b64_tr_b16 a[36:37], v7 offset:12352
 ds_read_b64_tr_b16 a[38:39], v7 offset:13120
 s_waitcnt lgkmcnt(0)
 s_waitcnt vmcnt(24)
 s_barrier
 s_add_u32 s89, s87, 4718592
 s_add_u32 m0, s88, 0
 s_nop 0
 buffer_load_dwordx4 v2, s[8:11], s89 offen lds
 s_add_u32 m0, s88, 1024
 s_nop 0
 buffer_load_dwordx4 v3, s[8:11], s89 offen lds
 s_add_u32 m0, s88, 2048
 s_nop 0
 buffer_load_dwordx4 v4, s[8:11], s89 offen lds
 s_add_u32 s89, s87, 4816896
 s_add_u32 m0, s88, 3072
 s_nop 0
 buffer_load_dwordx4 v2, s[8:11], s89 offen lds
 s_add_u32 m0, s88, 4096
 s_nop 0
 buffer_load_dwordx4 v3, s[8:11], s89 offen lds
 s_add_u32 m0, s88, 5120
 s_nop 0
 buffer_load_dwordx4 v4, s[8:11], s89 offen lds
 v_add_u32 v7, 24576, v5
 ds_read_b64_tr_b16 v[136:137], v7 offset:0
 ds_read_b64_tr_b16 v[138:139], v7 offset:768
 ds_read_b64_tr_b16 v[140:141], v7 offset:12288
 ds_read_b64_tr_b16 v[142:143], v7 offset:13056
 ds_read_b64_tr_b16 v[216:217], v7 offset:32
 ds_read_b64_tr_b16 v[218:219], v7 offset:800
 ds_read_b64_tr_b16 v[220:221], v7 offset:12320
 ds_read_b64_tr_b16 v[222:223], v7 offset:13088
 ds_read_b64_tr_b16 a[40:41], v7 offset:64
 ds_read_b64_tr_b16 a[42:43], v7 offset:832
 ds_read_b64_tr_b16 a[44:45], v7 offset:12352
 ds_read_b64_tr_b16 a[46:47], v7 offset:13120
 s_waitcnt lgkmcnt(0)
 s_waitcnt vmcnt(24)
 s_barrier
 s_add_u32 s89, s87, 5505024
 s_add_u32 m0, s88, 24576
 s_nop 0
 buffer_load_dwordx4 v2, s[8:11], s89 offen lds
 s_add_u32 m0, s88, 25600
 s_nop 0
 buffer_load_dwordx4 v3, s[8:11], s89 offen lds
 s_add_u32 m0, s88, 26624
 s_nop 0
 buffer_load_dwordx4 v4, s[8:11], s89 offen lds
 s_add_u32 s89, s87, 5603328
 s_add_u32 m0, s88, 27648
 s_nop 0
 buffer_load_dwordx4 v2, s[8:11], s89 offen lds
 s_add_u32 m0, s88, 28672
 s_nop 0
 buffer_load_dwordx4 v3, s[8:11], s89 offen lds
 s_add_u32 m0, s88, 29696
 s_nop 0
 buffer_load_dwordx4 v4, s[8:11], s89 offen lds
 v_add_u32 v7, 49152, v5
 ds_read_b64_tr_b16 v[144:145], v7 offset:0
 ds_read_b64_tr_b16 v[146:147], v7 offset:768
 ds_read_b64_tr_b16 v[148:149], v7 offset:12288
 ds_read_b64_tr_b16 v[150:151], v7 offset:13056
 ds_read_b64_tr_b16 v[224:225], v7 offset:32
 ds_read_b64_tr_b16 v[226:227], v7 offset:800
 ds_read_b64_tr_b16 v[228:229], v7 offset:12320
 ds_read_b64_tr_b16 v[230:231], v7 offset:13088
 ds_read_b64_tr_b16 v[56:57], v7 offset:64
 ds_read_b64_tr_b16 v[58:59], v7 offset:832
 ds_read_b64_tr_b16 v[60:61], v7 offset:12352
 ds_read_b64_tr_b16 v[62:63], v7 offset:13120
 s_waitcnt lgkmcnt(0)
 s_waitcnt vmcnt(24)
 s_barrier
 s_add_u32 s89, s87, 6291456
 s_add_u32 m0, s88, 49152
 s_nop 0
 buffer_load_dwordx4 v2, s[8:11], s89 offen lds
 s_add_u32 m0, s88, 50176
 s_nop 0
 buffer_load_dwordx4 v3, s[8:11], s89 offen lds
 s_add_u32 m0, s88, 51200
 s_nop 0
 buffer_load_dwordx4 v4, s[8:11], s89 offen lds
 s_add_u32 s89, s87, 6389760
 s_add_u32 m0, s88, 52224
 s_nop 0
 buffer_load_dwordx4 v2, s[8:11], s89 offen lds
 s_add_u32 m0, s88, 53248
 s_nop 0
 buffer_load_dwordx4 v3, s[8:11], s89 offen lds
 s_add_u32 m0, s88, 54272
 s_nop 0
 buffer_load_dwordx4 v4, s[8:11], s89 offen lds
 v_add_u32 v7, 73728, v5
 ds_read_b64_tr_b16 v[112:113], v7 offset:0
 ds_read_b64_tr_b16 v[114:115], v7 offset:768
 ds_read_b64_tr_b16 v[116:117], v7 offset:12288
 ds_read_b64_tr_b16 v[118:119], v7 offset:13056
 ds_read_b64_tr_b16 v[184:185], v7 offset:32
 ds_read_b64_tr_b16 v[186:187], v7 offset:800
 ds_read_b64_tr_b16 v[188:189], v7 offset:12320
 ds_read_b64_tr_b16 v[190:191], v7 offset:13088
 ds_read_b64_tr_b16 a[8:9], v7 offset:64
 ds_read_b64_tr_b16 a[10:11], v7 offset:832
 ds_read_b64_tr_b16 a[12:13], v7 offset:12352
 ds_read_b64_tr_b16 a[14:15], v7 offset:13120
 s_waitcnt lgkmcnt(0)
 s_waitcnt vmcnt(24)
 s_barrier
 s_add_u32 s89, s87, 7077888
 s_add_u32 m0, s88, 73728
 s_nop 0
 buffer_load_dwordx4 v2, s[8:11], s89 offen lds
 s_add_u32 m0, s88, 74752
 s_nop 0
 buffer_load_dwordx4 v3, s[8:11], s89 offen lds
 s_add_u32 m0, s88, 75776
 s_nop 0
 buffer_load_dwordx4 v4, s[8:11], s89 offen lds
 s_add_u32 s89, s87, 7176192
 s_add_u32 m0, s88, 76800
 s_nop 0
 buffer_load_dwordx4 v2, s[8:11], s89 offen lds
 s_add_u32 m0, s88, 77824
 s_nop 0
 buffer_load_dwordx4 v3, s[8:11], s89 offen lds
 s_add_u32 m0, s88, 78848
 s_nop 0
 buffer_load_dwordx4 v4, s[8:11], s89 offen lds
 v_add_u32 v7, 98304, v5
 ds_read_b64_tr_b16 v[152:153], v7 offset:0
 ds_read_b64_tr_b16 v[154:155], v7 offset:768
 ds_read_b64_tr_b16 v[156:157], v7 offset:12288
 ds_read_b64_tr_b16 v[158:159], v7 offset:13056
 ds_read_b64_tr_b16 v[232:233], v7 offset:32
 ds_read_b64_tr_b16 v[234:235], v7 offset:800
 ds_read_b64_tr_b16 v[236:237], v7 offset:12320
 ds_read_b64_tr_b16 v[238:239], v7 offset:13088
 ds_read_b64_tr_b16 v[64:65], v7 offset:64
 ds_read_b64_tr_b16 v[66:67], v7 offset:832
 ds_read_b64_tr_b16 v[68:69], v7 offset:12352
 ds_read_b64_tr_b16 v[70:71], v7 offset:13120
 s_waitcnt lgkmcnt(0)
 s_waitcnt vmcnt(24)
 s_barrier
 s_add_u32 s89, s87, 0
 s_add_u32 m0, s88, 98304
 s_nop 0
 buffer_load_dwordx4 v2, s[12:15], s89 offen lds
 s_add_u32 m0, s88, 99328
 s_nop 0
 buffer_load_dwordx4 v3, s[12:15], s89 offen lds
 s_add_u32 m0, s88, 100352
 s_nop 0
 buffer_load_dwordx4 v4, s[12:15], s89 offen lds
 s_add_u32 s89, s87, 98304
 s_add_u32 m0, s88, 101376
 s_nop 0
 buffer_load_dwordx4 v2, s[12:15], s89 offen lds
 s_add_u32 m0, s88, 102400
 s_nop 0
 buffer_load_dwordx4 v3, s[12:15], s89 offen lds
 s_add_u32 m0, s88, 103424
 s_nop 0
 buffer_load_dwordx4 v4, s[12:15], s89 offen lds
 v_add_u32 v7, 122880, v5
 ds_read_b64_tr_b16 v[160:161], v7 offset:0
 ds_read_b64_tr_b16 v[162:163], v7 offset:768
 ds_read_b64_tr_b16 v[164:165], v7 offset:12288
 ds_read_b64_tr_b16 v[166:167], v7 offset:13056
 ds_read_b64_tr_b16 v[240:241], v7 offset:32
 ds_read_b64_tr_b16 v[242:243], v7 offset:800
 ds_read_b64_tr_b16 v[244:245], v7 offset:12320
 ds_read_b64_tr_b16 v[246:247], v7 offset:13088
 ds_read_b64_tr_b16 v[72:73], v7 offset:64
 ds_read_b64_tr_b16 v[74:75], v7 offset:832
 ds_read_b64_tr_b16 v[76:77], v7 offset:12352
 ds_read_b64_tr_b16 v[78:79], v7 offset:13120
 s_waitcnt lgkmcnt(0)
 s_waitcnt vmcnt(24)
 s_barrier
 s_add_u32 s89, s87, 786432
 s_add_u32 m0, s88, 122880
 s_nop 0
 buffer_load_dwordx4 v2, s[12:15], s89 offen lds
 s_add_u32 m0, s88, 123904
 s_nop 0
 buffer_load_dwordx4 v3, s[12:15], s89 offen lds
 s_add_u32 m0, s88, 124928
 s_nop 0
 buffer_load_dwordx4 v4, s[12:15], s89 offen lds
 s_add_u32 s89, s87, 884736
 s_add_u32 m0, s88, 125952
 s_nop 0
 buffer_load_dwordx4 v2, s[12:15], s89 offen lds
 s_add_u32 m0, s88, 126976
 s_nop 0
 buffer_load_dwordx4 v3, s[12:15], s89 offen lds
 s_add_u32 m0, s88, 128000
 s_nop 0
 buffer_load_dwordx4 v4, s[12:15], s89 offen lds
 v_add_u32 v7, 0, v5
 ds_read_b64_tr_b16 v[168:169], v7 offset:0
 ds_read_b64_tr_b16 v[170:171], v7 offset:768
 ds_read_b64_tr_b16 v[172:173], v7 offset:12288
 ds_read_b64_tr_b16 v[174:175], v7 offset:13056
 ds_read_b64_tr_b16 v[248:249], v7 offset:32
 ds_read_b64_tr_b16 v[250:251], v7 offset:800
 ds_read_b64_tr_b16 v[252:253], v7 offset:12320
 ds_read_b64_tr_b16 v[254:255], v7 offset:13088
 ds_read_b64_tr_b16 v[80:81], v7 offset:64
 ds_read_b64_tr_b16 v[82:83], v7 offset:832
 ds_read_b64_tr_b16 v[84:85], v7 offset:12352
 ds_read_b64_tr_b16 v[86:87], v7 offset:13120
 s_waitcnt lgkmcnt(0)
 s_waitcnt vmcnt(24)
 s_barrier
 s_add_u32 s89, s87, 1572864
 s_add_u32 m0, s88, 0
 s_nop 0
 buffer_load_dwordx4 v2, s[12:15], s89 offen lds
 s_add_u32 m0, s88, 1024
 s_nop 0
 buffer_load_dwordx4 v3, s[12:15], s89 offen lds
 s_add_u32 m0, s88, 2048
 s_nop 0
 buffer_load_dwordx4 v4, s[12:15], s89 offen lds
 s_add_u32 s89, s87, 1671168
 s_add_u32 m0, s88, 3072
 s_nop 0
 buffer_load_dwordx4 v2, s[12:15], s89 offen lds
 s_add_u32 m0, s88, 4096
 s_nop 0
 buffer_load_dwordx4 v3, s[12:15], s89 offen lds
 s_add_u32 m0, s88, 5120
 s_nop 0
 buffer_load_dwordx4 v4, s[12:15], s89 offen lds
 v_add_u32 v7, 24576, v5
 ds_read_b64_tr_b16 v[120:121], v7 offset:0
 ds_read_b64_tr_b16 v[122:123], v7 offset:768
 ds_read_b64_tr_b16 v[124:125], v7 offset:12288
 ds_read_b64_tr_b16 v[126:127], v7 offset:13056
 ds_read_b64_tr_b16 v[192:193], v7 offset:32
 ds_read_b64_tr_b16 v[194:195], v7 offset:800
 ds_read_b64_tr_b16 v[196:197], v7 offset:12320
 ds_read_b64_tr_b16 v[198:199], v7 offset:13088
 ds_read_b64_tr_b16 a[16:17], v7 offset:64
 ds_read_b64_tr_b16 a[18:19], v7 offset:832
 ds_read_b64_tr_b16 a[20:21], v7 offset:12352
 ds_read_b64_tr_b16 a[22:23], v7 offset:13120
 s_waitcnt lgkmcnt(0)
 s_waitcnt vmcnt(24)
 s_barrier
 s_add_u32 s89, s87, 2359296
 s_add_u32 m0, s88, 24576
 s_nop 0
 buffer_load_dwordx4 v2, s[12:15], s89 offen lds
 s_add_u32 m0, s88, 25600
 s_nop 0
 buffer_load_dwordx4 v3, s[12:15], s89 offen lds
 s_add_u32 m0, s88, 26624
 s_nop 0
 buffer_load_dwordx4 v4, s[12:15], s89 offen lds
 s_add_u32 s89, s87, 2457600
 s_add_u32 m0, s88, 27648
 s_nop 0
 buffer_load_dwordx4 v2, s[12:15], s89 offen lds
 s_add_u32 m0, s88, 28672
 s_nop 0
 buffer_load_dwordx4 v3, s[12:15], s89 offen lds
 s_add_u32 m0, s88, 29696
 s_nop 0
 buffer_load_dwordx4 v4, s[12:15], s89 offen lds
 v_add_u32 v7, 49152, v5
 ds_read_b64_tr_b16 v[176:177], v7 offset:0
 ds_read_b64_tr_b16 v[178:179], v7 offset:768
 ds_read_b64_tr_b16 v[180:181], v7 offset:12288
 ds_read_b64_tr_b16 v[182:183], v7 offset:13056
 ds_read_b64_tr_b16 a[0:1], v7 offset:32
 ds_read_b64_tr_b16 a[2:3], v7 offset:800
 ds_read_b64_tr_b16 a[4:5], v7 offset:12320
 ds_read_b64_tr_b16 a[6:7], v7 offset:13088
 ds_read_b64_tr_b16 v[88:89], v7 offset:64
 ds_read_b64_tr_b16 v[90:91], v7 offset:832
 ds_read_b64_tr_b16 v[92:93], v7 offset:12352
 ds_read_b64_tr_b16 v[94:95], v7 offset:13120
 s_waitcnt lgkmcnt(0)
 s_waitcnt vmcnt(24)
 s_barrier
 s_add_u32 s89, s87, 3145728
 s_add_u32 m0, s88, 49152
 s_nop 0
 buffer_load_dwordx4 v2, s[12:15], s89 offen lds
 s_add_u32 m0, s88, 50176
 s_nop 0
 buffer_load_dwordx4 v3, s[12:15], s89 offen lds
 s_add_u32 m0, s88, 51200
 s_nop 0
 buffer_load_dwordx4 v4, s[12:15], s89 offen lds
 s_add_u32 s89, s87, 3244032
 s_add_u32 m0, s88, 52224
 s_nop 0
 buffer_load_dwordx4 v2, s[12:15], s89 offen lds
 s_add_u32 m0, s88, 53248
 s_nop 0
 buffer_load_dwordx4 v3, s[12:15], s89 offen lds
 s_add_u32 m0, s88, 54272
 s_nop 0
 buffer_load_dwordx4 v4, s[12:15], s89 offen lds
 v_add_u32 v7, 73728, v5
 ds_read_b64_tr_b16 v[48:49], v7 offset:0
 ds_read_b64_tr_b16 v[50:51], v7 offset:768
 ds_read_b64_tr_b16 v[52:53], v7 offset:12288
 ds_read_b64_tr_b16 v[54:55], v7 offset:13056
 ds_read_b64_tr_b16 v[200:201], v7 offset:32
 ds_read_b64_tr_b16 v[202:203], v7 offset:800
 ds_read_b64_tr_b16 v[204:205], v7 offset:12320
 ds_read_b64_tr_b16 v[206:207], v7 offset:13088
 ds_read_b64_tr_b16 a[24:25], v7 offset:64
 ds_read_b64_tr_b16 a[26:27], v7 offset:832
 ds_read_b64_tr_b16 a[28:29], v7 offset:12352
 ds_read_b64_tr_b16 a[30:31], v7 offset:13120
 s_waitcnt lgkmcnt(0)
 s_waitcnt vmcnt(24)
 s_barrier
 s_add_u32 s89, s87, 3932160
 s_add_u32 m0, s88, 73728
 s_nop 0
 buffer_load_dwordx4 v2, s[12:15], s89 offen lds
 s_add_u32 m0, s88, 74752
 s_nop 0
 buffer_load_dwordx4 v3, s[12:15], s89 offen lds
 s_add_u32 m0, s88, 75776
 s_nop 0
 buffer_load_dwordx4 v4, s[12:15], s89 offen lds
 s_add_u32 s89, s87, 4030464
 s_add_u32 m0, s88, 76800
 s_nop 0
 buffer_load_dwordx4 v2, s[12:15], s89 offen lds
 s_add_u32 m0, s88, 77824
 s_nop 0
 buffer_load_dwordx4 v3, s[12:15], s89 offen lds
 s_add_u32 m0, s88, 78848
 s_nop 0
 buffer_load_dwordx4 v4, s[12:15], s89 offen lds
 v_add_u32 v7, 98304, v5
 ds_read_b64_tr_b16 a[72:73], v7 offset:0
 ds_read_b64_tr_b16 a[74:75], v7 offset:768
 ds_read_b64_tr_b16 a[76:77], v7 offset:12288
 ds_read_b64_tr_b16 a[78:79], v7 offset:13056
 ds_read_b64_tr_b16 a[136:137], v7 offset:32
 ds_read_b64_tr_b16 a[138:139], v7 offset:800
 ds_read_b64_tr_b16 a[140:141], v7 offset:12320
 ds_read_b64_tr_b16 a[142:143], v7 offset:13088
 ds_read_b64_tr_b16 a[200:201], v7 offset:64
 ds_read_b64_tr_b16 a[202:203], v7 offset:832
 ds_read_b64_tr_b16 a[204:205], v7 offset:12352
 ds_read_b64_tr_b16 a[206:207], v7 offset:13120
 s_waitcnt lgkmcnt(0)
 s_waitcnt vmcnt(24)
 s_barrier
 s_add_u32 s89, s87, 4718592
 s_add_u32 m0, s88, 98304
 s_nop 0
 buffer_load_dwordx4 v2, s[12:15], s89 offen lds
 s_add_u32 m0, s88, 99328
 s_nop 0
 buffer_load_dwordx4 v3, s[12:15], s89 offen lds
 s_add_u32 m0, s88, 100352
 s_nop 0
 buffer_load_dwordx4 v4, s[12:15], s89 offen lds
 s_add_u32 s89, s87, 4816896
 s_add_u32 m0, s88, 101376
 s_nop 0
 buffer_load_dwordx4 v2, s[12:15], s89 offen lds
 s_add_u32 m0, s88, 102400
 s_nop 0
 buffer_load_dwordx4 v3, s[12:15], s89 offen lds
 s_add_u32 m0, s88, 103424
 s_nop 0
 buffer_load_dwordx4 v4, s[12:15], s89 offen lds
 v_add_u32 v7, 122880, v5
 ds_read_b64_tr_b16 a[80:81], v7 offset:0
 ds_read_b64_tr_b16 a[82:83], v7 offset:768
 ds_read_b64_tr_b16 a[84:85], v7 offset:12288
 ds_read_b64_tr_b16 a[86:87], v7 offset:13056
 ds_read_b64_tr_b16 a[144:145], v7 offset:32
 ds_read_b64_tr_b16 a[146:147], v7 offset:800
 ds_read_b64_tr_b16 a[148:149], v7 offset:12320
 ds_read_b64_tr_b16 a[150:151], v7 offset:13088
 ds_read_b64_tr_b16 a[208:209], v7 offset:64
 ds_read_b64_tr_b16 a[210:211], v7 offset:832
 ds_read_b64_tr_b16 a[212:213], v7 offset:12352
 ds_read_b64_tr_b16 a[214:215], v7 offset:13120
 s_waitcnt lgkmcnt(0)
 s_waitcnt vmcnt(24)
 s_barrier
 s_add_u32 s89, s87, 5505024
 s_add_u32 m0, s88, 122880
 s_nop 0
 buffer_load_dwordx4 v2, s[12:15], s89 offen lds
 s_add_u32 m0, s88, 123904
 s_nop 0
 buffer_load_dwordx4 v3, s[12:15], s89 offen lds
 s_add_u32 m0, s88, 124928
 s_nop 0
 buffer_load_dwordx4 v4, s[12:15], s89 offen lds
 s_add_u32 s89, s87, 5603328
 s_add_u32 m0, s88, 125952
 s_nop 0
 buffer_load_dwordx4 v2, s[12:15], s89 offen lds
 s_add_u32 m0, s88, 126976
 s_nop 0
 buffer_load_dwordx4 v3, s[12:15], s89 offen lds
 s_add_u32 m0, s88, 128000
 s_nop 0
 buffer_load_dwordx4 v4, s[12:15], s89 offen lds
 v_add_u32 v7, 0, v5
 ds_read_b64_tr_b16 a[88:89], v7 offset:0
 ds_read_b64_tr_b16 a[90:91], v7 offset:768
 ds_read_b64_tr_b16 a[92:93], v7 offset:12288
 ds_read_b64_tr_b16 a[94:95], v7 offset:13056
 ds_read_b64_tr_b16 a[152:153], v7 offset:32
 ds_read_b64_tr_b16 a[154:155], v7 offset:800
 ds_read_b64_tr_b16 a[156:157], v7 offset:12320
 ds_read_b64_tr_b16 a[158:159], v7 offset:13088
 ds_read_b64_tr_b16 a[216:217], v7 offset:64
 ds_read_b64_tr_b16 a[218:219], v7 offset:832
 ds_read_b64_tr_b16 a[220:221], v7 offset:12352
 ds_read_b64_tr_b16 a[222:223], v7 offset:13120
 s_waitcnt lgkmcnt(0)
 s_waitcnt vmcnt(24)
 s_barrier
 s_add_u32 s89, s87, 6291456
 s_add_u32 m0, s88, 0
 s_nop 0
 buffer_load_dwordx4 v2, s[12:15], s89 offen lds
 s_add_u32 m0, s88, 1024
 s_nop 0
 buffer_load_dwordx4 v3, s[12:15], s89 offen lds
 s_add_u32 m0, s88, 2048
 s_nop 0
 buffer_load_dwordx4 v4, s[12:15], s89 offen lds
 s_add_u32 s89, s87, 6389760
 s_add_u32 m0, s88, 3072
 s_nop 0
 buffer_load_dwordx4 v2, s[12:15], s89 offen lds
 s_add_u32 m0, s88, 4096
 s_nop 0
 buffer_load_dwordx4 v3, s[12:15], s89 offen lds
 s_add_u32 m0, s88, 5120
 s_nop 0
 buffer_load_dwordx4 v4, s[12:15], s89 offen lds
 v_add_u32 v7, 24576, v5
 ds_read_b64_tr_b16 a[48:49], v7 offset:0
 ds_read_b64_tr_b16 a[50:51], v7 offset:768
 ds_read_b64_tr_b16 a[52:53], v7 offset:12288
 ds_read_b64_tr_b16 a[54:55], v7 offset:13056
 ds_read_b64_tr_b16 v[16:17], v7 offset:32
 ds_read_b64_tr_b16 v[18:19], v7 offset:800
 ds_read_b64_tr_b16 v[20:21], v7 offset:12320
 ds_read_b64_tr_b16 v[22:23], v7 offset:13088
 ds_read_b64_tr_b16 v[24:25], v7 offset:64
 ds_read_b64_tr_b16 v[26:27], v7 offset:832
 ds_read_b64_tr_b16 v[28:29], v7 offset:12352
 ds_read_b64_tr_b16 v[30:31], v7 offset:13120
 s_waitcnt lgkmcnt(0)
 s_waitcnt vmcnt(24)
 s_barrier
 s_add_u32 s89, s87, 7077888
 s_add_u32 m0, s88, 24576
 s_nop 0
 buffer_load_dwordx4 v2, s[12:15], s89 offen lds
 s_add_u32 m0, s88, 25600
 s_nop 0
 buffer_load_dwordx4 v3, s[12:15], s89 offen lds
 s_add_u32 m0, s88, 26624
 s_nop 0
 buffer_load_dwordx4 v4, s[12:15], s89 offen lds
 s_add_u32 s89, s87, 7176192
 s_add_u32 m0, s88, 27648
 s_nop 0
 buffer_load_dwordx4 v2, s[12:15], s89 offen lds
 s_add_u32 m0, s88, 28672
 s_nop 0
 buffer_load_dwordx4 v3, s[12:15], s89 offen lds
 s_add_u32 m0, s88, 29696
 s_nop 0
 buffer_load_dwordx4 v4, s[12:15], s89 offen lds
 v_add_u32 v7, 49152, v5
 ds_read_b64_tr_b16 a[96:97], v7 offset:0
 ds_read_b64_tr_b16 a[98:99], v7 offset:768
 ds_read_b64_tr_b16 a[100:101], v7 offset:12288
 ds_read_b64_tr_b16 a[102:103], v7 offset:13056
 ds_read_b64_tr_b16 a[160:161], v7 offset:32
 ds_read_b64_tr_b16 a[162:163], v7 offset:800
 ds_read_b64_tr_b16 a[164:165], v7 offset:12320
 ds_read_b64_tr_b16 a[166:167], v7 offset:13088
 ds_read_b64_tr_b16 a[224:225], v7 offset:64
 ds_read_b64_tr_b16 a[226:227], v7 offset:832
 ds_read_b64_tr_b16 a[228:229], v7 offset:12352
 ds_read_b64_tr_b16 a[230:231], v7 offset:13120
 s_waitcnt lgkmcnt(0)
 s_waitcnt vmcnt(24)
 s_barrier
 v_add_u32 v7, 73728, v5
 ds_read_b64_tr_b16 a[104:105], v7 offset:0
 ds_read_b64_tr_b16 a[106:107], v7 offset:768
 ds_read_b64_tr_b16 a[108:109], v7 offset:12288
 ds_read_b64_tr_b16 a[110:111], v7 offset:13056
 ds_read_b64_tr_b16 a[168:169], v7 offset:32
 ds_read_b64_tr_b16 a[170:171], v7 offset:800
 ds_read_b64_tr_b16 a[172:173], v7 offset:12320
 ds_read_b64_tr_b16 a[174:175], v7 offset:13088
 ds_read_b64_tr_b16 a[232:233], v7 offset:64
 ds_read_b64_tr_b16 a[234:235], v7 offset:832
 ds_read_b64_tr_b16 a[236:237], v7 offset:12352
 ds_read_b64_tr_b16 a[238:239], v7 offset:13120
 s_waitcnt lgkmcnt(0)
 s_waitcnt vmcnt(18)
 s_barrier
 v_add_u32 v7, 98304, v5
 ds_read_b64_tr_b16 a[112:113], v7 offset:0
 ds_read_b64_tr_b16 a[114:115], v7 offset:768
 ds_read_b64_tr_b16 a[116:117], v7 offset:12288
 ds_read_b64_tr_b16 a[118:119], v7 offset:13056
 ds_read_b64_tr_b16 a[176:177], v7 offset:32
 ds_read_b64_tr_b16 a[178:179], v7 offset:800
 ds_read_b64_tr_b16 a[180:181], v7 offset:12320
 ds_read_b64_tr_b16 a[182:183], v7 offset:13088
 ds_read_b64_tr_b16 a[240:241], v7 offset:64
 ds_read_b64_tr_b16 a[242:243], v7 offset:832
 ds_read_b64_tr_b16 a[244:245], v7 offset:12352
 ds_read_b64_tr_b16 a[246:247], v7 offset:13120
 s_waitcnt lgkmcnt(0)
 s_waitcnt vmcnt(12)
 s_barrier
 v_add_u32 v7, 122880, v5
 ds_read_b64_tr_b16 a[56:57], v7 offset:0
 ds_read_b64_tr_b16 a[58:59], v7 offset:768
 ds_read_b64_tr_b16 a[60:61], v7 offset:12288
 ds_read_b64_tr_b16 a[62:63], v7 offset:13056
 ds_read_b64_tr_b16 v[32:33], v7 offset:32
 ds_read_b64_tr_b16 v[34:35], v7 offset:800
 ds_read_b64_tr_b16 v[36:37], v7 offset:12320
 ds_read_b64_tr_b16 v[38:39], v7 offset:13088
 ds_read_b64_tr_b16 v[40:41], v7 offset:64
 ds_read_b64_tr_b16 v[42:43], v7 offset:832
 ds_read_b64_tr_b16 v[44:45], v7 offset:12352
 ds_read_b64_tr_b16 v[46:47], v7 offset:13120
 s_waitcnt lgkmcnt(0)
 s_waitcnt vmcnt(6)
 s_barrier
 v_add_u32 v7, 0, v5
 ds_read_b64_tr_b16 a[120:121], v7 offset:0
 ds_read_b64_tr_b16 a[122:123], v7 offset:768
 ds_read_b64_tr_b16 a[124:125], v7 offset:12288
 ds_read_b64_tr_b16 a[126:127], v7 offset:13056
 ds_read_b64_tr_b16 a[184:185], v7 offset:32
 ds_read_b64_tr_b16 a[186:187], v7 offset:800
 ds_read_b64_tr_b16 a[188:189], v7 offset:12320
 ds_read_b64_tr_b16 a[190:191], v7 offset:13088
 ds_read_b64_tr_b16 a[248:249], v7 offset:64
 ds_read_b64_tr_b16 a[250:251], v7 offset:832
 ds_read_b64_tr_b16 a[252:253], v7 offset:12352
 ds_read_b64_tr_b16 a[254:255], v7 offset:13120
 s_waitcnt lgkmcnt(0)
 s_waitcnt vmcnt(0)
 s_barrier
 v_add_u32 v7, 24576, v5
 ds_read_b64_tr_b16 a[64:65], v7 offset:0
 ds_read_b64_tr_b16 a[66:67], v7 offset:768
 ds_read_b64_tr_b16 a[68:69], v7 offset:12288
 ds_read_b64_tr_b16 a[70:71], v7 offset:13056
 ds_read_b64_tr_b16 a[128:129], v7 offset:32
 ds_read_b64_tr_b16 a[130:131], v7 offset:800
 ds_read_b64_tr_b16 a[132:133], v7 offset:12320
 ds_read_b64_tr_b16 a[134:135], v7 offset:13088
 ds_read_b64_tr_b16 a[192:193], v7 offset:64
 ds_read_b64_tr_b16 a[194:195], v7 offset:832
 ds_read_b64_tr_b16 a[196:197], v7 offset:12352
 ds_read_b64_tr_b16 a[198:199], v7 offset:13120
 s_waitcnt lgkmcnt(0)
 s_barrier
 ds_write_b128 v6, v[16:19] offset:0
 ds_write_b128 v6, v[20:23] offset:1024
 ds_write_b128 v6, v[24:27] offset:2048
 ds_write_b128 v6, v[28:31] offset:3072
 ds_write_b128 v6, v[32:35] offset:4096
 ds_write_b128 v6, v[36:39] offset:5120
 ds_write_b128 v6, v[40:43] offset:6144
 ds_write_b128 v6, v[44:47] offset:7168
 s_waitcnt lgkmcnt(4)
 ds_write_b128 v6, v[48:51] offset:8192
 ds_write_b128 v6, v[52:55] offset:9216
 ds_write_b128 v6, v[56:59] offset:10240
 ds_write_b128 v6, v[60:63] offset:11264
 ds_write_b128 v6, v[64:67] offset:12288
 ds_write_b128 v6, v[68:71] offset:13312
 ds_write_b128 v6, v[72:75] offset:14336
 ds_write_b128 v6, v[76:79] offset:15360
 s_waitcnt lgkmcnt(4)
 ds_write_b128 v6, v[80:83] offset:16384
 ds_write_b128 v6, v[84:87] offset:17408
 ds_write_b128 v6, v[88:91] offset:18432
 ds_write_b128 v6, v[92:95] offset:19456
sagain_2220:
 v_mov_b32 v3, 1572864
 s_mov_b32 s100, 0
pw_2221:
 buffer_load_dword v4, v3, s[4:7], 0 offen sc1
 s_add_u32 s100, s100, 1
 s_cmp_gt_u32 s100, 200000
 s_cbranch_scc1 main_fail
 s_waitcnt vmcnt(0)
 v_cmp_eq_u32 vcc, -1, v4
 s_cbranch_vccnz pw_2221
 v_readfirstlane_b32 s19, v4
 s_nop 1
 s_and_b32 s19, s19, 0x2000
 s_add_u32 s19, s19, s18
 s_add_u32 s36, s19, 0
 s_add_u32 s37, s19, 131072
 s_add_u32 s38, s19, 262144
 s_add_u32 s39, s19, 393216
 s_mov_b32 s31, 0
 s_mul_i32 s25, s20, 12288
 s_add_u32 s25, s25, 53346304
 s_mul_i32 s26, s20, 6144
 s_add_u32 s26, s26, 208535552
 s_lshl_b32 s32, s20, 7
 s_add_u32 s33, s32, 0
 s_add_u32 s33, s33, s3
 s_add_u32 s32, s32, 12288
 s_add_u32 s32, s32, s3
 s_mov_b32 s34, 0
 s_mov_b32 s28, 24576
 v_bfe_u32 v111, v0, 0, 6
 v_lshlrev_b32 v5, 4, v111
 v_mov_b32 v7, 1152
 v_bfe_u32 v111, v0, 0, 4
 v_lshl_add_u32 v7, v111, 3, v7
 v_bfe_u32 v111, v0, 4, 1
 s_mov_b32 s101, 1568
 v_mad_u32_u24 v7, v111, s101, v7
 v_bfe_u32 v111, v0, 5, 1
 s_mov_b32 s101, 3200
 v_mad_u32_u24 v7, v111, s101, v7
 v_bfe_u32 v111, v0, 4, 2
 v_lshlrev_b32 v8, 6, v111
 v_bfe_u32 v111, v0, 2, 2
 v_lshl_add_u32 v8, v111, 3, v8
 v_bfe_u32 v111, v0, 0, 1
 s_mov_b32 s101, 1568
 v_mad_u32_u24 v8, v111, s101, v8
 v_bfe_u32 v111, v0, 1, 1
 s_mov_b32 s101, 3200
 v_mad_u32_u24 v8, v111, s101, v8
 v_and_b32 v111, 8, v0
 v_cmp_eq_u32 vcc, 0, v111
 v_mov_b32 v111, 0xeeee
 v_mov_b32 v15, 0x4444
 v_cndmask_b32 v15, v111, v15, vcc
 s_mov_b32 s56, 0x3dd53b95
 s_lshl_b32 s50, s20, 7
 s_add_u32 s50, s50, s19
 s_add_u32 s50, s50, 544768
 s_mov_b64 s[52:53], 0
 s_add_u32 s27, s19, 524288
 s_cmp_eq_u32 s20, 16
 s_cselect_b32 s27, s27, 0x80000000
 v_mov_b32 v3, s27
 v_bfe_u32 v111, v0, 0, 6
 v_lshl_add_u32 v3, v111, 7, v3
 v_add_u32 v4, 16384, v3
 v_and_b32 v14, 63, v0
 v_cmp_gt_u32 vcc, 16, v14
 v_mov_b32 v111, 0x80000000
 s_nop 0
 v_cndmask_b32 v4, v111, v4, vcc
s_2222:
 ds_read_b128 v[40:43], v6 offset:0
 ds_read_b128 v[44:47], v6 offset:1024
 ds_read_b128 v[48:51], v6 offset:2048
 ds_read_b128 v[52:55], v6 offset:3072
 ds_read_b128 v[56:59], v6 offset:4096
 ds_read_b128 v[60:63], v6 offset:5120
 ds_read_b128 v[64:67], v6 offset:6144
 ds_read_b128 v[68:71], v6 offset:7168
 ds_read_b128 v[72:75], v6 offset:8192
 ds_read_b128 v[76:79], v6 offset:9216
 s_add_u32 s51, s36, 0
 s_add_u32 s57, s36, 4096
 s_add_u32 s58, s36, 16384
 s_mov_b32 s99, 0
 s_waitcnt lgkmcnt(0)
 s_add_u32 s25, s25, 393216
 s_cmp_ge_u32 s31, 62
 s_cselect_b32 s25, 0x20000000, s25
 s_xor_b32 s35, s28, 61440
 s_add_u32 m0, s35, 9216
 s_add_u32 s89, s25, 9216
 s_add_u32 s29, s31, 1
 v_mov_b32 v14, s29
 s_mov_b32 s97, 0
 s_sub_u32 s29, s31, 1
 s_cbranch_scc1 nw_2226
 s_mov_b32 s100, 0
db_2227:
 s_load_dword s52, s[4:5], s50 glc
 s_add_u32 s100, s100, 1
 s_cmp_gt_u32 s100, 800000
 s_cbranch_scc1 main_fail
 s_waitcnt lgkmcnt(3)
 s_cmp_gt_u32 s52, s29
 s_cbranch_scc0 db_2227
nw_2226:
 s_barrier
 buffer_load_dwordx4 v[80:83], v5, s[4:7], s51 offen offset:3072 sc1
 v_mov_b32 v16, 0
 v_mov_b32 v17, 0
 v_mov_b32 v18, 0
 v_mov_b32 v19, 0
 v_mov_b32 v20, 0
 v_mov_b32 v21, 0
 v_mov_b32 v22, 0
 v_mov_b32 v23, 0
 buffer_load_dwordx4 v[84:87], v5, s[4:7], s57 offen offset:3072 sc1
 v_mov_b32 v24, 0
 v_mov_b32 v25, 0
 v_mov_b32 v26, 0
 v_mov_b32 v27, 0
 v_mov_b32 v28, 0
 v_mov_b32 v29, 0
 v_mov_b32 v30, 0
 v_mov_b32 v31, 0
 buffer_load_dwordx4 v[88:91], v5, s[4:7], s58 offen offset:1024 sc1
 v_mov_b32 v32, 0
 v_mov_b32 v33, 0
 v_mov_b32 v34, 0
 v_mov_b32 v35, 0
 v_mov_b32 v36, 0
 v_mov_b32 v37, 0
 v_mov_b32 v38, 0
 v_mov_b32 v39, 0
 s_waitcnt vmcnt(2)
 v_max3_u32 v108, v80, v81, v82
 v_max_u32 v108, v108, v83
 v_cmp_eq_u32 vcc, -1, v108
 s_cbranch_vccnz spl_2228
sst_2224:
 s_waitcnt vmcnt(2)
 v_smfmac_f32_16x16x64_bf16 v[16:19], v[80:83], v[112:119], v15
 ds_write_b128 v5, v[80:83] offset:3072
 v_smfmac_f32_16x16x64_bf16 v[20:23], v[80:83], v[184:191], v15
 v_max3_u32 v108, v80, v81, v82
 v_smfmac_f32_16x16x64_bf16 v[24:27], v[80:83], a[8:15], v15
 v_smfmac_f32_16x16x64_bf16 v[28:31], v[80:83], a[48:55], v15
 s_waitcnt vmcnt(1)
 ds_write_b128 v5, v[84:87] offset:7168
 v_smfmac_f32_16x16x64_bf16 v[32:35], v[80:83], v[40:47], v15
 v_max3_u32 v108, v108, v83, v84
 v_smfmac_f32_16x16x64_bf16 v[36:39], v[80:83], v[48:55], v15
 v_max3_u32 v108, v108, v85, v86
 v_smfmac_f32_16x16x64_bf16 v[16:19], v[84:87], v[120:127], v15
 v_smfmac_f32_16x16x64_bf16 v[20:23], v[84:87], v[192:199], v15
 s_waitcnt vmcnt(0)
 v_smfmac_f32_16x16x64_bf16 v[24:27], v[84:87], a[16:23], v15
 v_max3_u32 v108, v108, v87, v88
 v_max3_u32 v108, v108, v89, v90
 v_smfmac_f32_16x16x64_bf16 v[28:31], v[84:87], a[56:63], v15
 v_max_u32 v108, v108, v91
 v_cmp_eq_u32 vcc, -1, v108
 v_smfmac_f32_16x16x64_bf16 v[32:35], v[84:87], v[56:63], v15
 s_cbranch_vccnz srt_2225
 s_waitcnt lgkmcnt(0)
 s_barrier
 ds_read_b128 v[92:95], v5 offset:0
 v_smfmac_f32_16x16x64_bf16 v[36:39], v[84:87], v[64:71], v15
 ds_read_b128 v[96:99], v5 offset:1024
 v_smfmac_f32_16x16x64_bf16 v[16:19], v[88:91], v[72:79], v15
 ds_read_b128 v[100:103], v5 offset:2048
 v_smfmac_f32_16x16x64_bf16 v[20:23], v[88:91], v[200:207], v15
 ds_read_b128 v[104:107], v5 offset:4096
 v_smfmac_f32_16x16x64_bf16 v[24:27], v[88:91], a[24:31], v15
 ds_read_b128 v[80:83], v5 offset:5120
 v_smfmac_f32_16x16x64_bf16 v[28:31], v[88:91], a[64:71], v15
 ds_read_b128 v[84:87], v5 offset:6144
 v_smfmac_f32_16x16x64_bf16 v[32:35], v[88:91], a[128:135], v15
 v_smfmac_f32_16x16x64_bf16 v[36:39], v[88:91], a[192:199], v15
 ds_read_b128 v[88:91], v5 offset:8192
 s_waitcnt lgkmcnt(6)
 v_smfmac_f32_16x16x64_bf16 v[16:19], v[92:95], v[128:135], v15
 ds_read_b128 v[40:43], v6 offset:10240
 s_waitcnt lgkmcnt(6)
 v_smfmac_f32_16x16x64_bf16 v[16:19], v[96:99], v[136:143], v15
 ds_read_b128 v[44:47], v6 offset:11264
 s_waitcnt lgkmcnt(6)
 v_smfmac_f32_16x16x64_bf16 v[16:19], v[100:103], v[144:151], v15
 ds_read_b128 v[48:51], v6 offset:12288
 s_waitcnt lgkmcnt(6)
 v_smfmac_f32_16x16x64_bf16 v[16:19], v[104:107], v[152:159], v15
 ds_read_b128 v[52:55], v6 offset:13312
 s_waitcnt lgkmcnt(6)
 v_smfmac_f32_16x16x64_bf16 v[16:19], v[80:83], v[160:167], v15
 ds_read_b128 v[56:59], v6 offset:14336
 s_waitcnt lgkmcnt(6)
 v_smfmac_f32_16x16x64_bf16 v[16:19], v[84:87], v[168:175], v15
 ds_read_b128 v[60:63], v6 offset:15360
 s_waitcnt lgkmcnt(6)
 v_smfmac_f32_16x16x64_bf16 v[16:19], v[88:91], v[176:183], v15
 ds_read_b128 v[64:67], v6 offset:16384
 v_smfmac_f32_16x16x64_bf16 v[20:23], v[92:95], v[208:215], v15
 ds_read_b128 v[68:71], v6 offset:17408
 v_smfmac_f32_16x16x64_bf16 v[20:23], v[96:99], v[216:223], v15
 ds_read_b128 v[72:75], v6 offset:18432
 v_smfmac_f32_16x16x64_bf16 v[20:23], v[100:103], v[224:231], v15
 ds_read_b128 v[76:79], v6 offset:19456
 s_nop 0
 v_mul_f32 v16, s56, v16
 v_smfmac_f32_16x16x64_bf16 v[20:23], v[104:107], v[232:239], v15
 v_mul_f32 v17, s56, v17
 v_smfmac_f32_16x16x64_bf16 v[20:23], v[80:83], v[240:247], v15
 v_mul_f32 v18, s56, v18
 v_smfmac_f32_16x16x64_bf16 v[20:23], v[84:87], v[248:255], v15
 v_mul_f32 v19, s56, v19
 v_smfmac_f32_16x16x64_bf16 v[20:23], v[88:91], a[0:7], v15
 v_cvt_pk_bf16_f32 v16, v16, v17
 v_smfmac_f32_16x16x64_bf16 v[24:27], v[92:95], a[32:39], v15
 v_cvt_pk_bf16_f32 v17, v18, v19
 v_smfmac_f32_16x16x64_bf16 v[24:27], v[96:99], a[40:47], v15
 ds_write_b64 v7, v[16:17] offset:10240
 s_waitcnt lgkmcnt(1)
 v_smfmac_f32_16x16x64_bf16 v[24:27], v[100:103], v[40:47], v15
 s_nop 1
 v_mul_f32 v20, s56, v20
 v_smfmac_f32_16x16x64_bf16 v[24:27], v[104:107], v[48:55], v15
 v_mul_f32 v21, s56, v21
 v_smfmac_f32_16x16x64_bf16 v[24:27], v[80:83], v[56:63], v15
 v_mul_f32 v22, s56, v22
 v_smfmac_f32_16x16x64_bf16 v[24:27], v[84:87], v[64:71], v15
 v_mul_f32 v23, s56, v23
 v_smfmac_f32_16x16x64_bf16 v[24:27], v[88:91], v[72:79], v15
 v_cvt_pk_bf16_f32 v20, v20, v21
 v_smfmac_f32_16x16x64_bf16 v[28:31], v[92:95], a[72:79], v15
 v_cvt_pk_bf16_f32 v21, v22, v23
 v_smfmac_f32_16x16x64_bf16 v[28:31], v[96:99], a[80:87], v15
 ds_write_b64 v7, v[20:21] offset:10368
 v_smfmac_f32_16x16x64_bf16 v[28:31], v[100:103], a[88:95], v15
 s_nop 1
 v_mul_f32 v24, s56, v24
 v_smfmac_f32_16x16x64_bf16 v[28:31], v[104:107], a[96:103], v15
 buffer_load_dwordx4 v5, s[4:7], s89 offen offset:0 sc1 lds
 v_mul_f32 v25, s56, v25
 v_smfmac_f32_16x16x64_bf16 v[28:31], v[80:83], a[104:111], v15
 buffer_load_dwordx4 v5, s[4:7], s89 offen offset:1024 sc1 lds
 v_mul_f32 v26, s56, v26
 v_smfmac_f32_16x16x64_bf16 v[28:31], v[84:87], a[112:119], v15
 buffer_load_dwordx4 v5, s[4:7], s89 offen offset:2048 sc1 lds
 v_mul_f32 v27, s56, v27
 v_smfmac_f32_16x16x64_bf16 v[28:31], v[88:91], a[120:127], v15
 v_cvt_pk_bf16_f32 v24, v24, v25
 v_smfmac_f32_16x16x64_bf16 v[32:35], v[92:95], a[136:143], v15
 v_cvt_pk_bf16_f32 v25, v26, v27
 v_smfmac_f32_16x16x64_bf16 v[32:35], v[96:99], a[144:151], v15
 ds_write_b64 v7, v[24:25] offset:10496
 v_smfmac_f32_16x16x64_bf16 v[32:35], v[100:103], a[152:159], v15
 s_nop 1
 v_cvt_pk_bf16_f32 v28, v28, v29
 v_smfmac_f32_16x16x64_bf16 v[32:35], v[104:107], a[160:167], v15
 v_cvt_pk_bf16_f32 v29, v30, v31
 v_smfmac_f32_16x16x64_bf16 v[32:35], v[80:83], a[168:175], v15
 ds_write_b64 v7, v[28:29] offset:16640
 v_smfmac_f32_16x16x64_bf16 v[32:35], v[84:87], a[176:183], v15
 s_waitcnt lgkmcnt(1)
 s_barrier
 v_smfmac_f32_16x16x64_bf16 v[32:35], v[88:91], a[184:191], v15
 v_smfmac_f32_16x16x64_bf16 v[36:39], v[92:95], a[200:207], v15
 s_nop 2
 v_smfmac_f32_16x16x64_bf16 v[36:39], v[96:99], a[208:215], v15
 v_smfmac_f32_16x16x64_bf16 v[36:39], v[100:103], a[216:223], v15
 s_nop 1
 v_cvt_pk_bf16_f32 v32, v32, v33
 v_smfmac_f32_16x16x64_bf16 v[36:39], v[104:107], a[224:231], v15
 v_cvt_pk_bf16_f32 v33, v34, v35
 v_smfmac_f32_16x16x64_bf16 v[36:39], v[80:83], a[232:239], v15
 ds_write_b64 v7, v[32:33] offset:16768
 v_smfmac_f32_16x16x64_bf16 v[36:39], v[84:87], a[240:247], v15
 v_smfmac_f32_16x16x64_bf16 v[36:39], v[88:91], a[248:255], v15
 s_nop 7
 v_cvt_pk_bf16_f32 v36, v36, v37
 v_cvt_pk_bf16_f32 v37, v38, v39
 ds_write_b64 v7, v[36:37] offset:16896
 s_waitcnt lgkmcnt(0)
 s_barrier
 s_nop 15
 s_nop 15
 s_nop 11
 buffer_store_dword v14, v4, s[4:7], s97 offen sc1
 buffer_store_dword v14, v3, s[4:7], s97 offen sc1
 s_barrier
 s_xor_b32 s28, s28, 61440
 s_mov_b32 s30, s36
 s_mov_b32 s36, s37
 s_mov_b32 s37, s38
 s_mov_b32 s38, s39
 s_mov_b32 s39, s30
 s_add_u32 s31, s31, 1
 s_cmp_lt_u32 s31, 64
 s_cbranch_scc1 s_2222
sdone_2223:
 s_cmp_lg_u32 s98, 0
 s_cbranch_scc1 g2_task
 s_mov_b32 s98, 1
 s_add_u32 s3, s3, 655360
 s_add_u32 s18, s18, 655360
 s_waitcnt vmcnt(0) lgkmcnt(0)
 s_barrier
 s_branch sagain_2220
srt_2225:
 s_waitcnt lgkmcnt(0)
mr_2229:
 buffer_load_dwordx4 v[80:83], v5, s[4:7], s51 offen offset:3072 sc1
 buffer_load_dwordx4 v[84:87], v5, s[4:7], s57 offen offset:3072 sc1
 buffer_load_dwordx4 v[88:91], v5, s[4:7], s58 offen offset:1024 sc1
 s_add_u32 s99, s99, 1
 s_cmp_gt_u32 s99, 200000
 s_cbranch_scc1 main_fail
 s_waitcnt vmcnt(0)
 v_max3_u32 v108, v80, v81, v82
 v_max3_u32 v108, v108, v83, v84
 v_max3_u32 v108, v108, v85, v86
 v_max3_u32 v108, v108, v87, v88
 v_max3_u32 v108, v108, v89, v90
 v_max_u32 v108, v108, v91
 v_cmp_eq_u32 vcc, -1, v108
 s_cbranch_vccnz mr_2229
 v_mov_b32 v16, 0
 v_mov_b32 v17, 0
 v_mov_b32 v18, 0
 v_mov_b32 v19, 0
 v_mov_b32 v20, 0
 v_mov_b32 v21, 0
 v_mov_b32 v22, 0
 v_mov_b32 v23, 0
 v_mov_b32 v24, 0
 v_mov_b32 v25, 0
 v_mov_b32 v26, 0
 v_mov_b32 v27, 0
 v_mov_b32 v28, 0
 v_mov_b32 v29, 0
 v_mov_b32 v30, 0
 v_mov_b32 v31, 0
 v_mov_b32 v32, 0
 v_mov_b32 v33, 0
 v_mov_b32 v34, 0
 v_mov_b32 v35, 0
 v_mov_b32 v36, 0
 v_mov_b32 v37, 0
 v_mov_b32 v38, 0
 v_mov_b32 v39, 0
 s_branch sst_2224
spl_2228:
mp_2230:
 buffer_load_dwordx4 v[80:83], v5, s[4:7], s51 offen offset:3072 sc1
 s_waitcnt vmcnt(2)
 buffer_load_dwordx4 v[84:87], v5, s[4:7], s57 offen offset:3072 sc1
 s_waitcnt vmcnt(2)
 buffer_load_dwordx4 v[88:91], v5, s[4:7], s58 offen offset:1024 sc1
 s_add_u32 s99, s99, 1
 s_cmp_gt_u32 s99, 200000
 s_cbranch_scc1 main_fail
 s_waitcnt vmcnt(2)
 v_max3_u32 v108, v80, v81, v82
 v_max_u32 v108, v108, v83
 v_cmp_eq_u32 vcc, -1, v108
 s_cbranch_vccnz mp_2230
 s_branch sst_2224
.section .rodata,"a"
.p2align 6
.amdhsa_kernel init_kernel
  .amdhsa_next_free_vgpr 64
  .amdhsa_next_free_sgpr 102
  .amdhsa_accum_offset 64
  .amdhsa_group_segment_fixed_size 0
  .amdhsa_kernarg_size 120
  .amdhsa_user_sgpr_count 2
  .amdhsa_user_sgpr_kernarg_segment_ptr 1
  .amdhsa_system_sgpr_workgroup_id_x 1
  .amdhsa_float_denorm_mode_32 3
.end_amdhsa_kernel
.p2align 6
.amdhsa_kernel main_kernel
  .amdhsa_next_free_vgpr 512
  .amdhsa_next_free_sgpr 102
  .amdhsa_accum_offset 256
  .amdhsa_group_segment_fixed_size 0
  .amdhsa_kernarg_size 120
  .amdhsa_user_sgpr_count 2
  .amdhsa_user_sgpr_kernarg_segment_ptr 1
  .amdhsa_system_sgpr_workgroup_id_x 1
  .amdhsa_float_denorm_mode_32 3
.end_amdhsa_kernel
```
